```python
import torch

def _softmax(x, axis=-1):
    return torch.softmax(x, dim=axis)
def _gelu(x):
    return torch.nn.functional.gelu(x, approximate="tanh")
def _silu(x):
    return torch.nn.functional.silu(x)
def _sigmoid(x):
    return torch.sigmoid(x)
def _layernorm(x, axis=-1, eps=1e-5):
    m = x.mean(dim=axis, keepdim=True)
    v = x.var(dim=axis, keepdim=True, unbiased=False)
    return (x - m) / torch.sqrt(v + eps)
def _scatter_add(tgt, idx, src, axis=0):
    return tgt.clone().index_add_(axis, idx, src)
def _segment_sum(src, seg, n):
    out = torch.zeros((n,) + src.shape[1:], dtype=src.dtype)
    return out.index_add_(0, seg, src)
def _pad(x, pw):
    flat = tuple(v for pair in reversed(pw) for v in pair)
    return torch.nn.functional.pad(x, flat)

kernel_name = 'standalone__window_attn_swin__vision'

def setup_inputs():

    _w = (lambda a: (lambda t: t.to(torch.bfloat16) if t.is_floating_point() else t)(torch.as_tensor(a)))
    H = W = 224
    C = 192
    ws = 8
    nh = 4
    shift = ws // 2
    coords = torch.stack(torch.meshgrid(torch.arange(ws), torch.arange(ws), indexing='ij'), 0).reshape(2, -1)
    rel = coords[:, :, None] - coords[:, None, :]
    rel[0] += ws - 1
    rel[1] += ws - 1
    rel[0] *= 2 * ws - 1
    rp_idx = rel.sum(0).to(torch.int64)
    img_mask = torch.zeros((1, H, W, 1), dtype=float)
    cnt = 0
    for hs in (slice(0, H - ws), slice(H - ws, H - shift), slice(H - shift, H)):
        for vs in (slice(0, W - ws), slice(W - ws, W - shift), slice(W - shift, W)):
            img_mask[:, hs, vs, :] = cnt
            cnt += 1
    mw = img_mask.reshape(1, H // ws, ws, W // ws, ws, 1).permute(0, 1, 3, 2, 4, 5).reshape(-1, ws * ws)
    am = mw[:, :, None] - mw[:, None, :]
    attn_mask = torch.where(am != 0, -100.0, 0.0).to(float)
    return {
        "x": _w((lambda *s: torch.randn(*s, dtype=torch.bfloat16) * 1.6)(1, H, W, C)),
        "wqkv": _w((lambda *s: torch.randn(*s, dtype=torch.bfloat16) * 1.6)(C, 3 * C) * 0.02),
        "wo": _w((lambda *s: torch.randn(*s, dtype=torch.bfloat16) * 0.05)(C, C) * 0.02),
        "rpb": _w((lambda *s: torch.randn(*s, dtype=torch.bfloat16) * 0.2)((2 * ws - 1) * (2 * ws - 1), nh)),
        "rp_idx": _w(rp_idx),
        "attn_mask": _w(attn_mask),
    }

def reference(x, wqkv, wo, rpb, rp_idx, attn_mask):
    B, H, W, C = x.shape
    N = rp_idx.shape[0]
    ws = int(round(N ** 0.5))
    nh = rpb.shape[-1]
    hd = C // nh
    shift = ws // 2
    xs = torch.roll(x, (-shift, -shift), (1, 2))
    nWh = H // ws
    nWw = W // ws
    xw = (lambda x, *d: x.permute(*d))(xs.reshape(B, nWh, ws, nWw, ws, C), 0, 1, 3, 2, 4, 5).reshape(B * nWh * nWw, N, C)
    qkv = (lambda x, *d: x.permute(*d))(torch.einsum('wnc,cd->wnd', xw, wqkv).reshape(-1, N, 3, nh, hd), 2, 0, 3, 1, 4)
    q, k, v = qkv[0], qkv[1], qkv[2]
    attn = torch.einsum('whid,whjd->whij', q, k) * (hd ** -0.5)
    bias = (lambda x, *d: x.permute(*d))(rpb[rp_idx.reshape(-1)].reshape(N, N, nh), 2, 0, 1)
    attn = attn + bias[None, :, :, :]
    attn = (attn.reshape(B, nWh * nWw, nh, N, N) + attn_mask[None, :, None, :, :]).reshape(-1, nh, N, N)
    attn = _softmax(attn, axis=-1)
    out = (lambda x, *d: x.permute(*d))(torch.einsum('whij,whjd->whid', attn, v), 0, 2, 1, 3).reshape(-1, N, C)
    out = torch.einsum('wnc,cd->wnd', out, wo)
    out = (lambda x, *d: x.permute(*d))(out.reshape(B, nWh, nWw, ws, ws, C), 0, 1, 3, 2, 4, 5).reshape(B, H, W, C)
    return torch.roll(out, (shift, shift), (1, 2))
```

```asm
; @launch grid=(256,1,1) block=(256,1,1) lds=162816
.amdgcn_target "amdgcn-amd-amdhsa--gfx950"
.text
.globl standalone__window_attn_swin__vision_kernel
.p2align 8
.type standalone__window_attn_swin__vision_kernel,@function
standalone__window_attn_swin__vision_kernel:
s_getpc_b64 s[46:47]
s_cmp_lt_u32 s2, 0x100
s_cbranch_scc1 L_go
s_endpgm
s_nop 0
L_go:
s_load_dwordx8 s[4:11], s[0:1], 0
v_lshrrev_b32_e64 v65, 6, v0
s_sub_u32 s49, s2, 0x70
v_readfirstlane_b32 s48, v65
s_lshr_b32 s49, s49, 3
s_min_u32 s49, s49, 0x1000
s_lshl_b32 s49, s49, 2
v_and_b32_e32 v64, 63, v0
s_add_u32 s49, s49, s48
v_lshlrev_b32_e32 v82, 4, v64
s_mul_i32 s75, s49, 0x540
v_add_u32_e64 v66, s75, v82
v_min_u32 v66, L_code_end-standalone__window_attn_swin__vision_kernel-352, v66
global_load_dwordx4 v[124:127], v66, s[46:47] offset:0
s_load_dwordx4 s[12:15], s[0:1], 48
s_load_dwordx2 s[16:17], s[0:1], 64
s_mul_i32 s72, s2, 3
v_lshrrev_b32_e32 v67, 3, v64
s_mul_i32 s73, s72, 0x925
v_xor_b32_e32 v69, v67, v65
s_lshr_b32 s73, s73, 16
v_lshrrev_b32_e32 v68, 4, v64
v_and_b32_e32 v69, 1, v69
s_mul_i32 s74, s73, 28
v_lshl_or_b32 v68, v69, 2, v68
s_sub_u32 s62, s72, s74
global_load_dwordx4 v[128:131], v66, s[46:47] offset:320
v_and_b32_e64 v69, 7, v64
s_mul_i32 s72, s62, 0xc00
v_xor_b32_e64 v68, v68, v69
v_mul_u32_u24 v67, 0x180, v67
s_add_u32 s50, s72, 0x600
s_lshl_b32 s66, s73, 3
v_lshl_add_u32 v232, v68, 4, v67
s_add_u32 s72, s66, s48
s_lshl_b32 s87, s48, 10
v_add_u32_e32 v94, s50, v232
s_mul_i32 s72, s72, 0x15000
v_subrev_u32 v238, 0x15000, v94
s_add_u32 m0, s87, 0
s_add_u32 s54, s72, 0x54000
v_min_u32_e32 v94, v94, v238
s_mov_b32 s22, 0x1260000
s_mov_b32 s23, 0x20000
s_cmp_eq_u32 s73, 27
s_cselect_b32 s74, 0x1260000, 0
s_add_u32 s72, s72, 0xa8000
s_sub_u32 s92, s72, s74
s_mov_b32 s26, 0x36000
s_mov_b32 s27, 0x20000
s_mul_i32 s84, s49, 0xc00
v_add_u32_e64 v66, 0, v64
s_mul_i32 s86, s48, 0x4800
v_mul_u32_u24 v67, 0xab, v66
s_add_u32 s86, s86, 0x12c00
v_mul_u32_u24 v71, 0x60, v65
v_lshrrev_b32_e64 v68, 11, v67
v_bfe_u32 v69, v67, 10, 1
v_lshl_add_u32 v66, v66, 4, v71
v_mul_u32_u24 v69, 0x120, v69
v_mul_u32_u24 v68, 0x3c0, v68
v_add3_u32 v90, v68, v69, v66
s_mov_b32 s77, 0
v_add_u32_e32 v66, 64, v64
v_mul_u32_u24 v67, 0xab, v66
v_lshrrev_b32_e64 v68, 11, v67
v_bfe_u32 v69, v67, 10, 1
v_lshl_add_u32 v66, v66, 4, v71
v_mul_u32_u24 v69, 0x120, v69
v_mul_u32_u24 v68, 0x3c0, v68
v_add3_u32 v91, v68, v69, v66
v_add_u32 v66, 0x80, v64
v_mul_u32_u24 v67, 0xab, v66
v_lshrrev_b32_e64 v68, 11, v67
v_bfe_u32 v69, v67, 10, 1
v_lshl_add_u32 v66, v66, 4, v71
v_mul_u32_u24 v69, 0x120, v69
v_mul_u32_u24 v68, 0x3c0, v68
v_add3_u32 v92, v68, v69, v66
s_mul_i32 s81, s2, 3
s_add_u32 s81, s81, 1
s_mul_i32 s82, s81, 0x925
s_lshr_b32 s82, s82, 16
s_mul_i32 s83, s82, 28
s_sub_u32 s63, s81, s83
s_mul_i32 s81, s63, 0xc00
s_add_u32 s51, s81, 0x600
s_lshl_b32 s67, s82, 3
s_add_u32 s81, s67, s48
v_add_u32_e32 v139, s51, v232
s_mul_i32 s81, s81, 0x15000
v_subrev_u32 v238, 0x15000, v139
s_add_u32 s55, s81, 0x54000
v_min_u32_e32 v139, v139, v238
s_mov_b32 s78, 0x4800
s_waitcnt lgkmcnt(0)
s_mov_b32 s20, s4
s_mov_b32 s21, s5
buffer_load_dwordx4 v94, s[20:23], s54 offen nt lds
s_add_u32 m0, s87, 0x1000
s_mov_b32 s24, s6
s_mov_b32 s25, s7
s_mov_b32 s32, s10
s_mov_b32 s33, s11
s_mov_b32 s34, 0x708
s_mov_b32 s35, 0x20000
v_lshlrev_b32_e64 v83, 3, v0
s_mov_b32 s28, s8
s_mov_b32 s29, s9
s_mov_b32 s30, 0x12000
s_mov_b32 s31, 0x20000
buffer_load_dwordx4 v94, s[20:23], s92 offen nt lds
s_add_u32 m0, s86, 0
s_mul_i32 s85, s49, 0x400
v_lshrrev_b32_e32 v69, 4, v64
v_lshrrev_b32_e64 v67, 5, v64
v_bfe_u32 v72, v64, 2, 2
v_and_b32_e32 v75, 1, v69
v_and_b32_e32 v73, 3, v64
v_lshl_add_u32 v74, v67, 3, v72
v_lshlrev_b32_e64 v75, 5, v75
v_mul_u32_u24 v74, 0xc0, v74
v_lshl_add_u32 v76, v73, 3, v75
v_and_b32_e64 v66, 31, v64
buffer_load_dwordx4 v[112:115], v82, s[24:27], s84 offen
v_add3_u32 v93, v74, v76, s86
v_and_b32_e64 v76, 1, v66
v_bfe_u32 v74, v66, 1, 3
v_lshlrev_b32_e32 v76, 2, v76
v_xor_b32_e32 v74, v74, v76
v_xor_b32_e32 v74, v74, v67
v_lshlrev_b32_e32 v77, 7, v66
s_cmp_eq_u32 s82, 27
s_cselect_b32 s83, 0x1260000, 0
s_add_u32 s81, s81, 0xa8000
v_lshl_add_u32 v240, v74, 4, v77
s_sub_u32 s93, s81, s83
buffer_load_dwordx4 v[116:119], v82, s[24:27], s84 offen offset:1024
v_and_b32_e32 v68, 15, v64
v_xor_b32_e32 v241, 32, v240
v_xor_b32_e64 v242, 64, v240
v_xor_b32 v243, 0x60, v240
buffer_load_dwordx4 v[96:99], v82, s[24:27], s84 offen offset:2048
buffer_load_dwordx4 v90, s[24:27], s77 offen lds
s_add_u32 m0, s86, 0x400
s_nop 0
buffer_load_dwordx4 v91, s[24:27], s77 offen lds
s_add_u32 m0, s86, 0x800
s_nop 0
buffer_load_dwordx4 v92, s[24:27], s77 offen lds
s_add_u32 m0, s87, 0x6400
s_nop 0
buffer_load_dwordx4 v139, s[20:23], s55 offen nt lds
s_add_u32 m0, s86, 0xc00
s_nop 0
buffer_load_dwordx4 v90, s[24:27], s78 offen lds
s_add_u32 m0, s86, 0x1000
s_nop 0
buffer_load_dwordx4 v91, s[24:27], s78 offen lds
s_add_u32 m0, s86, 0x1400
s_nop 0
buffer_load_dwordx4 v92, s[24:27], s78 offen lds
buffer_load_dwordx2 v[84:85], v83, s[32:35], 0 offen
buffer_load_dwordx4 v[120:123], v82, s[28:31], s85 offen
s_mov_b32 s3, 0
s_cmp_lt_u32 s2, 16
s_cbranch_scc1 L_cons
s_cmp_lt_u32 s2, 48
s_cbranch_scc1 L_pqk
s_cmp_lt_u32 s2, 112
s_cbranch_scc1 L_pv
.p2align 3
L_norm:
s_mov_b32 s36, s12
s_mov_b32 s37, s13
s_add_u32 m0, s86, 0x1800
s_mov_b32 s77, 0x9000
s_mov_b32 s78, 0xd800
v_add_u32_e64 v78, 0, v64
v_mul_u32_u24 v79, 0xab, v78
v_lshl_add_u32 v74, v69, 3, v72
v_lshrrev_b32_e64 v80, 11, v79
v_mul_u32_u24 v74, 0x60, v74
v_lshrrev_b32_e64 v79, 10, v79
v_lshl_add_u32 v74, v73, 3, v74
buffer_load_dwordx4 v90, s[24:27], s77 offen lds
s_add_u32 m0, s86, 0x1c00
v_lshlrev_b32_e64 v78, 4, v78
v_mul_u32_u24 v80, 0xc0, v80
v_mul_u32_u24 v79, 0x420, v79
v_add_u32_e32 v143, s86, v74
v_add_u32_e32 v235, v80, v78
v_add3_u32 v79, v79, v78, v71
v_and_b32_e64 v74, 3, v68
v_bfe_u32 v76, v68, 2, 1
v_add_u32 v140, 0x300, v79
v_add_u32_e64 v78, 64, v64
v_lshl_or_b32 v74, v76, 3, v74
buffer_load_dwordx4 v91, s[24:27], s77 offen lds
s_add_u32 m0, s86, 0x2000
v_mul_u32_u24 v79, 0xab, v78
v_bfe_u32 v76, v68, 3, 1
v_lshrrev_b32_e64 v80, 11, v79
v_lshl_or_b32 v74, v76, 2, v74
v_lshrrev_b32_e32 v79, 10, v79
v_and_b32_e32 v77, 1, v74
v_lshlrev_b32_e64 v78, 4, v78
v_mul_u32_u24 v80, 0xc0, v80
v_mul_u32_u24 v79, 0x420, v79
v_bfe_u32 v76, v74, 1, 3
v_lshlrev_b32_e64 v77, 2, v77
buffer_load_dwordx4 v92, s[24:27], s77 offen lds
s_add_u32 m0, s87, 0x1f80
s_mov_b32 s77, 0x12000
v_add_u32_e64 v236, v80, v78
v_add3_u32 v79, v79, v78, v71
v_xor_b32_e64 v76, v76, v77
v_add_u32 v141, 0x300, v79
v_add_u32 v78, 0x80, v64
v_xor_b32_e32 v76, v76, v69
v_lshlrev_b32_e32 v74, 7, v74
v_mul_u32_u24 v79, 0xab, v78
v_lshl_add_u32 v244, v76, 4, v74
v_lshrrev_b32_e64 v80, 11, v79
buffer_load_dwordx4 v94, s[20:23], s54 offen offset:128 nt lds
s_add_u32 m0, s87, 0x2f80
v_and_b32_e32 v76, 1, v73
v_lshrrev_b32_e32 v79, 10, v79
v_lshlrev_b32_e32 v76, 1, v76
v_lshrrev_b32_e32 v77, 1, v73
v_lshlrev_b32_e64 v78, 4, v78
v_mul_u32_u24 v80, 0xc0, v80
v_mul_u32_u24 v79, 0x420, v79
v_or_b32_e32 v76, v76, v77
v_add_u32_e32 v237, v80, v78
v_add3_u32 v79, v79, v78, v71
v_lshl_add_u32 v74, v67, 2, v72
buffer_load_dwordx4 v94, s[20:23], s92 offen offset:128 nt lds
s_add_u32 m0, s86, 0x2400
v_lshrrev_b32_e64 v77, 1, v65
v_mul_u32_u24 v74, 0xc0, v74
v_lshl_add_u32 v76, v76, 3, v75
v_mul_u32_u24 v78, 0x9000, v77
v_add3_u32 v74, v74, v76, v78
v_add_u32 v249, 0x12c00, v74
v_mul_u32_u24 v74, 0x190, v66
v_and_b32_e64 v75, 1, v65
v_lshl_add_u32 v74, v67, 4, v74
v_mul_u32_u24 v75, 0x3200, v75
v_add_u32_e32 v247, v74, v71
buffer_load_dwordx4 v90, s[24:27], s78 offen lds
s_add_u32 m0, s86, 0x2800
s_waitcnt vmcnt(12)
ds_read_b64_tr_b16 a[0:1], v93
ds_read_b64_tr_b16 a[2:3], v93 offset:768
ds_read_b64_tr_b16 a[4:5], v93 offset:64
ds_read_b64_tr_b16 a[6:7], v93 offset:832
ds_read_b64_tr_b16 a[8:9], v93 offset:128
ds_read_b64_tr_b16 a[10:11], v93 offset:896
v_add_u32_e32 v246, v74, v75
v_lshrrev_b32_e32 v74, 2, v64
v_mul_u32_u24 v76, 0x190, v74
v_mul_u32_u24 v77, 0xc0, v77
v_and_b32_e64 v74, 7, v74
buffer_load_dwordx4 v91, s[24:27], s78 offen lds
s_add_u32 m0, s86, 0x2c00
s_waitcnt vmcnt(12)
s_barrier
ds_read_b128 a[216:219], v240
ds_read_b128 a[220:223], v240 offset:4096
ds_read_b128 a[224:227], v241
ds_read_b128 a[228:231], v241 offset:4096
ds_read_b128 a[232:235], v242
ds_read_b128 a[236:239], v242 offset:4096
buffer_load_dwordx4 v92, s[24:27], s78 offen lds
s_add_u32 m0, s87, 0x8380
s_mov_b32 s78, 0x16800
ds_read_b128 a[240:243], v243
v_lshl_add_u32 v78, v73, 4, v77
v_mul_u32_u24 v74, 0x180, v74
v_add3_u32 v231, v76, v75, v78
v_add_u32_e32 v74, v74, v78
s_mul_i32 s72, s2, 3
v_add_u32_e32 v76, s50, v74
s_add_u32 s72, s72, 2
v_subrev_u32 v78, 0x15000, v76
s_mul_i32 s73, s72, 0x925
v_mul_u32_u24 v75, 0x15000, v67
v_min_u32_e32 v76, v76, v78
s_lshr_b32 s73, s73, 16
v_add_u32_e32 v250, v76, v75
s_mul_i32 s74, s73, 28
v_add_u32_e32 v76, s51, v74
s_sub_u32 s64, s72, s74
v_subrev_u32 v78, 0x15000, v76
s_mul_i32 s72, s64, 0xc00
v_min_u32_e64 v76, v76, v78
s_add_u32 s52, s72, 0x600
v_add_u32_e64 v251, v76, v75
s_waitcnt lgkmcnt(5)
v_mfma_f32_32x32x16_bf16 v[0:15], a[0:3], a[216:219], 0
s_lshr_b32 s79, s48, 1
buffer_load_dwordx4 v139, s[20:23], s55 offen offset:128 nt lds
s_add_u32 m0, s86, 0x3000
ds_read_b128 a[244:247], v243 offset:4096
ds_read_b128 a[248:251], v240 offset:25600
v_add_u32_e32 v76, s52, v74
v_subrev_u32 v78, 0x15000, v76
v_mfma_f32_32x32x16_bf16 v[16:31], a[4:7], a[216:219], 0
s_mul_i32 s79, s79, 0xc0
s_waitcnt vmcnt(11)
ds_read_b64_tr_b16 a[12:13], v93 offset:3072
ds_read_b64_tr_b16 a[14:15], v93 offset:3840
ds_read_b64_tr_b16 a[16:17], v93 offset:3136
ds_read_b64_tr_b16 a[18:19], v93 offset:3904
ds_read_b64_tr_b16 a[20:21], v93 offset:3200
v_add_u32 v142, 0x300, v79
v_mfma_f32_32x32x16_bf16 v[192:207], a[8:11], a[216:219], 0
s_lshl_b32 s68, s73, 3
buffer_load_dwordx4 v90, s[24:27], s77 offen lds
s_add_u32 m0, s86, 0x3400
ds_read_b64_tr_b16 a[22:23], v93 offset:3968
v_min_u32_e32 v76, v76, v78
v_add_u32_e32 v252, v76, v75
v_and_b32_e32 v79, 7, v64
v_mfma_f32_32x32x16_bf16 v[32:47], a[0:3], a[220:223], 0
s_add_u32 s72, s68, s48
v_lshrrev_b32_e32 v80, 3, v66
v_sub_u32_e32 v74, 3, v80
v_sub_u32_e32 v75, 7, v79
v_mul_u32_u24 v81, 0xc00, v65
v_mul_u32_u24 v74, 0xc0, v74
v_lshl_add_u32 v75, v67, 2, v75
v_mfma_f32_32x32x16_bf16 v[48:63], a[4:7], a[220:223], 0
s_mul_i32 s72, s72, 0x15000
buffer_load_dwordx4 v91, s[24:27], s77 offen lds
s_add_u32 m0, s86, 0x3800
v_add_u32 v81, 0x24c00, v81
v_lshl_add_u32 v74, v75, 4, v74
v_add_u32_e32 v248, v74, v81
v_lshrrev_b32_e32 v74, 2, v79
v_mfma_f32_32x32x16_bf16 v[208:223], a[8:11], a[220:223], 0
s_add_u32 s56, s72, 0x54000
ds_read_b128 a[220:223], v241 offset:25600
v_xor_b32_e32 v74, v74, v67
v_cvt_f32_u32_e32 v74, v74
v_mul_f32 v253, 0xc31044fe, v74
v_lshrrev_b32_e64 v74, 1, v83
v_sub_u32 v74, 0x24ffc, v74
v_add_u32_e64 v75, 0, v64
v_mul_u32_u24 v76, 0xab, v75
v_lshrrev_b32_e32 v76, 11, v76
v_mul_u32_u24_e32 v76, 3, v76
s_waitcnt lgkmcnt(1)
v_mfma_f32_32x32x16_bf16 v[0:15], a[12:15], a[224:227], v[0:15]
s_cmp_eq_u32 s73, 27
s_cselect_b32 s74, 0x1260000, 0
buffer_load_dwordx4 v92, s[24:27], s77 offen lds
s_add_u32 m0, s86, 0x3c00
s_mov_b32 s77, 0x1b000
v_add_u32_e64 v75, v75, v76
v_lshl_add_u32 v75, v75, 2, v81
v_mfma_f32_32x32x16_bf16 v[16:31], a[16:19], a[224:227], v[16:31]
s_add_u32 s72, s72, 0xa8000
v_add_u32_e32 v230, v246, v77
v_xor_b32_e32 v245, 64, v244
v_add_u32_e64 v233, s52, v232
v_subrev_u32 v238, 0x15000, v233
v_min_u32_e32 v233, v233, v238
s_sub_u32 s94, s72, s74
v_mfma_f32_32x32x16_bf16 v[192:207], a[20:23], a[224:227], v[192:207]
s_add_u32 s74, s66, 8
s_add_u32 s73, s66, 4
buffer_load_dwordx4 v90, s[24:27], s78 offen lds
s_add_u32 m0, s86, 0x4000
s_cmp_eq_u32 s62, 27
s_cselect_b32 s62, 1.0, 0
v_mul_f32_e32 v254, s62, v253
v_mfma_f32_32x32x16_bf16 v[32:47], a[12:15], a[228:231], v[32:47]
s_cmp_eq_u32 s66, 0xd8
s_cselect_b32 s66, 0xc31044fe, 0
s_waitcnt vmcnt(10)
ds_read_b64_tr_b16 a[24:25], v93 offset:6144
ds_read_b64_tr_b16 a[26:27], v93 offset:6912
ds_read_b64_tr_b16 a[28:29], v93 offset:6208
ds_read_b64_tr_b16 a[30:31], v93 offset:6976
ds_read_b64_tr_b16 a[32:33], v93 offset:6272
v_mfma_f32_32x32x16_bf16 v[48:63], a[16:19], a[228:231], v[48:63]
s_mov_b32 s70, 0x3e553b95
ds_read_b64_tr_b16 a[34:35], v93 offset:7040
buffer_load_dwordx4 v91, s[24:27], s78 offen lds
s_add_u32 m0, s86, 0x4400
v_min_f32_e64 v255, s66, v254
s_mov_b32 s19, 0x3f803f80
v_mov_b32_e32 v134, s19
v_mfma_f32_32x32x16_bf16 v[208:223], a[20:23], a[228:231], v[208:223]
s_add_u32 s83, s67, 8
v_mov_b32_e32 v135, s19
s_add_u32 s82, s67, 4
s_cmp_eq_u32 s63, 27
s_cselect_b32 s63, 1.0, 0
s_cmp_eq_u32 s67, 0xd8
s_cselect_b32 s67, 0xc31044fe, 0
buffer_load_dwordx4 v92, s[24:27], s78 offen lds
s_add_u32 m0, s87, 0x3f00
s_mov_b32 s78, 0x1f800
s_cmp_ge_u32 s74, 0xe0
s_cselect_b32 s74, 0, s74
s_and_b32 s72, s48, 1
s_cmp_eq_u32 s72, 1
s_cselect_b32 s72, s74, s73
s_mov_b32 s38, 0x1260000
s_mov_b32 s39, 0x20000
s_mul_i32 s58, s72, 0x15000
s_add_u32 s76, s58, 0x2a000
s_add_u32 s74, s68, 8
s_add_u32 s73, s68, 4
s_cmp_eq_u32 s64, 27
s_cselect_b32 s64, 1.0, 0
s_waitcnt lgkmcnt(2)
v_mfma_f32_32x32x16_bf16 v[0:15], a[24:27], a[232:235], v[0:15]
s_cmp_eq_u32 s68, 0xd8
s_cselect_b32 s68, 0xc31044fe, 0
buffer_load_dwordx4 v94, s[20:23], s54 offen offset:256 nt lds
s_add_u32 m0, s87, 0x4f00
s_cmp_ge_u32 s83, 0xe0
s_cselect_b32 s83, 0, s83
s_and_b32 s81, s48, 1
v_mfma_f32_32x32x16_bf16 v[16:31], a[28:31], a[232:235], v[16:31]
s_cmp_eq_u32 s81, 1
s_cselect_b32 s81, s83, s82
s_mul_i32 s59, s81, 0x15000
s_add_u32 s84, s59, 0x2a000
s_cmp_ge_u32 s74, 0xe0
s_cselect_b32 s74, 0, s74
s_and_b32 s72, s48, 1
s_waitcnt lgkmcnt(0)
v_mfma_f32_32x32x16_bf16 v[192:207], a[32:35], a[232:235], v[192:207]
s_cmp_eq_u32 s72, 1
s_cselect_b32 s72, s74, s73
buffer_load_dwordx4 v94, s[20:23], s92 offen offset:256 nt lds
s_add_u32 m0, s87, 0xa300
ds_read_b128 a[232:235], v242 offset:25600
s_mul_i32 s60, s72, 0x15000
v_mfma_f32_32x32x16_bf16 v[32:47], a[24:27], a[236:239], v[32:47]
v_lshlrev_b32_e64 v86, 16, v84
v_and_b32 v87, 0xffff0000, v84
v_lshlrev_b32_e64 v88, 16, v85
v_and_b32 v89, 0xffff0000, v85
v_mul_f32 v86, 0x40ddb3d7, v86
v_mul_f32 v87, 0x40ddb3d7, v87
v_mfma_f32_32x32x16_bf16 v[48:63], a[28:31], a[236:239], v[48:63]
ds_write_b32 v74, v86
buffer_load_dwordx4 v139, s[20:23], s55 offen offset:256 nt lds
s_add_u32 m0, s86, 0
ds_write_b32 v74, v87 offset:3072
v_mfma_f32_32x32x16_bf16 v[208:223], a[32:35], a[236:239], v[208:223]
s_waitcnt vmcnt(10)
ds_read_b64_tr_b16 a[36:37], v93 offset:9216
ds_read_b64_tr_b16 a[38:39], v93 offset:9984
ds_read_b64_tr_b16 a[40:41], v93 offset:9280
ds_read_b64_tr_b16 a[42:43], v93 offset:10048
ds_read_b64_tr_b16 a[44:45], v93 offset:9344
ds_read_b64_tr_b16 a[46:47], v93 offset:10112
v_mul_f32 v88, 0x40ddb3d7, v88
buffer_load_dwordx4 v90, s[24:27], s77 offen lds
s_add_u32 m0, s86, 0x400
ds_write_b32 v74, v88 offset:6144
v_mul_f32 v89, 0x40ddb3d7, v89
ds_write_b32 v74, v89 offset:9216
v_lshl_add_u32 v74, v64, 4, v81
buffer_load_dwordx4 v91, s[24:27], s77 offen lds
s_add_u32 m0, s86, 0x800
s_waitcnt lgkmcnt(6)
v_mfma_f32_32x32x16_bf16 v[0:15], a[36:39], a[240:243], v[0:15]
s_waitcnt vmcnt(10) lgkmcnt(0)
s_barrier
buffer_load_dwordx4 v92, s[24:27], s77 offen lds
s_add_u32 m0, s86, 0xc00
s_mov_b32 s77, 0x24000
ds_read_b128 a[252:255], v240 offset:8192
ds_read_b128 a[216:219], v240 offset:12288
ds_read_b128 a[224:227], v241 offset:8192
v_mfma_f32_32x32x16_bf16 v[16:31], a[40:43], a[240:243], v[16:31]
s_nop 0
ds_read_b128 a[228:231], v241 offset:12288
ds_read_b128 a[236:239], v242 offset:8192
v_mfma_f32_32x32x16_bf16 v[192:207], a[44:47], a[240:243], v[192:207]
buffer_load_dwordx4 v90, s[24:27], s78 offen lds
s_add_u32 m0, s86, 0x1000
ds_read_b128 a[240:243], v242 offset:12288
ds_read2_b32 v[100:101], v75 offset0:31 offset1:32
v_mfma_f32_32x32x16_bf16 v[32:47], a[36:39], a[244:247], v[32:47]
s_waitcnt vmcnt(10)
ds_read_b64_tr_b16 a[48:49], v93 offset:12288
ds_read_b64_tr_b16 a[50:51], v93 offset:13056
ds_read_b64_tr_b16 a[52:53], v93 offset:12352
v_mfma_f32_32x32x16_bf16 v[48:63], a[40:43], a[244:247], v[48:63]
s_nop 0
buffer_load_dwordx4 v91, s[24:27], s78 offen lds
s_add_u32 m0, s86, 0x1400
ds_read_b64_tr_b16 a[54:55], v93 offset:13120
ds_read_b64_tr_b16 a[56:57], v93 offset:12416
ds_read_b64_tr_b16 a[58:59], v93 offset:13184
ds_read2_b32 v[102:103], v75 offset0:33 offset1:34
v_mfma_f32_32x32x16_bf16 v[208:223], a[44:47], a[244:247], v[208:223]
v_add_u32_e64 v75, 64, v64
v_mul_u32_u24 v76, 0xab, v75
v_lshrrev_b32_e32 v76, 11, v76
v_mul_u32_u24_e32 v76, 3, v76
v_add_u32_e64 v75, v75, v76
v_lshl_add_u32 v75, v75, 2, v81
v_mfma_f32_32x32x16_bf16 v[144:159], a[0:3], a[248:251], 0
buffer_load_dwordx4 v92, s[24:27], s78 offen lds
s_add_u32 m0, s86, 0x1800
s_mov_b32 s78, 0x28800
ds_read_b128 a[244:247], v243 offset:25600
ds_read2_b32 v[104:105], v75 offset0:31 offset1:32
ds_read2_b32 v[106:107], v75 offset0:33 offset1:34
v_mfma_f32_32x32x16_bf16 v[160:175], a[4:7], a[248:251], 0
v_add_u32 v75, 0x80, v64
v_mul_u32_u24 v76, 0xab, v75
v_lshrrev_b32_e32 v76, 11, v76
v_mul_u32_u24_e32 v76, 3, v76
v_add_u32_e64 v75, v75, v76
v_lshl_add_u32 v75, v75, 2, v81
v_mfma_f32_32x32x16_bf16 v[176:191], a[8:11], a[248:251], 0
buffer_load_dwordx4 v90, s[24:27], s77 offen lds
s_add_u32 m0, s86, 0x1c00
ds_read_b128 a[248:251], v243 offset:8192
ds_read2_b32 v[108:109], v75 offset0:31 offset1:32
ds_read2_b32 v[110:111], v75 offset0:33 offset1:34
s_waitcnt vmcnt(10) lgkmcnt(10)
ds_read_b64_tr_b16 a[60:61], v93 offset:15360
v_mfma_f32_32x32x16_bf16 v[0:15], a[48:51], a[252:255], v[0:15]
s_waitcnt lgkmcnt(9)
ds_read_b64_tr_b16 a[62:63], v93 offset:16128
ds_read_b64_tr_b16 a[64:65], v93 offset:15424
ds_read_b64_tr_b16 a[66:67], v93 offset:16192
v_mfma_f32_32x32x16_bf16 v[16:31], a[52:55], a[252:255], v[16:31]
s_waitcnt lgkmcnt(10)
buffer_load_dwordx4 v91, s[24:27], s77 offen lds
s_add_u32 m0, s86, 0x2000
ds_read_b64_tr_b16 a[68:69], v93 offset:15488
ds_read_b64_tr_b16 a[70:71], v93 offset:16256
v_mfma_f32_32x32x16_bf16 v[192:207], a[56:59], a[252:255], v[192:207]
s_nop 0
ds_read_b128 a[252:255], v243 offset:12288
ds_write_b128 v74, v[100:103]
v_mfma_f32_32x32x16_bf16 v[32:47], a[48:51], a[216:219], v[32:47]
buffer_load_dwordx4 v92, s[24:27], s77 offen lds
s_add_u32 m0, s86, 0x2400
s_mov_b32 s77, 0x2d000
v_mfma_f32_32x32x16_bf16 v[48:63], a[52:55], a[216:219], v[48:63]
s_waitcnt lgkmcnt(8)
ds_write_b128 v74, v[104:107] offset:1024
v_mfma_f32_32x32x16_bf16 v[208:223], a[56:59], a[216:219], v[208:223]
s_nop 0
buffer_load_dwordx4 v90, s[24:27], s78 offen lds
s_add_u32 m0, s86, 0x2800
ds_read_b128 a[216:219], v240 offset:33792
v_mfma_f32_32x32x16_bf16 v[144:159], a[12:15], a[220:223], v[144:159]
ds_write_b128 v74, v[108:111] offset:2048
v_mfma_f32_32x32x16_bf16 v[160:175], a[16:19], a[220:223], v[160:175]
buffer_load_dwordx4 v91, s[24:27], s78 offen lds
s_add_u32 m0, s86, 0x2c00
v_mfma_f32_32x32x16_bf16 v[176:191], a[20:23], a[220:223], v[176:191]
s_waitcnt lgkmcnt(3)
v_mfma_f32_32x32x16_bf16 v[0:15], a[60:63], a[224:227], v[0:15]
s_nop 0
buffer_load_dwordx4 v92, s[24:27], s78 offen lds
s_add_u32 m0, s86, 0x3000
s_mov_b32 s78, 0x31800
v_mfma_f32_32x32x16_bf16 v[16:31], a[64:67], a[224:227], v[16:31]
v_mfma_f32_32x32x16_bf16 v[192:207], a[68:71], a[224:227], v[192:207]
buffer_load_dwordx4 v90, s[24:27], s77 offen lds
s_add_u32 m0, s86, 0x3400
v_mfma_f32_32x32x16_bf16 v[32:47], a[60:63], a[228:231], v[32:47]
v_mfma_f32_32x32x16_bf16 v[48:63], a[64:67], a[228:231], v[48:63]
buffer_load_dwordx4 v91, s[24:27], s77 offen lds
s_add_u32 m0, s86, 0x3800
v_mfma_f32_32x32x16_bf16 v[208:223], a[68:71], a[228:231], v[208:223]
s_nop 0
ds_read_b128 a[228:231], v241 offset:33792
v_mfma_f32_32x32x16_bf16 v[144:159], a[24:27], a[232:235], v[144:159]
s_waitcnt vmcnt(11)
buffer_load_dwordx4 v92, s[24:27], s77 offen lds
s_add_u32 m0, s86, 0x3c00
ds_read_b64_tr_b16 a[72:73], v93
ds_read_b64_tr_b16 a[74:75], v93 offset:768
ds_read_b64_tr_b16 a[76:77], v93 offset:64
ds_read_b64_tr_b16 a[78:79], v93 offset:832
v_mfma_f32_32x32x16_bf16 v[160:175], a[28:31], a[232:235], v[160:175]
s_mov_b32 s77, 0
ds_read_b64_tr_b16 a[80:81], v93 offset:128
ds_read_b64_tr_b16 a[82:83], v93 offset:896
v_mfma_f32_32x32x16_bf16 v[176:191], a[32:35], a[232:235], v[176:191]
s_nop 0
buffer_load_dwordx4 v90, s[24:27], s78 offen lds
s_add_u32 m0, s86, 0x4000
s_nop 0
buffer_load_dwordx4 v91, s[24:27], s78 offen lds
s_add_u32 m0, s86, 0x4400
s_waitcnt lgkmcnt(4)
v_mfma_f32_32x32x16_bf16 v[0:15], a[72:75], a[236:239], v[0:15]
s_waitcnt vmcnt(11) lgkmcnt(0)
ds_read_b64_tr_b16 a[84:85], v93 offset:3072
ds_read_b64_tr_b16 a[86:87], v93 offset:3840
buffer_load_dwordx4 v92, s[24:27], s78 offen lds
v_mfma_f32_32x32x16_bf16 v[16:31], a[76:79], a[236:239], v[16:31]
s_add_u32 m0, s86, 0
ds_read_b64_tr_b16 a[88:89], v93 offset:3136
ds_read_b64_tr_b16 a[90:91], v93 offset:3904
ds_read_b64_tr_b16 a[92:93], v93 offset:3200
ds_read_b64_tr_b16 a[94:95], v93 offset:3968
s_mov_b32 s78, 0x9000
v_mfma_f32_32x32x16_bf16 v[192:207], a[80:83], a[236:239], v[192:207]
buffer_load_dwordx4 v140, s[24:27], s77 offen lds
v_mfma_f32_32x32x16_bf16 v[32:47], a[72:75], a[240:243], v[32:47]
s_add_u32 m0, s86, 0x400
v_mfma_f32_32x32x16_bf16 v[48:63], a[76:79], a[240:243], v[48:63]
s_nop 0
buffer_load_dwordx4 v141, s[24:27], s77 offen lds
v_mfma_f32_32x32x16_bf16 v[208:223], a[80:83], a[240:243], v[208:223]
s_add_u32 m0, s86, 0x800
ds_read_b128 a[240:243], v242 offset:33792
v_mfma_f32_32x32x16_bf16 v[144:159], a[36:39], a[244:247], v[144:159]
s_waitcnt vmcnt(11) lgkmcnt(1)
ds_read_b64_tr_b16 a[96:97], v93 offset:6144
ds_read_b64_tr_b16 a[98:99], v93 offset:6912
buffer_load_dwordx4 v142, s[24:27], s77 offen lds
v_mfma_f32_32x32x16_bf16 v[160:175], a[40:43], a[244:247], v[160:175]
s_add_u32 m0, s86, 0xc00
ds_read_b64_tr_b16 a[100:101], v93 offset:6208
ds_read_b64_tr_b16 a[102:103], v93 offset:6976
ds_read_b64_tr_b16 a[104:105], v93 offset:6272
ds_read_b64_tr_b16 a[106:107], v93 offset:7040
s_mov_b32 s77, 0x12000
v_mfma_f32_32x32x16_bf16 v[176:191], a[44:47], a[244:247], v[176:191]
s_nop 0
buffer_load_dwordx4 v140, s[24:27], s78 offen lds
v_mfma_f32_32x32x16_bf16 v[0:15], a[84:87], a[248:251], v[0:15]
s_add_u32 m0, s86, 0x1000
s_barrier
ds_read_b128 a[220:223], v240 offset:16384
ds_read_b128 a[224:227], v240 offset:20480
ds_read_b128 a[232:235], v241 offset:16384
ds_read_b128 a[236:239], v241 offset:20480
v_mfma_f32_32x32x16_bf16 v[16:31], a[88:91], a[248:251], v[16:31]
ds_read_b128 a[244:247], v242 offset:16384
buffer_load_dwordx4 v141, s[24:27], s78 offen lds
v_mfma_f32_32x32x16_bf16 v[192:207], a[92:95], a[248:251], v[192:207]
s_add_u32 m0, s86, 0x1400
ds_read_b128 a[248:251], v242 offset:20480
v_mfma_f32_32x32x16_bf16 v[32:47], a[84:87], a[252:255], v[32:47]
s_waitcnt vmcnt(11)
ds_read_b64_tr_b16 a[108:109], v93 offset:9216
ds_read_b64_tr_b16 a[110:111], v93 offset:9984
buffer_load_dwordx4 v142, s[24:27], s78 offen lds
v_mfma_f32_32x32x16_bf16 v[48:63], a[88:91], a[252:255], v[48:63]
s_add_u32 m0, s86, 0x1800
ds_read_b64_tr_b16 a[112:113], v93 offset:9280
ds_read_b64_tr_b16 a[114:115], v93 offset:10048
ds_read_b64_tr_b16 a[116:117], v93 offset:9344
ds_read_b64_tr_b16 a[118:119], v93 offset:10112
s_mov_b32 s78, 0x1b000
v_mfma_f32_32x32x16_bf16 v[208:223], a[92:95], a[252:255], v[208:223]
s_waitcnt lgkmcnt(10)
ds_read_b128 a[252:255], v243 offset:33792
buffer_load_dwordx4 v140, s[24:27], s77 offen lds
v_mfma_f32_32x32x16_bf16 v[144:159], a[48:51], a[216:219], v[144:159]
s_add_u32 m0, s86, 0x1c00
v_mfma_f32_32x32x16_bf16 v[160:175], a[52:55], a[216:219], v[160:175]
s_nop 0
buffer_load_dwordx4 v141, s[24:27], s77 offen lds
v_mfma_f32_32x32x16_bf16 v[176:191], a[56:59], a[216:219], v[176:191]
s_add_u32 m0, s86, 0x2000
ds_read_b128 a[216:219], v243 offset:16384
v_mfma_f32_32x32x16_bf16 v[0:15], a[96:99], a[220:223], v[0:15]
s_waitcnt vmcnt(11)
ds_read_b64_tr_b16 a[120:121], v93 offset:12288
ds_read_b64_tr_b16 a[122:123], v93 offset:13056
buffer_load_dwordx4 v142, s[24:27], s77 offen lds
v_mfma_f32_32x32x16_bf16 v[16:31], a[100:103], a[220:223], v[16:31]
s_add_u32 m0, s86, 0x2400
ds_read_b64_tr_b16 a[124:125], v93 offset:12352
ds_read_b64_tr_b16 a[126:127], v93 offset:13120
ds_read_b64_tr_b16 a[128:129], v93 offset:12416
ds_read_b64_tr_b16 a[130:131], v93 offset:13184
s_mov_b32 s77, 0x24000
v_mfma_f32_32x32x16_bf16 v[192:207], a[104:107], a[220:223], v[192:207]
s_waitcnt lgkmcnt(7)
ds_read_b128 a[220:223], v243 offset:20480
buffer_load_dwordx4 v140, s[24:27], s78 offen lds
v_mfma_f32_32x32x16_bf16 v[32:47], a[96:99], a[224:227], v[32:47]
s_add_u32 m0, s86, 0x2800
v_mfma_f32_32x32x16_bf16 v[48:63], a[100:103], a[224:227], v[48:63]
buffer_load_dwordx4 v141, s[24:27], s78 offen lds
v_mfma_f32_32x32x16_bf16 v[208:223], a[104:107], a[224:227], v[208:223]
s_add_u32 m0, s86, 0x2c00
ds_read_b128 a[224:227], v240 offset:41984
v_mfma_f32_32x32x16_bf16 v[144:159], a[60:63], a[228:231], v[144:159]
s_waitcnt vmcnt(11)
ds_read_b64_tr_b16 a[132:133], v93 offset:15360
ds_read_b64_tr_b16 a[134:135], v93 offset:16128
buffer_load_dwordx4 v142, s[24:27], s78 offen lds
v_mfma_f32_32x32x16_bf16 v[160:175], a[64:67], a[228:231], v[160:175]
s_add_u32 m0, s86, 0x3000
ds_read_b64_tr_b16 a[136:137], v93 offset:15424
ds_read_b64_tr_b16 a[138:139], v93 offset:16192
ds_read_b64_tr_b16 a[140:141], v93 offset:15488
ds_read_b64_tr_b16 a[142:143], v93 offset:16256
s_mov_b32 s78, 0x2d000
v_mfma_f32_32x32x16_bf16 v[176:191], a[68:71], a[228:231], v[176:191]
s_waitcnt lgkmcnt(7)
ds_read_b128 a[228:231], v241 offset:41984
buffer_load_dwordx4 v140, s[24:27], s77 offen lds
v_mfma_f32_32x32x16_bf16 v[0:15], a[108:111], a[232:235], v[0:15]
s_add_u32 m0, s86, 0x3400
v_mfma_f32_32x32x16_bf16 v[16:31], a[112:115], a[232:235], v[16:31]
s_nop 0
buffer_load_dwordx4 v141, s[24:27], s77 offen lds
v_mfma_f32_32x32x16_bf16 v[192:207], a[116:119], a[232:235], v[192:207]
s_add_u32 m0, s86, 0x3800
ds_read_b128 a[232:235], v242 offset:41984
v_mfma_f32_32x32x16_bf16 v[32:47], a[108:111], a[236:239], v[32:47]
s_waitcnt vmcnt(11)
ds_read_b64_tr_b16 a[144:145], v143
ds_read_b64_tr_b16 a[146:147], v143 offset:384
buffer_load_dwordx4 v142, s[24:27], s77 offen lds
v_mfma_f32_32x32x16_bf16 v[48:63], a[112:115], a[236:239], v[48:63]
s_add_u32 m0, s86, 0x3c00
ds_read_b64_tr_b16 a[148:149], v143 offset:32
ds_read_b64_tr_b16 a[150:151], v143 offset:416
ds_read_b64_tr_b16 a[152:153], v143 offset:64
ds_read_b64_tr_b16 a[154:155], v143 offset:448
v_mfma_f32_32x32x16_bf16 v[208:223], a[116:119], a[236:239], v[208:223]
s_waitcnt lgkmcnt(7)
ds_read_b128 a[236:239], v243 offset:41984
buffer_load_dwordx4 v140, s[24:27], s78 offen lds
v_mfma_f32_32x32x16_bf16 v[144:159], a[72:75], a[240:243], v[144:159]
s_add_u32 m0, s86, 0x4000
v_mfma_f32_32x32x16_bf16 v[160:175], a[76:79], a[240:243], v[160:175]
buffer_load_dwordx4 v141, s[24:27], s78 offen lds
v_mfma_f32_32x32x16_bf16 v[176:191], a[80:83], a[240:243], v[176:191]
s_add_u32 m0, s86, 0x4400
ds_read_b128 a[240:243], v244
v_mfma_f32_32x32x16_bf16 v[0:15], a[120:123], a[244:247], v[0:15]
s_waitcnt vmcnt(11)
ds_read_b64_tr_b16 a[156:157], v143 offset:3072
ds_read_b64_tr_b16 a[158:159], v143 offset:3456
buffer_load_dwordx4 v142, s[24:27], s78 offen lds
v_mfma_f32_32x32x16_bf16 v[16:31], a[124:127], a[244:247], v[16:31]
s_add_u32 m0, s87, 0x7400
s_and_b32 s78, s48, 1
s_mul_i32 s78, s78, 0x9000
s_add_u32 s79, s79, s78
s_add_u32 s78, s79, 0
ds_read_b64_tr_b16 a[160:161], v143 offset:3104
ds_read_b64_tr_b16 a[162:163], v143 offset:3488
v_mfma_f32_32x32x16_bf16 v[192:207], a[128:131], a[244:247], v[192:207]
ds_read_b64_tr_b16 a[164:165], v143 offset:3136
ds_read_b64_tr_b16 a[166:167], v143 offset:3520
ds_read_b128 a[244:247], v245
v_mov_b32_e64 v142, s19
v_mfma_f32_32x32x16_bf16 v[32:47], a[120:123], a[248:251], v[32:47]
buffer_load_dwordx4 v139, s[20:23], s93 offen nt lds
s_add_u32 m0, s87, 0x9380
v_mfma_f32_32x32x16_bf16 v[48:63], a[124:127], a[248:251], v[48:63]
v_mfma_f32_32x32x16_bf16 v[208:223], a[128:131], a[248:251], v[208:223]
buffer_load_dwordx4 v139, s[20:23], s93 offen offset:128 nt lds
s_add_u32 m0, s87, 0xb300
ds_read_b128 a[248:251], v244 offset:8192
v_mfma_f32_32x32x16_bf16 v[144:159], a[84:87], a[252:255], v[144:159]
s_waitcnt vmcnt(11) lgkmcnt(4)
ds_read_b64_tr_b16 a[168:169], v143 offset:6144
ds_read_b64_tr_b16 a[170:171], v143 offset:6528
ds_read_b64_tr_b16 a[172:173], v143 offset:6176
v_mfma_f32_32x32x16_bf16 v[160:175], a[88:91], a[252:255], v[160:175]
buffer_load_dwordx4 v139, s[20:23], s93 offen offset:256 nt lds
s_add_u32 m0, s86, 0
ds_read_b64_tr_b16 a[174:175], v143 offset:6560
ds_read_b64_tr_b16 a[176:177], v143 offset:6208
ds_read_b64_tr_b16 a[178:179], v143 offset:6592
v_mfma_f32_32x32x16_bf16 v[176:191], a[92:95], a[252:255], v[176:191]
ds_read_b128 a[252:255], v245 offset:8192
v_mfma_f32_32x32x16_bf16 v[0:15], a[132:135], a[216:219], v[0:15]
buffer_load_dwordx4 v235, s[28:31], s78 offen lds
s_add_u32 m0, s86, 0x400
v_mfma_f32_32x32x16_bf16 v[16:31], a[136:139], a[216:219], v[16:31]
s_nop 6
v_mfma_f32_32x32x16_bf16 v[192:207], a[140:143], a[216:219], v[192:207]
s_nop 0
buffer_load_dwordx4 v236, s[28:31], s78 offen lds
s_add_u32 m0, s86, 0x800
ds_read_b128 a[216:219], v244 offset:16384
v_cvt_pk_bf16_f32 v64, v0, v1
v_cvt_pk_bf16_f32 v65, v2, v3
v_cvt_pk_bf16_f32 v66, v4, v5
v_mfma_f32_32x32x16_bf16 v[32:47], a[132:135], a[220:223], v[32:47]
ds_read_b128 v[0:3], v248 offset:768
v_cvt_pk_bf16_f32 v67, v6, v7
v_cvt_pk_bf16_f32 v68, v8, v9
v_cvt_pk_bf16_f32 v69, v10, v11
v_cvt_pk_bf16_f32 v70, v12, v13
v_cvt_pk_bf16_f32 v71, v14, v15
v_mfma_f32_32x32x16_bf16 v[48:63], a[136:139], a[220:223], v[48:63]
s_waitcnt vmcnt(11) lgkmcnt(2)
buffer_load_dwordx4 v237, s[28:31], s78 offen lds
s_add_u32 m0, s86, 0xc00
s_add_u32 s78, s79, 0x1800
ds_read_b64_tr_b16 a[180:181], v143 offset:9216
ds_read_b64_tr_b16 a[182:183], v143 offset:9600
ds_read_b64_tr_b16 a[184:185], v143 offset:9248
v_mfma_f32_32x32x16_bf16 v[208:223], a[140:143], a[220:223], v[208:223]
s_nop 0
ds_read_b64_tr_b16 a[186:187], v143 offset:9632
ds_read_b64_tr_b16 a[188:189], v143 offset:9280
ds_read_b64_tr_b16 a[190:191], v143 offset:9664
ds_read_b128 v[4:7], v248 offset:960
v_cvt_pk_bf16_f32 v72, v16, v17
v_cvt_pk_bf16_f32 v73, v18, v19
v_mfma_f32_32x32x16_bf16 v[144:159], a[96:99], a[224:227], v[144:159]
buffer_load_dwordx4 v235, s[28:31], s78 offen lds
s_add_u32 m0, s86, 0x1000
ds_read_b128 v[8:11], v248 offset:1152
ds_read_b128 v[12:15], v248 offset:1344
v_cvt_pk_bf16_f32 v74, v20, v21
v_cvt_pk_bf16_f32 v75, v22, v23
v_mfma_f32_32x32x16_bf16 v[160:175], a[100:103], a[224:227], v[160:175]
ds_read_b128 v[16:19], v248 offset:1536
ds_read_b128 v[20:23], v248 offset:1728
v_cvt_pk_bf16_f32 v76, v24, v25
v_cvt_pk_bf16_f32 v77, v26, v27
v_cvt_pk_bf16_f32 v78, v28, v29
v_cvt_pk_bf16_f32 v79, v30, v31
v_mfma_f32_32x32x16_bf16 v[176:191], a[104:107], a[224:227], v[176:191]
buffer_load_dwordx4 v236, s[28:31], s78 offen lds
s_add_u32 m0, s86, 0x1400
ds_read_b128 v[24:27], v248 offset:1920
ds_read_b128 v[28:31], v248 offset:2112
v_cvt_pk_bf16_f32 v88, v32, v33
v_cvt_pk_bf16_f32 v89, v34, v35
v_mfma_f32_32x32x16_bf16 v[144:159], a[108:111], a[228:231], v[144:159]
s_nop 0
ds_read_b128 v[32:35], v248
ds_read_b128 a[220:223], v245 offset:16384
v_cvt_pk_bf16_f32 v90, v36, v37
v_cvt_pk_bf16_f32 v91, v38, v39
v_cvt_pk_bf16_f32 v92, v40, v41
v_cvt_pk_bf16_f32 v93, v42, v43
v_mfma_f32_32x32x16_bf16 v[160:175], a[112:115], a[228:231], v[160:175]
s_waitcnt vmcnt(11)
buffer_load_dwordx4 v237, s[28:31], s78 offen lds
s_add_u32 m0, s86, 0x1800
s_add_u32 s78, s79, 0x3000
ds_read_b128 v[36:39], v248 offset:192
ds_read_b128 v[40:43], v248 offset:384
ds_read_b64_tr_b16 a[192:193], v143 offset:12288
v_mfma_f32_32x32x16_bf16 v[176:191], a[116:119], a[228:231], v[176:191]
ds_read_b64_tr_b16 a[194:195], v143 offset:12672
ds_read_b64_tr_b16 a[196:197], v143 offset:12320
v_cvt_pk_bf16_f32 v94, v44, v45
v_cvt_pk_bf16_f32 v95, v46, v47
v_cvt_pk_bf16_f32 v96, v48, v49
v_cvt_pk_bf16_f32 v97, v50, v51
v_mfma_f32_32x32x16_bf16 v[144:159], a[120:123], a[232:235], v[144:159]
buffer_load_dwordx4 v235, s[28:31], s78 offen lds
s_add_u32 m0, s86, 0x1c00
ds_read_b128 v[44:47], v248 offset:576
ds_read_b64_tr_b16 a[198:199], v143 offset:12704
ds_read_b64_tr_b16 a[200:201], v143 offset:12352
ds_read_b64_tr_b16 a[202:203], v143 offset:12736
v_mfma_f32_32x32x16_bf16 v[160:175], a[124:127], a[232:235], v[160:175]
ds_read_b128 v[48:51], v248 offset:768
v_cvt_pk_bf16_f32 v98, v52, v53
v_cvt_pk_bf16_f32 v99, v54, v55
v_cvt_pk_bf16_f32 v100, v56, v57
v_cvt_pk_bf16_f32 v101, v58, v59
v_cvt_pk_bf16_f32 v102, v60, v61
v_mfma_f32_32x32x16_bf16 v[176:191], a[128:131], a[232:235], v[176:191]
buffer_load_dwordx4 v236, s[28:31], s78 offen lds
s_add_u32 m0, s86, 0x2000
ds_read_b128 v[52:55], v248 offset:960
ds_read_b128 v[56:59], v248 offset:1152
ds_read_b128 a[224:227], v244 offset:2048
v_cvt_pk_bf16_f32 v103, v62, v63
v_mfma_f32_32x32x16_bf16 v[144:159], a[132:135], a[236:239], v[144:159]
ds_read_b128 v[60:63], v248 offset:1344
v_cvt_pk_bf16_f32 v80, v192, v193
v_cvt_pk_bf16_f32 v81, v194, v195
v_cvt_pk_bf16_f32 v82, v196, v197
v_cvt_pk_bf16_f32 v83, v198, v199
v_cvt_pk_bf16_f32 v84, v200, v201
v_mfma_f32_32x32x16_bf16 v[160:175], a[136:139], a[236:239], v[160:175]
s_waitcnt vmcnt(11)
buffer_load_dwordx4 v237, s[28:31], s78 offen lds
s_add_u32 m0, s86, 0x2400
s_add_u32 s78, s79, 0x4800
ds_read_b64_tr_b16 a[204:205], v143 offset:15360
ds_read_b64_tr_b16 a[206:207], v143 offset:15744
ds_read_b64_tr_b16 a[208:209], v143 offset:15392
v_mfma_f32_32x32x16_bf16 v[176:191], a[140:143], a[236:239], v[176:191]
s_waitcnt lgkmcnt(11)
ds_read_b64_tr_b16 a[210:211], v143 offset:15776
ds_read_b64_tr_b16 a[212:213], v143 offset:15424
ds_read_b64_tr_b16 a[214:215], v143 offset:15808
ds_read_b128 a[228:231], v245 offset:2048
v_cvt_pk_bf16_f32 v85, v202, v203
v_cvt_pk_bf16_f32 v86, v204, v205
v_mfma_f32_32x32x16_bf16 v[0:15], v[76:79], v[64:67], v[0:15]
buffer_load_dwordx4 v235, s[28:31], s78 offen lds
s_add_u32 m0, s86, 0x2800
ds_read_b128 a[232:235], v244 offset:10240
ds_read_b128 a[236:239], v245 offset:10240
v_cvt_pk_bf16_f32 v87, v206, v207
v_cvt_pk_bf16_f32 v104, v208, v209
v_mfma_f32_32x32x16_bf16 v[0:15], v[80:83], v[68:71], v[0:15]
v_cvt_pk_bf16_f32 v105, v210, v211
v_cvt_pk_bf16_f32 v106, v212, v213
v_cvt_pk_bf16_f32 v107, v214, v215
v_cvt_pk_bf16_f32 v108, v216, v217
v_cvt_pk_bf16_f32 v109, v218, v219
v_cvt_pk_bf16_f32 v110, v220, v221
v_mfma_f32_32x32x16_bf16 v[0:15], v[84:87], v[72:75], v[0:15]
buffer_load_dwordx4 v236, s[28:31], s78 offen lds
s_add_u32 m0, s86, 0x2c00
v_cvt_pk_bf16_f32 v111, v222, v223
v_mov_b32_e32 v143, s19
s_nop 1
v_mfma_f32_32x32x16_bf16 v[16:31], v[100:103], v[64:67], v[16:31]
v_cvt_pk_bf16_f32 v64, v144, v145
v_cvt_pk_bf16_f32 v65, v146, v147
v_cvt_pk_bf16_f32 v66, v148, v149
v_cvt_pk_bf16_f32 v67, v150, v151
v_mfma_f32_32x32x16_bf16 v[16:31], v[104:107], v[68:71], v[16:31]
buffer_load_dwordx4 v237, s[28:31], s78 offen lds
s_add_u32 m0, s86, 0x3000
s_add_u32 s78, s79, 0x6000
s_waitcnt vmcnt(12) lgkmcnt(2)
s_barrier
v_max3_f32 v224, v0, v1, v2
v_max3_f32 v224, v224, v3, v4
v_mfma_f32_32x32x16_bf16 v[16:31], v[108:111], v[72:75], v[16:31]
v_max3_f32 v224, v224, v5, v6
v_max3_f32 v224, v224, v7, v8
v_max3_f32 v224, v224, v9, v10
v_max3_f32 v224, v224, v11, v12
v_max3_f32 v224, v224, v13, v14
v_max_f32_e64 v224, v224, v15
v_mfma_f32_32x32x16_bf16 v[32:47], v[76:79], v[88:91], v[32:47]
buffer_load_dwordx4 v235, s[28:31], s78 offen lds
s_add_u32 m0, s86, 0x3400
v_fma_f32 v224, v224, s70, v254
v_cvt_pk_bf16_f32 v68, v152, v153
v_cvt_pk_bf16_f32 v69, v154, v155
v_cvt_pk_bf16_f32 v70, v156, v157
v_mfma_f32_32x32x16_bf16 v[32:47], v[80:83], v[92:95], v[32:47]
v_max3_f32 v225, v16, v17, v18
v_max3_f32 v225, v225, v19, v20
v_max3_f32 v225, v225, v21, v22
v_max3_f32 v225, v225, v23, v24
v_max3_f32 v225, v225, v25, v26
v_max3_f32 v225, v225, v27, v28
v_mfma_f32_32x32x16_bf16 v[32:47], v[84:87], v[96:99], v[32:47]
buffer_load_dwordx4 v236, s[28:31], s78 offen lds
s_add_u32 m0, s86, 0x3800
v_max3_f32 v225, v225, v29, v30
v_max_f32_e64 v225, v225, v31
v_fma_f32 v225, v225, s70, v255
v_max_f32_e64 v224, v224, v225
v_mfma_f32_32x32x16_bf16 v[48:63], v[100:103], v[88:91], v[48:63]
v_mov_b32_e64 v225, v224
v_cvt_pk_bf16_f32 v71, v158, v159
v_cvt_pk_bf16_f32 v72, v160, v161
v_permlane32_swap_b32_e32 v224, v225
v_max_f32_e32 v224, v224, v225
v_mfma_f32_32x32x16_bf16 v[48:63], v[104:107], v[92:95], v[48:63]
buffer_load_dwordx4 v237, s[28:31], s78 offen lds
s_add_u32 m0, s86, 0x3c00
s_add_u32 s78, s79, 0x7800
v_sub_f32_e64 v226, v254, v224
v_fma_f32 v0, v0, s70, v226
v_fma_f32 v1, v1, s70, v226
v_mfma_f32_32x32x16_bf16 v[48:63], v[108:111], v[96:99], v[48:63]
v_exp_f32_e32 v0, v0
v_exp_f32_e32 v1, v1
v_fma_f32 v2, v2, s70, v226
v_fma_f32 v3, v3, s70, v226
v_mfma_f32_16x16x32_bf16 v[192:195], a[240:243], a[144:147], 0
buffer_load_dwordx4 v235, s[28:31], s78 offen lds
s_add_u32 m0, s86, 0x4000
v_mfma_f32_16x16x32_bf16 v[196:199], a[240:243], a[148:151], 0
v_exp_f32_e64 v2, v2
v_mfma_f32_16x16x32_bf16 v[200:203], a[240:243], a[152:155], 0
ds_read_b128 a[240:243], v244 offset:18432
v_fma_f32 v4, v4, s70, v226
v_mfma_f32_16x16x32_bf16 v[192:195], a[244:247], a[156:159], v[192:195]
v_exp_f32_e64 v3, v3
v_mfma_f32_16x16x32_bf16 v[196:199], a[244:247], a[160:163], v[196:199]
buffer_load_dwordx4 v236, s[28:31], s78 offen lds
s_add_u32 m0, s86, 0x4400
v_mfma_f32_16x16x32_bf16 v[200:203], a[244:247], a[164:167], v[200:203]
ds_read_b128 a[244:247], v245 offset:18432
v_fma_f32 v5, v5, s70, v226
v_mfma_f32_16x16x32_bf16 v[192:195], a[248:251], a[168:171], v[192:195]
v_fma_f32 v6, v6, s70, v226
v_fma_f32 v7, v7, s70, v226
v_mfma_f32_16x16x32_bf16 v[196:199], a[248:251], a[172:175], v[196:199]
v_exp_f32_e64 v4, v4
v_mfma_f32_16x16x32_bf16 v[200:203], a[248:251], a[176:179], v[200:203]
ds_read_b128 a[248:251], v244 offset:4096
buffer_load_dwordx4 v237, s[28:31], s78 offen lds
v_mfma_f32_16x16x32_bf16 v[192:195], a[252:255], a[180:183], v[192:195]
s_add_u32 m0, s87, 0
v_exp_f32_e32 v5, v5
v_mfma_f32_16x16x32_bf16 v[196:199], a[252:255], a[184:187], v[196:199]
v_exp_f32_e64 v6, v6
v_mfma_f32_16x16x32_bf16 v[200:203], a[252:255], a[188:191], v[200:203]
ds_read_b128 a[252:255], v245 offset:4096
v_cvt_pk_bf16_f32 v0, v0, v1
v_mfma_f32_16x16x32_bf16 v[192:195], a[216:219], a[192:195], v[192:195]
v_exp_f32_e64 v7, v7
v_mfma_f32_16x16x32_bf16 v[196:199], a[216:219], a[196:199], v[196:199]
v_cvt_pk_bf16_f32 v1, v2, v3
v_cvt_pk_bf16_f32 v2, v4, v5
v_mfma_f32_16x16x32_bf16 v[200:203], a[216:219], a[200:203], v[200:203]
ds_read_b128 a[216:219], v244 offset:12288
v_cvt_pk_bf16_f32 v3, v6, v7
v_mfma_f32_16x16x32_bf16 v[192:195], a[220:223], a[204:207], v[192:195]
v_fma_f32 v8, v8, s70, v226
v_fma_f32 v9, v9, s70, v226
v_mfma_f32_16x16x32_bf16 v[196:199], a[220:223], a[208:211], v[196:199]
v_fma_f32 v10, v10, s70, v226
v_fma_f32 v11, v11, s70, v226
v_mfma_f32_16x16x32_bf16 v[200:203], a[220:223], a[212:215], v[200:203]
ds_read_b128 a[220:223], v245 offset:12288
v_fma_f32 v12, v12, s70, v226
v_mfma_f32_16x16x32_bf16 v[204:207], a[224:227], a[144:147], 0
v_cvt_pk_bf16_f32 v112, v192, v193
v_cvt_pk_bf16_f32 v113, v194, v195
v_mfma_f32_16x16x32_bf16 v[208:211], a[224:227], a[148:151], 0
v_cvt_pk_bf16_f32 v114, v196, v197
v_cvt_pk_bf16_f32 v115, v198, v199
v_mfma_f32_16x16x32_bf16 v[212:215], a[224:227], a[152:155], 0
ds_read_b128 a[224:227], v244 offset:20480
v_cvt_pk_bf16_f32 v116, v200, v201
v_mfma_f32_16x16x32_bf16 v[204:207], a[228:231], a[156:159], v[204:207]
v_cvt_pk_bf16_f32 v117, v202, v203
v_fma_f32 v13, v13, s70, v226
v_mfma_f32_16x16x32_bf16 v[208:211], a[228:231], a[160:163], v[208:211]
v_permlane16_swap_b32_e32 v112, v114
v_mfma_f32_16x16x32_bf16 v[212:215], a[228:231], a[164:167], v[212:215]
s_waitcnt lgkmcnt(2)
ds_read_b128 a[228:231], v245 offset:20480
v_fma_f32 v14, v14, s70, v226
v_mfma_f32_16x16x32_bf16 v[204:207], a[232:235], a[168:171], v[204:207]
v_permlane16_swap_b32_e64 v113, v115
v_mfma_f32_16x16x32_bf16 v[208:211], a[232:235], a[172:175], v[208:211]
v_fma_f32 v15, v15, s70, v226
v_sub_f32_e64 v227, v255, v224
v_mfma_f32_16x16x32_bf16 v[212:215], a[232:235], a[176:179], v[212:215]
ds_read_b128 a[232:235], v244 offset:6144
v_fma_f32 v16, v16, s70, v227
v_mfma_f32_16x16x32_bf16 v[204:207], a[236:239], a[180:183], v[204:207]
v_exp_f32_e64 v8, v8
v_mfma_f32_16x16x32_bf16 v[208:211], a[236:239], a[184:187], v[208:211]
v_exp_f32_e64 v9, v9
v_mfma_f32_16x16x32_bf16 v[212:215], a[236:239], a[188:191], v[212:215]
ds_read_b128 a[236:239], v245 offset:6144
v_cvt_pk_bf16_f32 v4, v8, v9
v_mfma_f32_16x16x32_bf16 v[204:207], a[240:243], a[192:195], v[204:207]
v_exp_f32_e64 v10, v10
v_mfma_f32_16x16x32_bf16 v[208:211], a[240:243], a[196:199], v[208:211]
v_exp_f32_e64 v11, v11
v_mfma_f32_16x16x32_bf16 v[212:215], a[240:243], a[200:203], v[212:215]
ds_read_b128 a[240:243], v244 offset:14336
v_cvt_pk_bf16_f32 v5, v10, v11
v_mfma_f32_16x16x32_bf16 v[204:207], a[244:247], a[204:207], v[204:207]
v_exp_f32_e64 v12, v12
v_mfma_f32_16x16x32_bf16 v[208:211], a[244:247], a[208:211], v[208:211]
v_exp_f32_e64 v13, v13
v_mfma_f32_16x16x32_bf16 v[212:215], a[244:247], a[212:215], v[212:215]
ds_read_b128 a[244:247], v245 offset:14336
v_cvt_pk_bf16_f32 v6, v12, v13
v_mfma_f32_16x16x32_bf16 v[192:195], a[248:251], a[144:147], 0
v_exp_f32_e64 v14, v14
v_mfma_f32_16x16x32_bf16 v[196:199], a[248:251], a[148:151], 0
v_exp_f32_e64 v15, v15
v_mfma_f32_16x16x32_bf16 v[200:203], a[248:251], a[152:155], 0
ds_read_b128 a[248:251], v244 offset:22528
v_cvt_pk_bf16_f32 v7, v14, v15
v_mfma_f32_16x16x32_bf16 v[192:195], a[252:255], a[156:159], v[192:195]
v_fma_f32 v17, v17, s70, v227
v_fma_f32 v18, v18, s70, v227
v_mfma_f32_16x16x32_bf16 v[196:199], a[252:255], a[160:163], v[196:199]
v_fma_f32 v19, v19, s70, v227
v_fma_f32 v20, v20, s70, v227
v_mfma_f32_16x16x32_bf16 v[200:203], a[252:255], a[164:167], v[200:203]
ds_read_b128 a[252:255], v245 offset:22528
v_fma_f32 v21, v21, s70, v227
v_mfma_f32_16x16x32_bf16 v[192:195], a[216:219], a[168:171], v[192:195]
v_fma_f32 v22, v22, s70, v227
v_fma_f32 v23, v23, s70, v227
v_mfma_f32_16x16x32_bf16 v[196:199], a[216:219], a[172:175], v[196:199]
v_exp_f32_e32 v16, v16
v_mfma_f32_16x16x32_bf16 v[200:203], a[216:219], a[176:179], v[200:203]
s_waitcnt lgkmcnt(2)
ds_read_b128 a[216:219], v240 offset:29696
v_fma_f32 v24, v24, s70, v227
v_mfma_f32_16x16x32_bf16 v[192:195], a[220:223], a[180:183], v[192:195]
v_exp_f32_e64 v17, v17
v_mfma_f32_16x16x32_bf16 v[196:199], a[220:223], a[184:187], v[196:199]
v_exp_f32_e64 v18, v18
v_mfma_f32_16x16x32_bf16 v[200:203], a[220:223], a[188:191], v[200:203]
v_cvt_pk_bf16_f32 v120, v204, v205
v_cvt_pk_bf16_f32 v121, v206, v207
v_mfma_f32_16x16x32_bf16 v[192:195], a[224:227], a[192:195], v[192:195]
s_waitcnt lgkmcnt(1)
s_barrier
buffer_load_dwordx4 v233, s[20:23], s56 offen nt lds
v_mfma_f32_16x16x32_bf16 v[196:199], a[224:227], a[196:199], v[196:199]
s_add_u32 m0, s87, 0x1000
v_cvt_pk_bf16_f32 v122, v208, v209
v_cvt_pk_bf16_f32 v123, v210, v211
v_mfma_f32_16x16x32_bf16 v[200:203], a[224:227], a[200:203], v[200:203]
v_cvt_pk_bf16_f32 v124, v212, v213
v_cvt_pk_bf16_f32 v125, v214, v215
v_mfma_f32_16x16x32_bf16 v[192:195], a[228:231], a[204:207], v[192:195]
ds_read_b128 a[220:223], v241 offset:29696
ds_read_b128 a[224:227], v242 offset:29696
v_mfma_f32_16x16x32_bf16 v[196:199], a[228:231], a[208:211], v[196:199]
v_permlane16_swap_b32_e64 v120, v122
v_mfma_f32_16x16x32_bf16 v[200:203], a[228:231], a[212:215], v[200:203]
buffer_load_dwordx4 v233, s[20:23], s94 offen nt lds
s_add_u32 m0, s87, 0x1f80
v_mfma_f32_16x16x32_bf16 v[204:207], a[232:235], a[144:147], 0
ds_read_b128 a[228:231], v243 offset:29696
v_cvt_pk_bf16_f32 v8, v16, v17
v_mfma_f32_16x16x32_bf16 v[208:211], a[232:235], a[148:151], 0
v_permlane16_swap_b32_e64 v121, v123
v_mfma_f32_16x16x32_bf16 v[212:215], a[232:235], a[152:155], 0
v_cvt_pk_bf16_f32 v132, v200, v201
v_cvt_pk_bf16_f32 v133, v202, v203
v_mfma_f32_16x16x32_bf16 v[204:207], a[236:239], a[156:159], v[204:207]
buffer_load_dwordx4 v233, s[20:23], s56 offen offset:128 nt lds
ds_read_b128 a[232:235], v240 offset:37888
v_mfma_f32_16x16x32_bf16 v[208:211], a[236:239], a[160:163], v[208:211]
s_add_u32 m0, s87, 0x2f80
v_exp_f32_e64 v19, v19
v_mfma_f32_16x16x32_bf16 v[212:215], a[236:239], a[164:167], v[212:215]
v_exp_f32_e64 v20, v20
v_mfma_f32_16x16x32_bf16 v[204:207], a[240:243], a[168:171], v[204:207]
v_exp_f32_e64 v21, v21
v_mfma_f32_16x16x32_bf16 v[208:211], a[240:243], a[172:175], v[208:211]
v_exp_f32_e64 v22, v22
v_mfma_f32_16x16x32_bf16 v[212:215], a[240:243], a[176:179], v[212:215]
v_exp_f32_e64 v23, v23
v_mfma_f32_16x16x32_bf16 v[204:207], a[244:247], a[180:183], v[204:207]
v_cvt_pk_bf16_f32 v9, v18, v19
v_cvt_pk_bf16_f32 v10, v20, v21
v_mfma_f32_16x16x32_bf16 v[208:211], a[244:247], a[184:187], v[208:211]
v_mov_b32_e32 v118, s19
v_mov_b32_e32 v119, s19
v_mfma_f32_16x16x32_bf16 v[212:215], a[244:247], a[188:191], v[212:215]
v_permlane16_swap_b32_e64 v116, v118
v_mfma_f32_16x16x32_bf16 v[204:207], a[248:251], a[192:195], v[204:207]
v_permlane16_swap_b32_e64 v117, v119
v_mfma_f32_16x16x32_bf16 v[208:211], a[248:251], a[196:199], v[208:211]
v_cvt_pk_bf16_f32 v128, v192, v193
v_cvt_pk_bf16_f32 v129, v194, v195
v_mfma_f32_16x16x32_bf16 v[212:215], a[248:251], a[200:203], v[212:215]
v_cvt_pk_bf16_f32 v130, v196, v197
v_cvt_pk_bf16_f32 v131, v198, v199
v_mfma_f32_16x16x32_bf16 v[204:207], a[252:255], a[204:207], v[204:207]
v_mov_b32_e32 v126, s19
v_mov_b32_e32 v127, s19
v_mfma_f32_16x16x32_bf16 v[208:211], a[252:255], a[208:211], v[208:211]
v_permlane16_swap_b32_e64 v124, v126
v_mfma_f32_16x16x32_bf16 v[212:215], a[252:255], a[212:215], v[212:215]
v_permlane16_swap_b32_e64 v125, v127
v_cvt_pk_bf16_f32 v11, v22, v23
v_permlane16_swap_b32_e64 v132, v134
v_cvt_pk_bf16_f32 v136, v204, v205
v_cvt_pk_bf16_f32 v137, v206, v207
v_permlane16_swap_b32_e64 v133, v135
v_cvt_pk_bf16_f32 v138, v208, v209
v_cvt_pk_bf16_f32 v139, v210, v211
v_cvt_pk_bf16_f32 v140, v212, v213
v_cvt_pk_bf16_f32 v141, v214, v215
v_mfma_f32_32x32x16_bf16 v[208:223], v[116:119], v[0:3], 0
v_permlane16_swap_b32_e32 v128, v130
v_permlane16_swap_b32_e32 v129, v131
v_fma_f32 v25, v25, s70, v227
v_fma_f32 v26, v26, s70, v227
v_mfma_f32_32x32x16_bf16 v[192:207], v[112:115], v[0:3], 0
v_fma_f32 v27, v27, s70, v227
v_fma_f32 v28, v28, s70, v227
v_fma_f32 v29, v29, s70, v227
v_fma_f32 v30, v30, s70, v227
v_fma_f32 v31, v31, s70, v227
v_cvt_pk_bf16_f32 v73, v162, v163
v_mfma_f32_32x32x16_bf16 v[208:223], v[124:127], v[4:7], v[208:223]
v_exp_f32_e32 v24, v24
v_exp_f32_e32 v25, v25
v_exp_f32_e64 v26, v26
v_mfma_f32_32x32x16_bf16 v[192:207], v[120:123], v[4:7], v[192:207]
v_exp_f32_e32 v27, v27
v_exp_f32_e32 v28, v28
v_exp_f32_e64 v29, v29
v_mfma_f32_32x32x16_bf16 v[208:223], v[132:135], v[8:11], v[208:223]
v_exp_f32_e32 v30, v30
v_exp_f32_e32 v31, v31
v_cvt_pk_bf16_f32 v12, v24, v25
v_cvt_pk_bf16_f32 v13, v26, v27
v_mfma_f32_32x32x16_bf16 v[192:207], v[128:131], v[8:11], v[192:207]
v_cvt_pk_bf16_f32 v14, v28, v29
v_cvt_pk_bf16_f32 v15, v30, v31
v_permlane16_swap_b32_e32 v140, v142
v_permlane16_swap_b32_e32 v141, v143
v_permlane16_swap_b32_e64 v136, v138
v_cvt_pk_bf16_f32 v74, v164, v165
v_mfma_f32_32x32x16_bf16 v[208:223], v[140:143], v[12:15], v[208:223]
ds_read_b128 a[236:239], v241 offset:37888
v_permlane16_swap_b32_e32 v137, v139
v_cvt_pk_bf16_f32 v75, v166, v167
v_cvt_pk_bf16_f32 v76, v168, v169
v_cvt_pk_bf16_f32 v77, v170, v171
v_mfma_f32_32x32x16_bf16 v[192:207], v[136:139], v[12:15], v[192:207]
s_waitcnt lgkmcnt(1)
v_cvt_pk_bf16_f32 v78, v172, v173
v_cvt_pk_bf16_f32 v79, v174, v175
v_cvt_pk_bf16_f32 v80, v176, v177
v_cvt_pk_bf16_f32 v81, v178, v179
v_cvt_pk_bf16_f32 v82, v180, v181
v_cvt_pk_bf16_f32 v83, v182, v183
v_mfma_f32_32x32x16_bf16 v[144:159], a[0:3], a[216:219], 0
v_cvt_pk_bf16_f32 v84, v184, v185
v_cvt_pk_bf16_f32 v85, v186, v187
v_cvt_pk_bf16_f32 v86, v188, v189
v_cvt_pk_bf16_f32 v87, v190, v191
v_max3_f32 v224, v32, v33, v34
v_max3_f32 v225, v48, v49, v50
v_mfma_f32_32x32x16_bf16 v[160:175], a[4:7], a[216:219], 0
buffer_load_dwordx4 v233, s[20:23], s94 offen offset:128 nt lds
ds_read_b128 a[240:243], v242 offset:37888
ds_read_b128 a[244:247], v243 offset:37888
ds_read_b128 a[248:251], v244 offset:25600
v_max3_f32 v224, v224, v35, v36
v_max3_f32 v225, v225, v51, v52
v_mfma_f32_32x32x16_bf16 v[176:191], a[8:11], a[216:219], 0
s_add_u32 m0, s87, 0x3f00
v_max3_f32 v224, v224, v37, v38
v_max3_f32 v225, v225, v53, v54
v_max3_f32 v224, v224, v39, v40
v_max3_f32 v225, v225, v55, v56
v_max3_f32 v224, v224, v41, v42
v_max3_f32 v225, v225, v57, v58
v_mfma_f32_32x32x16_bf16 v[144:159], a[12:15], a[220:223], v[144:159]
v_max3_f32 v224, v224, v43, v44
v_max3_f32 v225, v225, v59, v60
v_max3_f32 v224, v224, v45, v46
v_max3_f32 v225, v225, v61, v62
v_max_f32_e32 v224, v224, v47
v_max_f32_e32 v225, v225, v63
v_mfma_f32_32x32x16_bf16 v[160:175], a[16:19], a[220:223], v[160:175]
v_fma_f32 v224, v224, s70, v255
v_fma_f32 v225, v225, s70, v254
v_max_f32_e32 v224, v224, v225
v_mov_b32_e32 v225, v224
v_rcp_f32_e64 v217, v216
v_mfma_f32_32x32x16_bf16 v[176:191], a[20:23], a[220:223], v[176:191]
ds_read_b128 a[252:255], v245 offset:25600
v_permlane32_swap_b32_e32 v224, v225
v_max_f32_e32 v224, v224, v225
v_sub_f32_e64 v228, v255, v224
v_fma_f32 v32, v32, s70, v228
v_mfma_f32_32x32x16_bf16 v[144:159], a[24:27], a[224:227], v[144:159]
v_fma_f32 v33, v33, s70, v228
v_exp_f32_e32 v32, v32
v_exp_f32_e32 v33, v33
v_fma_f32 v34, v34, s70, v228
v_mfma_f32_32x32x16_bf16 v[160:175], a[28:31], a[224:227], v[160:175]
v_fma_f32 v35, v35, s70, v228
v_exp_f32_e32 v34, v34
v_exp_f32_e32 v35, v35
v_fma_f32 v36, v36, s70, v228
v_mfma_f32_32x32x16_bf16 v[176:191], a[32:35], a[224:227], v[176:191]
v_fma_f32 v37, v37, s70, v228
v_fma_f32 v38, v38, s70, v228
v_fma_f32 v39, v39, s70, v228
v_exp_f32_e64 v36, v36
v_cvt_pk_bf16_f32 v32, v32, v33
v_mfma_f32_32x32x16_bf16 v[144:159], a[36:39], a[228:231], v[144:159]
v_exp_f32_e32 v37, v37
v_exp_f32_e32 v38, v38
v_exp_f32_e64 v39, v39
v_mfma_f32_32x32x16_bf16 v[160:175], a[40:43], a[228:231], v[160:175]
v_cvt_pk_bf16_f32 v33, v34, v35
v_cvt_pk_bf16_f32 v34, v36, v37
v_cvt_pk_bf16_f32 v35, v38, v39
v_fma_f32 v40, v40, s70, v228
v_fma_f32 v41, v41, s70, v228
v_fma_f32 v42, v42, s70, v228
v_mfma_f32_32x32x16_bf16 v[176:191], a[44:47], a[228:231], v[176:191]
ds_read_b128 a[216:219], v244 offset:33792
v_fma_f32 v43, v43, s70, v228
v_fma_f32 v44, v44, s70, v228
v_fma_f32 v45, v45, s70, v228
v_fma_f32 v46, v46, s70, v228
v_fma_f32 v47, v47, s70, v228
v_mfma_f32_32x32x16_bf16 v[144:159], a[48:51], a[232:235], v[144:159]
ds_read_b128 a[220:223], v245 offset:33792
v_exp_f32_e32 v40, v40
v_exp_f32_e32 v41, v41
v_sub_f32_e64 v229, v254, v224
v_mfma_f32_32x32x16_bf16 v[160:175], a[52:55], a[232:235], v[160:175]
v_exp_f32_e32 v42, v42
v_exp_f32_e32 v43, v43
v_exp_f32_e64 v44, v44
v_mfma_f32_32x32x16_bf16 v[176:191], a[56:59], a[232:235], v[176:191]
s_waitcnt lgkmcnt(2)
v_exp_f32_e32 v45, v45
v_exp_f32_e32 v46, v46
v_exp_f32_e32 v47, v47
v_mfma_f32_32x32x16_bf16 v[144:159], a[60:63], a[236:239], v[144:159]
v_cvt_pk_bf16_f32 v36, v40, v41
v_cvt_pk_bf16_f32 v37, v42, v43
v_cvt_pk_bf16_f32 v38, v44, v45
v_cvt_pk_bf16_f32 v39, v46, v47
v_fma_f32 v48, v48, s70, v229
v_fma_f32 v49, v49, s70, v229
v_mfma_f32_32x32x16_bf16 v[160:175], a[64:67], a[236:239], v[160:175]
ds_read_b128 a[224:227], v244 offset:41984
v_fma_f32 v50, v50, s70, v229
v_fma_f32 v51, v51, s70, v229
v_fma_f32 v52, v52, s70, v229
v_fma_f32 v53, v53, s70, v229
v_fma_f32 v54, v54, s70, v229
v_mfma_f32_32x32x16_bf16 v[176:191], a[68:71], a[236:239], v[176:191]
v_fma_f32 v55, v55, s70, v229
v_exp_f32_e32 v48, v48
v_exp_f32_e32 v49, v49
v_fma_f32 v56, v56, s70, v229
v_mfma_f32_32x32x16_bf16 v[16:31], v[116:119], v[32:35], 0
v_exp_f32_e32 v50, v50
v_exp_f32_e32 v51, v51
v_exp_f32_e64 v52, v52
v_mfma_f32_32x32x16_bf16 v[0:15], v[112:115], v[32:35], 0
v_exp_f32_e32 v53, v53
v_exp_f32_e32 v54, v54
v_exp_f32_e64 v55, v55
v_mfma_f32_32x32x16_bf16 v[16:31], v[124:127], v[36:39], v[16:31]
v_cvt_pk_bf16_f32 v40, v48, v49
v_cvt_pk_bf16_f32 v41, v50, v51
v_cvt_pk_bf16_f32 v42, v52, v53
v_cvt_pk_bf16_f32 v43, v54, v55
v_fma_f32 v57, v57, s70, v229
v_fma_f32 v58, v58, s70, v229
v_mfma_f32_32x32x16_bf16 v[0:15], v[120:123], v[36:39], v[0:15]
ds_read_b128 a[228:231], v245 offset:41984
v_fma_f32 v59, v59, s70, v229
v_fma_f32 v60, v60, s70, v229
v_fma_f32 v61, v61, s70, v229
v_fma_f32 v62, v62, s70, v229
v_fma_f32 v63, v63, s70, v229
v_mfma_f32_32x32x16_bf16 v[16:31], v[132:135], v[40:43], v[16:31]
v_exp_f32_e32 v56, v56
v_exp_f32_e32 v57, v57
v_exp_f32_e64 v58, v58
v_mfma_f32_32x32x16_bf16 v[0:15], v[128:131], v[40:43], v[0:15]
v_exp_f32_e32 v59, v59
v_exp_f32_e32 v60, v60
v_exp_f32_e32 v61, v61
v_exp_f32_e32 v62, v62
v_exp_f32_e64 v63, v63
v_cvt_pk_bf16_f32 v44, v56, v57
v_cvt_pk_bf16_f32 v45, v58, v59
v_cvt_pk_bf16_f32 v46, v60, v61
v_cvt_pk_bf16_f32 v47, v62, v63
v_mul_f32_e32 v192, v217, v192
v_mul_f32_e32 v193, v217, v193
v_mfma_f32_32x32x16_bf16 v[16:31], v[140:143], v[44:47], v[16:31]
ds_read_b128 a[232:235], v240 offset:46080
ds_read_b128 a[236:239], v241 offset:46080
buffer_load_dwordx4 v233, s[20:23], s56 offen offset:256 nt lds
v_mul_f32_e32 v194, v217, v194
v_mul_f32_e32 v195, v217, v195
v_cvt_pk_bf16_f32 v192, v192, v193
v_mfma_f32_32x32x16_bf16 v[0:15], v[136:139], v[44:47], v[0:15]
s_add_u32 m0, s87, 0x4f00
v_mul_f32_e32 v196, v217, v196
v_mul_f32_e32 v197, v217, v197
v_mul_f32_e32 v198, v217, v198
v_mul_f32_e32 v199, v217, v199
v_cvt_pk_bf16_f32 v193, v194, v195
v_cvt_pk_bf16_f32 v194, v196, v197
v_mfma_f32_32x32x16_bf16 v[144:159], a[72:75], a[240:243], v[144:159]
v_cvt_pk_bf16_f32 v195, v198, v199
v_mul_f32_e32 v200, v217, v200
v_mul_f32_e32 v201, v217, v201
v_mul_f32_e32 v202, v217, v202
v_mul_f32_e32 v203, v217, v203
v_cvt_pk_bf16_f32 v200, v200, v201
v_mfma_f32_32x32x16_bf16 v[160:175], a[76:79], a[240:243], v[160:175]
ds_write_b128 v247, v[192:195] offset:51200
v_mul_f32_e64 v204, v217, v204
v_mfma_f32_32x32x16_bf16 v[176:191], a[80:83], a[240:243], v[176:191]
v_mul_f32_e32 v205, v217, v205
v_mul_f32_e32 v206, v217, v206
v_mul_f32_e64 v207, v217, v207
v_cvt_pk_bf16_f32 v201, v202, v203
v_cvt_pk_bf16_f32 v202, v204, v205
v_cvt_pk_bf16_f32 v203, v206, v207
v_mfma_f32_32x32x16_bf16 v[144:159], a[84:87], a[244:247], v[144:159]
ds_write_b128 v247, v[200:203] offset:51232
v_mul_f32_e64 v208, v217, v208
v_mfma_f32_32x32x16_bf16 v[160:175], a[88:91], a[244:247], v[160:175]
v_mul_f32_e32 v209, v217, v209
v_mul_f32_e32 v210, v217, v210
v_mul_f32_e64 v211, v217, v211
v_cvt_pk_bf16_f32 v208, v208, v209
v_mul_f32_e32 v212, v217, v212
v_mul_f32_e32 v213, v217, v213
v_mfma_f32_32x32x16_bf16 v[176:191], a[92:95], a[244:247], v[176:191]
ds_read_b128 a[240:243], v244 offset:27648
ds_read_b128 a[244:247], v245 offset:27648
v_mul_f32_e32 v214, v217, v214
v_mul_f32_e32 v215, v217, v215
v_cvt_pk_bf16_f32 v209, v210, v211
v_cvt_pk_bf16_f32 v210, v212, v213
v_mfma_f32_16x16x32_bf16 v[192:195], a[248:251], a[144:147], 0
v_cvt_pk_bf16_f32 v211, v214, v215
v_mul_f32_e64 v254, s63, v253
v_mfma_f32_16x16x32_bf16 v[196:199], a[248:251], a[148:151], 0
buffer_load_dwordx4 v233, s[20:23], s94 offen offset:256 nt lds
ds_read_b128 v[28:31], v248 offset:2112
v_mfma_f32_16x16x32_bf16 v[200:203], a[248:251], a[152:155], 0
ds_read_b128 a[248:251], v244 offset:35840
ds_read_b128 v[32:35], v248
v_mfma_f32_16x16x32_bf16 v[192:195], a[252:255], a[156:159], v[192:195]
ds_read_b128 v[36:39], v248 offset:192
ds_read_b128 v[40:43], v248 offset:384
v_mfma_f32_16x16x32_bf16 v[196:199], a[252:255], a[160:163], v[196:199]
v_rcp_f32_e32 v25, v24
v_mfma_f32_16x16x32_bf16 v[200:203], a[252:255], a[164:167], v[200:203]
s_waitcnt lgkmcnt(7)
ds_read_b128 a[252:255], v245 offset:35840
ds_read_b128 v[44:47], v248 offset:576
v_mfma_f32_16x16x32_bf16 v[192:195], a[216:219], a[168:171], v[192:195]
v_mul_f32_e32 v0, v25, v0
v_mul_f32_e32 v1, v25, v1
v_mfma_f32_16x16x32_bf16 v[196:199], a[216:219], a[172:175], v[196:199]
ds_read_b128 v[48:51], v248 offset:768
ds_read_b128 v[52:55], v248 offset:960
v_mfma_f32_16x16x32_bf16 v[200:203], a[216:219], a[176:179], v[200:203]
v_mul_f32_e32 v8, v25, v8
v_mul_f32_e32 v9, v25, v9
v_mfma_f32_16x16x32_bf16 v[192:195], a[220:223], a[180:183], v[192:195]
ds_read_b128 a[216:219], v244 offset:44032
ds_read_b128 v[56:59], v248 offset:1152
v_mfma_f32_16x16x32_bf16 v[196:199], a[220:223], a[184:187], v[196:199]
v_mul_f32_e32 v2, v25, v2
v_mul_f32_e32 v3, v25, v3
v_mfma_f32_16x16x32_bf16 v[200:203], a[220:223], a[188:191], v[200:203]
ds_read_b128 a[220:223], v245 offset:44032
ds_read_b128 v[60:63], v248 offset:1344
v_mfma_f32_16x16x32_bf16 v[192:195], a[224:227], a[192:195], v[192:195]
v_cvt_pk_bf16_f32 v0, v0, v1
v_mul_f32_e64 v10, v25, v10
v_mfma_f32_16x16x32_bf16 v[196:199], a[224:227], a[196:199], v[196:199]
v_mul_f32_e64 v11, v25, v11
v_cvt_pk_bf16_f32 v8, v8, v9
v_mfma_f32_16x16x32_bf16 v[200:203], a[224:227], a[200:203], v[200:203]
ds_read_b128 a[224:227], v242 offset:46080
v_mul_f32_e64 v4, v25, v4
v_mfma_f32_16x16x32_bf16 v[192:195], a[228:231], a[204:207], v[192:195]
v_mul_f32_e32 v5, v25, v5
v_mul_f32_e32 v6, v25, v6
v_mfma_f32_16x16x32_bf16 v[196:199], a[228:231], a[208:211], v[196:199]
v_mul_f32_e64 v7, v25, v7
v_cvt_pk_bf16_f32 v1, v2, v3
v_mfma_f32_16x16x32_bf16 v[200:203], a[228:231], a[212:215], v[200:203]
ds_read_b128 a[228:231], v243 offset:46080
v_mul_f32_e64 v12, v25, v12
v_mfma_f32_32x32x16_bf16 v[144:159], a[96:99], a[232:235], v[144:159]
ds_write_b128 v247, v[208:211] offset:51264
v_cvt_pk_bf16_f32 v112, v192, v193
v_mfma_f32_32x32x16_bf16 v[160:175], a[100:103], a[232:235], v[160:175]
v_cvt_pk_bf16_f32 v113, v194, v195
v_cvt_pk_bf16_f32 v114, v196, v197
v_cvt_pk_bf16_f32 v115, v198, v199
v_cvt_pk_bf16_f32 v116, v200, v201
v_cvt_pk_bf16_f32 v117, v202, v203
v_mul_f32_e64 v13, v25, v13
v_mfma_f32_32x32x16_bf16 v[176:191], a[104:107], a[232:235], v[176:191]
ds_read_b128 a[232:235], v244 offset:29696
v_mul_f32_e32 v14, v25, v14
v_mul_f32_e32 v15, v25, v15
v_cvt_pk_bf16_f32 v9, v10, v11
v_cvt_pk_bf16_f32 v2, v4, v5
v_cvt_pk_bf16_f32 v3, v6, v7
v_mfma_f32_32x32x16_bf16 v[144:159], a[108:111], a[236:239], v[144:159]
ds_write_b128 v247, v[0:3] offset:64000
v_cvt_pk_bf16_f32 v10, v12, v13
v_mfma_f32_32x32x16_bf16 v[160:175], a[112:115], a[236:239], v[160:175]
v_cvt_pk_bf16_f32 v11, v14, v15
v_mul_f32_e32 v16, v25, v16
v_mul_f32_e32 v17, v25, v17
v_mul_f32_e64 v18, v25, v18
v_mul_f32_e32 v19, v25, v19
v_cvt_pk_bf16_f32 v16, v16, v17
v_mfma_f32_32x32x16_bf16 v[176:191], a[116:119], a[236:239], v[176:191]
s_waitcnt lgkmcnt(2)
ds_read_b128 a[236:239], v245 offset:29696
ds_write_b128 v247, v[8:11] offset:64032
v_mfma_f32_16x16x32_bf16 v[204:207], a[240:243], a[144:147], 0
v_mul_f32_e32 v20, v25, v20
v_mul_f32_e32 v21, v25, v21
v_mfma_f32_16x16x32_bf16 v[208:211], a[240:243], a[148:151], 0
ds_read_b128 v[0:3], v248 offset:768
ds_read_b128 v[4:7], v248 offset:960
v_mfma_f32_16x16x32_bf16 v[212:215], a[240:243], a[152:155], 0
v_mul_f32_e32 v22, v25, v22
v_mul_f32_e32 v23, v25, v23
v_mfma_f32_16x16x32_bf16 v[204:207], a[244:247], a[156:159], v[204:207]
ds_read_b128 a[240:243], v244 offset:37888
ds_read_b128 v[8:11], v248 offset:1152
v_mfma_f32_16x16x32_bf16 v[208:211], a[244:247], a[160:163], v[208:211]
v_cvt_pk_bf16_f32 v17, v18, v19
v_cvt_pk_bf16_f32 v18, v20, v21
v_mfma_f32_16x16x32_bf16 v[212:215], a[244:247], a[164:167], v[212:215]
ds_read_b128 a[244:247], v245 offset:37888
ds_read_b128 v[12:15], v248 offset:1344
v_mfma_f32_16x16x32_bf16 v[204:207], a[248:251], a[168:171], v[204:207]
v_cvt_pk_bf16_f32 v19, v22, v23
v_min_f32_e64 v255, s67, v254
v_mfma_f32_16x16x32_bf16 v[208:211], a[248:251], a[172:175], v[208:211]
ds_read_b128 v[20:23], v248 offset:1728
ds_read_b128 v[24:27], v248 offset:1920
v_mfma_f32_16x16x32_bf16 v[212:215], a[248:251], a[176:179], v[212:215]
v_mov_b32_e32 v118, s19
v_mov_b32_e32 v119, s19
v_mfma_f32_16x16x32_bf16 v[204:207], a[252:255], a[180:183], v[204:207]
ds_read_b128 a[248:251], v244 offset:46080
v_mov_b32_e64 v126, s19
v_mfma_f32_16x16x32_bf16 v[208:211], a[252:255], a[184:187], v[208:211]
v_permlane16_swap_b32_e64 v116, v118
v_mfma_f32_16x16x32_bf16 v[212:215], a[252:255], a[188:191], v[212:215]
ds_read_b128 a[252:255], v245 offset:46080
v_mov_b32_e64 v127, s19
v_mfma_f32_16x16x32_bf16 v[204:207], a[216:219], a[192:195], v[204:207]
v_permlane16_swap_b32_e64 v117, v119
v_mfma_f32_16x16x32_bf16 v[208:211], a[216:219], a[196:199], v[208:211]
v_permlane16_swap_b32_e64 v112, v114
v_mfma_f32_16x16x32_bf16 v[212:215], a[216:219], a[200:203], v[212:215]
ds_read_b128 a[216:219], v244 offset:31744
v_mov_b32_e64 v134, s19
v_mfma_f32_16x16x32_bf16 v[204:207], a[220:223], a[204:207], v[204:207]
v_permlane16_swap_b32_e64 v113, v115
v_mfma_f32_16x16x32_bf16 v[208:211], a[220:223], a[208:211], v[208:211]
v_mov_b32_e32 v135, s19
v_mov_b32_e32 v142, s19
v_mfma_f32_16x16x32_bf16 v[212:215], a[220:223], a[212:215], v[212:215]
ds_read_b128 a[220:223], v245 offset:31744
v_mov_b32_e64 v143, s19
v_mfma_f32_32x32x16_bf16 v[144:159], a[120:123], a[224:227], v[144:159]
ds_write_b128 v247, v[16:19] offset:64064
v_cvt_pk_bf16_f32 v120, v204, v205
v_mfma_f32_32x32x16_bf16 v[160:175], a[124:127], a[224:227], v[160:175]
v_cvt_pk_bf16_f32 v121, v206, v207
v_cvt_pk_bf16_f32 v122, v208, v209
v_cvt_pk_bf16_f32 v123, v210, v211
v_cvt_pk_bf16_f32 v124, v212, v213
v_cvt_pk_bf16_f32 v125, v214, v215
v_mfma_f32_32x32x16_bf16 v[176:191], a[128:131], a[224:227], v[176:191]
ds_read_b128 a[224:227], v244 offset:39936
ds_read_b128 v[16:19], v248 offset:1536
v_permlane16_swap_b32_e32 v124, v126
v_permlane16_swap_b32_e32 v125, v127
v_mfma_f32_32x32x16_bf16 v[144:159], a[132:135], a[228:231], v[144:159]
v_permlane16_swap_b32_e64 v120, v122
v_permlane16_swap_b32_e32 v121, v123
s_nop 1
v_mfma_f32_32x32x16_bf16 v[160:175], a[136:139], a[228:231], v[160:175]
s_nop 6
v_mfma_f32_32x32x16_bf16 v[176:191], a[140:143], a[228:231], v[176:191]
s_waitcnt lgkmcnt(2)
ds_read_b128 a[228:231], v245 offset:39936
v_cvt_pk_bf16_f32 v88, v144, v145
v_cvt_pk_bf16_f32 v89, v146, v147
v_cvt_pk_bf16_f32 v90, v148, v149
v_cvt_pk_bf16_f32 v91, v150, v151
v_cvt_pk_bf16_f32 v92, v152, v153
v_mfma_f32_16x16x32_bf16 v[192:195], a[232:235], a[144:147], 0
v_cvt_pk_bf16_f32 v100, v168, v169
v_cvt_pk_bf16_f32 v101, v170, v171
v_mfma_f32_16x16x32_bf16 v[196:199], a[232:235], a[148:151], 0
v_cvt_pk_bf16_f32 v102, v172, v173
v_cvt_pk_bf16_f32 v103, v174, v175
v_mfma_f32_16x16x32_bf16 v[200:203], a[232:235], a[152:155], 0
ds_read_b128 a[232:235], v244 offset:48128
v_cvt_pk_bf16_f32 v104, v176, v177
v_mfma_f32_16x16x32_bf16 v[192:195], a[236:239], a[156:159], v[192:195]
v_cvt_pk_bf16_f32 v105, v178, v179
v_cvt_pk_bf16_f32 v106, v180, v181
v_mfma_f32_16x16x32_bf16 v[196:199], a[236:239], a[160:163], v[196:199]
v_cvt_pk_bf16_f32 v107, v182, v183
v_cvt_pk_bf16_f32 v108, v184, v185
v_mfma_f32_16x16x32_bf16 v[200:203], a[236:239], a[164:167], v[200:203]
ds_read_b128 a[236:239], v245 offset:48128
v_cvt_pk_bf16_f32 v109, v186, v187
v_mfma_f32_16x16x32_bf16 v[192:195], a[240:243], a[168:171], v[192:195]
v_cvt_pk_bf16_f32 v110, v188, v189
v_cvt_pk_bf16_f32 v111, v190, v191
v_mfma_f32_16x16x32_bf16 v[196:199], a[240:243], a[172:175], v[196:199]
v_cvt_pk_bf16_f32 v93, v154, v155
v_cvt_pk_bf16_f32 v94, v156, v157
v_mfma_f32_16x16x32_bf16 v[200:203], a[240:243], a[176:179], v[200:203]
v_cvt_pk_bf16_f32 v95, v158, v159
v_cvt_pk_bf16_f32 v96, v160, v161
v_mfma_f32_16x16x32_bf16 v[192:195], a[244:247], a[180:183], v[192:195]
v_cvt_pk_bf16_f32 v97, v162, v163
v_cvt_pk_bf16_f32 v98, v164, v165
v_mfma_f32_16x16x32_bf16 v[196:199], a[244:247], a[184:187], v[196:199]
v_cvt_pk_bf16_f32 v99, v166, v167
v_mfma_f32_16x16x32_bf16 v[200:203], a[244:247], a[188:191], v[200:203]
v_mfma_f32_16x16x32_bf16 v[192:195], a[248:251], a[192:195], v[192:195]
v_mfma_f32_16x16x32_bf16 v[196:199], a[248:251], a[196:199], v[196:199]
v_mfma_f32_16x16x32_bf16 v[200:203], a[248:251], a[200:203], v[200:203]
v_mfma_f32_16x16x32_bf16 v[192:195], a[252:255], a[204:207], v[192:195]
s_nop 2
v_mfma_f32_16x16x32_bf16 v[196:199], a[252:255], a[208:211], v[196:199]
s_nop 2
v_mfma_f32_16x16x32_bf16 v[200:203], a[252:255], a[212:215], v[200:203]
v_cvt_pk_bf16_f32 v128, v192, v193
v_cvt_pk_bf16_f32 v129, v194, v195
v_mfma_f32_16x16x32_bf16 v[204:207], a[216:219], a[144:147], 0
s_nop 0
v_cvt_pk_bf16_f32 v130, v196, v197
v_cvt_pk_bf16_f32 v131, v198, v199
v_mfma_f32_16x16x32_bf16 v[208:211], a[216:219], a[148:151], 0
v_permlane16_swap_b32_e32 v128, v130
v_mfma_f32_16x16x32_bf16 v[212:215], a[216:219], a[152:155], 0
v_cvt_pk_bf16_f32 v132, v200, v201
v_cvt_pk_bf16_f32 v133, v202, v203
v_mfma_f32_16x16x32_bf16 v[204:207], a[220:223], a[156:159], v[204:207]
v_permlane16_swap_b32_e64 v132, v134
v_mfma_f32_16x16x32_bf16 v[208:211], a[220:223], a[160:163], v[208:211]
v_permlane16_swap_b32_e64 v133, v135
v_mfma_f32_16x16x32_bf16 v[212:215], a[220:223], a[164:167], v[212:215]
s_waitcnt lgkmcnt(0)
v_permlane16_swap_b32_e32 v129, v131
v_mfma_f32_16x16x32_bf16 v[204:207], a[224:227], a[168:171], v[204:207]
v_mfma_f32_16x16x32_bf16 v[208:211], a[224:227], a[172:175], v[208:211]
v_mfma_f32_16x16x32_bf16 v[212:215], a[224:227], a[176:179], v[212:215]
v_mfma_f32_16x16x32_bf16 v[204:207], a[228:231], a[180:183], v[204:207]
v_mfma_f32_16x16x32_bf16 v[208:211], a[228:231], a[184:187], v[208:211]
v_mfma_f32_16x16x32_bf16 v[212:215], a[228:231], a[188:191], v[212:215]
v_mfma_f32_16x16x32_bf16 v[204:207], a[232:235], a[192:195], v[204:207]
v_mfma_f32_16x16x32_bf16 v[208:211], a[232:235], a[196:199], v[208:211]
v_mfma_f32_16x16x32_bf16 v[212:215], a[232:235], a[200:203], v[212:215]
v_mfma_f32_16x16x32_bf16 v[204:207], a[236:239], a[204:207], v[204:207]
s_nop 2
v_mfma_f32_16x16x32_bf16 v[208:211], a[236:239], a[208:211], v[208:211]
s_nop 2
v_mfma_f32_16x16x32_bf16 v[212:215], a[236:239], a[212:215], v[212:215]
v_cvt_pk_bf16_f32 v136, v204, v205
v_cvt_pk_bf16_f32 v137, v206, v207
v_mfma_f32_32x32x16_bf16 v[0:15], v[76:79], v[64:67], v[0:15]
s_nop 0
v_cvt_pk_bf16_f32 v138, v208, v209
v_cvt_pk_bf16_f32 v139, v210, v211
s_nop 1
v_cvt_pk_bf16_f32 v140, v212, v213
v_cvt_pk_bf16_f32 v141, v214, v215
v_mfma_f32_32x32x16_bf16 v[0:15], v[80:83], v[68:71], v[0:15]
v_permlane16_swap_b32_e32 v140, v142
v_permlane16_swap_b32_e32 v141, v143
v_permlane16_swap_b32_e64 v136, v138
v_mfma_f32_32x32x16_bf16 v[0:15], v[84:87], v[72:75], v[0:15]
s_waitcnt vmcnt(0)
v_permlane16_swap_b32_e32 v137, v139
s_nop 3
v_mfma_f32_32x32x16_bf16 v[16:31], v[100:103], v[64:67], v[16:31]
s_barrier
ds_read_b128 a[216:219], v246 offset:51200
ds_read_b64_tr_b16 a[220:221], v249
ds_read_b64_tr_b16 a[222:223], v249 offset:1536
ds_read_b64_tr_b16 a[224:225], v249 offset:64
ds_read_b64_tr_b16 a[226:227], v249 offset:1600
ds_read_b64_tr_b16 a[228:229], v249 offset:128
v_mfma_f32_32x32x16_bf16 v[16:31], v[104:107], v[68:71], v[16:31]
ds_read_b64_tr_b16 a[230:231], v249 offset:1664
v_max3_f32 v224, v0, v1, v2
v_max3_f32 v224, v224, v3, v4
v_max3_f32 v224, v224, v5, v6
v_max3_f32 v224, v224, v7, v8
v_max3_f32 v224, v224, v9, v10
v_mfma_f32_32x32x16_bf16 v[16:31], v[108:111], v[72:75], v[16:31]
ds_read_b128 a[232:235], v246 offset:51232
ds_read_b64_tr_b16 a[236:237], v249 offset:3072
ds_read_b64_tr_b16 a[238:239], v249 offset:4608
ds_read_b64_tr_b16 a[240:241], v249 offset:3136
v_max3_f32 v224, v224, v11, v12
v_max3_f32 v224, v224, v13, v14
v_mfma_f32_32x32x16_bf16 v[32:47], v[76:79], v[88:91], v[32:47]
ds_read_b64_tr_b16 a[242:243], v249 offset:4672
ds_read_b64_tr_b16 a[244:245], v249 offset:3200
ds_read_b64_tr_b16 a[246:247], v249 offset:4736
v_max_f32_e64 v224, v224, v15
v_fma_f32 v224, v224, s70, v254
v_mfma_f32_32x32x16_bf16 v[32:47], v[80:83], v[92:95], v[32:47]
ds_read_b128 a[248:251], v246 offset:51264
ds_read_b64_tr_b16 a[252:253], v249 offset:6144
v_max3_f32 v225, v16, v17, v18
v_max3_f32 v225, v225, v19, v20
v_max3_f32 v225, v225, v21, v22
v_max3_f32 v225, v225, v23, v24
v_mfma_f32_32x32x16_bf16 v[32:47], v[84:87], v[96:99], v[32:47]
ds_read_b64_tr_b16 a[254:255], v249 offset:7680
ds_read_b64_tr_b16 v[232:233], v249 offset:6208
ds_read_b64_tr_b16 v[234:235], v249 offset:7744
ds_read_b64_tr_b16 v[236:237], v249 offset:6272
ds_read_b64_tr_b16 v[238:239], v249 offset:7808
v_max3_f32 v225, v225, v25, v26
v_mfma_f32_32x32x16_bf16 v[48:63], v[100:103], v[88:91], v[48:63]
v_max3_f32 v225, v225, v27, v28
v_max3_f32 v225, v225, v29, v30
v_max_f32_e64 v225, v225, v31
v_fma_f32 v225, v225, s70, v255
v_max_f32_e32 v224, v224, v225
v_mov_b32_e32 v225, v224
v_mfma_f32_32x32x16_bf16 v[48:63], v[104:107], v[92:95], v[48:63]
s_nop 0
v_permlane32_swap_b32_e32 v224, v225
v_max_f32_e32 v224, v224, v225
v_sub_f32_e32 v226, v254, v224
v_fma_f32 v0, v0, s70, v226
v_fma_f32 v1, v1, s70, v226
v_mfma_f32_32x32x16_bf16 v[48:63], v[108:111], v[96:99], v[48:63]
s_waitcnt lgkmcnt(8)
v_exp_f32_e32 v0, v0
v_exp_f32_e64 v1, v1
v_fma_f32 v2, v2, s70, v226
v_fma_f32 v3, v3, s70, v226
v_mfma_f32_32x32x16_bf16 v[64:79], a[220:223], a[216:219], 0
ds_read_b64_tr_b16 a[220:221], v249 offset:9216
ds_read_b64_tr_b16 a[222:223], v249 offset:10752
v_exp_f32_e32 v2, v2
v_exp_f32_e32 v3, v3
v_mfma_f32_32x32x16_bf16 v[80:95], a[224:227], a[216:219], 0
ds_read_b64_tr_b16 a[224:225], v249 offset:9280
ds_read_b64_tr_b16 a[226:227], v249 offset:10816
v_fma_f32 v4, v4, s70, v226
v_fma_f32 v5, v5, s70, v226
v_fma_f32 v6, v6, s70, v226
v_fma_f32 v7, v7, s70, v226
v_mfma_f32_32x32x16_bf16 v[96:111], a[228:231], a[216:219], 0
ds_read_b128 a[216:219], v246 offset:51296
ds_read_b64_tr_b16 a[228:229], v249 offset:9344
ds_read_b64_tr_b16 a[230:231], v249 offset:10880
v_exp_f32_e64 v4, v4
v_cvt_pk_bf16_f32 v0, v0, v1
v_mfma_f32_32x32x16_bf16 v[64:79], a[236:239], a[232:235], v[64:79]
ds_read_b64_tr_b16 a[236:237], v249 offset:12288
ds_read_b64_tr_b16 a[238:239], v249 offset:13824
v_exp_f32_e64 v5, v5
v_exp_f32_e32 v6, v6
v_mfma_f32_32x32x16_bf16 v[80:95], a[240:243], a[232:235], v[80:95]
s_waitcnt lgkmcnt(9)
ds_read_b64_tr_b16 a[240:241], v249 offset:12352
ds_read_b64_tr_b16 a[242:243], v249 offset:13888
v_exp_f32_e64 v7, v7
v_cvt_pk_bf16_f32 v1, v2, v3
v_cvt_pk_bf16_f32 v2, v4, v5
v_mfma_f32_32x32x16_bf16 v[96:111], a[244:247], a[232:235], v[96:111]
ds_read_b128 a[232:235], v246 offset:51328
ds_read_b64_tr_b16 a[244:245], v249 offset:12416
ds_read_b64_tr_b16 a[246:247], v249 offset:13952
v_cvt_pk_bf16_f32 v3, v6, v7
v_fma_f32 v8, v8, s70, v226
v_fma_f32 v9, v9, s70, v226
v_mfma_f32_32x32x16_bf16 v[64:79], a[252:255], a[248:251], v[64:79]
ds_read_b64_tr_b16 a[252:253], v249 offset:15360
ds_read_b64_tr_b16 a[254:255], v249 offset:16896
v_fma_f32 v10, v10, s70, v226
v_fma_f32 v11, v11, s70, v226
v_fma_f32 v12, v12, s70, v226
v_fma_f32 v13, v13, s70, v226
v_mfma_f32_32x32x16_bf16 v[80:95], v[232:235], a[248:251], v[80:95]
ds_read_b64_tr_b16 v[232:233], v249 offset:15424
ds_read_b64_tr_b16 v[234:235], v249 offset:16960
v_fma_f32 v14, v14, s70, v226
v_fma_f32 v15, v15, s70, v226
v_exp_f32_e32 v8, v8
v_mfma_f32_32x32x16_bf16 v[96:111], v[236:239], a[248:251], v[96:111]
s_waitcnt lgkmcnt(9)
ds_read_b128 a[248:251], v246 offset:51360
ds_read_b64_tr_b16 v[236:237], v249 offset:15488
ds_read_b64_tr_b16 v[238:239], v249 offset:17024
v_exp_f32_e32 v9, v9
v_sub_f32_e32 v227, v255, v224
v_mfma_f32_32x32x16_bf16 v[64:79], a[220:223], a[216:219], v[64:79]
ds_read_b64_tr_b16 a[220:221], v249 offset:18432
ds_read_b64_tr_b16 a[222:223], v249 offset:19968
v_exp_f32_e32 v10, v10
v_exp_f32_e32 v11, v11
v_mfma_f32_32x32x16_bf16 v[80:95], a[224:227], a[216:219], v[80:95]
ds_read_b64_tr_b16 a[224:225], v249 offset:18496
ds_read_b64_tr_b16 a[226:227], v249 offset:20032
v_exp_f32_e64 v12, v12
v_exp_f32_e32 v13, v13
v_mfma_f32_32x32x16_bf16 v[96:111], a[228:231], a[216:219], v[96:111]
s_waitcnt lgkmcnt(9)
ds_read_b128 a[216:219], v246 offset:51392
ds_read_b64_tr_b16 a[228:229], v249 offset:18560
ds_read_b64_tr_b16 a[230:231], v249 offset:20096
v_exp_f32_e64 v14, v14
v_cvt_pk_bf16_f32 v4, v8, v9
v_mfma_f32_32x32x16_bf16 v[64:79], a[236:239], a[232:235], v[64:79]
ds_read_b64_tr_b16 a[236:237], v249 offset:21504
ds_read_b64_tr_b16 a[238:239], v249 offset:23040
v_exp_f32_e64 v15, v15
v_cvt_pk_bf16_f32 v5, v10, v11
v_cvt_pk_bf16_f32 v6, v12, v13
v_mfma_f32_32x32x16_bf16 v[80:95], a[240:243], a[232:235], v[80:95]
s_nop 0
ds_read_b64_tr_b16 a[240:241], v249 offset:21568
ds_read_b64_tr_b16 a[242:243], v249 offset:23104
v_cvt_pk_bf16_f32 v7, v14, v15
v_fma_f32 v16, v16, s70, v227
v_fma_f32 v17, v17, s70, v227
v_fma_f32 v18, v18, s70, v227
v_mfma_f32_32x32x16_bf16 v[96:111], a[244:247], a[232:235], v[96:111]
s_waitcnt lgkmcnt(9)
ds_read_b128 a[232:235], v246 offset:51424
ds_read_b64_tr_b16 a[244:245], v249 offset:21632
ds_read_b64_tr_b16 a[246:247], v249 offset:23168
v_fma_f32 v19, v19, s70, v227
v_fma_f32 v20, v20, s70, v227
v_fma_f32 v21, v21, s70, v227
v_mfma_f32_32x32x16_bf16 v[64:79], a[252:255], a[248:251], v[64:79]
ds_read_b64_tr_b16 a[252:253], v249 offset:24576
ds_read_b64_tr_b16 a[254:255], v249 offset:26112
v_fma_f32 v22, v22, s70, v227
v_fma_f32 v23, v23, s70, v227
v_exp_f32_e64 v16, v16
v_mfma_f32_32x32x16_bf16 v[80:95], v[232:235], a[248:251], v[80:95]
ds_read_b64_tr_b16 v[232:233], v249 offset:24640
ds_read_b64_tr_b16 v[234:235], v249 offset:26176
v_exp_f32_e64 v17, v17
v_exp_f32_e32 v18, v18
v_mfma_f32_32x32x16_bf16 v[96:111], v[236:239], a[248:251], v[96:111]
s_waitcnt lgkmcnt(9)
ds_read_b128 a[248:251], v246 offset:51456
ds_read_b64_tr_b16 v[236:237], v249 offset:24704
ds_read_b64_tr_b16 v[238:239], v249 offset:26240
v_exp_f32_e64 v19, v19
v_cvt_pk_bf16_f32 v8, v16, v17
v_mfma_f32_32x32x16_bf16 v[64:79], a[220:223], a[216:219], v[64:79]
ds_read_b64_tr_b16 a[220:221], v249 offset:27648
ds_read_b64_tr_b16 a[222:223], v249 offset:29184
v_exp_f32_e32 v20, v20
v_exp_f32_e32 v21, v21
v_mfma_f32_32x32x16_bf16 v[80:95], a[224:227], a[216:219], v[80:95]
ds_read_b64_tr_b16 a[224:225], v249 offset:27712
ds_read_b64_tr_b16 a[226:227], v249 offset:29248
v_exp_f32_e64 v22, v22
v_exp_f32_e32 v23, v23
v_mfma_f32_32x32x16_bf16 v[96:111], a[228:231], a[216:219], v[96:111]
s_waitcnt lgkmcnt(9)
ds_read_b128 a[216:219], v246 offset:51488
ds_read_b64_tr_b16 a[228:229], v249 offset:27776
ds_read_b64_tr_b16 a[230:231], v249 offset:29312
v_cvt_pk_bf16_f32 v9, v18, v19
v_cvt_pk_bf16_f32 v10, v20, v21
v_cvt_pk_bf16_f32 v11, v22, v23
v_mfma_f32_32x32x16_bf16 v[64:79], a[236:239], a[232:235], v[64:79]
ds_read_b64_tr_b16 a[236:237], v249 offset:30720
ds_read_b64_tr_b16 a[238:239], v249 offset:32256
v_fma_f32 v24, v24, s70, v227
v_fma_f32 v25, v25, s70, v227
v_fma_f32 v26, v26, s70, v227
v_fma_f32 v27, v27, s70, v227
v_mfma_f32_32x32x16_bf16 v[80:95], a[240:243], a[232:235], v[80:95]
ds_read_b64_tr_b16 a[240:241], v249 offset:30784
ds_read_b64_tr_b16 a[242:243], v249 offset:32320
v_fma_f32 v28, v28, s70, v227
v_fma_f32 v29, v29, s70, v227
v_fma_f32 v30, v30, s70, v227
v_fma_f32 v31, v31, s70, v227
v_mfma_f32_32x32x16_bf16 v[96:111], a[244:247], a[232:235], v[96:111]
s_waitcnt lgkmcnt(9)
ds_read_b128 a[232:235], v246 offset:51520
ds_read_b64_tr_b16 a[244:245], v249 offset:30848
ds_read_b64_tr_b16 a[246:247], v249 offset:32384
v_exp_f32_e32 v24, v24
v_max3_f32 v224, v32, v33, v34
v_mfma_f32_32x32x16_bf16 v[64:79], a[252:255], a[248:251], v[64:79]
ds_read_b64_tr_b16 a[252:253], v249 offset:33792
ds_read_b64_tr_b16 a[254:255], v249 offset:35328
v_exp_f32_e32 v25, v25
v_exp_f32_e32 v26, v26
v_mfma_f32_32x32x16_bf16 v[80:95], v[232:235], a[248:251], v[80:95]
ds_read_b64_tr_b16 v[232:233], v249 offset:33856
ds_read_b64_tr_b16 v[234:235], v249 offset:35392
v_exp_f32_e64 v27, v27
v_exp_f32_e32 v28, v28
v_mfma_f32_32x32x16_bf16 v[96:111], v[236:239], a[248:251], v[96:111]
s_waitcnt lgkmcnt(9)
ds_read_b128 a[248:251], v246 offset:51552
ds_read_b64_tr_b16 v[236:237], v249 offset:33920
ds_read_b64_tr_b16 v[238:239], v249 offset:35456
v_exp_f32_e64 v29, v29
v_cvt_pk_bf16_f32 v12, v24, v25
v_mfma_f32_32x32x16_bf16 v[64:79], a[220:223], a[216:219], v[64:79]
v_exp_f32_e32 v30, v30
v_exp_f32_e32 v31, v31
v_cvt_pk_bf16_f32 v13, v26, v27
v_cvt_pk_bf16_f32 v14, v28, v29
v_mfma_f32_32x32x16_bf16 v[80:95], a[224:227], a[216:219], v[80:95]
v_cvt_pk_bf16_f32 v15, v30, v31
v_max3_f32 v225, v48, v49, v50
v_max3_f32 v224, v224, v35, v36
v_max3_f32 v225, v225, v51, v52
v_max3_f32 v224, v224, v37, v38
v_max3_f32 v225, v225, v53, v54
v_mfma_f32_32x32x16_bf16 v[96:111], a[228:231], a[216:219], v[96:111]
v_max3_f32 v224, v224, v39, v40
v_max3_f32 v225, v225, v55, v56
v_max3_f32 v224, v224, v41, v42
v_max3_f32 v225, v225, v57, v58
s_waitcnt lgkmcnt(2)
s_barrier
v_max3_f32 v224, v224, v43, v44
v_mfma_f32_32x32x16_bf16 v[64:79], a[236:239], a[232:235], v[64:79]
ds_read_b128 a[216:219], v240
ds_read_b128 a[220:223], v241
ds_read_b128 a[224:227], v242
v_max3_f32 v225, v225, v59, v60
v_max3_f32 v224, v224, v45, v46
v_max3_f32 v225, v225, v61, v62
v_mfma_f32_32x32x16_bf16 v[80:95], a[240:243], a[232:235], v[80:95]
ds_read_b128 a[228:231], v243
ds_read_b128 a[236:239], v241 offset:8192
v_max_f32_e32 v224, v224, v47
v_max_f32_e32 v225, v225, v63
v_fma_f32 v224, v224, s70, v255
v_fma_f32 v225, v225, s70, v254
v_mfma_f32_32x32x16_bf16 v[96:111], a[244:247], a[232:235], v[96:111]
ds_read_b128 a[232:235], v240 offset:8192
ds_read_b128 a[240:243], v242 offset:8192
v_max_f32_e64 v224, v224, v225
v_mov_b32_e32 v225, v224
s_nop 0
v_mfma_f32_32x32x16_bf16 v[64:79], a[252:255], a[248:251], v[64:79]
ds_read_b128 a[244:247], v243 offset:8192
ds_read_b128 a[252:255], v241 offset:16384
v_permlane32_swap_b32_e32 v224, v225
v_max_f32_e32 v224, v224, v225
v_sub_f32_e32 v228, v255, v224
v_mfma_f32_32x32x16_bf16 v[80:95], v[232:235], a[248:251], v[80:95]
s_waitcnt lgkmcnt(9)
ds_read_b128 v[232:235], v242 offset:16384
v_fma_f32 v32, v32, s70, v228
v_fma_f32 v33, v33, s70, v228
v_exp_f32_e32 v32, v32
v_fma_f32 v34, v34, s70, v228
v_mfma_f32_32x32x16_bf16 v[96:111], v[236:239], a[248:251], v[96:111]
s_waitcnt lgkmcnt(8)
ds_read_b128 a[248:251], v240 offset:16384
ds_read_b128 v[236:239], v243 offset:16384
v_cvt_pk_bf16_f32 v64, v64, v65
v_cvt_pk_bf16_f32 v72, v72, v73
v_cvt_pk_bf16_f32 v65, v66, v67
v_cvt_pk_bf16_f32 v73, v74, v75
v_mfma_f32_32x32x16_bf16 v[144:159], a[0:3], a[216:219], 0
v_cvt_pk_bf16_f32 v66, v68, v69
v_cvt_pk_bf16_f32 v67, v70, v71
v_cvt_pk_bf16_f32 v74, v76, v77
v_cvt_pk_bf16_f32 v75, v78, v79
v_cvt_pk_bf16_f32 v80, v80, v81
v_cvt_pk_bf16_f32 v88, v88, v89
v_mfma_f32_32x32x16_bf16 v[160:175], a[4:7], a[216:219], 0
ds_write_b128 v230, v[64:67] offset:25600
v_cvt_pk_bf16_f32 v81, v82, v83
v_mfma_f32_32x32x16_bf16 v[176:191], a[8:11], a[216:219], 0
v_cvt_pk_bf16_f32 v89, v90, v91
v_cvt_pk_bf16_f32 v82, v84, v85
v_cvt_pk_bf16_f32 v83, v86, v87
v_cvt_pk_bf16_f32 v90, v92, v93
v_cvt_pk_bf16_f32 v91, v94, v95
v_fma_f32 v35, v35, s70, v228
v_mfma_f32_32x32x16_bf16 v[144:159], a[12:15], a[220:223], v[144:159]
ds_write_b128 v230, v[72:75] offset:25632
v_fma_f32 v36, v36, s70, v228
v_mfma_f32_32x32x16_bf16 v[160:175], a[16:19], a[220:223], v[160:175]
v_exp_f32_e32 v33, v33
v_exp_f32_e32 v34, v34
v_exp_f32_e32 v35, v35
v_mfma_f32_32x32x16_bf16 v[176:191], a[20:23], a[220:223], v[176:191]
s_waitcnt lgkmcnt(1)
ds_read_b128 v[68:71], v231 offset:25600
ds_read_b128 v[76:79], v231 offset:32000
ds_read_b128 a[216:219], v240 offset:4096
v_fma_f32 v37, v37, s70, v228
v_fma_f32 v38, v38, s70, v228
v_fma_f32 v39, v39, s70, v228
v_mfma_f32_32x32x16_bf16 v[144:159], a[24:27], a[224:227], v[144:159]
ds_write_b128 v230, v[80:83] offset:25664
v_cvt_pk_bf16_f32 v32, v32, v33
v_mfma_f32_32x32x16_bf16 v[160:175], a[28:31], a[224:227], v[160:175]
v_exp_f32_e32 v36, v36
v_exp_f32_e32 v37, v37
v_exp_f32_e64 v38, v38
v_mfma_f32_32x32x16_bf16 v[176:191], a[32:35], a[224:227], v[176:191]
s_nop 0
ds_write_b128 v230, v[88:91] offset:25696
v_cvt_pk_bf16_f32 v33, v34, v35
v_mfma_f32_32x32x16_bf16 v[144:159], a[36:39], a[228:231], v[144:159]
s_waitcnt lgkmcnt(4)
buffer_store_dwordx4 v[68:71], v250, s[36:39], s58 offen sc1
ds_read_b128 v[84:87], v231 offset:25664
v_mfma_f32_32x32x16_bf16 v[160:175], a[40:43], a[228:231], v[160:175]
ds_read_b128 a[220:223], v241 offset:4096
ds_read_b128 a[224:227], v242 offset:4096
v_exp_f32_e64 v39, v39
v_cvt_pk_bf16_f32 v34, v36, v37
v_cvt_pk_bf16_f32 v35, v38, v39
v_mfma_f32_32x32x16_bf16 v[176:191], a[44:47], a[228:231], v[176:191]
ds_read_b128 a[228:231], v243 offset:4096
v_fma_f32 v40, v40, s70, v228
v_fma_f32 v41, v41, s70, v228
v_fma_f32 v42, v42, s70, v228
v_fma_f32 v43, v43, s70, v228
v_fma_f32 v44, v44, s70, v228
v_mfma_f32_32x32x16_bf16 v[144:159], a[48:51], a[232:235], v[144:159]
v_fma_f32 v45, v45, s70, v228
v_fma_f32 v46, v46, s70, v228
v_fma_f32 v47, v47, s70, v228
v_exp_f32_e64 v40, v40
v_sub_f32_e32 v229, v254, v224
v_mfma_f32_32x32x16_bf16 v[160:175], a[52:55], a[232:235], v[160:175]
s_waitcnt lgkmcnt(4)
buffer_store_dwordx4 v[76:79], v250, s[36:39], s76 offen sc1
v_fma_f32 v48, v48, s70, v229
v_mfma_f32_32x32x16_bf16 v[176:191], a[56:59], a[232:235], v[176:191]
ds_read_b128 a[232:235], v240 offset:12288
v_exp_f32_e32 v41, v41
v_exp_f32_e32 v42, v42
v_cvt_pk_bf16_f32 v36, v40, v41
v_mfma_f32_32x32x16_bf16 v[144:159], a[60:63], a[236:239], v[144:159]
v_exp_f32_e32 v43, v43
v_exp_f32_e32 v44, v44
v_exp_f32_e64 v45, v45
v_mfma_f32_32x32x16_bf16 v[160:175], a[64:67], a[236:239], v[160:175]
v_exp_f32_e64 v46, v46
v_exp_f32_e32 v47, v47
v_cvt_pk_bf16_f32 v37, v42, v43
v_cvt_pk_bf16_f32 v38, v44, v45
v_mfma_f32_32x32x16_bf16 v[176:191], a[68:71], a[236:239], v[176:191]
s_waitcnt lgkmcnt(1)
buffer_store_dwordx4 v[84:87], v250, s[36:39], s58 offen offset:64 sc1
ds_read_b128 a[236:239], v241 offset:12288
v_mfma_f32_32x32x16_bf16 v[144:159], a[72:75], a[240:243], v[144:159]
v_cvt_pk_bf16_f32 v39, v46, v47
v_fma_f32 v49, v49, s70, v229
v_fma_f32 v50, v50, s70, v229
v_fma_f32 v51, v51, s70, v229
v_fma_f32 v52, v52, s70, v229
v_fma_f32 v53, v53, s70, v229
v_mfma_f32_32x32x16_bf16 v[160:175], a[76:79], a[240:243], v[160:175]
v_fma_f32 v54, v54, s70, v229
v_fma_f32 v55, v55, s70, v229
v_exp_f32_e32 v48, v48
v_exp_f32_e32 v49, v49
v_mfma_f32_32x32x16_bf16 v[176:191], a[80:83], a[240:243], v[176:191]
ds_read_b128 a[240:243], v242 offset:12288
v_exp_f32_e32 v50, v50
v_exp_f32_e32 v51, v51
v_cvt_pk_bf16_f32 v40, v48, v49
v_mfma_f32_32x32x16_bf16 v[144:159], a[84:87], a[244:247], v[144:159]
v_exp_f32_e32 v52, v52
v_exp_f32_e32 v53, v53
v_exp_f32_e64 v54, v54
v_mfma_f32_32x32x16_bf16 v[160:175], a[88:91], a[244:247], v[160:175]
v_exp_f32_e64 v55, v55
v_cvt_pk_bf16_f32 v41, v50, v51
v_cvt_pk_bf16_f32 v42, v52, v53
v_cvt_pk_bf16_f32 v43, v54, v55
v_fma_f32 v56, v56, s70, v229
v_mfma_f32_32x32x16_bf16 v[176:191], a[92:95], a[244:247], v[176:191]
ds_read_b128 a[244:247], v243 offset:12288
v_fma_f32 v57, v57, s70, v229
v_fma_f32 v58, v58, s70, v229
v_fma_f32 v59, v59, s70, v229
v_fma_f32 v60, v60, s70, v229
v_fma_f32 v61, v61, s70, v229
v_mfma_f32_32x32x16_bf16 v[144:159], a[96:99], a[248:251], v[144:159]
v_fma_f32 v62, v62, s70, v229
v_fma_f32 v63, v63, s70, v229
v_exp_f32_e32 v56, v56
v_exp_f32_e32 v57, v57
v_mfma_f32_32x32x16_bf16 v[160:175], a[100:103], a[248:251], v[160:175]
v_exp_f32_e32 v58, v58
v_exp_f32_e32 v59, v59
v_exp_f32_e64 v60, v60
v_mfma_f32_32x32x16_bf16 v[176:191], a[104:107], a[248:251], v[176:191]
ds_read_b128 a[248:251], v244
v_exp_f32_e32 v61, v61
v_exp_f32_e32 v62, v62
v_cvt_pk_bf16_f32 v44, v56, v57
v_mfma_f32_32x32x16_bf16 v[144:159], a[108:111], a[252:255], v[144:159]
v_exp_f32_e64 v63, v63
v_cvt_pk_bf16_f32 v45, v58, v59
v_cvt_pk_bf16_f32 v46, v60, v61
v_cvt_pk_bf16_f32 v47, v62, v63
v_cvt_pk_bf16_f32 v96, v96, v97
v_mfma_f32_32x32x16_bf16 v[160:175], a[112:115], a[252:255], v[160:175]
ds_read_b128 v[92:95], v231 offset:32064
ds_read_b128 v[48:51], v248 offset:768
ds_read_b128 v[52:55], v248 offset:960
v_cvt_pk_bf16_f32 v104, v104, v105
v_cvt_pk_bf16_f32 v97, v98, v99
v_cvt_pk_bf16_f32 v105, v106, v107
v_mfma_f32_32x32x16_bf16 v[176:191], a[116:119], a[252:255], v[176:191]
ds_read_b128 a[252:255], v245
ds_read_b128 v[56:59], v248 offset:1152
v_cvt_pk_bf16_f32 v98, v100, v101
v_cvt_pk_bf16_f32 v99, v102, v103
v_cvt_pk_bf16_f32 v106, v108, v109
v_cvt_pk_bf16_f32 v107, v110, v111
v_mfma_f32_32x32x16_bf16 v[144:159], a[120:123], v[232:235], v[144:159]
ds_write_b128 v230, v[96:99] offset:25728
v_mul_f32_e64 v254, s64, v253
v_mfma_f32_32x32x16_bf16 v[160:175], a[124:127], v[232:235], v[160:175]
v_min_f32_e64 v255, s68, v254
ds_read_b128 v[60:63], v248 offset:1344
v_mfma_f32_32x32x16_bf16 v[176:191], a[128:131], v[232:235], v[176:191]
ds_read_b128 v[232:235], v244 offset:8192
ds_write_b128 v230, v[104:107] offset:25760
v_mfma_f32_32x32x16_bf16 v[144:159], a[132:135], v[236:239], v[144:159]
s_waitcnt lgkmcnt(7)
buffer_store_dwordx4 v[92:95], v250, s[36:39], s76 offen offset:64 sc1
s_nop 0
v_mfma_f32_32x32x16_bf16 v[160:175], a[136:139], v[236:239], v[160:175]
ds_read_b128 v[100:103], v231 offset:25728
ds_read_b128 v[108:111], v231 offset:32128
s_nop 2
v_mfma_f32_32x32x16_bf16 v[176:191], a[140:143], v[236:239], v[176:191]
ds_read_b128 v[236:239], v245 offset:8192
s_nop 1
v_cvt_pk_bf16_f32 v64, v144, v145
v_cvt_pk_bf16_f32 v65, v146, v147
v_cvt_pk_bf16_f32 v66, v148, v149
v_mfma_f32_32x32x16_bf16 v[208:223], v[116:119], v[0:3], 0
v_cvt_pk_bf16_f32 v67, v150, v151
v_cvt_pk_bf16_f32 v68, v152, v153
v_cvt_pk_bf16_f32 v69, v154, v155
v_cvt_pk_bf16_f32 v70, v156, v157
v_cvt_pk_bf16_f32 v71, v158, v159
v_cvt_pk_bf16_f32 v72, v160, v161
v_mfma_f32_32x32x16_bf16 v[192:207], v[112:115], v[0:3], 0
v_cvt_pk_bf16_f32 v73, v162, v163
v_cvt_pk_bf16_f32 v74, v164, v165
v_cvt_pk_bf16_f32 v75, v166, v167
v_cvt_pk_bf16_f32 v76, v168, v169
v_cvt_pk_bf16_f32 v77, v170, v171
v_cvt_pk_bf16_f32 v78, v172, v173
v_mfma_f32_32x32x16_bf16 v[208:223], v[124:127], v[4:7], v[208:223]
v_cvt_pk_bf16_f32 v79, v174, v175
v_cvt_pk_bf16_f32 v80, v176, v177
v_cvt_pk_bf16_f32 v81, v178, v179
v_cvt_pk_bf16_f32 v82, v180, v181
v_cvt_pk_bf16_f32 v83, v182, v183
v_cvt_pk_bf16_f32 v84, v184, v185
v_mfma_f32_32x32x16_bf16 v[192:207], v[120:123], v[4:7], v[192:207]
v_cvt_pk_bf16_f32 v85, v186, v187
v_cvt_pk_bf16_f32 v86, v188, v189
v_cvt_pk_bf16_f32 v87, v190, v191
v_mfma_f32_32x32x16_bf16 v[208:223], v[132:135], v[8:11], v[208:223]
s_waitcnt lgkmcnt(0)
buffer_store_dwordx4 v[100:103], v250, s[36:39], s58 offen offset:128 sc1
v_mfma_f32_32x32x16_bf16 v[192:207], v[128:131], v[8:11], v[192:207]
s_nop 0
v_mfma_f32_32x32x16_bf16 v[208:223], v[140:143], v[12:15], v[208:223]
s_nop 6
v_mfma_f32_32x32x16_bf16 v[192:207], v[136:139], v[12:15], v[192:207]
s_nop 2
v_mfma_f32_32x32x16_bf16 v[144:159], a[0:3], a[216:219], 0
v_rcp_f32_e64 v217, v216
ds_read_b64_tr_b16 a[0:1], v249
v_mul_f32_e64 v208, v217, v208
v_mfma_f32_32x32x16_bf16 v[160:175], a[4:7], a[216:219], 0
v_mul_f32_e32 v209, v217, v209
v_mul_f32_e32 v210, v217, v210
v_mul_f32_e64 v211, v217, v211
v_cvt_pk_bf16_f32 v208, v208, v209
v_mul_f32_e32 v192, v217, v192
v_mul_f32_e32 v193, v217, v193
v_mfma_f32_32x32x16_bf16 v[176:191], a[8:11], a[216:219], 0
ds_read_b128 a[216:219], v244 offset:16384
v_mul_f32_e32 v194, v217, v194
v_mul_f32_e32 v195, v217, v195
v_cvt_pk_bf16_f32 v192, v192, v193
v_mul_f32_e32 v196, v217, v196
v_mul_f32_e32 v197, v217, v197
v_mfma_f32_32x32x16_bf16 v[144:159], a[12:15], a[220:223], v[144:159]
v_mul_f32_e32 v198, v217, v198
v_mul_f32_e32 v199, v217, v199
v_cvt_pk_bf16_f32 v193, v194, v195
v_cvt_pk_bf16_f32 v194, v196, v197
v_cvt_pk_bf16_f32 v195, v198, v199
v_mul_f32_e64 v200, v217, v200
v_mfma_f32_32x32x16_bf16 v[160:175], a[16:19], a[220:223], v[160:175]
ds_write_b128 v247, v[192:195] offset:51200
v_mul_f32_e64 v201, v217, v201
v_mfma_f32_32x32x16_bf16 v[176:191], a[20:23], a[220:223], v[176:191]
v_mul_f32_e32 v202, v217, v202
v_mul_f32_e32 v203, v217, v203
v_cvt_pk_bf16_f32 v200, v200, v201
v_mul_f32_e32 v204, v217, v204
v_mul_f32_e32 v205, v217, v205
v_mul_f32_e64 v206, v217, v206
v_mfma_f32_32x32x16_bf16 v[144:159], a[24:27], a[224:227], v[144:159]
ds_read_b128 a[220:223], v245 offset:16384
v_mul_f32_e64 v207, v217, v207
v_cvt_pk_bf16_f32 v201, v202, v203
v_cvt_pk_bf16_f32 v202, v204, v205
v_cvt_pk_bf16_f32 v203, v206, v207
v_mul_f32_e64 v212, v217, v212
v_mfma_f32_32x32x16_bf16 v[160:175], a[28:31], a[224:227], v[160:175]
ds_write_b128 v247, v[200:203] offset:51232
v_mul_f32_e64 v213, v217, v213
v_mfma_f32_32x32x16_bf16 v[176:191], a[32:35], a[224:227], v[176:191]
v_mul_f32_e32 v214, v217, v214
v_mul_f32_e32 v215, v217, v215
v_cvt_pk_bf16_f32 v209, v210, v211
v_cvt_pk_bf16_f32 v210, v212, v213
v_cvt_pk_bf16_f32 v211, v214, v215
v_mfma_f32_32x32x16_bf16 v[144:159], a[36:39], a[228:231], v[144:159]
ds_read_b128 a[224:227], v240 offset:20480
ds_write_b128 v247, v[208:211] offset:51264
v_mfma_f32_32x32x16_bf16 v[160:175], a[40:43], a[228:231], v[160:175]
buffer_store_dwordx4 v[108:111], v250, s[36:39], s76 offen offset:128 sc1
ds_read_b64_tr_b16 a[2:3], v249 offset:1536
v_mfma_f32_32x32x16_bf16 v[176:191], a[44:47], a[228:231], v[176:191]
s_add_u32 s76, s60, 0x2a000
ds_read_b128 a[228:231], v241 offset:20480
ds_read_b64_tr_b16 a[4:5], v249 offset:64
ds_read_b64_tr_b16 a[6:7], v249 offset:1600
ds_read_b64_tr_b16 a[8:9], v249 offset:128
v_mfma_f32_32x32x16_bf16 v[144:159], a[48:51], a[232:235], v[144:159]
ds_read_b64_tr_b16 a[10:11], v249 offset:1664
ds_read_b64_tr_b16 a[12:13], v249 offset:3072
ds_read_b64_tr_b16 a[14:15], v249 offset:4608
ds_read_b64_tr_b16 a[16:17], v249 offset:3136
v_mfma_f32_32x32x16_bf16 v[160:175], a[52:55], a[232:235], v[160:175]
ds_read_b64_tr_b16 a[18:19], v249 offset:4672
ds_read_b64_tr_b16 a[20:21], v249 offset:3200
ds_read_b64_tr_b16 a[22:23], v249 offset:4736
v_mfma_f32_32x32x16_bf16 v[176:191], a[56:59], a[232:235], v[176:191]
ds_read_b128 a[232:235], v244 offset:2048
ds_read_b64_tr_b16 a[24:25], v249 offset:6144
ds_read_b64_tr_b16 a[26:27], v249 offset:7680
v_mfma_f32_32x32x16_bf16 v[144:159], a[60:63], a[236:239], v[144:159]
ds_read_b64_tr_b16 a[28:29], v249 offset:6208
ds_read_b64_tr_b16 a[30:31], v249 offset:7744
v_mfma_f32_32x32x16_bf16 v[160:175], a[64:67], a[236:239], v[160:175]
ds_read_b64_tr_b16 a[32:33], v249 offset:6272
ds_read_b64_tr_b16 a[34:35], v249 offset:7808
ds_read_b64_tr_b16 a[36:37], v249 offset:9216
ds_read_b64_tr_b16 a[38:39], v249 offset:10752
v_mfma_f32_32x32x16_bf16 v[176:191], a[68:71], a[236:239], v[176:191]
ds_read_b128 a[236:239], v245 offset:2048
ds_read_b64_tr_b16 a[40:41], v249 offset:9280
ds_read_b64_tr_b16 a[42:43], v249 offset:10816
v_mfma_f32_32x32x16_bf16 v[16:31], v[116:119], v[32:35], 0
ds_read_b64_tr_b16 a[44:45], v249 offset:9344
ds_read_b64_tr_b16 a[46:47], v249 offset:10880
ds_read_b64_tr_b16 a[48:49], v249 offset:12288
v_mov_b32_e32 v118, s19
v_mov_b32_e32 v119, s19
v_mfma_f32_32x32x16_bf16 v[0:15], v[112:115], v[32:35], 0
ds_read_b128 v[32:35], v248
ds_read_b64_tr_b16 a[50:51], v249 offset:13824
ds_read_b64_tr_b16 a[52:53], v249 offset:12352
ds_read_b64_tr_b16 a[54:55], v249 offset:13888
v_mfma_f32_32x32x16_bf16 v[16:31], v[124:127], v[36:39], v[16:31]
ds_read_b64_tr_b16 a[56:57], v249 offset:12416
ds_read_b64_tr_b16 a[58:59], v249 offset:13952
v_mov_b32_e32 v126, s19
v_mov_b32_e32 v127, s19
v_mfma_f32_32x32x16_bf16 v[0:15], v[120:123], v[36:39], v[0:15]
ds_read_b128 v[36:39], v248 offset:192
ds_read_b64_tr_b16 a[60:61], v249 offset:15360
ds_read_b64_tr_b16 a[62:63], v249 offset:16896
ds_read_b64_tr_b16 a[64:65], v249 offset:15424
v_mfma_f32_32x32x16_bf16 v[16:31], v[132:135], v[40:43], v[16:31]
ds_read_b64_tr_b16 a[66:67], v249 offset:16960
ds_read_b64_tr_b16 a[68:69], v249 offset:15488
v_mov_b32_e32 v134, s19
v_mov_b32_e32 v135, s19
v_mfma_f32_32x32x16_bf16 v[0:15], v[128:131], v[40:43], v[0:15]
ds_read_b128 v[40:43], v248 offset:384
ds_read_b64_tr_b16 a[70:71], v249 offset:17024
v_mfma_f32_32x32x16_bf16 v[16:31], v[140:143], v[44:47], v[16:31]
v_mov_b32_e64 v142, s19
v_mov_b32_e32 v143, s19
s_nop 3
v_mfma_f32_32x32x16_bf16 v[0:15], v[136:139], v[44:47], v[0:15]
s_nop 0
ds_read_b128 v[44:47], v248 offset:576
s_nop 2
v_mfma_f32_32x32x16_bf16 v[144:159], a[72:75], a[240:243], v[144:159]
ds_read_b128 v[28:31], v248 offset:2112
v_rcp_f32_e64 v25, v24
ds_read_b64_tr_b16 a[72:73], v249 offset:18432
v_mfma_f32_32x32x16_bf16 v[160:175], a[76:79], a[240:243], v[160:175]
v_mul_f32_e32 v16, v25, v16
v_mul_f32_e32 v17, v25, v17
v_mul_f32_e32 v18, v25, v18
v_mul_f32_e32 v0, v25, v0
v_mul_f32_e32 v1, v25, v1
v_mul_f32_e32 v8, v25, v8
v_mfma_f32_32x32x16_bf16 v[176:191], a[80:83], a[240:243], v[176:191]
ds_read_b128 a[240:243], v244 offset:10240
v_mul_f32_e32 v9, v25, v9
v_mul_f32_e32 v2, v25, v2
v_mul_f32_e64 v3, v25, v3
v_cvt_pk_bf16_f32 v0, v0, v1
v_mul_f32_e64 v10, v25, v10
v_mfma_f32_32x32x16_bf16 v[144:159], a[84:87], a[244:247], v[144:159]
v_mul_f32_e64 v11, v25, v11
v_cvt_pk_bf16_f32 v8, v8, v9
v_mul_f32_e32 v4, v25, v4
v_mul_f32_e32 v5, v25, v5
v_mul_f32_e32 v6, v25, v6
v_mul_f32_e32 v7, v25, v7
v_mfma_f32_32x32x16_bf16 v[160:175], a[88:91], a[244:247], v[160:175]
v_cvt_pk_bf16_f32 v1, v2, v3
v_mul_f32_e32 v12, v25, v12
v_mul_f32_e32 v13, v25, v13
v_mul_f32_e32 v14, v25, v14
v_mul_f32_e32 v15, v25, v15
v_cvt_pk_bf16_f32 v9, v10, v11
v_mfma_f32_32x32x16_bf16 v[176:191], a[92:95], a[244:247], v[176:191]
ds_read_b128 a[244:247], v245 offset:10240
v_cvt_pk_bf16_f32 v2, v4, v5
v_cvt_pk_bf16_f32 v3, v6, v7
v_cvt_pk_bf16_f32 v10, v12, v13
v_cvt_pk_bf16_f32 v11, v14, v15
v_mul_f32_e64 v19, v25, v19
v_mfma_f32_16x16x32_bf16 v[192:195], a[248:251], a[144:147], 0
ds_read_b128 v[4:7], v248 offset:960
ds_read_b128 v[12:15], v248 offset:1344
v_mfma_f32_16x16x32_bf16 v[196:199], a[248:251], a[148:151], 0
v_cvt_pk_bf16_f32 v16, v16, v17
v_mul_f32_e64 v20, v25, v20
v_mfma_f32_16x16x32_bf16 v[200:203], a[248:251], a[152:155], 0
ds_read_b128 a[248:251], v244 offset:18432
v_mul_f32_e64 v21, v25, v21
v_mfma_f32_16x16x32_bf16 v[192:195], a[252:255], a[156:159], v[192:195]
v_mul_f32_e32 v22, v25, v22
v_mul_f32_e32 v23, v25, v23
v_mfma_f32_16x16x32_bf16 v[196:199], a[252:255], a[160:163], v[196:199]
ds_read_b128 v[24:27], v248 offset:1920
v_cvt_pk_bf16_f32 v17, v18, v19
v_mfma_f32_16x16x32_bf16 v[200:203], a[252:255], a[164:167], v[200:203]
ds_read_b128 a[252:255], v245 offset:18432
v_cvt_pk_bf16_f32 v18, v20, v21
v_mfma_f32_16x16x32_bf16 v[192:195], v[232:235], a[168:171], v[192:195]
v_cvt_pk_bf16_f32 v19, v22, v23
v_mfma_f32_16x16x32_bf16 v[196:199], v[232:235], a[172:175], v[196:199]
ds_read_b128 v[20:23], v248 offset:1728
ds_read_b64_tr_b16 a[74:75], v249 offset:19968
v_mfma_f32_16x16x32_bf16 v[200:203], v[232:235], a[176:179], v[200:203]
ds_read_b128 v[232:235], v242 offset:20480
ds_read_b64_tr_b16 a[76:77], v249 offset:18496
v_mfma_f32_16x16x32_bf16 v[192:195], v[236:239], a[180:183], v[192:195]
ds_read_b64_tr_b16 a[78:79], v249 offset:20032
ds_read_b64_tr_b16 a[80:81], v249 offset:18560
v_mfma_f32_16x16x32_bf16 v[196:199], v[236:239], a[184:187], v[196:199]
ds_read_b64_tr_b16 a[82:83], v249 offset:20096
ds_read_b64_tr_b16 a[84:85], v249 offset:21504
v_mfma_f32_16x16x32_bf16 v[200:203], v[236:239], a[188:191], v[200:203]
s_waitcnt lgkmcnt(10)
ds_read_b128 v[236:239], v243 offset:20480
v_mfma_f32_16x16x32_bf16 v[192:195], a[216:219], a[192:195], v[192:195]
s_nop 0
ds_read_b64_tr_b16 a[86:87], v249 offset:23040
ds_read_b64_tr_b16 a[88:89], v249 offset:21568
v_mfma_f32_16x16x32_bf16 v[196:199], a[216:219], a[196:199], v[196:199]
ds_read_b64_tr_b16 a[90:91], v249 offset:23104
ds_read_b64_tr_b16 a[92:93], v249 offset:21632
v_mfma_f32_16x16x32_bf16 v[200:203], a[216:219], a[200:203], v[200:203]
ds_read_b128 a[216:219], v244 offset:4096
v_mfma_f32_16x16x32_bf16 v[192:195], a[220:223], a[204:207], v[192:195]
ds_read_b64_tr_b16 a[94:95], v249 offset:23168
s_nop 0
v_mfma_f32_16x16x32_bf16 v[196:199], a[220:223], a[208:211], v[196:199]
s_nop 2
v_mfma_f32_16x16x32_bf16 v[200:203], a[220:223], a[212:215], v[200:203]
ds_read_b128 a[220:223], v245 offset:4096
v_cvt_pk_bf16_f32 v112, v192, v193
v_mfma_f32_32x32x16_bf16 v[144:159], a[96:99], a[224:227], v[144:159]
v_cvt_pk_bf16_f32 v113, v194, v195
v_cvt_pk_bf16_f32 v114, v196, v197
v_cvt_pk_bf16_f32 v115, v198, v199
ds_read_b64_tr_b16 a[96:97], v249 offset:24576
v_mfma_f32_32x32x16_bf16 v[160:175], a[100:103], a[224:227], v[160:175]
ds_write_b128 v247, v[0:3] offset:64000
v_cvt_pk_bf16_f32 v116, v200, v201
v_mfma_f32_32x32x16_bf16 v[176:191], a[104:107], a[224:227], v[176:191]
v_cvt_pk_bf16_f32 v117, v202, v203
v_permlane16_swap_b32_e32 v116, v118
v_permlane16_swap_b32_e32 v112, v114
v_mfma_f32_32x32x16_bf16 v[144:159], a[108:111], a[228:231], v[144:159]
ds_read_b128 a[224:227], v244 offset:12288
ds_write_b128 v247, v[8:11] offset:64032
v_mfma_f32_32x32x16_bf16 v[160:175], a[112:115], a[228:231], v[160:175]
v_permlane16_swap_b32_e32 v117, v119
v_permlane16_swap_b32_e32 v113, v115
v_mfma_f32_32x32x16_bf16 v[176:191], a[116:119], a[228:231], v[176:191]
ds_read_b128 a[228:231], v245 offset:12288
ds_read_b128 v[0:3], v248 offset:768
ds_read_b128 v[8:11], v248 offset:1152
ds_read_b64_tr_b16 a[98:99], v249 offset:26112
v_mfma_f32_16x16x32_bf16 v[204:207], a[232:235], a[144:147], 0
ds_read_b64_tr_b16 a[100:101], v249 offset:24640
v_mfma_f32_16x16x32_bf16 v[208:211], a[232:235], a[148:151], 0
ds_read_b64_tr_b16 a[102:103], v249 offset:26176
ds_read_b64_tr_b16 a[104:105], v249 offset:24704
v_mfma_f32_16x16x32_bf16 v[212:215], a[232:235], a[152:155], 0
ds_read_b128 a[232:235], v244 offset:20480
v_mfma_f32_16x16x32_bf16 v[204:207], a[236:239], a[156:159], v[204:207]
ds_read_b64_tr_b16 a[106:107], v249 offset:26240
ds_read_b64_tr_b16 a[108:109], v249 offset:27648
v_mfma_f32_16x16x32_bf16 v[208:211], a[236:239], a[160:163], v[208:211]
ds_read_b64_tr_b16 a[110:111], v249 offset:29184
ds_read_b64_tr_b16 a[112:113], v249 offset:27712
v_mfma_f32_16x16x32_bf16 v[212:215], a[236:239], a[164:167], v[212:215]
ds_read_b128 a[236:239], v245 offset:20480
v_mfma_f32_16x16x32_bf16 v[204:207], a[240:243], a[168:171], v[204:207]
ds_read_b64_tr_b16 a[114:115], v249 offset:29248
v_mfma_f32_16x16x32_bf16 v[208:211], a[240:243], a[172:175], v[208:211]
ds_read_b64_tr_b16 a[116:117], v249 offset:27776
ds_read_b64_tr_b16 a[118:119], v249 offset:29312
v_mfma_f32_16x16x32_bf16 v[212:215], a[240:243], a[176:179], v[212:215]
ds_read_b128 a[240:243], v244 offset:6144
v_mfma_f32_16x16x32_bf16 v[204:207], a[244:247], a[180:183], v[204:207]
v_mfma_f32_16x16x32_bf16 v[208:211], a[244:247], a[184:187], v[208:211]
v_mfma_f32_16x16x32_bf16 v[212:215], a[244:247], a[188:191], v[212:215]
ds_read_b128 a[244:247], v245 offset:6144
v_mfma_f32_16x16x32_bf16 v[204:207], a[248:251], a[192:195], v[204:207]
v_mfma_f32_16x16x32_bf16 v[208:211], a[248:251], a[196:199], v[208:211]
s_nop 0
v_mfma_f32_16x16x32_bf16 v[212:215], a[248:251], a[200:203], v[212:215]
s_waitcnt lgkmcnt(7)
ds_read_b128 a[248:251], v244 offset:14336
v_mfma_f32_16x16x32_bf16 v[204:207], a[252:255], a[204:207], v[204:207]
s_nop 2
v_mfma_f32_16x16x32_bf16 v[208:211], a[252:255], a[208:211], v[208:211]
s_nop 2
v_mfma_f32_16x16x32_bf16 v[212:215], a[252:255], a[212:215], v[212:215]
ds_read_b128 a[252:255], v245 offset:14336
v_cvt_pk_bf16_f32 v120, v204, v205
v_mfma_f32_32x32x16_bf16 v[144:159], a[120:123], v[232:235], v[144:159]
ds_write_b128 v247, v[16:19] offset:64064
v_cvt_pk_bf16_f32 v121, v206, v207
v_mfma_f32_32x32x16_bf16 v[160:175], a[124:127], v[232:235], v[160:175]
v_cvt_pk_bf16_f32 v122, v208, v209
v_cvt_pk_bf16_f32 v123, v210, v211
v_cvt_pk_bf16_f32 v124, v212, v213
v_cvt_pk_bf16_f32 v125, v214, v215
v_permlane16_swap_b32_e64 v120, v122
v_mfma_f32_32x32x16_bf16 v[176:191], a[128:131], v[232:235], v[176:191]
ds_read_b128 v[232:235], v244 offset:22528
ds_read_b128 v[16:19], v248 offset:1536
ds_read_b64_tr_b16 a[120:121], v249 offset:30720
ds_read_b64_tr_b16 a[122:123], v249 offset:32256
v_permlane16_swap_b32_e64 v124, v126
v_mfma_f32_32x32x16_bf16 v[144:159], a[132:135], v[236:239], v[144:159]
ds_read_b64_tr_b16 a[124:125], v249 offset:30784
ds_read_b64_tr_b16 a[126:127], v249 offset:32320
ds_read_b64_tr_b16 a[128:129], v249 offset:30848
v_permlane16_swap_b32_e32 v125, v127
s_nop 0
v_mfma_f32_32x32x16_bf16 v[160:175], a[136:139], v[236:239], v[160:175]
ds_read_b64_tr_b16 a[130:131], v249 offset:32384
ds_read_b64_tr_b16 a[132:133], v249 offset:33792
ds_read_b64_tr_b16 a[134:135], v249 offset:35328
ds_read_b64_tr_b16 a[136:137], v249 offset:33856
v_permlane16_swap_b32_e64 v121, v123
v_mfma_f32_32x32x16_bf16 v[176:191], a[140:143], v[236:239], v[176:191]
ds_read_b128 v[236:239], v245 offset:22528
v_cvt_pk_bf16_f32 v88, v144, v145
v_cvt_pk_bf16_f32 v89, v146, v147
v_cvt_pk_bf16_f32 v90, v148, v149
v_cvt_pk_bf16_f32 v91, v150, v151
v_cvt_pk_bf16_f32 v92, v152, v153
v_mfma_f32_16x16x32_bf16 v[192:195], a[216:219], a[144:147], 0
v_cvt_pk_bf16_f32 v100, v168, v169
v_cvt_pk_bf16_f32 v101, v170, v171
v_mfma_f32_16x16x32_bf16 v[196:199], a[216:219], a[148:151], 0
v_cvt_pk_bf16_f32 v102, v172, v173
v_cvt_pk_bf16_f32 v103, v174, v175
v_mfma_f32_16x16x32_bf16 v[200:203], a[216:219], a[152:155], 0
v_cvt_pk_bf16_f32 v104, v176, v177
v_cvt_pk_bf16_f32 v105, v178, v179
v_mfma_f32_16x16x32_bf16 v[192:195], a[220:223], a[156:159], v[192:195]
v_cvt_pk_bf16_f32 v106, v180, v181
v_cvt_pk_bf16_f32 v107, v182, v183
v_mfma_f32_16x16x32_bf16 v[196:199], a[220:223], a[160:163], v[196:199]
v_cvt_pk_bf16_f32 v108, v184, v185
v_cvt_pk_bf16_f32 v109, v186, v187
v_mfma_f32_16x16x32_bf16 v[200:203], a[220:223], a[164:167], v[200:203]
v_cvt_pk_bf16_f32 v110, v188, v189
v_cvt_pk_bf16_f32 v111, v190, v191
v_mfma_f32_16x16x32_bf16 v[192:195], a[224:227], a[168:171], v[192:195]
v_cvt_pk_bf16_f32 v93, v154, v155
v_cvt_pk_bf16_f32 v94, v156, v157
v_mfma_f32_16x16x32_bf16 v[196:199], a[224:227], a[172:175], v[196:199]
s_waitcnt lgkmcnt(0)
s_barrier
ds_read_b128 a[216:219], v246 offset:51200
ds_read_b128 a[220:223], v246 offset:51232
v_mfma_f32_16x16x32_bf16 v[200:203], a[224:227], a[176:179], v[200:203]
ds_read_b128 a[224:227], v246 offset:51264
v_cvt_pk_bf16_f32 v95, v158, v159
v_mfma_f32_16x16x32_bf16 v[192:195], a[228:231], a[180:183], v[192:195]
v_cvt_pk_bf16_f32 v96, v160, v161
v_cvt_pk_bf16_f32 v97, v162, v163
v_mfma_f32_16x16x32_bf16 v[196:199], a[228:231], a[184:187], v[196:199]
v_cvt_pk_bf16_f32 v98, v164, v165
v_cvt_pk_bf16_f32 v99, v166, v167
v_mfma_f32_16x16x32_bf16 v[200:203], a[228:231], a[188:191], v[200:203]
ds_read_b128 a[228:231], v246 offset:51296
ds_read_b64_tr_b16 a[138:139], v249 offset:35392
v_mfma_f32_16x16x32_bf16 v[192:195], a[232:235], a[192:195], v[192:195]
ds_read_b64_tr_b16 a[140:141], v249 offset:33920
ds_read_b64_tr_b16 a[142:143], v249 offset:35456
v_mfma_f32_16x16x32_bf16 v[196:199], a[232:235], a[196:199], v[196:199]
v_mfma_f32_16x16x32_bf16 v[200:203], a[232:235], a[200:203], v[200:203]
ds_read_b128 a[232:235], v246 offset:51328
v_mfma_f32_16x16x32_bf16 v[192:195], a[236:239], a[204:207], v[192:195]
s_nop 2
v_mfma_f32_16x16x32_bf16 v[196:199], a[236:239], a[208:211], v[196:199]
s_nop 2
v_mfma_f32_16x16x32_bf16 v[200:203], a[236:239], a[212:215], v[200:203]
ds_read_b128 a[236:239], v246 offset:51360
v_cvt_pk_bf16_f32 v128, v192, v193
v_mfma_f32_16x16x32_bf16 v[204:207], a[240:243], a[144:147], 0
v_cvt_pk_bf16_f32 v129, v194, v195
v_cvt_pk_bf16_f32 v130, v196, v197
v_mfma_f32_16x16x32_bf16 v[208:211], a[240:243], a[148:151], 0
v_cvt_pk_bf16_f32 v131, v198, v199
v_mfma_f32_16x16x32_bf16 v[212:215], a[240:243], a[152:155], 0
ds_read_b128 a[240:243], v246 offset:51392
v_cvt_pk_bf16_f32 v132, v200, v201
v_mfma_f32_16x16x32_bf16 v[204:207], a[244:247], a[156:159], v[204:207]
v_cvt_pk_bf16_f32 v133, v202, v203
s_nop 0
v_mfma_f32_16x16x32_bf16 v[208:211], a[244:247], a[160:163], v[208:211]
v_permlane16_swap_b32_e32 v132, v134
v_mfma_f32_16x16x32_bf16 v[212:215], a[244:247], a[164:167], v[212:215]
ds_read_b128 a[244:247], v246 offset:51424
v_mfma_f32_16x16x32_bf16 v[204:207], a[248:251], a[168:171], v[204:207]
v_permlane16_swap_b32_e64 v133, v135
v_mfma_f32_16x16x32_bf16 v[208:211], a[248:251], a[172:175], v[208:211]
v_permlane16_swap_b32_e64 v128, v130
v_mfma_f32_16x16x32_bf16 v[212:215], a[248:251], a[176:179], v[212:215]
ds_read_b128 a[248:251], v246 offset:51456
v_mfma_f32_16x16x32_bf16 v[204:207], a[252:255], a[180:183], v[204:207]
v_permlane16_swap_b32_e64 v129, v131
v_mfma_f32_16x16x32_bf16 v[208:211], a[252:255], a[184:187], v[208:211]
v_mfma_f32_16x16x32_bf16 v[212:215], a[252:255], a[188:191], v[212:215]
ds_read_b128 a[252:255], v246 offset:51488
v_mfma_f32_16x16x32_bf16 v[204:207], v[232:235], a[192:195], v[204:207]
v_mfma_f32_16x16x32_bf16 v[208:211], v[232:235], a[196:199], v[208:211]
v_mfma_f32_16x16x32_bf16 v[212:215], v[232:235], a[200:203], v[212:215]
ds_read_b128 v[232:235], v246 offset:51520
v_mfma_f32_16x16x32_bf16 v[204:207], v[236:239], a[204:207], v[204:207]
s_nop 2
v_mfma_f32_16x16x32_bf16 v[208:211], v[236:239], a[208:211], v[208:211]
s_nop 2
v_mfma_f32_16x16x32_bf16 v[212:215], v[236:239], a[212:215], v[212:215]
ds_read_b128 v[236:239], v246 offset:51552
v_cvt_pk_bf16_f32 v136, v204, v205
v_mfma_f32_32x32x16_bf16 v[0:15], v[76:79], v[64:67], v[0:15]
v_cvt_pk_bf16_f32 v137, v206, v207
v_cvt_pk_bf16_f32 v138, v208, v209
v_cvt_pk_bf16_f32 v139, v210, v211
s_nop 1
v_cvt_pk_bf16_f32 v140, v212, v213
v_mfma_f32_32x32x16_bf16 v[0:15], v[80:83], v[68:71], v[0:15]
s_nop 0
v_cvt_pk_bf16_f32 v141, v214, v215
v_permlane16_swap_b32_e32 v140, v142
v_permlane16_swap_b32_e32 v136, v138
v_mfma_f32_32x32x16_bf16 v[0:15], v[84:87], v[72:75], v[0:15]
v_permlane16_swap_b32_e32 v141, v143
v_permlane16_swap_b32_e32 v137, v139
s_nop 1
v_mfma_f32_32x32x16_bf16 v[16:31], v[100:103], v[64:67], v[16:31]
s_nop 5
v_mfma_f32_32x32x16_bf16 v[16:31], v[104:107], v[68:71], v[16:31]
v_max3_f32 v224, v0, v1, v2
v_max3_f32 v224, v224, v3, v4
v_max3_f32 v224, v224, v5, v6
v_max3_f32 v224, v224, v7, v8
v_max3_f32 v224, v224, v9, v10
v_max3_f32 v224, v224, v11, v12
v_mfma_f32_32x32x16_bf16 v[16:31], v[108:111], v[72:75], v[16:31]
v_max3_f32 v224, v224, v13, v14
v_max_f32_e64 v224, v224, v15
v_fma_f32 v224, v224, s70, v254
s_nop 2
v_mfma_f32_32x32x16_bf16 v[32:47], v[76:79], v[88:91], v[32:47]
s_nop 3
v_mfma_f32_32x32x16_bf16 v[32:47], v[80:83], v[92:95], v[32:47]
v_max3_f32 v225, v16, v17, v18
v_max3_f32 v225, v225, v19, v20
v_max3_f32 v225, v225, v21, v22
v_max3_f32 v225, v225, v23, v24
v_max3_f32 v225, v225, v25, v26
v_max3_f32 v225, v225, v27, v28
v_mfma_f32_32x32x16_bf16 v[32:47], v[84:87], v[96:99], v[32:47]
v_max3_f32 v225, v225, v29, v30
v_max_f32_e64 v225, v225, v31
v_fma_f32 v225, v225, s70, v255
v_max_f32_e64 v224, v224, v225
v_mov_b32_e32 v225, v224
s_nop 0
v_mfma_f32_32x32x16_bf16 v[48:63], v[100:103], v[88:91], v[48:63]
v_permlane32_swap_b32_e32 v224, v225
v_max_f32_e32 v224, v224, v225
v_sub_f32_e64 v226, v254, v224
v_fma_f32 v0, v0, s70, v226
v_fma_f32 v1, v1, s70, v226
v_mfma_f32_32x32x16_bf16 v[48:63], v[104:107], v[92:95], v[48:63]
v_exp_f32_e32 v0, v0
v_exp_f32_e32 v1, v1
v_fma_f32 v2, v2, s70, v226
v_fma_f32 v3, v3, s70, v226
v_mfma_f32_32x32x16_bf16 v[48:63], v[108:111], v[96:99], v[48:63]
s_waitcnt lgkmcnt(0)
v_exp_f32_e32 v2, v2
v_exp_f32_e64 v3, v3
v_fma_f32 v4, v4, s70, v226
v_fma_f32 v5, v5, s70, v226
v_mfma_f32_32x32x16_bf16 v[64:79], a[0:3], a[216:219], 0
v_fma_f32 v6, v6, s70, v226
v_fma_f32 v7, v7, s70, v226
v_exp_f32_e32 v4, v4
v_exp_f32_e32 v5, v5
v_mfma_f32_32x32x16_bf16 v[80:95], a[4:7], a[216:219], 0
v_exp_f32_e32 v6, v6
v_exp_f32_e32 v7, v7
v_cvt_pk_bf16_f32 v0, v0, v1
v_cvt_pk_bf16_f32 v1, v2, v3
v_mfma_f32_32x32x16_bf16 v[96:111], a[8:11], a[216:219], 0
v_cvt_pk_bf16_f32 v2, v4, v5
v_cvt_pk_bf16_f32 v3, v6, v7
v_fma_f32 v8, v8, s70, v226
v_fma_f32 v9, v9, s70, v226
v_fma_f32 v10, v10, s70, v226
v_fma_f32 v11, v11, s70, v226
v_mfma_f32_32x32x16_bf16 v[64:79], a[12:15], a[220:223], v[64:79]
v_fma_f32 v12, v12, s70, v226
v_fma_f32 v13, v13, s70, v226
v_fma_f32 v14, v14, s70, v226
v_fma_f32 v15, v15, s70, v226
v_sub_f32_e64 v227, v255, v224
v_max3_f32 v224, v32, v33, v34
v_mfma_f32_32x32x16_bf16 v[80:95], a[16:19], a[220:223], v[80:95]
v_exp_f32_e32 v8, v8
v_exp_f32_e32 v9, v9
v_exp_f32_e64 v10, v10
v_mfma_f32_32x32x16_bf16 v[96:111], a[20:23], a[220:223], v[96:111]
v_exp_f32_e32 v11, v11
v_exp_f32_e32 v12, v12
v_exp_f32_e64 v13, v13
v_mfma_f32_32x32x16_bf16 v[64:79], a[24:27], a[224:227], v[64:79]
v_exp_f32_e32 v14, v14
v_exp_f32_e32 v15, v15
v_max3_f32 v225, v48, v49, v50
v_max3_f32 v224, v224, v35, v36
v_mfma_f32_32x32x16_bf16 v[80:95], a[28:31], a[224:227], v[80:95]
v_max3_f32 v225, v225, v51, v52
v_cvt_pk_bf16_f32 v4, v8, v9
v_cvt_pk_bf16_f32 v5, v10, v11
v_cvt_pk_bf16_f32 v6, v12, v13
v_cvt_pk_bf16_f32 v7, v14, v15
v_max3_f32 v224, v224, v37, v38
v_mfma_f32_32x32x16_bf16 v[96:111], a[32:35], a[224:227], v[96:111]
v_max3_f32 v225, v225, v53, v54
v_max3_f32 v224, v224, v39, v40
v_max3_f32 v225, v225, v55, v56
v_max3_f32 v224, v224, v41, v42
v_max3_f32 v225, v225, v57, v58
v_max3_f32 v224, v224, v43, v44
v_mfma_f32_32x32x16_bf16 v[64:79], a[36:39], a[228:231], v[64:79]
v_max3_f32 v225, v225, v59, v60
v_max3_f32 v224, v224, v45, v46
v_max3_f32 v225, v225, v61, v62
v_max_f32_e32 v224, v224, v47
v_max_f32_e32 v225, v225, v63
v_fma_f32 v224, v224, s70, v255
v_mfma_f32_32x32x16_bf16 v[80:95], a[40:43], a[228:231], v[80:95]
v_fma_f32 v225, v225, s70, v254
v_max_f32_e32 v224, v224, v225
v_mov_b32_e32 v225, v224
v_fma_f32 v16, v16, s70, v227
v_fma_f32 v17, v17, s70, v227
v_fma_f32 v18, v18, s70, v227
v_mfma_f32_32x32x16_bf16 v[96:111], a[44:47], a[228:231], v[96:111]
v_permlane32_swap_b32_e64 v224, v225
v_fma_f32 v19, v19, s70, v227
v_fma_f32 v20, v20, s70, v227
v_fma_f32 v21, v21, s70, v227
v_fma_f32 v22, v22, s70, v227
v_mfma_f32_32x32x16_bf16 v[64:79], a[48:51], a[232:235], v[64:79]
v_fma_f32 v23, v23, s70, v227
v_max_f32_e32 v224, v224, v225
v_exp_f32_e32 v16, v16
v_exp_f32_e64 v17, v17
v_mfma_f32_32x32x16_bf16 v[80:95], a[52:55], a[232:235], v[80:95]
v_exp_f32_e32 v18, v18
v_exp_f32_e32 v19, v19
v_exp_f32_e64 v20, v20
v_mfma_f32_32x32x16_bf16 v[96:111], a[56:59], a[232:235], v[96:111]
v_exp_f32_e32 v21, v21
v_exp_f32_e32 v22, v22
v_exp_f32_e64 v23, v23
v_mfma_f32_32x32x16_bf16 v[64:79], a[60:63], a[236:239], v[64:79]
v_sub_f32_e64 v228, v255, v224
v_fma_f32 v24, v24, s70, v227
v_fma_f32 v25, v25, s70, v227
v_fma_f32 v26, v26, s70, v227
v_fma_f32 v27, v27, s70, v227
v_fma_f32 v28, v28, s70, v227
v_mfma_f32_32x32x16_bf16 v[80:95], a[64:67], a[236:239], v[80:95]
v_fma_f32 v29, v29, s70, v227
v_fma_f32 v30, v30, s70, v227
v_fma_f32 v31, v31, s70, v227
v_fma_f32 v32, v32, s70, v228
v_fma_f32 v33, v33, s70, v228
v_fma_f32 v34, v34, s70, v228
v_mfma_f32_32x32x16_bf16 v[96:111], a[68:71], a[236:239], v[96:111]
v_exp_f32_e32 v24, v24
v_exp_f32_e32 v25, v25
v_exp_f32_e64 v26, v26
v_mfma_f32_32x32x16_bf16 v[64:79], a[72:75], a[240:243], v[64:79]
v_exp_f32_e32 v27, v27
v_exp_f32_e32 v28, v28
v_exp_f32_e64 v29, v29
v_mfma_f32_32x32x16_bf16 v[80:95], a[76:79], a[240:243], v[80:95]
v_exp_f32_e32 v30, v30
v_exp_f32_e32 v31, v31
v_exp_f32_e64 v32, v32
v_mfma_f32_32x32x16_bf16 v[96:111], a[80:83], a[240:243], v[96:111]
v_exp_f32_e64 v33, v33
v_fma_f32 v35, v35, s70, v228
v_cvt_pk_bf16_f32 v8, v16, v17
v_cvt_pk_bf16_f32 v9, v18, v19
v_cvt_pk_bf16_f32 v10, v20, v21
v_mfma_f32_32x32x16_bf16 v[64:79], a[84:87], a[244:247], v[64:79]
v_cvt_pk_bf16_f32 v11, v22, v23
v_exp_f32_e32 v34, v34
v_exp_f32_e32 v35, v35
v_fma_f32 v36, v36, s70, v228
v_mfma_f32_32x32x16_bf16 v[80:95], a[88:91], a[244:247], v[80:95]
v_fma_f32 v37, v37, s70, v228
v_fma_f32 v38, v38, s70, v228
v_fma_f32 v39, v39, s70, v228
v_exp_f32_e64 v36, v36
v_cvt_pk_bf16_f32 v12, v24, v25
v_mfma_f32_32x32x16_bf16 v[96:111], a[92:95], a[244:247], v[96:111]
v_exp_f32_e32 v37, v37
v_exp_f32_e32 v38, v38
v_exp_f32_e64 v39, v39
v_mfma_f32_32x32x16_bf16 v[64:79], a[96:99], a[248:251], v[64:79]
v_cvt_pk_bf16_f32 v13, v26, v27
v_cvt_pk_bf16_f32 v14, v28, v29
v_cvt_pk_bf16_f32 v15, v30, v31
v_cvt_pk_bf16_f32 v32, v32, v33
v_fma_f32 v40, v40, s70, v228
v_fma_f32 v41, v41, s70, v228
v_mfma_f32_32x32x16_bf16 v[80:95], a[100:103], a[248:251], v[80:95]
v_fma_f32 v42, v42, s70, v228
v_fma_f32 v43, v43, s70, v228
v_fma_f32 v44, v44, s70, v228
v_fma_f32 v45, v45, s70, v228
v_fma_f32 v46, v46, s70, v228
v_fma_f32 v47, v47, s70, v228
v_mfma_f32_32x32x16_bf16 v[96:111], a[104:107], a[248:251], v[96:111]
v_sub_f32_e64 v229, v254, v224
v_cvt_pk_bf16_f32 v33, v34, v35
v_exp_f32_e32 v40, v40
v_exp_f32_e32 v41, v41
v_mfma_f32_32x32x16_bf16 v[64:79], a[108:111], a[252:255], v[64:79]
v_exp_f32_e32 v42, v42
v_exp_f32_e32 v43, v43
v_exp_f32_e64 v44, v44
v_mfma_f32_32x32x16_bf16 v[80:95], a[112:115], a[252:255], v[80:95]
v_exp_f32_e32 v45, v45
v_exp_f32_e32 v46, v46
v_exp_f32_e64 v47, v47
v_mfma_f32_32x32x16_bf16 v[96:111], a[116:119], a[252:255], v[96:111]
v_cvt_pk_bf16_f32 v34, v36, v37
v_cvt_pk_bf16_f32 v35, v38, v39
v_fma_f32 v48, v48, s70, v229
v_fma_f32 v49, v49, s70, v229
v_fma_f32 v50, v50, s70, v229
v_fma_f32 v51, v51, s70, v229
v_mfma_f32_32x32x16_bf16 v[64:79], a[120:123], v[232:235], v[64:79]
v_fma_f32 v52, v52, s70, v229
v_fma_f32 v53, v53, s70, v229
v_fma_f32 v54, v54, s70, v229
v_fma_f32 v55, v55, s70, v229
v_exp_f32_e64 v48, v48
v_mfma_f32_32x32x16_bf16 v[80:95], a[124:127], v[232:235], v[80:95]
v_exp_f32_e32 v49, v49
v_exp_f32_e32 v50, v50
v_exp_f32_e64 v51, v51
v_mfma_f32_32x32x16_bf16 v[96:111], a[128:131], v[232:235], v[96:111]
v_exp_f32_e32 v52, v52
v_exp_f32_e32 v53, v53
v_exp_f32_e64 v54, v54
v_mfma_f32_32x32x16_bf16 v[64:79], a[132:135], v[236:239], v[64:79]
v_exp_f32_e64 v55, v55
v_cvt_pk_bf16_f32 v36, v40, v41
v_cvt_pk_bf16_f32 v37, v42, v43
v_cvt_pk_bf16_f32 v38, v44, v45
v_cvt_pk_bf16_f32 v39, v46, v47
v_mfma_f32_32x32x16_bf16 v[80:95], a[136:139], v[236:239], v[80:95]
v_fma_f32 v56, v56, s70, v229
v_fma_f32 v57, v57, s70, v229
v_fma_f32 v58, v58, s70, v229
v_fma_f32 v59, v59, s70, v229
v_fma_f32 v60, v60, s70, v229
v_fma_f32 v61, v61, s70, v229
v_mfma_f32_32x32x16_bf16 v[96:111], a[140:143], v[236:239], v[96:111]
v_fma_f32 v62, v62, s70, v229
v_fma_f32 v63, v63, s70, v229
v_exp_f32_e32 v56, v56
v_exp_f32_e32 v57, v57
v_mfma_f32_32x32x16_bf16 v[208:223], v[116:119], v[0:3], 0
v_exp_f32_e32 v58, v58
v_exp_f32_e32 v59, v59
v_exp_f32_e64 v60, v60
v_mfma_f32_32x32x16_bf16 v[192:207], v[112:115], v[0:3], 0
v_exp_f32_e32 v61, v61
v_exp_f32_e32 v62, v62
v_exp_f32_e64 v63, v63
v_mfma_f32_32x32x16_bf16 v[208:223], v[124:127], v[4:7], v[208:223]
v_cvt_pk_bf16_f32 v40, v48, v49
v_cvt_pk_bf16_f32 v41, v50, v51
v_cvt_pk_bf16_f32 v42, v52, v53
v_cvt_pk_bf16_f32 v43, v54, v55
v_cvt_pk_bf16_f32 v44, v56, v57
v_cvt_pk_bf16_f32 v45, v58, v59
v_mfma_f32_32x32x16_bf16 v[192:207], v[120:123], v[4:7], v[192:207]
v_cvt_pk_bf16_f32 v46, v60, v61
v_cvt_pk_bf16_f32 v47, v62, v63
v_cvt_pk_bf16_f32 v64, v64, v65
v_cvt_pk_bf16_f32 v72, v72, v73
v_cvt_pk_bf16_f32 v65, v66, v67
v_cvt_pk_bf16_f32 v73, v74, v75
v_mfma_f32_32x32x16_bf16 v[208:223], v[132:135], v[8:11], v[208:223]
v_cvt_pk_bf16_f32 v66, v68, v69
v_cvt_pk_bf16_f32 v67, v70, v71
v_cvt_pk_bf16_f32 v74, v76, v77
v_cvt_pk_bf16_f32 v75, v78, v79
v_cvt_pk_bf16_f32 v80, v80, v81
v_cvt_pk_bf16_f32 v88, v88, v89
v_mfma_f32_32x32x16_bf16 v[192:207], v[128:131], v[8:11], v[192:207]
ds_write_b128 v230, v[64:67] offset:25600
v_cvt_pk_bf16_f32 v81, v82, v83
v_mfma_f32_32x32x16_bf16 v[208:223], v[140:143], v[12:15], v[208:223]
v_cvt_pk_bf16_f32 v89, v90, v91
v_cvt_pk_bf16_f32 v82, v84, v85
v_cvt_pk_bf16_f32 v83, v86, v87
v_cvt_pk_bf16_f32 v90, v92, v93
v_cvt_pk_bf16_f32 v91, v94, v95
v_cvt_pk_bf16_f32 v96, v96, v97
v_mfma_f32_32x32x16_bf16 v[192:207], v[136:139], v[12:15], v[192:207]
ds_write_b128 v230, v[72:75] offset:25632
v_cvt_pk_bf16_f32 v104, v104, v105
v_mfma_f32_32x32x16_bf16 v[16:31], v[116:119], v[32:35], 0
v_cvt_pk_bf16_f32 v97, v98, v99
v_cvt_pk_bf16_f32 v105, v106, v107
v_rcp_f32_e64 v217, v216
v_cvt_pk_bf16_f32 v98, v100, v101
v_mul_f32_e64 v208, v217, v208
v_mfma_f32_32x32x16_bf16 v[0:15], v[112:115], v[32:35], 0
ds_read_b128 v[68:71], v231 offset:25600
ds_read_b128 v[76:79], v231 offset:32000
v_mul_f32_e32 v209, v217, v209
v_mul_f32_e32 v192, v217, v192
v_mul_f32_e32 v193, v217, v193
v_mul_f32_e32 v200, v217, v200
v_mfma_f32_32x32x16_bf16 v[16:31], v[124:127], v[36:39], v[16:31]
ds_write_b128 v230, v[80:83] offset:25664
v_mul_f32_e64 v201, v217, v201
v_mfma_f32_32x32x16_bf16 v[0:15], v[120:123], v[36:39], v[0:15]
v_mul_f32_e32 v210, v217, v210
v_mul_f32_e32 v211, v217, v211
v_cvt_pk_bf16_f32 v208, v208, v209
v_mul_f32_e32 v194, v217, v194
v_mul_f32_e32 v195, v217, v195
v_cvt_pk_bf16_f32 v192, v192, v193
v_mfma_f32_32x32x16_bf16 v[16:31], v[132:135], v[40:43], v[16:31]
ds_write_b128 v230, v[88:91] offset:25696
v_mul_f32_e32 v202, v217, v202
v_mfma_f32_32x32x16_bf16 v[0:15], v[128:131], v[40:43], v[0:15]
s_waitcnt lgkmcnt(3)
buffer_store_dwordx4 v[68:71], v251, s[36:39], s59 offen sc1
ds_read_b128 v[84:87], v231 offset:25664
v_mfma_f32_32x32x16_bf16 v[16:31], v[140:143], v[44:47], v[16:31]
v_mul_f32_e64 v203, v217, v203
v_cvt_pk_bf16_f32 v200, v200, v201
v_mul_f32_e32 v212, v217, v212
v_mul_f32_e32 v213, v217, v213
v_mul_f32_e32 v214, v217, v214
v_mul_f32_e32 v215, v217, v215
v_mfma_f32_32x32x16_bf16 v[0:15], v[136:139], v[44:47], v[0:15]
v_cvt_pk_bf16_f32 v209, v210, v211
v_mul_f32_e32 v196, v217, v196
v_mul_f32_e32 v197, v217, v197
v_mul_f32_e32 v198, v217, v198
v_mul_f32_e32 v199, v217, v199
v_cvt_pk_bf16_f32 v193, v194, v195
v_rcp_f32_e32 v25, v24
v_mul_f32_e32 v204, v217, v204
v_mul_f32_e32 v16, v25, v16
v_mul_f32_e32 v17, v25, v17
v_mul_f32_e32 v18, v25, v18
v_mul_f32_e32 v19, v25, v19
v_cvt_pk_bf16_f32 v16, v16, v17
v_mul_f32_e32 v0, v25, v0
v_mul_f32_e32 v1, v25, v1
v_mul_f32_e32 v8, v25, v8
v_mul_f32_e32 v9, v25, v9
v_mul_f32_e32 v2, v25, v2
v_mul_f32_e32 v3, v25, v3
v_cvt_pk_bf16_f32 v0, v0, v1
v_mul_f32_e32 v10, v25, v10
v_mul_f32_e32 v11, v25, v11
v_cvt_pk_bf16_f32 v8, v8, v9
v_mul_f32_e32 v205, v217, v205
v_mul_f32_e32 v206, v217, v206
v_mul_f32_e64 v207, v217, v207
v_cvt_pk_bf16_f32 v201, v202, v203
v_mul_f32_e32 v20, v25, v20
v_mul_f32_e32 v21, v25, v21
v_mul_f32_e32 v22, v25, v22
v_mul_f32_e32 v23, v25, v23
v_cvt_pk_bf16_f32 v17, v18, v19
v_mul_f32_e32 v4, v25, v4
v_mul_f32_e32 v5, v25, v5
v_mul_f32_e32 v6, v25, v6
v_mul_f32_e32 v7, v25, v7
v_cvt_pk_bf16_f32 v1, v2, v3
v_mul_f32_e32 v12, v25, v12
v_mul_f32_e32 v13, v25, v13
v_mul_f32_e64 v14, v25, v14
v_mul_f32_e32 v15, v25, v15
v_cvt_pk_bf16_f32 v9, v10, v11
v_cvt_pk_bf16_f32 v210, v212, v213
v_cvt_pk_bf16_f32 v211, v214, v215
v_cvt_pk_bf16_f32 v194, v196, v197
v_cvt_pk_bf16_f32 v195, v198, v199
v_cvt_pk_bf16_f32 v202, v204, v205
v_cvt_pk_bf16_f32 v203, v206, v207
v_cvt_pk_bf16_f32 v18, v20, v21
v_cvt_pk_bf16_f32 v19, v22, v23
v_cvt_pk_bf16_f32 v2, v4, v5
v_cvt_pk_bf16_f32 v3, v6, v7
v_cvt_pk_bf16_f32 v10, v12, v13
v_cvt_pk_bf16_f32 v11, v14, v15
ds_write_b128 v247, v[208:211] offset:64
s_waitcnt lgkmcnt(1)
buffer_store_dwordx4 v[76:79], v251, s[36:39], s84 offen sc1
ds_write_b128 v247, v[192:195]
v_cvt_pk_bf16_f32 v99, v102, v103
v_cvt_pk_bf16_f32 v106, v108, v109
v_cvt_pk_bf16_f32 v107, v110, v111
ds_write_b128 v247, v[200:203] offset:32
ds_write_b128 v247, v[16:19] offset:12864
buffer_store_dwordx4 v[84:87], v251, s[36:39], s59 offen offset:64 sc1
ds_write_b128 v247, v[0:3] offset:12800
ds_write_b128 v247, v[8:11] offset:12832
ds_read_b128 v[92:95], v231 offset:32064
ds_write_b128 v230, v[96:99] offset:25728
ds_write_b128 v230, v[104:107] offset:25760
s_waitcnt lgkmcnt(3)
s_barrier
ds_read_b128 v[144:147], v246
ds_read_b128 v[148:151], v246 offset:32
ds_read_b128 v[152:155], v246 offset:64
ds_read_b128 v[156:159], v246 offset:96
ds_read_b128 v[160:163], v246 offset:128
ds_read_b128 v[164:167], v246 offset:160
ds_read_b128 v[168:171], v246 offset:192
ds_read_b128 v[172:175], v246 offset:224
ds_read_b128 v[176:179], v246 offset:256
s_waitcnt lgkmcnt(9)
buffer_store_dwordx4 v[92:95], v251, s[36:39], s84 offen offset:64 sc1
ds_read_b128 v[180:183], v246 offset:288
ds_read_b128 v[184:187], v246 offset:320
ds_read_b128 v[188:191], v246 offset:352
s_waitcnt lgkmcnt(9)
v_mfma_f32_32x32x16_bf16 v[64:79], a[0:3], v[144:147], 0
ds_read_b128 v[100:103], v231 offset:25728
ds_read_b128 v[108:111], v231 offset:32128
v_mfma_f32_32x32x16_bf16 v[64:79], a[12:15], v[148:151], v[64:79]
s_nop 0
v_mfma_f32_32x32x16_bf16 v[64:79], a[24:27], v[152:155], v[64:79]
s_waitcnt lgkmcnt(8)
v_mfma_f32_32x32x16_bf16 v[64:79], a[36:39], v[156:159], v[64:79]
v_mfma_f32_32x32x16_bf16 v[64:79], a[48:51], v[160:163], v[64:79]
s_nop 0
v_mfma_f32_32x32x16_bf16 v[64:79], a[60:63], v[164:167], v[64:79]
s_waitcnt lgkmcnt(1)
buffer_store_dwordx4 v[100:103], v251, s[36:39], s59 offen offset:128 sc1
v_mfma_f32_32x32x16_bf16 v[64:79], a[72:75], v[168:171], v[64:79]
v_mfma_f32_32x32x16_bf16 v[64:79], a[84:87], v[172:175], v[64:79]
v_mfma_f32_32x32x16_bf16 v[64:79], a[96:99], v[176:179], v[64:79]
s_nop 0
v_mfma_f32_32x32x16_bf16 v[64:79], a[108:111], v[180:183], v[64:79]
s_waitcnt lgkmcnt(0)
buffer_store_dwordx4 v[108:111], v251, s[36:39], s84 offen offset:128 sc1
v_mfma_f32_32x32x16_bf16 v[64:79], a[120:123], v[184:187], v[64:79]
v_mfma_f32_32x32x16_bf16 v[64:79], a[132:135], v[188:191], v[64:79]
s_nop 6
v_mfma_f32_32x32x16_bf16 v[80:95], a[4:7], v[144:147], 0
s_nop 2
v_mfma_f32_32x32x16_bf16 v[80:95], a[16:19], v[148:151], v[80:95]
v_cvt_pk_bf16_f32 v64, v64, v65
v_cvt_pk_bf16_f32 v72, v72, v73
v_cvt_pk_bf16_f32 v65, v66, v67
v_cvt_pk_bf16_f32 v73, v74, v75
v_cvt_pk_bf16_f32 v66, v68, v69
v_cvt_pk_bf16_f32 v67, v70, v71
v_mfma_f32_32x32x16_bf16 v[80:95], a[28:31], v[152:155], v[80:95]
ds_write_b128 v230, v[64:67] offset:25600
v_cvt_pk_bf16_f32 v74, v76, v77
v_mfma_f32_32x32x16_bf16 v[80:95], a[40:43], v[156:159], v[80:95]
v_cvt_pk_bf16_f32 v75, v78, v79
v_mfma_f32_32x32x16_bf16 v[80:95], a[52:55], v[160:163], v[80:95]
ds_write_b128 v230, v[72:75] offset:25632
v_mfma_f32_32x32x16_bf16 v[80:95], a[64:67], v[164:167], v[80:95]
ds_read_b128 v[68:71], v231 offset:25600
ds_read_b128 v[76:79], v231 offset:32000
v_mfma_f32_32x32x16_bf16 v[80:95], a[76:79], v[168:171], v[80:95]
v_mfma_f32_32x32x16_bf16 v[80:95], a[88:91], v[172:175], v[80:95]
v_mfma_f32_32x32x16_bf16 v[80:95], a[100:103], v[176:179], v[80:95]
s_nop 0
v_mfma_f32_32x32x16_bf16 v[80:95], a[112:115], v[180:183], v[80:95]
s_waitcnt lgkmcnt(1)
buffer_store_dwordx4 v[68:71], v252, s[36:39], s60 offen sc1
v_mfma_f32_32x32x16_bf16 v[80:95], a[124:127], v[184:187], v[80:95]
v_mfma_f32_32x32x16_bf16 v[80:95], a[136:139], v[188:191], v[80:95]
s_nop 6
v_mfma_f32_32x32x16_bf16 v[96:111], a[8:11], v[144:147], 0
s_nop 2
v_mfma_f32_32x32x16_bf16 v[96:111], a[20:23], v[148:151], v[96:111]
v_cvt_pk_bf16_f32 v80, v80, v81
v_cvt_pk_bf16_f32 v88, v88, v89
v_cvt_pk_bf16_f32 v81, v82, v83
v_cvt_pk_bf16_f32 v89, v90, v91
v_cvt_pk_bf16_f32 v82, v84, v85
v_cvt_pk_bf16_f32 v83, v86, v87
v_mfma_f32_32x32x16_bf16 v[96:111], a[32:35], v[152:155], v[96:111]
s_nop 0
ds_write_b128 v230, v[80:83] offset:25664
v_cvt_pk_bf16_f32 v90, v92, v93
v_mfma_f32_32x32x16_bf16 v[96:111], a[44:47], v[156:159], v[96:111]
s_waitcnt lgkmcnt(1)
buffer_store_dwordx4 v[76:79], v252, s[36:39], s76 offen sc1
v_cvt_pk_bf16_f32 v91, v94, v95
v_mfma_f32_32x32x16_bf16 v[96:111], a[56:59], v[160:163], v[96:111]
ds_write_b128 v230, v[88:91] offset:25696
v_mfma_f32_32x32x16_bf16 v[96:111], a[68:71], v[164:167], v[96:111]
ds_read_b128 v[84:87], v231 offset:25664
ds_read_b128 v[92:95], v231 offset:32064
v_mfma_f32_32x32x16_bf16 v[96:111], a[80:83], v[168:171], v[96:111]
v_mfma_f32_32x32x16_bf16 v[96:111], a[92:95], v[172:175], v[96:111]
v_mfma_f32_32x32x16_bf16 v[96:111], a[104:107], v[176:179], v[96:111]
s_nop 0
v_mfma_f32_32x32x16_bf16 v[96:111], a[116:119], v[180:183], v[96:111]
s_waitcnt lgkmcnt(1)
buffer_store_dwordx4 v[84:87], v252, s[36:39], s60 offen offset:64 sc1
v_mfma_f32_32x32x16_bf16 v[96:111], a[128:131], v[184:187], v[96:111]
v_mfma_f32_32x32x16_bf16 v[96:111], a[140:143], v[188:191], v[96:111]
s_waitcnt lgkmcnt(0)
buffer_store_dwordx4 v[92:95], v252, s[36:39], s76 offen offset:64 sc1
s_nop 10
v_cvt_pk_bf16_f32 v96, v96, v97
v_cvt_pk_bf16_f32 v104, v104, v105
v_cvt_pk_bf16_f32 v97, v98, v99
v_cvt_pk_bf16_f32 v105, v106, v107
v_cvt_pk_bf16_f32 v98, v100, v101
v_cvt_pk_bf16_f32 v99, v102, v103
v_cvt_pk_bf16_f32 v106, v108, v109
v_cvt_pk_bf16_f32 v107, v110, v111
ds_write_b128 v230, v[96:99] offset:25728
ds_write_b128 v230, v[104:107] offset:25760
ds_read_b128 v[100:103], v231 offset:25728
ds_read_b128 v[108:111], v231 offset:32128
s_waitcnt lgkmcnt(1)
buffer_store_dwordx4 v[100:103], v252, s[36:39], s60 offen offset:128 sc1
s_waitcnt lgkmcnt(0)
buffer_store_dwordx4 v[108:111], v252, s[36:39], s76 offen offset:128 sc1
s_endpgm
.p2align 6
L_cons:
s_mov_b32 s36, s12
s_mov_b32 s37, s13
s_mov_b32 s88, s14
s_mov_b32 s89, s15
s_mov_b32 s40, s16
s_mov_b32 s41, s17
s_add_u32 m0, s86, 0x1800
s_mov_b32 s77, 0x9000
s_mov_b32 s78, 0xd800
v_add_u32_e64 v78, 0, v64
v_mul_u32_u24 v79, 0xab, v78
v_lshl_add_u32 v74, v69, 3, v72
buffer_load_dwordx4 v90, s[24:27], s77 offen lds
s_add_u32 m0, s86, 0x1c00
v_lshrrev_b32_e64 v80, 11, v79
v_mul_u32_u24 v74, 0x60, v74
v_lshrrev_b32_e64 v79, 10, v79
v_lshl_add_u32 v74, v73, 3, v74
v_lshlrev_b32_e64 v78, 4, v78
v_mul_u32_u24 v80, 0xc0, v80
v_mul_u32_u24 v79, 0x420, v79
v_add_u32_e32 v143, s86, v74
v_add_u32_e32 v235, v80, v78
v_add3_u32 v79, v79, v78, v71
v_and_b32_e64 v74, 3, v68
buffer_load_dwordx4 v91, s[24:27], s77 offen lds
s_add_u32 m0, s86, 0x2000
v_bfe_u32 v76, v68, 2, 1
v_add_u32 v140, 0x300, v79
v_add_u32_e64 v78, 64, v64
v_lshl_or_b32 v74, v76, 3, v74
v_mul_u32_u24 v79, 0xab, v78
v_bfe_u32 v76, v68, 3, 1
v_lshrrev_b32_e64 v80, 11, v79
v_lshl_or_b32 v74, v76, 2, v74
v_lshrrev_b32_e32 v79, 10, v79
v_and_b32_e32 v77, 1, v74
v_lshlrev_b32_e64 v78, 4, v78
buffer_load_dwordx4 v92, s[24:27], s77 offen lds
s_add_u32 m0, s87, 0x1f80
s_mov_b32 s77, 0x12000
v_mul_u32_u24 v80, 0xc0, v80
v_mul_u32_u24 v79, 0x420, v79
v_bfe_u32 v76, v74, 1, 3
v_lshlrev_b32_e32 v77, 2, v77
v_add_u32_e32 v236, v80, v78
v_add3_u32 v79, v79, v78, v71
v_xor_b32_e64 v76, v76, v77
v_add_u32 v141, 0x300, v79
v_add_u32 v78, 0x80, v64
v_xor_b32_e64 v76, v76, v69
buffer_load_dwordx4 v94, s[20:23], s54 offen offset:128 nt lds
s_add_u32 m0, s87, 0x2f80
v_lshlrev_b32_e64 v74, 7, v74
v_mul_u32_u24 v79, 0xab, v78
v_lshl_add_u32 v244, v76, 4, v74
v_lshrrev_b32_e32 v80, 11, v79
v_and_b32_e32 v76, 1, v73
v_lshrrev_b32_e32 v79, 10, v79
v_lshlrev_b32_e32 v76, 1, v76
v_lshrrev_b32_e32 v77, 1, v73
v_lshlrev_b32_e32 v78, 4, v78
v_mul_u32_u24 v80, 0xc0, v80
v_mul_u32_u24 v79, 0x420, v79
buffer_load_dwordx4 v94, s[20:23], s92 offen offset:128 nt lds
s_add_u32 m0, s86, 0x2400
v_or_b32_e32 v76, v76, v77
v_add_u32_e32 v237, v80, v78
v_add3_u32 v79, v79, v78, v71
v_lshl_add_u32 v74, v67, 2, v72
v_lshrrev_b32_e64 v77, 1, v65
v_mul_u32_u24 v74, 0xc0, v74
v_lshl_add_u32 v76, v76, 3, v75
v_mul_u32_u24 v78, 0x9000, v77
v_add3_u32 v74, v74, v76, v78
v_add_u32 v249, 0x12c00, v74
v_mul_u32_u24 v74, 0x190, v66
buffer_load_dwordx4 v90, s[24:27], s78 offen lds
s_add_u32 m0, s86, 0x2800
s_waitcnt vmcnt(12)
ds_read_b64_tr_b16 a[0:1], v93
ds_read_b64_tr_b16 a[2:3], v93 offset:768
ds_read_b64_tr_b16 a[4:5], v93 offset:64
ds_read_b64_tr_b16 a[6:7], v93 offset:832
ds_read_b64_tr_b16 a[8:9], v93 offset:128
ds_read_b64_tr_b16 a[10:11], v93 offset:896
v_and_b32_e32 v75, 1, v65
v_lshl_add_u32 v74, v67, 4, v74
v_mul_u32_u24 v75, 0x3200, v75
v_add_u32_e32 v247, v74, v71
v_add_u32_e32 v246, v74, v75
buffer_load_dwordx4 v91, s[24:27], s78 offen lds
s_add_u32 m0, s86, 0x2c00
s_waitcnt vmcnt(12)
s_barrier
ds_read_b128 a[216:219], v240
ds_read_b128 a[220:223], v240 offset:4096
ds_read_b128 a[224:227], v241
ds_read_b128 a[228:231], v241 offset:4096
ds_read_b128 a[232:235], v242
ds_read_b128 a[236:239], v242 offset:4096
buffer_load_dwordx4 v92, s[24:27], s78 offen lds
s_add_u32 m0, s87, 0x8380
s_mov_b32 s78, 0x16800
ds_read_b128 a[240:243], v243
v_lshrrev_b32_e64 v74, 2, v64
v_mul_u32_u24 v76, 0x190, v74
v_mul_u32_u24 v77, 0xc0, v77
v_and_b32_e64 v74, 7, v74
v_lshl_add_u32 v78, v73, 4, v77
v_mul_u32_u24 v74, 0x180, v74
v_add3_u32 v231, v76, v75, v78
v_add_u32_e32 v74, v74, v78
s_mul_i32 s72, s2, 3
v_add_u32_e32 v76, s50, v74
s_add_u32 s72, s72, 2
v_subrev_u32 v78, 0x15000, v76
s_mul_i32 s73, s72, 0x925
v_mul_u32_u24 v75, 0x15000, v67
v_min_u32_e32 v76, v76, v78
s_lshr_b32 s73, s73, 16
v_add_u32_e32 v250, v76, v75
s_mul_i32 s74, s73, 28
v_add_u32_e64 v76, s51, v74
s_sub_u32 s64, s72, s74
s_add_u32 s81, s2, 0x300
s_waitcnt lgkmcnt(5)
v_mfma_f32_32x32x16_bf16 v[0:15], a[0:3], a[216:219], 0
s_mul_i32 s72, s64, 0xc00
buffer_load_dwordx4 v139, s[20:23], s55 offen offset:128 nt lds
s_add_u32 m0, s86, 0x3000
ds_read_b128 a[244:247], v243 offset:4096
ds_read_b128 a[248:251], v240 offset:25600
v_subrev_u32 v78, 0x15000, v76
s_mul_i32 s82, s81, 0x925
v_mfma_f32_32x32x16_bf16 v[16:31], a[4:7], a[216:219], 0
s_add_u32 s52, s72, 0x600
s_waitcnt vmcnt(11)
ds_read_b64_tr_b16 a[12:13], v93 offset:3072
ds_read_b64_tr_b16 a[14:15], v93 offset:3840
ds_read_b64_tr_b16 a[16:17], v93 offset:3136
ds_read_b64_tr_b16 a[18:19], v93 offset:3904
ds_read_b64_tr_b16 a[20:21], v93 offset:3200
v_min_u32_e64 v76, v76, v78
v_mfma_f32_32x32x16_bf16 v[192:207], a[8:11], a[216:219], 0
s_lshr_b32 s82, s82, 16
buffer_load_dwordx4 v90, s[24:27], s77 offen lds
s_add_u32 m0, s86, 0x3400
ds_read_b64_tr_b16 a[22:23], v93 offset:3968
v_add_u32_e32 v251, v76, v75
s_mul_i32 s83, s82, 28
v_add_u32_e32 v76, s52, v74
v_mfma_f32_32x32x16_bf16 v[32:47], a[0:3], a[220:223], 0
s_sub_u32 s65, s81, s83
v_subrev_u32 v78, 0x15000, v76
s_mul_i32 s81, s65, 0xc00
v_min_u32_e64 v76, v76, v78
s_add_u32 s53, s81, 0x600
v_add_u32_e64 v252, v76, v75
v_add_u32_e32 v76, s53, v74
v_mfma_f32_32x32x16_bf16 v[48:63], a[4:7], a[220:223], 0
s_lshr_b32 s79, s48, 1
buffer_load_dwordx4 v91, s[24:27], s77 offen lds
s_add_u32 m0, s86, 0x3800
v_subrev_u32 v78, 0x15000, v76
v_add_u32 v142, 0x300, v79
v_min_u32_e32 v76, v76, v78
v_add_u32_e32 v239, v76, v75
v_mfma_f32_32x32x16_bf16 v[208:223], a[8:11], a[220:223], 0
s_mul_i32 s79, s79, 0xc0
ds_read_b128 a[220:223], v241 offset:25600
v_and_b32_e32 v79, 7, v64
v_lshrrev_b32_e32 v80, 3, v66
v_sub_u32_e32 v74, 3, v80
v_sub_u32_e32 v75, 7, v79
v_mul_u32_u24 v81, 0xc00, v65
v_mul_u32_u24 v74, 0xc0, v74
v_lshl_add_u32 v75, v67, 2, v75
v_add_u32 v81, 0x24c00, v81
v_lshl_add_u32 v74, v75, 4, v74
s_waitcnt lgkmcnt(1)
v_mfma_f32_32x32x16_bf16 v[0:15], a[12:15], a[224:227], v[0:15]
s_lshl_b32 s68, s73, 3
buffer_load_dwordx4 v92, s[24:27], s77 offen lds
s_add_u32 m0, s86, 0x3c00
s_mov_b32 s77, 0x1b000
v_add_u32_e32 v248, v74, v81
v_lshrrev_b32_e32 v74, 2, v79
v_xor_b32_e64 v74, v74, v67
v_mfma_f32_32x32x16_bf16 v[16:31], a[16:19], a[224:227], v[16:31]
s_add_u32 s72, s68, s48
v_cvt_f32_u32_e32 v74, v74
v_mul_f32 v253, 0xc31044fe, v74
v_lshrrev_b32_e64 v74, 1, v83
v_sub_u32 v74, 0x24ffc, v74
v_add_u32_e64 v75, 0, v64
v_mul_u32_u24 v76, 0xab, v75
v_mfma_f32_32x32x16_bf16 v[192:207], a[20:23], a[224:227], v[192:207]
s_mul_i32 s72, s72, 0x15000
buffer_load_dwordx4 v90, s[24:27], s78 offen lds
s_add_u32 m0, s86, 0x4000
v_lshrrev_b32_e32 v76, 11, v76
v_mul_u32_u24_e32 v76, 3, v76
v_add_u32_e64 v75, v75, v76
v_lshl_add_u32 v75, v75, 2, v81
v_mfma_f32_32x32x16_bf16 v[32:47], a[12:15], a[228:231], v[32:47]
s_add_u32 s56, s72, 0x54000
v_add_u32_e32 v230, v246, v77
v_xor_b32_e32 v245, 64, v244
v_add_u32_e64 v233, s52, v232
v_subrev_u32 v238, 0x15000, v233
v_min_u32_e32 v233, v233, v238
s_add_u32 s72, s72, 0xa8000
v_mfma_f32_32x32x16_bf16 v[48:63], a[16:19], a[228:231], v[48:63]
s_cmp_eq_u32 s73, 27
s_cselect_b32 s74, 0x1260000, 0
buffer_load_dwordx4 v91, s[24:27], s78 offen lds
s_add_u32 m0, s86, 0x4400
s_waitcnt vmcnt(11)
ds_read_b64_tr_b16 a[24:25], v93 offset:6144
ds_read_b64_tr_b16 a[26:27], v93 offset:6912
ds_read_b64_tr_b16 a[28:29], v93 offset:6208
v_mfma_f32_32x32x16_bf16 v[208:223], a[20:23], a[228:231], v[208:223]
s_sub_u32 s94, s72, s74
ds_read_b64_tr_b16 a[30:31], v93 offset:6976
ds_read_b64_tr_b16 a[32:33], v93 offset:6272
ds_read_b64_tr_b16 a[34:35], v93 offset:7040
s_add_u32 s74, s66, 8
s_add_u32 s73, s66, 4
s_cmp_eq_u32 s62, 27
s_cselect_b32 s62, 1.0, 0
buffer_load_dwordx4 v92, s[24:27], s78 offen lds
s_add_u32 m0, s87, 0x3f00
s_mov_b32 s78, 0x1f800
s_cmp_eq_u32 s66, 0xd8
s_cselect_b32 s66, 0xc31044fe, 0
v_mul_f32_e64 v254, s62, v253
s_mov_b32 s70, 0x3e553b95
v_min_f32_e64 v255, s66, v254
s_mov_b32 s19, 0x3f803f80
v_mov_b32_e64 v134, s19
v_mov_b32_e32 v135, s19
s_cmp_ge_u32 s74, 0xe0
s_cselect_b32 s74, 0, s74
s_and_b32 s72, s48, 1
s_cmp_eq_u32 s72, 1
s_cselect_b32 s72, s74, s73
buffer_load_dwordx4 v94, s[20:23], s54 offen offset:256 nt lds
s_add_u32 m0, s87, 0x4f00
s_mov_b32 s38, 0x1260000
s_mov_b32 s39, 0x20000
s_mul_i32 s58, s72, 0x15000
s_and_b32 s76, s2, 15
s_lshl_b32 s76, s76, 2
s_add_u32 s76, s76, s48
s_mul_i32 s71, s76, 0xa000
s_and_b32 s76, s2, 15
s_waitcnt lgkmcnt(0)
v_mfma_f32_32x32x16_bf16 v[0:15], a[24:27], a[232:235], v[0:15]
s_lshl_b32 s44, s76, 4
s_add_u32 s76, s58, 0x2a000
s_lshl_b32 s69, s82, 3
s_add_u32 s83, s67, 8
s_add_u32 s82, s67, 4
buffer_load_dwordx4 v94, s[20:23], s92 offen offset:256 nt lds
s_add_u32 m0, s87, 0xa300
v_mfma_f32_32x32x16_bf16 v[16:31], a[28:31], a[232:235], v[16:31]
s_cmp_eq_u32 s63, 27
s_cselect_b32 s63, 1.0, 0
s_cmp_eq_u32 s67, 0xd8
s_cselect_b32 s67, 0xc31044fe, 0
s_mov_b32 s90, 0x100
s_mov_b32 s91, 0x20000
s_and_b32 s81, s48, 1
v_mfma_f32_32x32x16_bf16 v[192:207], a[32:35], a[232:235], v[192:207]
s_cmp_ge_u32 s83, 0xe0
s_cselect_b32 s83, 0, s83
ds_read_b128 a[232:235], v242 offset:25600
s_cmp_eq_u32 s81, 1
s_cselect_b32 s81, s83, s82
buffer_load_dwordx4 v139, s[20:23], s55 offen offset:256 nt lds
s_add_u32 m0, s86, 0
v_mfma_f32_32x32x16_bf16 v[32:47], a[24:27], a[236:239], v[32:47]
s_mul_i32 s59, s81, 0x15000
v_lshlrev_b32_e32 v86, 16, v84
v_and_b32 v87, 0xffff0000, v84
v_lshlrev_b32_e32 v88, 16, v85
v_and_b32 v89, 0xffff0000, v85
v_mul_f32 v86, 0x40ddb3d7, v86
v_mul_f32 v87, 0x40ddb3d7, v87
v_mfma_f32_32x32x16_bf16 v[48:63], a[28:31], a[236:239], v[48:63]
s_add_u32 s83, s69, 8
s_waitcnt vmcnt(10)
ds_read_b64_tr_b16 a[36:37], v93 offset:9216
ds_read_b64_tr_b16 a[38:39], v93 offset:9984
ds_read_b64_tr_b16 a[40:41], v93 offset:9280
ds_read_b64_tr_b16 a[42:43], v93 offset:10048
buffer_load_dwordx4 v90, s[24:27], s77 offen lds
s_add_u32 m0, s86, 0x400
v_mfma_f32_32x32x16_bf16 v[208:223], a[32:35], a[236:239], v[208:223]
s_cmp_ge_u32 s83, 0xe0
s_cselect_b32 s83, 0, s83
ds_read_b64_tr_b16 a[44:45], v93 offset:9344
ds_read_b64_tr_b16 a[46:47], v93 offset:10112
ds_write_b32 v74, v86
ds_write_b32 v74, v87 offset:3072
v_mul_f32 v88, 0x40ddb3d7, v88
v_mul_f32 v89, 0x40ddb3d7, v89
buffer_load_dwordx4 v91, s[24:27], s77 offen lds
s_add_u32 m0, s86, 0x800
ds_write_b32 v74, v88 offset:6144
ds_write_b32 v74, v89 offset:9216
v_lshl_add_u32 v74, v64, 4, v81
s_add_u32 s82, s69, 4
s_and_b32 s81, s48, 1
s_cmp_eq_u32 s81, 1
s_cselect_b32 s81, s83, s82
v_mbcnt_lo_u32_b32 v238, -1, 0
s_mul_i32 s61, s81, 0x15000
v_mbcnt_hi_u32_b32 v238, -1, v238
s_mov_b32 s42, 0x280000
s_mov_b32 s43, 0x20000
buffer_load_dwordx4 v92, s[24:27], s77 offen lds
s_add_u32 m0, s86, 0xc00
s_mov_b32 s77, 0x24000
v_lshlrev_b32_e32 v238, 4, v238
s_waitcnt lgkmcnt(6)
v_mfma_f32_32x32x16_bf16 v[0:15], a[36:39], a[240:243], v[0:15]
s_add_u32 s81, s71, 0x8000
s_add_u32 s82, s71, 0x9000
s_add_u32 s74, s68, 8
s_add_u32 s73, s68, 4
s_cmp_eq_u32 s64, 27
s_cselect_b32 s64, 1.0, 0
s_add_u32 s84, s59, 0x2a000
v_mfma_f32_32x32x16_bf16 v[16:31], a[40:43], a[240:243], v[16:31]
s_waitcnt vmcnt(11) lgkmcnt(0)
s_barrier
ds_read_b128 a[252:255], v240 offset:8192
ds_read_b128 a[216:219], v240 offset:12288
buffer_load_dwordx4 v90, s[24:27], s78 offen lds
s_add_u32 m0, s86, 0x1000
ds_read_b128 a[224:227], v241 offset:8192
ds_read_b128 a[228:231], v241 offset:12288
v_mfma_f32_32x32x16_bf16 v[192:207], a[44:47], a[240:243], v[192:207]
s_cmp_eq_u32 s68, 0xd8
s_cselect_b32 s68, 0xc31044fe, 0
ds_read_b128 a[236:239], v242 offset:8192
s_cmp_eq_u32 s65, 27
s_cselect_b32 s65, 1.0, 0
s_waitcnt vmcnt(10)
ds_read_b64_tr_b16 a[48:49], v93 offset:12288
s_and_b32 s72, s48, 1
v_mfma_f32_32x32x16_bf16 v[32:47], a[36:39], a[244:247], v[32:47]
s_cmp_eq_u32 s69, 0xd8
s_cselect_b32 s69, 0xc31044fe, 0
ds_read_b64_tr_b16 a[50:51], v93 offset:13056
buffer_load_dwordx4 v91, s[24:27], s78 offen lds
s_add_u32 m0, s86, 0x1400
ds_read_b64_tr_b16 a[52:53], v93 offset:12352
ds_read_b64_tr_b16 a[54:55], v93 offset:13120
v_mfma_f32_32x32x16_bf16 v[48:63], a[40:43], a[244:247], v[48:63]
s_cmp_ge_u32 s74, 0xe0
s_cselect_b32 s74, 0, s74
ds_read_b64_tr_b16 a[56:57], v93 offset:12416
ds_read_b64_tr_b16 a[58:59], v93 offset:13184
ds_read_b128 a[240:243], v242 offset:12288
s_cmp_eq_u32 s72, 1
s_cselect_b32 s72, s74, s73
v_mfma_f32_32x32x16_bf16 v[208:223], a[44:47], a[244:247], v[208:223]
s_mul_i32 s60, s72, 0x15000
ds_read_b128 a[244:247], v243 offset:25600
ds_read2_b32 v[100:101], v75 offset0:31 offset1:32
buffer_load_dwordx4 v92, s[24:27], s78 offen lds
s_add_u32 m0, s86, 0x1800
s_mov_b32 s78, 0x28800
v_mfma_f32_32x32x16_bf16 v[144:159], a[0:3], a[248:251], 0
s_nop 0
ds_read2_b32 v[102:103], v75 offset0:33 offset1:34
v_add_u32_e64 v75, 64, v64
v_mul_u32_u24 v76, 0xab, v75
v_lshrrev_b32_e32 v76, 11, v76
v_mul_u32_u24_e32 v76, 3, v76
v_add_u32_e64 v75, v75, v76
v_mfma_f32_32x32x16_bf16 v[160:175], a[4:7], a[248:251], 0
v_lshl_add_u32 v75, v75, 2, v81
buffer_load_dwordx4 v90, s[24:27], s77 offen lds
s_add_u32 m0, s86, 0x1c00
ds_read2_b32 v[104:105], v75 offset0:31 offset1:32
v_mfma_f32_32x32x16_bf16 v[176:191], a[8:11], a[248:251], 0
s_waitcnt lgkmcnt(9)
ds_read_b128 a[248:251], v243 offset:8192
ds_read2_b32 v[106:107], v75 offset0:33 offset1:34
v_add_u32 v75, 0x80, v64
v_mul_u32_u24 v76, 0xab, v75
v_lshrrev_b32_e32 v76, 11, v76
v_mul_u32_u24_e32 v76, 3, v76
v_mfma_f32_32x32x16_bf16 v[0:15], a[48:51], a[252:255], v[0:15]
s_waitcnt vmcnt(10) lgkmcnt(8)
ds_read_b64_tr_b16 a[60:61], v93 offset:15360
ds_read_b64_tr_b16 a[62:63], v93 offset:16128
ds_read_b64_tr_b16 a[64:65], v93 offset:15424
buffer_load_dwordx4 v91, s[24:27], s77 offen lds
s_add_u32 m0, s86, 0x2000
ds_read_b64_tr_b16 a[66:67], v93 offset:16192
v_mfma_f32_32x32x16_bf16 v[16:31], a[52:55], a[252:255], v[16:31]
s_waitcnt lgkmcnt(9)
ds_read_b64_tr_b16 a[68:69], v93 offset:15488
ds_read_b64_tr_b16 a[70:71], v93 offset:16256
v_add_u32_e32 v75, v75, v76
v_lshl_add_u32 v75, v75, 2, v81
v_mfma_f32_32x32x16_bf16 v[192:207], a[56:59], a[252:255], v[192:207]
ds_read_b128 a[252:255], v243 offset:12288
ds_read2_b32 v[108:109], v75 offset0:31 offset1:32
ds_read2_b32 v[110:111], v75 offset0:33 offset1:34
buffer_load_dwordx4 v92, s[24:27], s77 offen lds
s_add_u32 m0, s86, 0x2400
s_mov_b32 s77, 0x2d000
v_mfma_f32_32x32x16_bf16 v[32:47], a[48:51], a[216:219], v[32:47]
s_waitcnt lgkmcnt(11)
ds_write_b128 v74, v[100:103]
v_mfma_f32_32x32x16_bf16 v[48:63], a[52:55], a[216:219], v[48:63]
buffer_load_dwordx4 v90, s[24:27], s78 offen lds
s_add_u32 m0, s86, 0x2800
v_mfma_f32_32x32x16_bf16 v[208:223], a[56:59], a[216:219], v[208:223]
s_waitcnt lgkmcnt(7)
ds_read_b128 a[216:219], v240 offset:33792
ds_write_b128 v74, v[104:107] offset:1024
v_mfma_f32_32x32x16_bf16 v[144:159], a[12:15], a[220:223], v[144:159]
buffer_load_dwordx4 v91, s[24:27], s78 offen lds
s_add_u32 m0, s86, 0x2c00
v_mfma_f32_32x32x16_bf16 v[160:175], a[16:19], a[220:223], v[160:175]
s_waitcnt lgkmcnt(3)
ds_write_b128 v74, v[108:111] offset:2048
v_mfma_f32_32x32x16_bf16 v[176:191], a[20:23], a[220:223], v[176:191]
s_nop 0
buffer_load_dwordx4 v92, s[24:27], s78 offen lds
s_add_u32 m0, s86, 0x3000
s_mov_b32 s78, 0x31800
v_mfma_f32_32x32x16_bf16 v[0:15], a[60:63], a[224:227], v[0:15]
v_mfma_f32_32x32x16_bf16 v[16:31], a[64:67], a[224:227], v[16:31]
buffer_load_dwordx4 v90, s[24:27], s77 offen lds
s_add_u32 m0, s86, 0x3400
v_mfma_f32_32x32x16_bf16 v[192:207], a[68:71], a[224:227], v[192:207]
v_mfma_f32_32x32x16_bf16 v[32:47], a[60:63], a[228:231], v[32:47]
buffer_load_dwordx4 v91, s[24:27], s77 offen lds
s_add_u32 m0, s86, 0x3800
v_mfma_f32_32x32x16_bf16 v[48:63], a[64:67], a[228:231], v[48:63]
v_mfma_f32_32x32x16_bf16 v[208:223], a[68:71], a[228:231], v[208:223]
ds_read_b128 a[228:231], v241 offset:33792
s_waitcnt vmcnt(11)
ds_read_b64_tr_b16 a[72:73], v93
buffer_load_dwordx4 v92, s[24:27], s77 offen lds
s_add_u32 m0, s86, 0x3c00
v_mfma_f32_32x32x16_bf16 v[144:159], a[24:27], a[232:235], v[144:159]
s_mov_b32 s77, 0
ds_read_b64_tr_b16 a[74:75], v93 offset:768
ds_read_b64_tr_b16 a[76:77], v93 offset:64
ds_read_b64_tr_b16 a[78:79], v93 offset:832
ds_read_b64_tr_b16 a[80:81], v93 offset:128
ds_read_b64_tr_b16 a[82:83], v93 offset:896
v_mfma_f32_32x32x16_bf16 v[160:175], a[28:31], a[232:235], v[160:175]
buffer_load_dwordx4 v90, s[24:27], s78 offen lds
s_add_u32 m0, s86, 0x4000
v_mfma_f32_32x32x16_bf16 v[176:191], a[32:35], a[232:235], v[176:191]
s_nop 0
buffer_load_dwordx4 v91, s[24:27], s78 offen lds
s_add_u32 m0, s86, 0x4400
s_waitcnt lgkmcnt(4)
v_mfma_f32_32x32x16_bf16 v[0:15], a[72:75], a[236:239], v[0:15]
s_waitcnt vmcnt(11) lgkmcnt(0)
ds_read_b64_tr_b16 a[84:85], v93 offset:3072
buffer_load_dwordx4 v92, s[24:27], s78 offen lds
s_add_u32 m0, s86, 0
v_mfma_f32_32x32x16_bf16 v[16:31], a[76:79], a[236:239], v[16:31]
s_mov_b32 s78, 0x9000
ds_read_b64_tr_b16 a[86:87], v93 offset:3840
ds_read_b64_tr_b16 a[88:89], v93 offset:3136
ds_read_b64_tr_b16 a[90:91], v93 offset:3904
ds_read_b64_tr_b16 a[92:93], v93 offset:3200
ds_read_b64_tr_b16 a[94:95], v93 offset:3968
v_mfma_f32_32x32x16_bf16 v[192:207], a[80:83], a[236:239], v[192:207]
buffer_load_dwordx4 v140, s[24:27], s77 offen lds
s_add_u32 m0, s86, 0x400
v_mfma_f32_32x32x16_bf16 v[32:47], a[72:75], a[240:243], v[32:47]
v_mfma_f32_32x32x16_bf16 v[48:63], a[76:79], a[240:243], v[48:63]
buffer_load_dwordx4 v141, s[24:27], s77 offen lds
s_add_u32 m0, s86, 0x800
v_mfma_f32_32x32x16_bf16 v[208:223], a[80:83], a[240:243], v[208:223]
s_nop 0
ds_read_b128 a[240:243], v242 offset:33792
v_mfma_f32_32x32x16_bf16 v[144:159], a[36:39], a[244:247], v[144:159]
s_waitcnt vmcnt(11) lgkmcnt(1)
ds_read_b64_tr_b16 a[96:97], v93 offset:6144
buffer_load_dwordx4 v142, s[24:27], s77 offen lds
s_add_u32 m0, s86, 0xc00
v_mfma_f32_32x32x16_bf16 v[160:175], a[40:43], a[244:247], v[160:175]
s_mov_b32 s77, 0x12000
ds_read_b64_tr_b16 a[98:99], v93 offset:6912
ds_read_b64_tr_b16 a[100:101], v93 offset:6208
ds_read_b64_tr_b16 a[102:103], v93 offset:6976
ds_read_b64_tr_b16 a[104:105], v93 offset:6272
ds_read_b64_tr_b16 a[106:107], v93 offset:7040
v_mfma_f32_32x32x16_bf16 v[176:191], a[44:47], a[244:247], v[176:191]
s_nop 0
buffer_load_dwordx4 v140, s[24:27], s78 offen lds
s_add_u32 m0, s86, 0x1000
v_mfma_f32_32x32x16_bf16 v[0:15], a[84:87], a[248:251], v[0:15]
s_barrier
ds_read_b128 a[220:223], v240 offset:16384
ds_read_b128 a[224:227], v240 offset:20480
ds_read_b128 a[232:235], v241 offset:16384
ds_read_b128 a[236:239], v241 offset:20480
v_mfma_f32_32x32x16_bf16 v[16:31], a[88:91], a[248:251], v[16:31]
ds_read_b128 a[244:247], v242 offset:16384
buffer_load_dwordx4 v141, s[24:27], s78 offen lds
s_add_u32 m0, s86, 0x1400
v_mfma_f32_32x32x16_bf16 v[192:207], a[92:95], a[248:251], v[192:207]
s_nop 0
ds_read_b128 a[248:251], v242 offset:20480
v_mfma_f32_32x32x16_bf16 v[32:47], a[84:87], a[252:255], v[32:47]
s_waitcnt vmcnt(11)
ds_read_b64_tr_b16 a[108:109], v93 offset:9216
buffer_load_dwordx4 v142, s[24:27], s78 offen lds
s_add_u32 m0, s86, 0x1800
v_mfma_f32_32x32x16_bf16 v[48:63], a[88:91], a[252:255], v[48:63]
s_mov_b32 s78, 0x1b000
ds_read_b64_tr_b16 a[110:111], v93 offset:9984
ds_read_b64_tr_b16 a[112:113], v93 offset:9280
ds_read_b64_tr_b16 a[114:115], v93 offset:10048
ds_read_b64_tr_b16 a[116:117], v93 offset:9344
ds_read_b64_tr_b16 a[118:119], v93 offset:10112
v_mfma_f32_32x32x16_bf16 v[208:223], a[92:95], a[252:255], v[208:223]
s_waitcnt lgkmcnt(10)
ds_read_b128 a[252:255], v243 offset:33792
buffer_load_dwordx4 v140, s[24:27], s77 offen lds
s_add_u32 m0, s86, 0x1c00
v_mfma_f32_32x32x16_bf16 v[144:159], a[48:51], a[216:219], v[144:159]
s_nop 0
v_mfma_f32_32x32x16_bf16 v[160:175], a[52:55], a[216:219], v[160:175]
buffer_load_dwordx4 v141, s[24:27], s77 offen lds
s_add_u32 m0, s86, 0x2000
v_mfma_f32_32x32x16_bf16 v[176:191], a[56:59], a[216:219], v[176:191]
s_nop 0
ds_read_b128 a[216:219], v243 offset:16384
v_mfma_f32_32x32x16_bf16 v[0:15], a[96:99], a[220:223], v[0:15]
s_waitcnt vmcnt(11)
ds_read_b64_tr_b16 a[120:121], v93 offset:12288
buffer_load_dwordx4 v142, s[24:27], s77 offen lds
s_add_u32 m0, s86, 0x2400
v_mfma_f32_32x32x16_bf16 v[16:31], a[100:103], a[220:223], v[16:31]
s_mov_b32 s77, 0x24000
ds_read_b64_tr_b16 a[122:123], v93 offset:13056
ds_read_b64_tr_b16 a[124:125], v93 offset:12352
ds_read_b64_tr_b16 a[126:127], v93 offset:13120
ds_read_b64_tr_b16 a[128:129], v93 offset:12416
ds_read_b64_tr_b16 a[130:131], v93 offset:13184
v_mfma_f32_32x32x16_bf16 v[192:207], a[104:107], a[220:223], v[192:207]
s_waitcnt lgkmcnt(7)
ds_read_b128 a[220:223], v243 offset:20480
buffer_load_dwordx4 v140, s[24:27], s78 offen lds
s_add_u32 m0, s86, 0x2800
v_mfma_f32_32x32x16_bf16 v[32:47], a[96:99], a[224:227], v[32:47]
s_nop 0
v_mfma_f32_32x32x16_bf16 v[48:63], a[100:103], a[224:227], v[48:63]
buffer_load_dwordx4 v141, s[24:27], s78 offen lds
s_add_u32 m0, s86, 0x2c00
v_mfma_f32_32x32x16_bf16 v[208:223], a[104:107], a[224:227], v[208:223]
s_nop 0
ds_read_b128 a[224:227], v240 offset:41984
v_mfma_f32_32x32x16_bf16 v[144:159], a[60:63], a[228:231], v[144:159]
s_waitcnt vmcnt(11)
ds_read_b64_tr_b16 a[132:133], v93 offset:15360
buffer_load_dwordx4 v142, s[24:27], s78 offen lds
s_add_u32 m0, s86, 0x3000
v_mfma_f32_32x32x16_bf16 v[160:175], a[64:67], a[228:231], v[160:175]
s_mov_b32 s78, 0x2d000
ds_read_b64_tr_b16 a[134:135], v93 offset:16128
ds_read_b64_tr_b16 a[136:137], v93 offset:15424
ds_read_b64_tr_b16 a[138:139], v93 offset:16192
ds_read_b64_tr_b16 a[140:141], v93 offset:15488
ds_read_b64_tr_b16 a[142:143], v93 offset:16256
v_mfma_f32_32x32x16_bf16 v[176:191], a[68:71], a[228:231], v[176:191]
s_waitcnt lgkmcnt(7)
ds_read_b128 a[228:231], v241 offset:41984
buffer_load_dwordx4 v140, s[24:27], s77 offen lds
s_add_u32 m0, s86, 0x3400
v_mfma_f32_32x32x16_bf16 v[0:15], a[108:111], a[232:235], v[0:15]
s_nop 0
v_mfma_f32_32x32x16_bf16 v[16:31], a[112:115], a[232:235], v[16:31]
buffer_load_dwordx4 v141, s[24:27], s77 offen lds
s_add_u32 m0, s86, 0x3800
v_mfma_f32_32x32x16_bf16 v[192:207], a[116:119], a[232:235], v[192:207]
s_nop 0
ds_read_b128 a[232:235], v242 offset:41984
v_mfma_f32_32x32x16_bf16 v[32:47], a[108:111], a[236:239], v[32:47]
s_waitcnt vmcnt(11)
ds_read_b64_tr_b16 a[144:145], v143
buffer_load_dwordx4 v142, s[24:27], s77 offen lds
s_add_u32 m0, s86, 0x3c00
v_mfma_f32_32x32x16_bf16 v[48:63], a[112:115], a[236:239], v[48:63]
ds_read_b64_tr_b16 a[146:147], v143 offset:384
ds_read_b64_tr_b16 a[148:149], v143 offset:32
ds_read_b64_tr_b16 a[150:151], v143 offset:416
ds_read_b64_tr_b16 a[152:153], v143 offset:64
ds_read_b64_tr_b16 a[154:155], v143 offset:448
v_mfma_f32_32x32x16_bf16 v[208:223], a[116:119], a[236:239], v[208:223]
s_waitcnt lgkmcnt(7)
ds_read_b128 a[236:239], v243 offset:41984
buffer_load_dwordx4 v140, s[24:27], s78 offen lds
s_add_u32 m0, s86, 0x4000
v_mfma_f32_32x32x16_bf16 v[144:159], a[72:75], a[240:243], v[144:159]
s_nop 0
v_mfma_f32_32x32x16_bf16 v[160:175], a[76:79], a[240:243], v[160:175]
buffer_load_dwordx4 v141, s[24:27], s78 offen lds
s_add_u32 m0, s86, 0x4400
v_mfma_f32_32x32x16_bf16 v[176:191], a[80:83], a[240:243], v[176:191]
ds_read_b128 a[240:243], v244
v_mfma_f32_32x32x16_bf16 v[0:15], a[120:123], a[244:247], v[0:15]
s_waitcnt vmcnt(11)
ds_read_b64_tr_b16 a[156:157], v143 offset:3072
buffer_load_dwordx4 v142, s[24:27], s78 offen lds
s_add_u32 m0, s87, 0x7400
v_mfma_f32_32x32x16_bf16 v[16:31], a[124:127], a[244:247], v[16:31]
s_and_b32 s78, s48, 1
s_mul_i32 s78, s78, 0x9000
s_add_u32 s79, s79, s78
s_add_u32 s78, s79, 0
ds_read_b64_tr_b16 a[158:159], v143 offset:3456
ds_read_b64_tr_b16 a[160:161], v143 offset:3104
ds_read_b64_tr_b16 a[162:163], v143 offset:3488
v_mfma_f32_32x32x16_bf16 v[192:207], a[128:131], a[244:247], v[192:207]
ds_read_b64_tr_b16 a[164:165], v143 offset:3136
ds_read_b64_tr_b16 a[166:167], v143 offset:3520
ds_read_b128 a[244:247], v245
v_mov_b32_e64 v142, s19
v_mfma_f32_32x32x16_bf16 v[32:47], a[120:123], a[248:251], v[32:47]
buffer_load_dwordx4 v139, s[20:23], s93 offen nt lds
s_add_u32 m0, s87, 0x9380
v_mfma_f32_32x32x16_bf16 v[48:63], a[124:127], a[248:251], v[48:63]
v_mfma_f32_32x32x16_bf16 v[208:223], a[128:131], a[248:251], v[208:223]
buffer_load_dwordx4 v139, s[20:23], s93 offen offset:128 nt lds
s_add_u32 m0, s87, 0xb300
ds_read_b128 a[248:251], v244 offset:8192
v_mfma_f32_32x32x16_bf16 v[144:159], a[84:87], a[252:255], v[144:159]
s_waitcnt vmcnt(11) lgkmcnt(5)
ds_read_b64_tr_b16 a[168:169], v143 offset:6144
ds_read_b64_tr_b16 a[170:171], v143 offset:6528
ds_read_b64_tr_b16 a[172:173], v143 offset:6176
v_mfma_f32_32x32x16_bf16 v[160:175], a[88:91], a[252:255], v[160:175]
buffer_load_dwordx4 v139, s[20:23], s93 offen offset:256 nt lds
s_add_u32 m0, s86, 0
ds_read_b64_tr_b16 a[174:175], v143 offset:6560
ds_read_b64_tr_b16 a[176:177], v143 offset:6208
ds_read_b64_tr_b16 a[178:179], v143 offset:6592
v_mfma_f32_32x32x16_bf16 v[176:191], a[92:95], a[252:255], v[176:191]
ds_read_b128 a[252:255], v245 offset:8192
v_mfma_f32_32x32x16_bf16 v[0:15], a[132:135], a[216:219], v[0:15]
buffer_load_dwordx4 v235, s[28:31], s78 offen lds
s_add_u32 m0, s86, 0x400
v_mfma_f32_32x32x16_bf16 v[16:31], a[136:139], a[216:219], v[16:31]
s_nop 6
v_mfma_f32_32x32x16_bf16 v[192:207], a[140:143], a[216:219], v[192:207]
s_nop 0
buffer_load_dwordx4 v236, s[28:31], s78 offen lds
s_add_u32 m0, s86, 0x800
ds_read_b128 a[216:219], v244 offset:16384
v_cvt_pk_bf16_f32 v64, v0, v1
v_cvt_pk_bf16_f32 v65, v2, v3
v_cvt_pk_bf16_f32 v66, v4, v5
v_mfma_f32_32x32x16_bf16 v[32:47], a[132:135], a[220:223], v[32:47]
s_nop 0
ds_read_b128 v[0:3], v248 offset:768
v_cvt_pk_bf16_f32 v67, v6, v7
v_cvt_pk_bf16_f32 v68, v8, v9
v_cvt_pk_bf16_f32 v69, v10, v11
v_cvt_pk_bf16_f32 v70, v12, v13
v_cvt_pk_bf16_f32 v71, v14, v15
v_mfma_f32_32x32x16_bf16 v[48:63], a[136:139], a[220:223], v[48:63]
s_waitcnt vmcnt(11) lgkmcnt(2)
buffer_load_dwordx4 v237, s[28:31], s78 offen lds
s_add_u32 m0, s86, 0xc00
s_add_u32 s78, s79, 0x1800
ds_read_b64_tr_b16 a[180:181], v143 offset:9216
ds_read_b64_tr_b16 a[182:183], v143 offset:9600
ds_read_b64_tr_b16 a[184:185], v143 offset:9248
v_mfma_f32_32x32x16_bf16 v[208:223], a[140:143], a[220:223], v[208:223]
ds_read_b64_tr_b16 a[186:187], v143 offset:9632
ds_read_b64_tr_b16 a[188:189], v143 offset:9280
ds_read_b64_tr_b16 a[190:191], v143 offset:9664
ds_read_b128 v[4:7], v248 offset:960
v_cvt_pk_bf16_f32 v72, v16, v17
v_cvt_pk_bf16_f32 v73, v18, v19
v_mfma_f32_32x32x16_bf16 v[144:159], a[96:99], a[224:227], v[144:159]
buffer_load_dwordx4 v235, s[28:31], s78 offen lds
s_add_u32 m0, s86, 0x1000
ds_read_b128 v[8:11], v248 offset:1152
ds_read_b128 v[12:15], v248 offset:1344
v_cvt_pk_bf16_f32 v74, v20, v21
v_cvt_pk_bf16_f32 v75, v22, v23
v_mfma_f32_32x32x16_bf16 v[160:175], a[100:103], a[224:227], v[160:175]
ds_read_b128 v[16:19], v248 offset:1536
ds_read_b128 v[20:23], v248 offset:1728
v_cvt_pk_bf16_f32 v76, v24, v25
v_cvt_pk_bf16_f32 v77, v26, v27
v_cvt_pk_bf16_f32 v78, v28, v29
v_cvt_pk_bf16_f32 v79, v30, v31
v_mfma_f32_32x32x16_bf16 v[176:191], a[104:107], a[224:227], v[176:191]
buffer_load_dwordx4 v236, s[28:31], s78 offen lds
s_add_u32 m0, s86, 0x1400
ds_read_b128 v[24:27], v248 offset:1920
ds_read_b128 v[28:31], v248 offset:2112
v_cvt_pk_bf16_f32 v88, v32, v33
v_cvt_pk_bf16_f32 v89, v34, v35
v_mfma_f32_32x32x16_bf16 v[144:159], a[108:111], a[228:231], v[144:159]
s_nop 0
ds_read_b128 v[32:35], v248
ds_read_b128 a[220:223], v245 offset:16384
v_cvt_pk_bf16_f32 v90, v36, v37
v_cvt_pk_bf16_f32 v91, v38, v39
v_cvt_pk_bf16_f32 v92, v40, v41
v_cvt_pk_bf16_f32 v93, v42, v43
v_mfma_f32_32x32x16_bf16 v[160:175], a[112:115], a[228:231], v[160:175]
s_waitcnt vmcnt(11)
buffer_load_dwordx4 v237, s[28:31], s78 offen lds
s_add_u32 m0, s86, 0x1800
s_add_u32 s78, s79, 0x3000
ds_read_b128 v[36:39], v248 offset:192
ds_read_b128 v[40:43], v248 offset:384
ds_read_b64_tr_b16 a[192:193], v143 offset:12288
v_mfma_f32_32x32x16_bf16 v[176:191], a[116:119], a[228:231], v[176:191]
ds_read_b64_tr_b16 a[194:195], v143 offset:12672
ds_read_b64_tr_b16 a[196:197], v143 offset:12320
v_cvt_pk_bf16_f32 v94, v44, v45
v_cvt_pk_bf16_f32 v95, v46, v47
v_cvt_pk_bf16_f32 v96, v48, v49
v_cvt_pk_bf16_f32 v97, v50, v51
v_mfma_f32_32x32x16_bf16 v[144:159], a[120:123], a[232:235], v[144:159]
buffer_load_dwordx4 v235, s[28:31], s78 offen lds
s_add_u32 m0, s86, 0x1c00
ds_read_b128 v[44:47], v248 offset:576
ds_read_b64_tr_b16 a[198:199], v143 offset:12704
ds_read_b64_tr_b16 a[200:201], v143 offset:12352
ds_read_b64_tr_b16 a[202:203], v143 offset:12736
v_mfma_f32_32x32x16_bf16 v[160:175], a[124:127], a[232:235], v[160:175]
ds_read_b128 v[48:51], v248 offset:768
v_cvt_pk_bf16_f32 v98, v52, v53
v_cvt_pk_bf16_f32 v99, v54, v55
v_cvt_pk_bf16_f32 v100, v56, v57
v_cvt_pk_bf16_f32 v101, v58, v59
v_cvt_pk_bf16_f32 v102, v60, v61
v_mfma_f32_32x32x16_bf16 v[176:191], a[128:131], a[232:235], v[176:191]
buffer_load_dwordx4 v236, s[28:31], s78 offen lds
s_add_u32 m0, s86, 0x2000
ds_read_b128 v[52:55], v248 offset:960
ds_read_b128 v[56:59], v248 offset:1152
ds_read_b128 a[224:227], v244 offset:2048
v_cvt_pk_bf16_f32 v103, v62, v63
v_mfma_f32_32x32x16_bf16 v[144:159], a[132:135], a[236:239], v[144:159]
ds_read_b128 v[60:63], v248 offset:1344
v_cvt_pk_bf16_f32 v80, v192, v193
v_cvt_pk_bf16_f32 v81, v194, v195
v_cvt_pk_bf16_f32 v82, v196, v197
v_cvt_pk_bf16_f32 v83, v198, v199
v_cvt_pk_bf16_f32 v84, v200, v201
v_mfma_f32_32x32x16_bf16 v[160:175], a[136:139], a[236:239], v[160:175]
s_waitcnt vmcnt(11)
buffer_load_dwordx4 v237, s[28:31], s78 offen lds
s_add_u32 m0, s86, 0x2400
s_add_u32 s78, s79, 0x4800
ds_read_b64_tr_b16 a[204:205], v143 offset:15360
ds_read_b64_tr_b16 a[206:207], v143 offset:15744
ds_read_b64_tr_b16 a[208:209], v143 offset:15392
v_mfma_f32_32x32x16_bf16 v[176:191], a[140:143], a[236:239], v[176:191]
s_waitcnt lgkmcnt(11)
ds_read_b64_tr_b16 a[210:211], v143 offset:15776
ds_read_b64_tr_b16 a[212:213], v143 offset:15424
ds_read_b64_tr_b16 a[214:215], v143 offset:15808
ds_read_b128 a[228:231], v245 offset:2048
v_cvt_pk_bf16_f32 v85, v202, v203
v_cvt_pk_bf16_f32 v86, v204, v205
v_mfma_f32_32x32x16_bf16 v[0:15], v[76:79], v[64:67], v[0:15]
buffer_load_dwordx4 v235, s[28:31], s78 offen lds
s_add_u32 m0, s86, 0x2800
ds_read_b128 a[232:235], v244 offset:10240
ds_read_b128 a[236:239], v245 offset:10240
v_cvt_pk_bf16_f32 v87, v206, v207
v_cvt_pk_bf16_f32 v104, v208, v209
v_mfma_f32_32x32x16_bf16 v[0:15], v[80:83], v[68:71], v[0:15]
v_cvt_pk_bf16_f32 v105, v210, v211
v_cvt_pk_bf16_f32 v106, v212, v213
v_cvt_pk_bf16_f32 v107, v214, v215
v_cvt_pk_bf16_f32 v108, v216, v217
v_cvt_pk_bf16_f32 v109, v218, v219
v_cvt_pk_bf16_f32 v110, v220, v221
v_mfma_f32_32x32x16_bf16 v[0:15], v[84:87], v[72:75], v[0:15]
buffer_load_dwordx4 v236, s[28:31], s78 offen lds
s_add_u32 m0, s86, 0x2c00
v_cvt_pk_bf16_f32 v111, v222, v223
v_mov_b32_e32 v143, s19
s_nop 1
v_mfma_f32_32x32x16_bf16 v[16:31], v[100:103], v[64:67], v[16:31]
v_cvt_pk_bf16_f32 v64, v144, v145
v_cvt_pk_bf16_f32 v65, v146, v147
v_cvt_pk_bf16_f32 v66, v148, v149
v_cvt_pk_bf16_f32 v67, v150, v151
v_mfma_f32_32x32x16_bf16 v[16:31], v[104:107], v[68:71], v[16:31]
buffer_load_dwordx4 v237, s[28:31], s78 offen lds
s_add_u32 m0, s86, 0x3000
s_add_u32 s78, s79, 0x6000
s_waitcnt vmcnt(12) lgkmcnt(2)
s_barrier
v_max3_f32 v224, v0, v1, v2
v_max3_f32 v224, v224, v3, v4
v_mfma_f32_32x32x16_bf16 v[16:31], v[108:111], v[72:75], v[16:31]
v_max3_f32 v224, v224, v5, v6
v_max3_f32 v224, v224, v7, v8
v_max3_f32 v224, v224, v9, v10
v_max3_f32 v224, v224, v11, v12
v_max3_f32 v224, v224, v13, v14
v_max_f32_e64 v224, v224, v15
v_mfma_f32_32x32x16_bf16 v[32:47], v[76:79], v[88:91], v[32:47]
buffer_load_dwordx4 v235, s[28:31], s78 offen lds
s_add_u32 m0, s86, 0x3400
v_fma_f32 v224, v224, s70, v254
v_cvt_pk_bf16_f32 v68, v152, v153
v_cvt_pk_bf16_f32 v69, v154, v155
v_cvt_pk_bf16_f32 v70, v156, v157
v_mfma_f32_32x32x16_bf16 v[32:47], v[80:83], v[92:95], v[32:47]
v_max3_f32 v225, v16, v17, v18
v_max3_f32 v225, v225, v19, v20
v_max3_f32 v225, v225, v21, v22
v_max3_f32 v225, v225, v23, v24
v_max3_f32 v225, v225, v25, v26
v_max3_f32 v225, v225, v27, v28
v_mfma_f32_32x32x16_bf16 v[32:47], v[84:87], v[96:99], v[32:47]
buffer_load_dwordx4 v236, s[28:31], s78 offen lds
s_add_u32 m0, s86, 0x3800
v_max3_f32 v225, v225, v29, v30
v_max_f32_e64 v225, v225, v31
v_fma_f32 v225, v225, s70, v255
v_max_f32_e64 v224, v224, v225
v_mfma_f32_32x32x16_bf16 v[48:63], v[100:103], v[88:91], v[48:63]
v_mov_b32_e64 v225, v224
v_cvt_pk_bf16_f32 v71, v158, v159
v_cvt_pk_bf16_f32 v72, v160, v161
v_permlane32_swap_b32_e32 v224, v225
v_max_f32_e32 v224, v224, v225
v_mfma_f32_32x32x16_bf16 v[48:63], v[104:107], v[92:95], v[48:63]
buffer_load_dwordx4 v237, s[28:31], s78 offen lds
s_add_u32 m0, s86, 0x3c00
s_add_u32 s78, s79, 0x7800
v_sub_f32_e64 v226, v254, v224
v_fma_f32 v0, v0, s70, v226
v_fma_f32 v1, v1, s70, v226
v_mfma_f32_32x32x16_bf16 v[48:63], v[108:111], v[96:99], v[48:63]
v_exp_f32_e32 v0, v0
v_exp_f32_e32 v1, v1
v_fma_f32 v2, v2, s70, v226
v_fma_f32 v3, v3, s70, v226
v_mfma_f32_16x16x32_bf16 v[192:195], a[240:243], a[144:147], 0
buffer_load_dwordx4 v235, s[28:31], s78 offen lds
s_add_u32 m0, s86, 0x4000
v_mfma_f32_16x16x32_bf16 v[196:199], a[240:243], a[148:151], 0
v_exp_f32_e64 v2, v2
v_mfma_f32_16x16x32_bf16 v[200:203], a[240:243], a[152:155], 0
ds_read_b128 a[240:243], v244 offset:18432
v_fma_f32 v4, v4, s70, v226
v_mfma_f32_16x16x32_bf16 v[192:195], a[244:247], a[156:159], v[192:195]
v_exp_f32_e64 v3, v3
v_mfma_f32_16x16x32_bf16 v[196:199], a[244:247], a[160:163], v[196:199]
buffer_load_dwordx4 v236, s[28:31], s78 offen lds
s_add_u32 m0, s86, 0x4400
v_mfma_f32_16x16x32_bf16 v[200:203], a[244:247], a[164:167], v[200:203]
ds_read_b128 a[244:247], v245 offset:18432
v_fma_f32 v5, v5, s70, v226
v_mfma_f32_16x16x32_bf16 v[192:195], a[248:251], a[168:171], v[192:195]
v_fma_f32 v6, v6, s70, v226
v_fma_f32 v7, v7, s70, v226
v_mfma_f32_16x16x32_bf16 v[196:199], a[248:251], a[172:175], v[196:199]
v_exp_f32_e64 v4, v4
v_mfma_f32_16x16x32_bf16 v[200:203], a[248:251], a[176:179], v[200:203]
ds_read_b128 a[248:251], v244 offset:4096
buffer_load_dwordx4 v237, s[28:31], s78 offen lds
v_mfma_f32_16x16x32_bf16 v[192:195], a[252:255], a[180:183], v[192:195]
s_add_u32 m0, s87, 0
v_exp_f32_e32 v5, v5
v_mfma_f32_16x16x32_bf16 v[196:199], a[252:255], a[184:187], v[196:199]
v_exp_f32_e64 v6, v6
v_mfma_f32_16x16x32_bf16 v[200:203], a[252:255], a[188:191], v[200:203]
ds_read_b128 a[252:255], v245 offset:4096
v_cvt_pk_bf16_f32 v0, v0, v1
v_mfma_f32_16x16x32_bf16 v[192:195], a[216:219], a[192:195], v[192:195]
v_exp_f32_e64 v7, v7
v_mfma_f32_16x16x32_bf16 v[196:199], a[216:219], a[196:199], v[196:199]
v_cvt_pk_bf16_f32 v1, v2, v3
v_cvt_pk_bf16_f32 v2, v4, v5
v_mfma_f32_16x16x32_bf16 v[200:203], a[216:219], a[200:203], v[200:203]
ds_read_b128 a[216:219], v244 offset:12288
v_cvt_pk_bf16_f32 v3, v6, v7
v_mfma_f32_16x16x32_bf16 v[192:195], a[220:223], a[204:207], v[192:195]
v_fma_f32 v8, v8, s70, v226
v_fma_f32 v9, v9, s70, v226
v_mfma_f32_16x16x32_bf16 v[196:199], a[220:223], a[208:211], v[196:199]
v_fma_f32 v10, v10, s70, v226
v_fma_f32 v11, v11, s70, v226
v_mfma_f32_16x16x32_bf16 v[200:203], a[220:223], a[212:215], v[200:203]
ds_read_b128 a[220:223], v245 offset:12288
v_fma_f32 v12, v12, s70, v226
v_mfma_f32_16x16x32_bf16 v[204:207], a[224:227], a[144:147], 0
v_cvt_pk_bf16_f32 v112, v192, v193
v_cvt_pk_bf16_f32 v113, v194, v195
v_mfma_f32_16x16x32_bf16 v[208:211], a[224:227], a[148:151], 0
v_cvt_pk_bf16_f32 v114, v196, v197
v_cvt_pk_bf16_f32 v115, v198, v199
v_mfma_f32_16x16x32_bf16 v[212:215], a[224:227], a[152:155], 0
ds_read_b128 a[224:227], v244 offset:20480
v_cvt_pk_bf16_f32 v116, v200, v201
v_mfma_f32_16x16x32_bf16 v[204:207], a[228:231], a[156:159], v[204:207]
v_cvt_pk_bf16_f32 v117, v202, v203
v_fma_f32 v13, v13, s70, v226
v_mfma_f32_16x16x32_bf16 v[208:211], a[228:231], a[160:163], v[208:211]
v_permlane16_swap_b32_e32 v112, v114
v_mfma_f32_16x16x32_bf16 v[212:215], a[228:231], a[164:167], v[212:215]
s_waitcnt lgkmcnt(2)
ds_read_b128 a[228:231], v245 offset:20480
v_fma_f32 v14, v14, s70, v226
v_mfma_f32_16x16x32_bf16 v[204:207], a[232:235], a[168:171], v[204:207]
v_permlane16_swap_b32_e64 v113, v115
v_mfma_f32_16x16x32_bf16 v[208:211], a[232:235], a[172:175], v[208:211]
v_fma_f32 v15, v15, s70, v226
v_sub_f32_e64 v227, v255, v224
v_mfma_f32_16x16x32_bf16 v[212:215], a[232:235], a[176:179], v[212:215]
ds_read_b128 a[232:235], v244 offset:6144
v_fma_f32 v16, v16, s70, v227
v_mfma_f32_16x16x32_bf16 v[204:207], a[236:239], a[180:183], v[204:207]
v_exp_f32_e64 v8, v8
v_mfma_f32_16x16x32_bf16 v[208:211], a[236:239], a[184:187], v[208:211]
v_exp_f32_e64 v9, v9
v_mfma_f32_16x16x32_bf16 v[212:215], a[236:239], a[188:191], v[212:215]
ds_read_b128 a[236:239], v245 offset:6144
v_cvt_pk_bf16_f32 v4, v8, v9
v_mfma_f32_16x16x32_bf16 v[204:207], a[240:243], a[192:195], v[204:207]
v_exp_f32_e64 v10, v10
v_mfma_f32_16x16x32_bf16 v[208:211], a[240:243], a[196:199], v[208:211]
v_exp_f32_e64 v11, v11
v_mfma_f32_16x16x32_bf16 v[212:215], a[240:243], a[200:203], v[212:215]
ds_read_b128 a[240:243], v244 offset:14336
v_cvt_pk_bf16_f32 v5, v10, v11
v_mfma_f32_16x16x32_bf16 v[204:207], a[244:247], a[204:207], v[204:207]
v_exp_f32_e64 v12, v12
v_mfma_f32_16x16x32_bf16 v[208:211], a[244:247], a[208:211], v[208:211]
v_exp_f32_e64 v13, v13
v_mfma_f32_16x16x32_bf16 v[212:215], a[244:247], a[212:215], v[212:215]
ds_read_b128 a[244:247], v245 offset:14336
v_cvt_pk_bf16_f32 v6, v12, v13
v_mfma_f32_16x16x32_bf16 v[192:195], a[248:251], a[144:147], 0
v_exp_f32_e64 v14, v14
v_mfma_f32_16x16x32_bf16 v[196:199], a[248:251], a[148:151], 0
v_exp_f32_e64 v15, v15
v_mfma_f32_16x16x32_bf16 v[200:203], a[248:251], a[152:155], 0
ds_read_b128 a[248:251], v244 offset:22528
v_cvt_pk_bf16_f32 v7, v14, v15
v_mfma_f32_16x16x32_bf16 v[192:195], a[252:255], a[156:159], v[192:195]
v_fma_f32 v17, v17, s70, v227
v_fma_f32 v18, v18, s70, v227
v_mfma_f32_16x16x32_bf16 v[196:199], a[252:255], a[160:163], v[196:199]
v_fma_f32 v19, v19, s70, v227
v_fma_f32 v20, v20, s70, v227
v_mfma_f32_16x16x32_bf16 v[200:203], a[252:255], a[164:167], v[200:203]
ds_read_b128 a[252:255], v245 offset:22528
v_fma_f32 v21, v21, s70, v227
v_mfma_f32_16x16x32_bf16 v[192:195], a[216:219], a[168:171], v[192:195]
v_fma_f32 v22, v22, s70, v227
v_fma_f32 v23, v23, s70, v227
v_mfma_f32_16x16x32_bf16 v[196:199], a[216:219], a[172:175], v[196:199]
v_exp_f32_e32 v16, v16
v_mfma_f32_16x16x32_bf16 v[200:203], a[216:219], a[176:179], v[200:203]
s_waitcnt lgkmcnt(2)
ds_read_b128 a[216:219], v240 offset:29696
v_fma_f32 v24, v24, s70, v227
v_mfma_f32_16x16x32_bf16 v[192:195], a[220:223], a[180:183], v[192:195]
v_exp_f32_e64 v17, v17
v_mfma_f32_16x16x32_bf16 v[196:199], a[220:223], a[184:187], v[196:199]
v_exp_f32_e64 v18, v18
v_mfma_f32_16x16x32_bf16 v[200:203], a[220:223], a[188:191], v[200:203]
v_cvt_pk_bf16_f32 v120, v204, v205
v_cvt_pk_bf16_f32 v121, v206, v207
v_mfma_f32_16x16x32_bf16 v[192:195], a[224:227], a[192:195], v[192:195]
s_waitcnt lgkmcnt(1)
s_barrier
buffer_load_dwordx4 v233, s[20:23], s56 offen nt lds
v_mfma_f32_16x16x32_bf16 v[196:199], a[224:227], a[196:199], v[196:199]
s_add_u32 m0, s87, 0x1000
v_cvt_pk_bf16_f32 v122, v208, v209
v_cvt_pk_bf16_f32 v123, v210, v211
v_mfma_f32_16x16x32_bf16 v[200:203], a[224:227], a[200:203], v[200:203]
v_cvt_pk_bf16_f32 v124, v212, v213
v_cvt_pk_bf16_f32 v125, v214, v215
v_mfma_f32_16x16x32_bf16 v[192:195], a[228:231], a[204:207], v[192:195]
ds_read_b128 a[220:223], v241 offset:29696
ds_read_b128 a[224:227], v242 offset:29696
v_mfma_f32_16x16x32_bf16 v[196:199], a[228:231], a[208:211], v[196:199]
v_permlane16_swap_b32_e64 v120, v122
v_mfma_f32_16x16x32_bf16 v[200:203], a[228:231], a[212:215], v[200:203]
buffer_load_dwordx4 v233, s[20:23], s94 offen nt lds
s_add_u32 m0, s87, 0x1f80
v_mfma_f32_16x16x32_bf16 v[204:207], a[232:235], a[144:147], 0
ds_read_b128 a[228:231], v243 offset:29696
v_cvt_pk_bf16_f32 v8, v16, v17
v_mfma_f32_16x16x32_bf16 v[208:211], a[232:235], a[148:151], 0
v_permlane16_swap_b32_e64 v121, v123
v_mfma_f32_16x16x32_bf16 v[212:215], a[232:235], a[152:155], 0
v_cvt_pk_bf16_f32 v132, v200, v201
v_cvt_pk_bf16_f32 v133, v202, v203
v_mfma_f32_16x16x32_bf16 v[204:207], a[236:239], a[156:159], v[204:207]
buffer_load_dwordx4 v233, s[20:23], s56 offen offset:128 nt lds
ds_read_b128 a[232:235], v240 offset:37888
v_mfma_f32_16x16x32_bf16 v[208:211], a[236:239], a[160:163], v[208:211]
s_add_u32 m0, s87, 0x2f80
v_exp_f32_e64 v19, v19
v_mfma_f32_16x16x32_bf16 v[212:215], a[236:239], a[164:167], v[212:215]
v_exp_f32_e64 v20, v20
v_mfma_f32_16x16x32_bf16 v[204:207], a[240:243], a[168:171], v[204:207]
v_exp_f32_e64 v21, v21
v_mfma_f32_16x16x32_bf16 v[208:211], a[240:243], a[172:175], v[208:211]
v_exp_f32_e64 v22, v22
v_mfma_f32_16x16x32_bf16 v[212:215], a[240:243], a[176:179], v[212:215]
v_exp_f32_e64 v23, v23
v_mfma_f32_16x16x32_bf16 v[204:207], a[244:247], a[180:183], v[204:207]
v_cvt_pk_bf16_f32 v9, v18, v19
v_cvt_pk_bf16_f32 v10, v20, v21
v_mfma_f32_16x16x32_bf16 v[208:211], a[244:247], a[184:187], v[208:211]
v_mov_b32_e32 v118, s19
v_mov_b32_e32 v119, s19
v_mfma_f32_16x16x32_bf16 v[212:215], a[244:247], a[188:191], v[212:215]
v_permlane16_swap_b32_e64 v116, v118
v_mfma_f32_16x16x32_bf16 v[204:207], a[248:251], a[192:195], v[204:207]
v_permlane16_swap_b32_e64 v117, v119
v_mfma_f32_16x16x32_bf16 v[208:211], a[248:251], a[196:199], v[208:211]
v_cvt_pk_bf16_f32 v128, v192, v193
v_cvt_pk_bf16_f32 v129, v194, v195
v_mfma_f32_16x16x32_bf16 v[212:215], a[248:251], a[200:203], v[212:215]
v_cvt_pk_bf16_f32 v130, v196, v197
v_cvt_pk_bf16_f32 v131, v198, v199
v_mfma_f32_16x16x32_bf16 v[204:207], a[252:255], a[204:207], v[204:207]
v_mov_b32_e32 v126, s19
v_mov_b32_e32 v127, s19
v_mfma_f32_16x16x32_bf16 v[208:211], a[252:255], a[208:211], v[208:211]
v_permlane16_swap_b32_e64 v124, v126
v_mfma_f32_16x16x32_bf16 v[212:215], a[252:255], a[212:215], v[212:215]
v_permlane16_swap_b32_e64 v125, v127
v_cvt_pk_bf16_f32 v11, v22, v23
v_permlane16_swap_b32_e64 v132, v134
v_cvt_pk_bf16_f32 v136, v204, v205
v_cvt_pk_bf16_f32 v137, v206, v207
v_permlane16_swap_b32_e64 v133, v135
v_cvt_pk_bf16_f32 v138, v208, v209
v_cvt_pk_bf16_f32 v139, v210, v211
v_cvt_pk_bf16_f32 v140, v212, v213
v_cvt_pk_bf16_f32 v141, v214, v215
v_mfma_f32_32x32x16_bf16 v[208:223], v[116:119], v[0:3], 0
v_permlane16_swap_b32_e32 v128, v130
v_permlane16_swap_b32_e32 v129, v131
v_fma_f32 v25, v25, s70, v227
v_fma_f32 v26, v26, s70, v227
v_mfma_f32_32x32x16_bf16 v[192:207], v[112:115], v[0:3], 0
v_fma_f32 v27, v27, s70, v227
v_fma_f32 v28, v28, s70, v227
v_fma_f32 v29, v29, s70, v227
v_fma_f32 v30, v30, s70, v227
v_fma_f32 v31, v31, s70, v227
v_cvt_pk_bf16_f32 v73, v162, v163
v_mfma_f32_32x32x16_bf16 v[208:223], v[124:127], v[4:7], v[208:223]
v_exp_f32_e32 v24, v24
v_exp_f32_e32 v25, v25
v_exp_f32_e64 v26, v26
v_mfma_f32_32x32x16_bf16 v[192:207], v[120:123], v[4:7], v[192:207]
v_exp_f32_e32 v27, v27
v_exp_f32_e32 v28, v28
v_exp_f32_e64 v29, v29
v_mfma_f32_32x32x16_bf16 v[208:223], v[132:135], v[8:11], v[208:223]
v_exp_f32_e32 v30, v30
v_exp_f32_e32 v31, v31
v_cvt_pk_bf16_f32 v12, v24, v25
v_cvt_pk_bf16_f32 v13, v26, v27
v_mfma_f32_32x32x16_bf16 v[192:207], v[128:131], v[8:11], v[192:207]
v_cvt_pk_bf16_f32 v14, v28, v29
v_cvt_pk_bf16_f32 v15, v30, v31
v_permlane16_swap_b32_e32 v140, v142
v_permlane16_swap_b32_e32 v141, v143
v_permlane16_swap_b32_e64 v136, v138
v_cvt_pk_bf16_f32 v74, v164, v165
v_mfma_f32_32x32x16_bf16 v[208:223], v[140:143], v[12:15], v[208:223]
ds_read_b128 a[236:239], v241 offset:37888
v_permlane16_swap_b32_e32 v137, v139
v_cvt_pk_bf16_f32 v75, v166, v167
v_cvt_pk_bf16_f32 v76, v168, v169
v_cvt_pk_bf16_f32 v77, v170, v171
v_mfma_f32_32x32x16_bf16 v[192:207], v[136:139], v[12:15], v[192:207]
s_waitcnt lgkmcnt(1)
v_cvt_pk_bf16_f32 v78, v172, v173
v_cvt_pk_bf16_f32 v79, v174, v175
v_cvt_pk_bf16_f32 v80, v176, v177
v_cvt_pk_bf16_f32 v81, v178, v179
v_cvt_pk_bf16_f32 v82, v180, v181
v_cvt_pk_bf16_f32 v83, v182, v183
v_mfma_f32_32x32x16_bf16 v[144:159], a[0:3], a[216:219], 0
v_cvt_pk_bf16_f32 v84, v184, v185
v_cvt_pk_bf16_f32 v85, v186, v187
v_cvt_pk_bf16_f32 v86, v188, v189
v_cvt_pk_bf16_f32 v87, v190, v191
v_max3_f32 v224, v32, v33, v34
v_max3_f32 v225, v48, v49, v50
v_mfma_f32_32x32x16_bf16 v[160:175], a[4:7], a[216:219], 0
ds_read_b128 a[240:243], v242 offset:37888
buffer_load_dwordx4 v233, s[20:23], s94 offen offset:128 nt lds
ds_read_b128 a[244:247], v243 offset:37888
ds_read_b128 a[248:251], v244 offset:25600
v_max3_f32 v224, v224, v35, v36
v_max3_f32 v225, v225, v51, v52
v_mfma_f32_32x32x16_bf16 v[176:191], a[8:11], a[216:219], 0
s_add_u32 m0, s87, 0x3f00
v_max3_f32 v224, v224, v37, v38
v_max3_f32 v225, v225, v53, v54
v_max3_f32 v224, v224, v39, v40
v_max3_f32 v225, v225, v55, v56
v_max3_f32 v224, v224, v41, v42
v_max3_f32 v225, v225, v57, v58
v_mfma_f32_32x32x16_bf16 v[144:159], a[12:15], a[220:223], v[144:159]
v_max3_f32 v224, v224, v43, v44
v_max3_f32 v225, v225, v59, v60
v_max3_f32 v224, v224, v45, v46
v_max3_f32 v225, v225, v61, v62
v_max_f32_e32 v224, v224, v47
v_max_f32_e32 v225, v225, v63
v_mfma_f32_32x32x16_bf16 v[160:175], a[16:19], a[220:223], v[160:175]
v_fma_f32 v224, v224, s70, v255
v_fma_f32 v225, v225, s70, v254
v_max_f32_e32 v224, v224, v225
v_mov_b32_e32 v225, v224
v_rcp_f32_e64 v217, v216
v_mfma_f32_32x32x16_bf16 v[176:191], a[20:23], a[220:223], v[176:191]
ds_read_b128 a[252:255], v245 offset:25600
v_permlane32_swap_b32_e32 v224, v225
v_max_f32_e32 v224, v224, v225
v_sub_f32_e64 v228, v255, v224
v_fma_f32 v32, v32, s70, v228
v_mfma_f32_32x32x16_bf16 v[144:159], a[24:27], a[224:227], v[144:159]
v_fma_f32 v33, v33, s70, v228
v_exp_f32_e32 v32, v32
v_exp_f32_e32 v33, v33
v_fma_f32 v34, v34, s70, v228
v_mfma_f32_32x32x16_bf16 v[160:175], a[28:31], a[224:227], v[160:175]
v_fma_f32 v35, v35, s70, v228
v_exp_f32_e32 v34, v34
v_exp_f32_e32 v35, v35
v_fma_f32 v36, v36, s70, v228
v_mfma_f32_32x32x16_bf16 v[176:191], a[32:35], a[224:227], v[176:191]
v_fma_f32 v37, v37, s70, v228
v_fma_f32 v38, v38, s70, v228
v_fma_f32 v39, v39, s70, v228
v_exp_f32_e64 v36, v36
v_cvt_pk_bf16_f32 v32, v32, v33
v_mfma_f32_32x32x16_bf16 v[144:159], a[36:39], a[228:231], v[144:159]
v_exp_f32_e32 v37, v37
v_exp_f32_e32 v38, v38
v_exp_f32_e64 v39, v39
v_mfma_f32_32x32x16_bf16 v[160:175], a[40:43], a[228:231], v[160:175]
v_cvt_pk_bf16_f32 v33, v34, v35
v_cvt_pk_bf16_f32 v34, v36, v37
v_cvt_pk_bf16_f32 v35, v38, v39
v_fma_f32 v40, v40, s70, v228
v_fma_f32 v41, v41, s70, v228
v_fma_f32 v42, v42, s70, v228
v_mfma_f32_32x32x16_bf16 v[176:191], a[44:47], a[228:231], v[176:191]
ds_read_b128 a[216:219], v244 offset:33792
v_fma_f32 v43, v43, s70, v228
v_fma_f32 v44, v44, s70, v228
v_fma_f32 v45, v45, s70, v228
v_fma_f32 v46, v46, s70, v228
v_fma_f32 v47, v47, s70, v228
v_mfma_f32_32x32x16_bf16 v[144:159], a[48:51], a[232:235], v[144:159]
ds_read_b128 a[220:223], v245 offset:33792
v_exp_f32_e32 v40, v40
v_exp_f32_e32 v41, v41
v_sub_f32_e64 v229, v254, v224
v_mfma_f32_32x32x16_bf16 v[160:175], a[52:55], a[232:235], v[160:175]
v_exp_f32_e32 v42, v42
v_exp_f32_e32 v43, v43
v_exp_f32_e64 v44, v44
v_mfma_f32_32x32x16_bf16 v[176:191], a[56:59], a[232:235], v[176:191]
s_waitcnt lgkmcnt(2)
v_exp_f32_e32 v45, v45
v_exp_f32_e32 v46, v46
v_exp_f32_e32 v47, v47
v_mfma_f32_32x32x16_bf16 v[144:159], a[60:63], a[236:239], v[144:159]
v_cvt_pk_bf16_f32 v36, v40, v41
v_cvt_pk_bf16_f32 v37, v42, v43
v_cvt_pk_bf16_f32 v38, v44, v45
v_cvt_pk_bf16_f32 v39, v46, v47
v_fma_f32 v48, v48, s70, v229
v_fma_f32 v49, v49, s70, v229
v_mfma_f32_32x32x16_bf16 v[160:175], a[64:67], a[236:239], v[160:175]
ds_read_b128 a[224:227], v244 offset:41984
v_fma_f32 v50, v50, s70, v229
v_fma_f32 v51, v51, s70, v229
v_fma_f32 v52, v52, s70, v229
v_fma_f32 v53, v53, s70, v229
v_fma_f32 v54, v54, s70, v229
v_mfma_f32_32x32x16_bf16 v[176:191], a[68:71], a[236:239], v[176:191]
v_fma_f32 v55, v55, s70, v229
v_exp_f32_e32 v48, v48
v_exp_f32_e32 v49, v49
v_fma_f32 v56, v56, s70, v229
v_mfma_f32_32x32x16_bf16 v[16:31], v[116:119], v[32:35], 0
v_exp_f32_e32 v50, v50
v_exp_f32_e32 v51, v51
v_exp_f32_e64 v52, v52
v_mfma_f32_32x32x16_bf16 v[0:15], v[112:115], v[32:35], 0
v_exp_f32_e32 v53, v53
v_exp_f32_e32 v54, v54
v_exp_f32_e64 v55, v55
v_mfma_f32_32x32x16_bf16 v[16:31], v[124:127], v[36:39], v[16:31]
v_cvt_pk_bf16_f32 v40, v48, v49
v_cvt_pk_bf16_f32 v41, v50, v51
v_cvt_pk_bf16_f32 v42, v52, v53
v_cvt_pk_bf16_f32 v43, v54, v55
v_fma_f32 v57, v57, s70, v229
v_fma_f32 v58, v58, s70, v229
v_mfma_f32_32x32x16_bf16 v[0:15], v[120:123], v[36:39], v[0:15]
ds_read_b128 a[228:231], v245 offset:41984
v_fma_f32 v59, v59, s70, v229
v_fma_f32 v60, v60, s70, v229
v_fma_f32 v61, v61, s70, v229
v_fma_f32 v62, v62, s70, v229
v_fma_f32 v63, v63, s70, v229
v_mfma_f32_32x32x16_bf16 v[16:31], v[132:135], v[40:43], v[16:31]
v_exp_f32_e32 v56, v56
v_exp_f32_e32 v57, v57
v_exp_f32_e64 v58, v58
v_mfma_f32_32x32x16_bf16 v[0:15], v[128:131], v[40:43], v[0:15]
v_exp_f32_e32 v59, v59
v_exp_f32_e32 v60, v60
v_exp_f32_e32 v61, v61
v_exp_f32_e32 v62, v62
v_exp_f32_e64 v63, v63
v_cvt_pk_bf16_f32 v44, v56, v57
v_cvt_pk_bf16_f32 v45, v58, v59
v_cvt_pk_bf16_f32 v46, v60, v61
v_cvt_pk_bf16_f32 v47, v62, v63
v_mul_f32_e32 v192, v217, v192
v_mul_f32_e32 v193, v217, v193
v_mfma_f32_32x32x16_bf16 v[16:31], v[140:143], v[44:47], v[16:31]
ds_read_b128 a[232:235], v240 offset:46080
ds_read_b128 a[236:239], v241 offset:46080
v_mul_f32_e32 v194, v217, v194
v_mul_f32_e32 v195, v217, v195
v_cvt_pk_bf16_f32 v192, v192, v193
v_mul_f32_e64 v196, v217, v196
v_mfma_f32_32x32x16_bf16 v[0:15], v[136:139], v[44:47], v[0:15]
v_mul_f32_e32 v197, v217, v197
v_mul_f32_e32 v198, v217, v198
v_mul_f32_e64 v199, v217, v199
v_cvt_pk_bf16_f32 v193, v194, v195
v_cvt_pk_bf16_f32 v194, v196, v197
v_cvt_pk_bf16_f32 v195, v198, v199
v_mfma_f32_32x32x16_bf16 v[144:159], a[72:75], a[240:243], v[144:159]
ds_write_b128 v247, v[192:195] offset:51200
v_mul_f32_e64 v200, v217, v200
v_mfma_f32_32x32x16_bf16 v[160:175], a[76:79], a[240:243], v[160:175]
v_mul_f32_e32 v201, v217, v201
v_mul_f32_e32 v202, v217, v202
v_mul_f32_e64 v203, v217, v203
v_cvt_pk_bf16_f32 v200, v200, v201
v_mul_f32_e32 v204, v217, v204
v_mul_f32_e32 v205, v217, v205
v_mfma_f32_32x32x16_bf16 v[176:191], a[80:83], a[240:243], v[176:191]
ds_read_b128 a[240:243], v244 offset:27648
v_mul_f32_e32 v206, v217, v206
v_mul_f32_e32 v207, v217, v207
v_cvt_pk_bf16_f32 v201, v202, v203
v_cvt_pk_bf16_f32 v202, v204, v205
v_cvt_pk_bf16_f32 v203, v206, v207
v_mfma_f32_32x32x16_bf16 v[144:159], a[84:87], a[244:247], v[144:159]
ds_write_b128 v247, v[200:203] offset:51232
buffer_load_dwordx4 v233, s[20:23], s56 offen offset:256 nt lds
v_mfma_f32_32x32x16_bf16 v[160:175], a[88:91], a[244:247], v[160:175]
s_add_u32 m0, s87, 0x4f00
v_mul_f32_e32 v208, v217, v208
v_mul_f32_e32 v209, v217, v209
v_mul_f32_e32 v210, v217, v210
v_mul_f32_e32 v211, v217, v211
v_cvt_pk_bf16_f32 v208, v208, v209
v_mul_f32_e64 v212, v217, v212
v_mfma_f32_32x32x16_bf16 v[176:191], a[92:95], a[244:247], v[176:191]
ds_read_b128 a[244:247], v245 offset:27648
v_mul_f32_e32 v213, v217, v213
v_mul_f32_e32 v214, v217, v214
v_mul_f32_e64 v215, v217, v215
v_cvt_pk_bf16_f32 v209, v210, v211
v_cvt_pk_bf16_f32 v210, v212, v213
v_mfma_f32_16x16x32_bf16 v[192:195], a[248:251], a[144:147], 0
v_cvt_pk_bf16_f32 v211, v214, v215
v_mul_f32_e64 v254, s63, v253
v_mfma_f32_16x16x32_bf16 v[196:199], a[248:251], a[148:151], 0
buffer_load_dwordx4 v233, s[20:23], s94 offen offset:256 nt lds
ds_read_b128 v[28:31], v248 offset:2112
v_mfma_f32_16x16x32_bf16 v[200:203], a[248:251], a[152:155], 0
ds_read_b128 a[248:251], v244 offset:35840
ds_read_b128 v[32:35], v248
v_mfma_f32_16x16x32_bf16 v[192:195], a[252:255], a[156:159], v[192:195]
ds_read_b128 v[36:39], v248 offset:192
ds_read_b128 v[40:43], v248 offset:384
v_mfma_f32_16x16x32_bf16 v[196:199], a[252:255], a[160:163], v[196:199]
v_rcp_f32_e32 v25, v24
v_mfma_f32_16x16x32_bf16 v[200:203], a[252:255], a[164:167], v[200:203]
s_waitcnt lgkmcnt(6)
ds_read_b128 a[252:255], v245 offset:35840
ds_read_b128 v[44:47], v248 offset:576
v_mfma_f32_16x16x32_bf16 v[192:195], a[216:219], a[168:171], v[192:195]
v_mul_f32_e32 v0, v25, v0
v_mul_f32_e32 v1, v25, v1
v_mfma_f32_16x16x32_bf16 v[196:199], a[216:219], a[172:175], v[196:199]
ds_read_b128 v[48:51], v248 offset:768
ds_read_b128 v[52:55], v248 offset:960
v_mfma_f32_16x16x32_bf16 v[200:203], a[216:219], a[176:179], v[200:203]
v_mul_f32_e32 v8, v25, v8
v_mul_f32_e32 v9, v25, v9
v_mfma_f32_16x16x32_bf16 v[192:195], a[220:223], a[180:183], v[192:195]
ds_read_b128 a[216:219], v244 offset:44032
ds_read_b128 v[56:59], v248 offset:1152
v_mfma_f32_16x16x32_bf16 v[196:199], a[220:223], a[184:187], v[196:199]
v_mul_f32_e32 v2, v25, v2
v_mul_f32_e32 v3, v25, v3
v_mfma_f32_16x16x32_bf16 v[200:203], a[220:223], a[188:191], v[200:203]
ds_read_b128 a[220:223], v245 offset:44032
ds_read_b128 v[60:63], v248 offset:1344
v_mfma_f32_16x16x32_bf16 v[192:195], a[224:227], a[192:195], v[192:195]
v_cvt_pk_bf16_f32 v0, v0, v1
v_mul_f32_e64 v10, v25, v10
v_mfma_f32_16x16x32_bf16 v[196:199], a[224:227], a[196:199], v[196:199]
v_mul_f32_e64 v11, v25, v11
v_cvt_pk_bf16_f32 v8, v8, v9
v_mfma_f32_16x16x32_bf16 v[200:203], a[224:227], a[200:203], v[200:203]
ds_read_b128 a[224:227], v242 offset:46080
v_mul_f32_e64 v4, v25, v4
v_mfma_f32_16x16x32_bf16 v[192:195], a[228:231], a[204:207], v[192:195]
v_mul_f32_e32 v5, v25, v5
v_mul_f32_e32 v6, v25, v6
v_mfma_f32_16x16x32_bf16 v[196:199], a[228:231], a[208:211], v[196:199]
v_mul_f32_e64 v7, v25, v7
v_cvt_pk_bf16_f32 v1, v2, v3
v_mfma_f32_16x16x32_bf16 v[200:203], a[228:231], a[212:215], v[200:203]
ds_read_b128 a[228:231], v243 offset:46080
v_mul_f32_e64 v12, v25, v12
v_mfma_f32_32x32x16_bf16 v[144:159], a[96:99], a[232:235], v[144:159]
ds_write_b128 v247, v[208:211] offset:51264
v_cvt_pk_bf16_f32 v112, v192, v193
v_mfma_f32_32x32x16_bf16 v[160:175], a[100:103], a[232:235], v[160:175]
v_cvt_pk_bf16_f32 v113, v194, v195
v_cvt_pk_bf16_f32 v114, v196, v197
v_cvt_pk_bf16_f32 v115, v198, v199
v_cvt_pk_bf16_f32 v116, v200, v201
v_cvt_pk_bf16_f32 v117, v202, v203
v_mul_f32_e64 v13, v25, v13
v_mfma_f32_32x32x16_bf16 v[176:191], a[104:107], a[232:235], v[176:191]
ds_read_b128 a[232:235], v244 offset:29696
v_mul_f32_e32 v14, v25, v14
v_mul_f32_e32 v15, v25, v15
v_cvt_pk_bf16_f32 v9, v10, v11
v_cvt_pk_bf16_f32 v2, v4, v5
v_cvt_pk_bf16_f32 v3, v6, v7
v_mfma_f32_32x32x16_bf16 v[144:159], a[108:111], a[236:239], v[144:159]
ds_write_b128 v247, v[0:3] offset:64000
v_cvt_pk_bf16_f32 v10, v12, v13
v_mfma_f32_32x32x16_bf16 v[160:175], a[112:115], a[236:239], v[160:175]
v_cvt_pk_bf16_f32 v11, v14, v15
v_mul_f32_e32 v16, v25, v16
v_mul_f32_e32 v17, v25, v17
v_mul_f32_e32 v18, v25, v18
v_mul_f32_e32 v19, v25, v19
v_cvt_pk_bf16_f32 v16, v16, v17
v_mfma_f32_32x32x16_bf16 v[176:191], a[116:119], a[236:239], v[176:191]
ds_read_b128 a[236:239], v245 offset:29696
ds_write_b128 v247, v[8:11] offset:64032
v_mfma_f32_16x16x32_bf16 v[204:207], a[240:243], a[144:147], 0
v_mul_f32_e32 v20, v25, v20
v_mul_f32_e32 v21, v25, v21
v_mfma_f32_16x16x32_bf16 v[208:211], a[240:243], a[148:151], 0
ds_read_b128 v[0:3], v248 offset:768
ds_read_b128 v[4:7], v248 offset:960
v_mfma_f32_16x16x32_bf16 v[212:215], a[240:243], a[152:155], 0
s_waitcnt lgkmcnt(4)
v_mul_f32_e32 v22, v25, v22
v_mul_f32_e64 v23, v25, v23
v_mfma_f32_16x16x32_bf16 v[204:207], a[244:247], a[156:159], v[204:207]
ds_read_b128 a[240:243], v244 offset:37888
ds_read_b128 v[8:11], v248 offset:1152
v_mfma_f32_16x16x32_bf16 v[208:211], a[244:247], a[160:163], v[208:211]
v_cvt_pk_bf16_f32 v17, v18, v19
v_cvt_pk_bf16_f32 v18, v20, v21
v_mfma_f32_16x16x32_bf16 v[212:215], a[244:247], a[164:167], v[212:215]
ds_read_b128 a[244:247], v245 offset:37888
ds_read_b128 v[12:15], v248 offset:1344
v_mfma_f32_16x16x32_bf16 v[204:207], a[248:251], a[168:171], v[204:207]
v_cvt_pk_bf16_f32 v19, v22, v23
v_min_f32_e64 v255, s67, v254
v_mfma_f32_16x16x32_bf16 v[208:211], a[248:251], a[172:175], v[208:211]
ds_read_b128 v[20:23], v248 offset:1728
ds_read_b128 v[24:27], v248 offset:1920
v_mfma_f32_16x16x32_bf16 v[212:215], a[248:251], a[176:179], v[212:215]
v_mov_b32_e32 v118, s19
v_mov_b32_e32 v119, s19
v_mfma_f32_16x16x32_bf16 v[204:207], a[252:255], a[180:183], v[204:207]
ds_read_b128 a[248:251], v244 offset:46080
v_mov_b32_e64 v126, s19
v_mfma_f32_16x16x32_bf16 v[208:211], a[252:255], a[184:187], v[208:211]
v_permlane16_swap_b32_e64 v116, v118
v_mfma_f32_16x16x32_bf16 v[212:215], a[252:255], a[188:191], v[212:215]
ds_read_b128 a[252:255], v245 offset:46080
v_mov_b32_e64 v127, s19
v_mfma_f32_16x16x32_bf16 v[204:207], a[216:219], a[192:195], v[204:207]
v_permlane16_swap_b32_e64 v117, v119
v_mfma_f32_16x16x32_bf16 v[208:211], a[216:219], a[196:199], v[208:211]
v_permlane16_swap_b32_e64 v112, v114
v_mfma_f32_16x16x32_bf16 v[212:215], a[216:219], a[200:203], v[212:215]
ds_read_b128 a[216:219], v244 offset:31744
v_mov_b32_e64 v134, s19
v_mfma_f32_16x16x32_bf16 v[204:207], a[220:223], a[204:207], v[204:207]
v_permlane16_swap_b32_e64 v113, v115
v_mfma_f32_16x16x32_bf16 v[208:211], a[220:223], a[208:211], v[208:211]
v_mov_b32_e32 v135, s19
v_mov_b32_e32 v142, s19
v_mfma_f32_16x16x32_bf16 v[212:215], a[220:223], a[212:215], v[212:215]
ds_read_b128 a[220:223], v245 offset:31744
v_mov_b32_e64 v143, s19
v_mfma_f32_32x32x16_bf16 v[144:159], a[120:123], a[224:227], v[144:159]
ds_write_b128 v247, v[16:19] offset:64064
v_cvt_pk_bf16_f32 v120, v204, v205
v_mfma_f32_32x32x16_bf16 v[160:175], a[124:127], a[224:227], v[160:175]
v_cvt_pk_bf16_f32 v121, v206, v207
v_cvt_pk_bf16_f32 v122, v208, v209
v_cvt_pk_bf16_f32 v123, v210, v211
v_cvt_pk_bf16_f32 v124, v212, v213
v_cvt_pk_bf16_f32 v125, v214, v215
v_mov_b32_e64 v235, 0
v_mfma_f32_32x32x16_bf16 v[176:191], a[128:131], a[224:227], v[176:191]
ds_read_b128 a[224:227], v244 offset:39936
ds_read_b128 v[16:19], v248 offset:1536
v_permlane16_swap_b32_e32 v124, v126
v_permlane16_swap_b32_e32 v125, v127
v_mfma_f32_32x32x16_bf16 v[144:159], a[132:135], a[228:231], v[144:159]
v_permlane16_swap_b32_e32 v120, v122
v_permlane16_swap_b32_e32 v121, v123
s_nop 1
v_mfma_f32_32x32x16_bf16 v[160:175], a[136:139], a[228:231], v[160:175]
s_nop 6
v_mfma_f32_32x32x16_bf16 v[176:191], a[140:143], a[228:231], v[176:191]
ds_read_b128 a[228:231], v245 offset:39936
v_cvt_pk_bf16_f32 v88, v144, v145
v_cvt_pk_bf16_f32 v89, v146, v147
v_cvt_pk_bf16_f32 v90, v148, v149
v_cvt_pk_bf16_f32 v91, v150, v151
v_cvt_pk_bf16_f32 v92, v152, v153
v_mfma_f32_16x16x32_bf16 v[192:195], a[232:235], a[144:147], 0
v_cvt_pk_bf16_f32 v100, v168, v169
v_cvt_pk_bf16_f32 v101, v170, v171
v_mfma_f32_16x16x32_bf16 v[196:199], a[232:235], a[148:151], 0
s_nop 0
v_cvt_pk_bf16_f32 v102, v172, v173
v_cvt_pk_bf16_f32 v103, v174, v175
v_mfma_f32_16x16x32_bf16 v[200:203], a[232:235], a[152:155], 0
s_waitcnt lgkmcnt(1)
ds_read_b128 a[232:235], v244 offset:48128
v_cvt_pk_bf16_f32 v104, v176, v177
v_mfma_f32_16x16x32_bf16 v[192:195], a[236:239], a[156:159], v[192:195]
v_cvt_pk_bf16_f32 v105, v178, v179
v_cvt_pk_bf16_f32 v106, v180, v181
v_mfma_f32_16x16x32_bf16 v[196:199], a[236:239], a[160:163], v[196:199]
v_cvt_pk_bf16_f32 v107, v182, v183
v_cvt_pk_bf16_f32 v108, v184, v185
v_mfma_f32_16x16x32_bf16 v[200:203], a[236:239], a[164:167], v[200:203]
ds_read_b128 a[236:239], v245 offset:48128
v_cvt_pk_bf16_f32 v109, v186, v187
v_mfma_f32_16x16x32_bf16 v[192:195], a[240:243], a[168:171], v[192:195]
v_cvt_pk_bf16_f32 v110, v188, v189
v_cvt_pk_bf16_f32 v111, v190, v191
v_mfma_f32_16x16x32_bf16 v[196:199], a[240:243], a[172:175], v[196:199]
v_cvt_pk_bf16_f32 v93, v154, v155
v_cvt_pk_bf16_f32 v94, v156, v157
v_mfma_f32_16x16x32_bf16 v[200:203], a[240:243], a[176:179], v[200:203]
v_cvt_pk_bf16_f32 v95, v158, v159
v_cvt_pk_bf16_f32 v96, v160, v161
v_mfma_f32_16x16x32_bf16 v[192:195], a[244:247], a[180:183], v[192:195]
v_cvt_pk_bf16_f32 v97, v162, v163
v_cvt_pk_bf16_f32 v98, v164, v165
v_mfma_f32_16x16x32_bf16 v[196:199], a[244:247], a[184:187], v[196:199]
v_cvt_pk_bf16_f32 v99, v166, v167
v_mfma_f32_16x16x32_bf16 v[200:203], a[244:247], a[188:191], v[200:203]
v_mfma_f32_16x16x32_bf16 v[192:195], a[248:251], a[192:195], v[192:195]
v_mfma_f32_16x16x32_bf16 v[196:199], a[248:251], a[196:199], v[196:199]
v_mfma_f32_16x16x32_bf16 v[200:203], a[248:251], a[200:203], v[200:203]
v_mfma_f32_16x16x32_bf16 v[192:195], a[252:255], a[204:207], v[192:195]
s_nop 2
v_mfma_f32_16x16x32_bf16 v[196:199], a[252:255], a[208:211], v[196:199]
s_nop 2
v_mfma_f32_16x16x32_bf16 v[200:203], a[252:255], a[212:215], v[200:203]
v_cvt_pk_bf16_f32 v128, v192, v193
v_cvt_pk_bf16_f32 v129, v194, v195
v_mfma_f32_16x16x32_bf16 v[204:207], a[216:219], a[144:147], 0
s_nop 0
v_cvt_pk_bf16_f32 v130, v196, v197
v_cvt_pk_bf16_f32 v131, v198, v199
v_mfma_f32_16x16x32_bf16 v[208:211], a[216:219], a[148:151], 0
v_permlane16_swap_b32_e32 v128, v130
v_mfma_f32_16x16x32_bf16 v[212:215], a[216:219], a[152:155], 0
v_cvt_pk_bf16_f32 v132, v200, v201
v_cvt_pk_bf16_f32 v133, v202, v203
v_mfma_f32_16x16x32_bf16 v[204:207], a[220:223], a[156:159], v[204:207]
v_permlane16_swap_b32_e64 v132, v134
v_mfma_f32_16x16x32_bf16 v[208:211], a[220:223], a[160:163], v[208:211]
v_permlane16_swap_b32_e64 v133, v135
v_mfma_f32_16x16x32_bf16 v[212:215], a[220:223], a[164:167], v[212:215]
v_permlane16_swap_b32_e64 v129, v131
v_mfma_f32_16x16x32_bf16 v[204:207], a[224:227], a[168:171], v[204:207]
v_mfma_f32_16x16x32_bf16 v[208:211], a[224:227], a[172:175], v[208:211]
s_nop 0
v_mfma_f32_16x16x32_bf16 v[212:215], a[224:227], a[176:179], v[212:215]
s_waitcnt lgkmcnt(0)
v_mfma_f32_16x16x32_bf16 v[204:207], a[228:231], a[180:183], v[204:207]
v_mfma_f32_16x16x32_bf16 v[208:211], a[228:231], a[184:187], v[208:211]
v_mfma_f32_16x16x32_bf16 v[212:215], a[228:231], a[188:191], v[212:215]
v_mfma_f32_16x16x32_bf16 v[204:207], a[232:235], a[192:195], v[204:207]
v_mfma_f32_16x16x32_bf16 v[208:211], a[232:235], a[196:199], v[208:211]
v_mfma_f32_16x16x32_bf16 v[212:215], a[232:235], a[200:203], v[212:215]
v_mfma_f32_16x16x32_bf16 v[204:207], a[236:239], a[204:207], v[204:207]
s_nop 2
v_mfma_f32_16x16x32_bf16 v[208:211], a[236:239], a[208:211], v[208:211]
s_nop 2
v_mfma_f32_16x16x32_bf16 v[212:215], a[236:239], a[212:215], v[212:215]
v_cvt_pk_bf16_f32 v136, v204, v205
v_cvt_pk_bf16_f32 v137, v206, v207
v_mfma_f32_32x32x16_bf16 v[0:15], v[76:79], v[64:67], v[0:15]
s_nop 0
v_cvt_pk_bf16_f32 v138, v208, v209
v_cvt_pk_bf16_f32 v139, v210, v211
s_nop 1
v_cvt_pk_bf16_f32 v140, v212, v213
v_cvt_pk_bf16_f32 v141, v214, v215
v_mfma_f32_32x32x16_bf16 v[0:15], v[80:83], v[68:71], v[0:15]
v_permlane16_swap_b32_e32 v140, v142
v_permlane16_swap_b32_e32 v141, v143
v_permlane16_swap_b32_e64 v136, v138
v_mfma_f32_32x32x16_bf16 v[0:15], v[84:87], v[72:75], v[0:15]
s_waitcnt vmcnt(0)
v_permlane16_swap_b32_e32 v137, v139
s_nop 3
v_mfma_f32_32x32x16_bf16 v[16:31], v[100:103], v[64:67], v[16:31]
s_barrier
ds_read_b128 a[240:243], v246 offset:51200
ds_read_b64_tr_b16 a[244:245], v249
ds_read_b64_tr_b16 a[246:247], v249 offset:1536
ds_read_b64_tr_b16 a[248:249], v249 offset:64
ds_read_b64_tr_b16 a[250:251], v249 offset:1600
ds_read_b64_tr_b16 a[252:253], v249 offset:128
v_mfma_f32_32x32x16_bf16 v[16:31], v[104:107], v[68:71], v[16:31]
ds_read_b64_tr_b16 a[254:255], v249 offset:1664
v_max3_f32 v224, v0, v1, v2
v_max3_f32 v224, v224, v3, v4
v_max3_f32 v224, v224, v5, v6
v_max3_f32 v224, v224, v7, v8
v_max3_f32 v224, v224, v9, v10
v_mfma_f32_32x32x16_bf16 v[16:31], v[108:111], v[72:75], v[16:31]
ds_read_b128 a[216:219], v246 offset:51232
ds_read_b64_tr_b16 a[220:221], v249 offset:3072
ds_read_b64_tr_b16 a[222:223], v249 offset:4608
ds_read_b64_tr_b16 a[224:225], v249 offset:3136
v_max3_f32 v224, v224, v11, v12
v_max3_f32 v224, v224, v13, v14
v_mfma_f32_32x32x16_bf16 v[32:47], v[76:79], v[88:91], v[32:47]
ds_read_b64_tr_b16 a[226:227], v249 offset:4672
ds_read_b64_tr_b16 a[228:229], v249 offset:3200
ds_read_b64_tr_b16 a[230:231], v249 offset:4736
v_max_f32_e64 v224, v224, v15
v_fma_f32 v224, v224, s70, v254
v_mfma_f32_32x32x16_bf16 v[32:47], v[80:83], v[92:95], v[32:47]
ds_read_b128 a[232:235], v246 offset:51264
ds_read_b64_tr_b16 a[236:237], v249 offset:6144
v_max3_f32 v225, v16, v17, v18
v_max3_f32 v225, v225, v19, v20
v_max3_f32 v225, v225, v21, v22
v_max3_f32 v225, v225, v23, v24
v_mfma_f32_32x32x16_bf16 v[32:47], v[84:87], v[96:99], v[32:47]
ds_read_b64_tr_b16 a[238:239], v249 offset:7680
v_max3_f32 v225, v225, v25, v26
v_max3_f32 v225, v225, v27, v28
v_max3_f32 v225, v225, v29, v30
v_max_f32_e64 v225, v225, v31
v_fma_f32 v225, v225, s70, v255
v_mfma_f32_32x32x16_bf16 v[48:63], v[100:103], v[88:91], v[48:63]
v_max_f32_e32 v224, v224, v225
v_mov_b32_e32 v225, v224
s_nop 1
v_permlane32_swap_b32_e32 v224, v225
v_mfma_f32_32x32x16_bf16 v[48:63], v[104:107], v[92:95], v[48:63]
v_max_f32_e32 v224, v224, v225
v_sub_f32_e32 v226, v254, v224
v_fma_f32 v0, v0, s70, v226
v_fma_f32 v1, v1, s70, v226
v_exp_f32_e64 v0, v0
v_mfma_f32_32x32x16_bf16 v[48:63], v[108:111], v[96:99], v[48:63]
s_waitcnt lgkmcnt(4)
v_exp_f32_e32 v1, v1
v_fma_f32 v2, v2, s70, v226
v_fma_f32 v3, v3, s70, v226
v_exp_f32_e64 v2, v2
v_mfma_f32_32x32x16_bf16 v[64:79], a[244:247], a[240:243], 0
ds_read_b64_tr_b16 a[244:245], v249 offset:6272
ds_read_b64_tr_b16 a[246:247], v249 offset:7808
v_exp_f32_e64 v3, v3
v_fma_f32 v4, v4, s70, v226
v_fma_f32 v5, v5, s70, v226
v_mfma_f32_32x32x16_bf16 v[80:95], a[248:251], a[240:243], 0
ds_read_b128 a[248:251], v246 offset:51296
v_fma_f32 v6, v6, s70, v226
v_fma_f32 v7, v7, s70, v226
v_exp_f32_e64 v4, v4
v_cvt_pk_bf16_f32 v0, v0, v1
v_mfma_f32_32x32x16_bf16 v[96:111], a[252:255], a[240:243], 0
ds_read_b64_tr_b16 a[240:241], v249 offset:6208
ds_read_b64_tr_b16 a[242:243], v249 offset:7744
ds_read_b64_tr_b16 a[252:253], v249 offset:9216
ds_read_b64_tr_b16 a[254:255], v249 offset:10752
v_exp_f32_e64 v5, v5
v_mfma_f32_32x32x16_bf16 v[64:79], a[220:223], a[216:219], v[64:79]
ds_read_b64_tr_b16 a[220:221], v249 offset:9344
ds_read_b64_tr_b16 a[222:223], v249 offset:10880
v_exp_f32_e64 v6, v6
v_exp_f32_e32 v7, v7
v_mfma_f32_32x32x16_bf16 v[80:95], a[224:227], a[216:219], v[80:95]
s_waitcnt lgkmcnt(9)
ds_read_b128 a[224:227], v246 offset:51328
v_cvt_pk_bf16_f32 v1, v2, v3
v_cvt_pk_bf16_f32 v2, v4, v5
v_cvt_pk_bf16_f32 v3, v6, v7
v_fma_f32 v8, v8, s70, v226
v_fma_f32 v9, v9, s70, v226
v_mfma_f32_32x32x16_bf16 v[96:111], a[228:231], a[216:219], v[96:111]
ds_read_b64_tr_b16 a[216:217], v249 offset:9280
ds_read_b64_tr_b16 a[218:219], v249 offset:10816
ds_read_b64_tr_b16 a[228:229], v249 offset:12288
ds_read_b64_tr_b16 a[230:231], v249 offset:13824
v_fma_f32 v10, v10, s70, v226
v_fma_f32 v11, v11, s70, v226
v_mfma_f32_32x32x16_bf16 v[64:79], a[236:239], a[232:235], v[64:79]
s_waitcnt lgkmcnt(9)
ds_read_b64_tr_b16 a[236:237], v249 offset:12416
ds_read_b64_tr_b16 a[238:239], v249 offset:13952
v_fma_f32 v12, v12, s70, v226
v_fma_f32 v13, v13, s70, v226
v_fma_f32 v14, v14, s70, v226
v_fma_f32 v15, v15, s70, v226
v_exp_f32_e32 v8, v8
v_mfma_f32_32x32x16_bf16 v[80:95], a[240:243], a[232:235], v[80:95]
ds_read_b128 a[240:243], v246 offset:51360
v_exp_f32_e64 v9, v9
v_exp_f32_e32 v10, v10
v_cvt_pk_bf16_f32 v4, v8, v9
v_mfma_f32_32x32x16_bf16 v[96:111], a[244:247], a[232:235], v[96:111]
s_waitcnt lgkmcnt(7)
ds_read_b64_tr_b16 a[232:233], v249 offset:12352
ds_read_b64_tr_b16 a[234:235], v249 offset:13888
ds_read_b64_tr_b16 a[244:245], v249 offset:15360
ds_read_b64_tr_b16 a[246:247], v249 offset:16896
v_exp_f32_e32 v11, v11
v_mfma_f32_32x32x16_bf16 v[64:79], a[252:255], a[248:251], v[64:79]
s_waitcnt lgkmcnt(9)
ds_read_b64_tr_b16 a[252:253], v249 offset:15488
ds_read_b64_tr_b16 a[254:255], v249 offset:17024
v_exp_f32_e32 v12, v12
v_exp_f32_e32 v13, v13
v_mfma_f32_32x32x16_bf16 v[80:95], a[216:219], a[248:251], v[80:95]
ds_read_b128 a[216:219], v246 offset:51392
v_exp_f32_e64 v14, v14
v_exp_f32_e32 v15, v15
v_cvt_pk_bf16_f32 v5, v10, v11
v_mfma_f32_32x32x16_bf16 v[96:111], a[220:223], a[248:251], v[96:111]
s_waitcnt lgkmcnt(8)
ds_read_b64_tr_b16 a[248:249], v249 offset:15424
ds_read_b64_tr_b16 a[250:251], v249 offset:16960
ds_read_b64_tr_b16 a[220:221], v249 offset:18432
ds_read_b64_tr_b16 a[222:223], v249 offset:19968
v_cvt_pk_bf16_f32 v6, v12, v13
v_cvt_pk_bf16_f32 v7, v14, v15
v_mfma_f32_32x32x16_bf16 v[64:79], a[228:231], a[224:227], v[64:79]
s_waitcnt lgkmcnt(9)
ds_read_b64_tr_b16 a[228:229], v249 offset:18560
ds_read_b64_tr_b16 a[230:231], v249 offset:20096
v_sub_f32_e32 v227, v255, v224
v_fma_f32 v16, v16, s70, v227
v_fma_f32 v17, v17, s70, v227
v_fma_f32 v18, v18, s70, v227
v_fma_f32 v19, v19, s70, v227
v_fma_f32 v20, v20, s70, v227
v_mfma_f32_32x32x16_bf16 v[80:95], a[232:235], a[224:227], v[80:95]
ds_read_b128 a[232:235], v246 offset:51424
v_fma_f32 v21, v21, s70, v227
v_fma_f32 v22, v22, s70, v227
v_fma_f32 v23, v23, s70, v227
v_exp_f32_e32 v16, v16
v_mfma_f32_32x32x16_bf16 v[96:111], a[236:239], a[224:227], v[96:111]
s_waitcnt lgkmcnt(7)
ds_read_b64_tr_b16 a[224:225], v249 offset:18496
ds_read_b64_tr_b16 a[226:227], v249 offset:20032
ds_read_b64_tr_b16 a[236:237], v249 offset:21504
ds_read_b64_tr_b16 a[238:239], v249 offset:23040
v_exp_f32_e32 v17, v17
v_mfma_f32_32x32x16_bf16 v[64:79], a[244:247], a[240:243], v[64:79]
s_waitcnt lgkmcnt(9)
ds_read_b64_tr_b16 a[244:245], v249 offset:21632
ds_read_b64_tr_b16 a[246:247], v249 offset:23168
v_exp_f32_e32 v18, v18
v_exp_f32_e32 v19, v19
v_mfma_f32_32x32x16_bf16 v[80:95], a[248:251], a[240:243], v[80:95]
ds_read_b128 a[248:251], v246 offset:51456
v_exp_f32_e64 v20, v20
v_exp_f32_e32 v21, v21
v_cvt_pk_bf16_f32 v8, v16, v17
v_mfma_f32_32x32x16_bf16 v[96:111], a[252:255], a[240:243], v[96:111]
s_waitcnt lgkmcnt(8)
ds_read_b64_tr_b16 a[240:241], v249 offset:21568
ds_read_b64_tr_b16 a[242:243], v249 offset:23104
ds_read_b64_tr_b16 a[252:253], v249 offset:24576
ds_read_b64_tr_b16 a[254:255], v249 offset:26112
v_exp_f32_e32 v22, v22
v_mfma_f32_32x32x16_bf16 v[64:79], a[220:223], a[216:219], v[64:79]
s_waitcnt lgkmcnt(9)
ds_read_b64_tr_b16 a[220:221], v249 offset:24704
ds_read_b64_tr_b16 a[222:223], v249 offset:26240
v_exp_f32_e64 v23, v23
v_cvt_pk_bf16_f32 v9, v18, v19
v_cvt_pk_bf16_f32 v10, v20, v21
v_cvt_pk_bf16_f32 v11, v22, v23
v_fma_f32 v24, v24, s70, v227
v_mfma_f32_32x32x16_bf16 v[80:95], a[224:227], a[216:219], v[80:95]
ds_read_b128 a[224:227], v246 offset:51488
v_fma_f32 v25, v25, s70, v227
v_fma_f32 v26, v26, s70, v227
v_fma_f32 v27, v27, s70, v227
v_fma_f32 v28, v28, s70, v227
v_fma_f32 v29, v29, s70, v227
v_mfma_f32_32x32x16_bf16 v[96:111], a[228:231], a[216:219], v[96:111]
s_waitcnt lgkmcnt(7)
ds_read_b64_tr_b16 a[216:217], v249 offset:24640
ds_read_b64_tr_b16 a[218:219], v249 offset:26176
ds_read_b64_tr_b16 a[228:229], v249 offset:27648
ds_read_b64_tr_b16 a[230:231], v249 offset:29184
v_fma_f32 v30, v30, s70, v227
v_fma_f32 v31, v31, s70, v227
v_mfma_f32_32x32x16_bf16 v[64:79], a[236:239], a[232:235], v[64:79]
s_waitcnt lgkmcnt(9)
ds_read_b64_tr_b16 a[236:237], v249 offset:27776
ds_read_b64_tr_b16 a[238:239], v249 offset:29312
v_exp_f32_e32 v24, v24
v_exp_f32_e32 v25, v25
v_mfma_f32_32x32x16_bf16 v[80:95], a[240:243], a[232:235], v[80:95]
ds_read_b128 a[240:243], v246 offset:51520
v_exp_f32_e64 v26, v26
v_exp_f32_e32 v27, v27
v_cvt_pk_bf16_f32 v12, v24, v25
v_mfma_f32_32x32x16_bf16 v[96:111], a[244:247], a[232:235], v[96:111]
s_waitcnt lgkmcnt(8)
ds_read_b64_tr_b16 a[232:233], v249 offset:27712
ds_read_b64_tr_b16 a[234:235], v249 offset:29248
ds_read_b64_tr_b16 a[244:245], v249 offset:30720
ds_read_b64_tr_b16 a[246:247], v249 offset:32256
v_exp_f32_e32 v28, v28
v_mfma_f32_32x32x16_bf16 v[64:79], a[252:255], a[248:251], v[64:79]
s_waitcnt lgkmcnt(9)
ds_read_b64_tr_b16 a[252:253], v249 offset:30848
ds_read_b64_tr_b16 a[254:255], v249 offset:32384
v_exp_f32_e32 v29, v29
v_exp_f32_e32 v30, v30
v_exp_f32_e64 v31, v31
v_mfma_f32_32x32x16_bf16 v[80:95], a[216:219], a[248:251], v[80:95]
ds_read_b128 a[216:219], v246 offset:51552
v_cvt_pk_bf16_f32 v13, v26, v27
v_cvt_pk_bf16_f32 v14, v28, v29
v_cvt_pk_bf16_f32 v15, v30, v31
v_max3_f32 v224, v32, v33, v34
v_max3_f32 v225, v48, v49, v50
v_mfma_f32_32x32x16_bf16 v[96:111], a[220:223], a[248:251], v[96:111]
s_waitcnt lgkmcnt(7)
ds_read_b64_tr_b16 a[248:249], v249 offset:30784
ds_read_b64_tr_b16 a[250:251], v249 offset:32320
ds_read_b64_tr_b16 a[220:221], v249 offset:33792
ds_read_b64_tr_b16 a[222:223], v249 offset:35328
v_max3_f32 v224, v224, v35, v36
v_max3_f32 v225, v225, v51, v52
v_mfma_f32_32x32x16_bf16 v[64:79], a[228:231], a[224:227], v[64:79]
s_waitcnt lgkmcnt(9)
ds_read_b64_tr_b16 a[228:229], v249 offset:33920
ds_read_b64_tr_b16 a[230:231], v249 offset:35456
v_max3_f32 v224, v224, v37, v38
v_max3_f32 v225, v225, v53, v54
v_max3_f32 v224, v224, v39, v40
v_max3_f32 v225, v225, v55, v56
v_mfma_f32_32x32x16_bf16 v[80:95], a[232:235], a[224:227], v[80:95]
v_max3_f32 v224, v224, v41, v42
v_max3_f32 v225, v225, v57, v58
v_max3_f32 v224, v224, v43, v44
v_max3_f32 v225, v225, v59, v60
s_waitcnt lgkmcnt(6)
s_barrier
v_max3_f32 v224, v224, v45, v46
v_mfma_f32_32x32x16_bf16 v[96:111], a[236:239], a[224:227], v[96:111]
ds_read_b64_tr_b16 a[224:225], v249 offset:33856
ds_read_b64_tr_b16 a[226:227], v249 offset:35392
ds_read_b128 a[232:235], v240
ds_read_b128 a[236:239], v241
v_max3_f32 v225, v225, v61, v62
v_max_f32_e32 v224, v224, v47
v_mfma_f32_32x32x16_bf16 v[64:79], a[244:247], a[240:243], v[64:79]
s_waitcnt lgkmcnt(8)
ds_read_b128 a[244:247], v243
v_max_f32_e64 v225, v225, v63
v_fma_f32 v224, v224, s70, v255
v_fma_f32 v225, v225, s70, v254
v_max_f32_e64 v224, v224, v225
v_mov_b32_e32 v225, v224
s_nop 1
v_mfma_f32_32x32x16_bf16 v[80:95], a[248:251], a[240:243], v[80:95]
ds_read_b128 a[248:251], v240 offset:8192
v_permlane32_swap_b32_e32 v224, v225
v_max_f32_e32 v224, v224, v225
v_sub_f32_e32 v228, v255, v224
v_fma_f32 v32, v32, s70, v228
v_mfma_f32_32x32x16_bf16 v[96:111], a[252:255], a[240:243], v[96:111]
s_waitcnt lgkmcnt(6)
ds_read_b128 a[240:243], v242
ds_read_b128 a[252:255], v241 offset:8192
v_fma_f32 v33, v33, s70, v228
v_exp_f32_e64 v32, v32
v_fma_f32 v34, v34, s70, v228
v_mfma_f32_32x32x16_bf16 v[64:79], a[220:223], a[216:219], v[64:79]
s_waitcnt lgkmcnt(6)
ds_read_b128 a[220:223], v243 offset:8192
v_exp_f32_e32 v33, v33
v_fma_f32 v35, v35, s70, v228
v_exp_f32_e64 v34, v34
v_mfma_f32_32x32x16_bf16 v[80:95], a[224:227], a[216:219], v[80:95]
ds_read_b128 a[224:227], v240 offset:16384
v_exp_f32_e32 v35, v35
v_fma_f32 v36, v36, s70, v228
v_fma_f32 v37, v37, s70, v228
v_fma_f32 v38, v38, s70, v228
v_mfma_f32_32x32x16_bf16 v[96:111], a[228:231], a[216:219], v[96:111]
s_waitcnt lgkmcnt(5)
ds_read_b128 a[216:219], v242 offset:8192
ds_read_b128 a[228:231], v241 offset:16384
v_cvt_pk_bf16_f32 v64, v64, v65
v_cvt_pk_bf16_f32 v72, v72, v73
v_cvt_pk_bf16_f32 v65, v66, v67
v_cvt_pk_bf16_f32 v73, v74, v75
v_mfma_f32_32x32x16_bf16 v[144:159], a[0:3], a[232:235], 0
v_cvt_pk_bf16_f32 v66, v68, v69
v_cvt_pk_bf16_f32 v67, v70, v71
v_cvt_pk_bf16_f32 v74, v76, v77
v_cvt_pk_bf16_f32 v75, v78, v79
v_cvt_pk_bf16_f32 v80, v80, v81
v_cvt_pk_bf16_f32 v88, v88, v89
v_mfma_f32_32x32x16_bf16 v[160:175], a[4:7], a[232:235], 0
ds_write_b128 v230, v[64:67] offset:25600
v_cvt_pk_bf16_f32 v81, v82, v83
v_mfma_f32_32x32x16_bf16 v[176:191], a[8:11], a[232:235], 0
v_cvt_pk_bf16_f32 v89, v90, v91
v_cvt_pk_bf16_f32 v82, v84, v85
v_cvt_pk_bf16_f32 v83, v86, v87
v_cvt_pk_bf16_f32 v90, v92, v93
v_cvt_pk_bf16_f32 v91, v94, v95
v_cvt_pk_bf16_f32 v96, v96, v97
v_mfma_f32_32x32x16_bf16 v[144:159], a[12:15], a[236:239], v[144:159]
ds_write_b128 v230, v[72:75] offset:25632
v_cvt_pk_bf16_f32 v104, v104, v105
v_mfma_f32_32x32x16_bf16 v[160:175], a[16:19], a[236:239], v[160:175]
v_cvt_pk_bf16_f32 v97, v98, v99
v_cvt_pk_bf16_f32 v105, v106, v107
v_cvt_pk_bf16_f32 v98, v100, v101
v_cvt_pk_bf16_f32 v99, v102, v103
v_cvt_pk_bf16_f32 v106, v108, v109
v_cvt_pk_bf16_f32 v107, v110, v111
v_mfma_f32_32x32x16_bf16 v[176:191], a[20:23], a[236:239], v[176:191]
s_waitcnt lgkmcnt(1)
ds_read_b128 v[68:71], v231 offset:25600
ds_read_b128 a[232:235], v242 offset:16384
ds_read_b128 v[76:79], v231 offset:32000
v_fma_f32 v39, v39, s70, v228
v_exp_f32_e32 v36, v36
v_mfma_f32_32x32x16_bf16 v[144:159], a[24:27], a[240:243], v[144:159]
ds_read_b128 a[236:239], v243 offset:16384
ds_write_b128 v230, v[80:83] offset:25664
v_mfma_f32_32x32x16_bf16 v[160:175], a[28:31], a[240:243], v[160:175]
v_exp_f32_e32 v37, v37
v_exp_f32_e32 v38, v38
v_exp_f32_e64 v39, v39
v_mfma_f32_32x32x16_bf16 v[176:191], a[32:35], a[240:243], v[176:191]
s_nop 0
ds_write_b128 v230, v[88:91] offset:25696
v_cvt_pk_bf16_f32 v32, v32, v33
v_mfma_f32_32x32x16_bf16 v[144:159], a[36:39], a[244:247], v[144:159]
s_waitcnt lgkmcnt(5)
buffer_store_dwordx4 v[68:71], v250, s[36:39], s58 offen sc1
ds_read_b128 v[84:87], v231 offset:25664
v_mfma_f32_32x32x16_bf16 v[160:175], a[40:43], a[244:247], v[160:175]
ds_read_b128 v[92:95], v231 offset:32064
v_cvt_pk_bf16_f32 v33, v34, v35
v_cvt_pk_bf16_f32 v34, v36, v37
v_cvt_pk_bf16_f32 v35, v38, v39
v_fma_f32 v40, v40, s70, v228
v_fma_f32 v41, v41, s70, v228
v_mfma_f32_32x32x16_bf16 v[176:191], a[44:47], a[244:247], v[176:191]
ds_write_b128 v230, v[96:99] offset:25728
v_fma_f32 v42, v42, s70, v228
v_mfma_f32_32x32x16_bf16 v[144:159], a[48:51], a[248:251], v[144:159]
v_fma_f32 v43, v43, s70, v228
v_fma_f32 v44, v44, s70, v228
v_fma_f32 v45, v45, s70, v228
v_fma_f32 v46, v46, s70, v228
v_fma_f32 v47, v47, s70, v228
v_sub_f32_e32 v229, v254, v224
v_mfma_f32_32x32x16_bf16 v[160:175], a[52:55], a[248:251], v[160:175]
s_waitcnt lgkmcnt(3)
buffer_store_dwordx4 v[76:79], v250, s[36:39], s76 offen sc1
ds_read_b128 a[240:243], v240 offset:4096
v_mfma_f32_32x32x16_bf16 v[176:191], a[56:59], a[248:251], v[176:191]
ds_write_b128 v230, v[104:107] offset:25760
v_fma_f32 v48, v48, s70, v229
v_mfma_f32_32x32x16_bf16 v[144:159], a[60:63], a[252:255], v[144:159]
v_exp_f32_e32 v40, v40
v_exp_f32_e32 v41, v41
v_exp_f32_e64 v42, v42
v_mfma_f32_32x32x16_bf16 v[160:175], a[64:67], a[252:255], v[160:175]
ds_read_b128 v[100:103], v231 offset:25728
ds_read_b128 v[108:111], v231 offset:32128
ds_read_b128 a[244:247], v241 offset:4096
v_exp_f32_e32 v43, v43
v_cvt_pk_bf16_f32 v36, v40, v41
v_mfma_f32_32x32x16_bf16 v[176:191], a[68:71], a[252:255], v[176:191]
s_waitcnt lgkmcnt(5)
buffer_store_dwordx4 v[84:87], v250, s[36:39], s58 offen offset:64 sc1
ds_read_b128 a[248:251], v242 offset:4096
v_mfma_f32_32x32x16_bf16 v[144:159], a[72:75], a[216:219], v[144:159]
ds_read_b128 a[252:255], v243 offset:4096
v_exp_f32_e32 v44, v44
v_exp_f32_e32 v45, v45
v_cvt_pk_bf16_f32 v37, v42, v43
v_mfma_f32_32x32x16_bf16 v[160:175], a[76:79], a[216:219], v[160:175]
v_exp_f32_e32 v46, v46
v_exp_f32_e32 v47, v47
v_cvt_pk_bf16_f32 v38, v44, v45
v_cvt_pk_bf16_f32 v39, v46, v47
v_mfma_f32_32x32x16_bf16 v[176:191], a[80:83], a[216:219], v[176:191]
ds_read_b128 a[216:219], v240 offset:12288
v_fma_f32 v49, v49, s70, v229
v_fma_f32 v50, v50, s70, v229
v_fma_f32 v51, v51, s70, v229
v_fma_f32 v52, v52, s70, v229
v_fma_f32 v53, v53, s70, v229
v_mfma_f32_32x32x16_bf16 v[144:159], a[84:87], a[220:223], v[144:159]
buffer_store_dwordx4 v[92:95], v250, s[36:39], s76 offen offset:64 sc1
v_fma_f32 v54, v54, s70, v229
v_mfma_f32_32x32x16_bf16 v[160:175], a[88:91], a[220:223], v[160:175]
v_fma_f32 v55, v55, s70, v229
v_exp_f32_e32 v48, v48
v_exp_f32_e32 v49, v49
v_fma_f32 v56, v56, s70, v229
v_mfma_f32_32x32x16_bf16 v[176:191], a[92:95], a[220:223], v[176:191]
ds_read_b128 a[220:223], v241 offset:12288
v_exp_f32_e32 v50, v50
v_exp_f32_e32 v51, v51
v_cvt_pk_bf16_f32 v40, v48, v49
v_mfma_f32_32x32x16_bf16 v[144:159], a[96:99], a[224:227], v[144:159]
v_exp_f32_e32 v52, v52
v_exp_f32_e32 v53, v53
v_exp_f32_e32 v54, v54
v_mfma_f32_32x32x16_bf16 v[160:175], a[100:103], a[224:227], v[160:175]
s_waitcnt lgkmcnt(1)
buffer_store_dwordx4 v[100:103], v250, s[36:39], s58 offen offset:128 sc1
v_cvt_pk_bf16_f32 v41, v50, v51
v_mfma_f32_32x32x16_bf16 v[176:191], a[104:107], a[224:227], v[176:191]
ds_read_b128 a[224:227], v242 offset:12288
v_exp_f32_e64 v55, v55
v_cvt_pk_bf16_f32 v42, v52, v53
v_cvt_pk_bf16_f32 v43, v54, v55
v_fma_f32 v57, v57, s70, v229
v_mfma_f32_32x32x16_bf16 v[144:159], a[108:111], a[228:231], v[144:159]
v_fma_f32 v58, v58, s70, v229
v_fma_f32 v59, v59, s70, v229
v_fma_f32 v60, v60, s70, v229
v_fma_f32 v61, v61, s70, v229
v_fma_f32 v62, v62, s70, v229
v_fma_f32 v63, v63, s70, v229
v_mfma_f32_32x32x16_bf16 v[160:175], a[112:115], a[228:231], v[160:175]
v_exp_f32_e32 v56, v56
v_exp_f32_e32 v57, v57
v_exp_f32_e64 v58, v58
v_mfma_f32_32x32x16_bf16 v[176:191], a[116:119], a[228:231], v[176:191]
buffer_store_dwordx4 v[108:111], v250, s[36:39], s76 offen offset:128 sc1
ds_read_b128 a[228:231], v243 offset:12288
v_mfma_f32_32x32x16_bf16 v[144:159], a[120:123], a[232:235], v[144:159]
s_add_u32 s76, s60, 0x2a000
v_exp_f32_e32 v59, v59
v_exp_f32_e32 v60, v60
v_exp_f32_e64 v61, v61
v_mfma_f32_32x32x16_bf16 v[160:175], a[124:127], a[232:235], v[160:175]
v_exp_f32_e32 v62, v62
v_exp_f32_e32 v63, v63
v_cvt_pk_bf16_f32 v44, v56, v57
v_cvt_pk_bf16_f32 v45, v58, v59
v_mfma_f32_32x32x16_bf16 v[176:191], a[128:131], a[232:235], v[176:191]
ds_read_b128 a[232:235], v240 offset:20480
v_cvt_pk_bf16_f32 v46, v60, v61
v_cvt_pk_bf16_f32 v47, v62, v63
v_mul_f32_e32 v254, s64, v253
v_min_f32_e32 v255, s68, v254
v_mfma_f32_32x32x16_bf16 v[144:159], a[132:135], a[236:239], v[144:159]
ds_read_b128 v[48:51], v248 offset:768
ds_read_b128 v[52:55], v248 offset:960
ds_read_b128 v[56:59], v248 offset:1152
ds_read_b128 v[60:63], v248 offset:1344
s_nop 0
v_mfma_f32_32x32x16_bf16 v[160:175], a[136:139], a[236:239], v[160:175]
s_nop 4
v_mfma_f32_32x32x16_bf16 v[176:191], a[140:143], a[236:239], v[176:191]
v_cvt_pk_bf16_f32 v64, v144, v145
v_cvt_pk_bf16_f32 v65, v146, v147
v_cvt_pk_bf16_f32 v66, v148, v149
v_cvt_pk_bf16_f32 v67, v150, v151
v_cvt_pk_bf16_f32 v68, v152, v153
v_cvt_pk_bf16_f32 v69, v154, v155
v_mfma_f32_32x32x16_bf16 v[208:223], v[116:119], v[0:3], 0
v_cvt_pk_bf16_f32 v70, v156, v157
v_cvt_pk_bf16_f32 v71, v158, v159
v_cvt_pk_bf16_f32 v72, v160, v161
v_cvt_pk_bf16_f32 v73, v162, v163
v_cvt_pk_bf16_f32 v74, v164, v165
v_cvt_pk_bf16_f32 v75, v166, v167
v_mfma_f32_32x32x16_bf16 v[192:207], v[112:115], v[0:3], 0
v_cvt_pk_bf16_f32 v76, v168, v169
v_cvt_pk_bf16_f32 v77, v170, v171
v_cvt_pk_bf16_f32 v78, v172, v173
v_cvt_pk_bf16_f32 v79, v174, v175
v_cvt_pk_bf16_f32 v80, v176, v177
v_cvt_pk_bf16_f32 v81, v178, v179
v_mfma_f32_32x32x16_bf16 v[208:223], v[124:127], v[4:7], v[208:223]
v_cvt_pk_bf16_f32 v82, v180, v181
v_cvt_pk_bf16_f32 v83, v182, v183
v_cvt_pk_bf16_f32 v84, v184, v185
v_cvt_pk_bf16_f32 v85, v186, v187
v_cvt_pk_bf16_f32 v86, v188, v189
v_cvt_pk_bf16_f32 v87, v190, v191
v_mfma_f32_32x32x16_bf16 v[192:207], v[120:123], v[4:7], v[192:207]
ds_read_b128 a[236:239], v241 offset:20480
v_mfma_f32_32x32x16_bf16 v[208:223], v[132:135], v[8:11], v[208:223]
v_mfma_f32_32x32x16_bf16 v[192:207], v[128:131], v[8:11], v[192:207]
v_mfma_f32_32x32x16_bf16 v[208:223], v[140:143], v[12:15], v[208:223]
s_nop 6
v_mfma_f32_32x32x16_bf16 v[192:207], v[136:139], v[12:15], v[192:207]
s_nop 2
v_mfma_f32_32x32x16_bf16 v[144:159], a[0:3], a[240:243], 0
ds_read_b64_tr_b16 a[0:1], v249
ds_read_b64_tr_b16 a[2:3], v249 offset:1536
v_rcp_f32_e32 v217, v216
s_nop 0
v_mul_f32_e64 v208, v217, v208
v_mfma_f32_32x32x16_bf16 v[160:175], a[4:7], a[240:243], 0
ds_read_b64_tr_b16 a[4:5], v249 offset:64
ds_read_b64_tr_b16 a[6:7], v249 offset:1600
v_mul_f32_e32 v209, v217, v209
v_mul_f32_e32 v192, v217, v192
v_mul_f32_e32 v193, v217, v193
v_mul_f32_e32 v200, v217, v200
v_mfma_f32_32x32x16_bf16 v[176:191], a[8:11], a[240:243], 0
ds_read_b128 a[240:243], v242 offset:20480
ds_read_b64_tr_b16 a[8:9], v249 offset:128
ds_read_b64_tr_b16 a[10:11], v249 offset:1664
v_mul_f32_e32 v201, v217, v201
v_mul_f32_e32 v210, v217, v210
v_mul_f32_e64 v211, v217, v211
v_mfma_f32_32x32x16_bf16 v[144:159], a[12:15], a[244:247], v[144:159]
ds_read_b64_tr_b16 a[12:13], v249 offset:3072
ds_read_b64_tr_b16 a[14:15], v249 offset:4608
v_cvt_pk_bf16_f32 v208, v208, v209
v_mul_f32_e32 v194, v217, v194
v_mul_f32_e32 v195, v217, v195
v_cvt_pk_bf16_f32 v192, v192, v193
v_mfma_f32_32x32x16_bf16 v[160:175], a[16:19], a[244:247], v[160:175]
ds_read_b64_tr_b16 a[16:17], v249 offset:3136
ds_read_b64_tr_b16 a[18:19], v249 offset:4672
v_mul_f32_e32 v202, v217, v202
v_mul_f32_e32 v203, v217, v203
v_cvt_pk_bf16_f32 v200, v200, v201
v_mul_f32_e64 v212, v217, v212
v_mfma_f32_32x32x16_bf16 v[176:191], a[20:23], a[244:247], v[176:191]
ds_read_b128 a[244:247], v243 offset:20480
ds_read_b64_tr_b16 a[20:21], v249 offset:3200
ds_read_b64_tr_b16 a[22:23], v249 offset:4736
v_mul_f32_e32 v213, v217, v213
v_mul_f32_e32 v214, v217, v214
v_mul_f32_e64 v215, v217, v215
v_mfma_f32_32x32x16_bf16 v[144:159], a[24:27], a[248:251], v[144:159]
ds_read_b64_tr_b16 a[24:25], v249 offset:6144
ds_read_b64_tr_b16 a[26:27], v249 offset:7680
v_cvt_pk_bf16_f32 v209, v210, v211
v_mul_f32_e32 v196, v217, v196
v_mul_f32_e32 v197, v217, v197
v_mul_f32_e64 v198, v217, v198
v_mfma_f32_32x32x16_bf16 v[160:175], a[28:31], a[248:251], v[160:175]
ds_read_b64_tr_b16 a[28:29], v249 offset:6208
ds_read_b64_tr_b16 a[30:31], v249 offset:7744
v_mul_f32_e64 v199, v217, v199
v_cvt_pk_bf16_f32 v193, v194, v195
v_mul_f32_e32 v204, v217, v204
v_mul_f32_e32 v205, v217, v205
v_mfma_f32_32x32x16_bf16 v[176:191], a[32:35], a[248:251], v[176:191]
ds_read_b64_tr_b16 a[32:33], v249 offset:6272
ds_read_b64_tr_b16 a[34:35], v249 offset:7808
v_mul_f32_e32 v206, v217, v206
v_mul_f32_e32 v207, v217, v207
v_cvt_pk_bf16_f32 v201, v202, v203
v_cvt_pk_bf16_f32 v210, v212, v213
v_mfma_f32_32x32x16_bf16 v[144:159], a[36:39], a[252:255], v[144:159]
ds_read_b64_tr_b16 a[36:37], v249 offset:9216
ds_read_b64_tr_b16 a[38:39], v249 offset:10752
v_cvt_pk_bf16_f32 v211, v214, v215
v_cvt_pk_bf16_f32 v194, v196, v197
v_cvt_pk_bf16_f32 v195, v198, v199
v_cvt_pk_bf16_f32 v202, v204, v205
v_mfma_f32_32x32x16_bf16 v[160:175], a[40:43], a[252:255], v[160:175]
ds_write_b128 v247, v[208:211] offset:51264
v_cvt_pk_bf16_f32 v203, v206, v207
v_mfma_f32_32x32x16_bf16 v[176:191], a[44:47], a[252:255], v[176:191]
ds_read_b64_tr_b16 a[40:41], v249 offset:9280
ds_read_b64_tr_b16 a[42:43], v249 offset:10816
ds_read_b64_tr_b16 a[44:45], v249 offset:9344
v_mfma_f32_32x32x16_bf16 v[144:159], a[48:51], a[216:219], v[144:159]
ds_write_b128 v247, v[192:195] offset:51200
v_mfma_f32_32x32x16_bf16 v[160:175], a[52:55], a[216:219], v[160:175]
ds_read_b64_tr_b16 a[46:47], v249 offset:10880
ds_read_b64_tr_b16 a[48:49], v249 offset:12288
v_mfma_f32_32x32x16_bf16 v[176:191], a[56:59], a[216:219], v[176:191]
s_waitcnt lgkmcnt(6)
ds_write_b128 v247, v[200:203] offset:51232
v_mfma_f32_32x32x16_bf16 v[144:159], a[60:63], a[220:223], v[144:159]
s_nop 0
ds_read_b64_tr_b16 a[50:51], v249 offset:13824
ds_read_b64_tr_b16 a[52:53], v249 offset:12352
v_mfma_f32_32x32x16_bf16 v[160:175], a[64:67], a[220:223], v[160:175]
ds_read_b64_tr_b16 a[54:55], v249 offset:13888
ds_read_b64_tr_b16 a[56:57], v249 offset:12416
ds_read_b64_tr_b16 a[58:59], v249 offset:13952
v_mfma_f32_32x32x16_bf16 v[176:191], a[68:71], a[220:223], v[176:191]
ds_read_b64_tr_b16 a[60:61], v249 offset:15360
ds_read_b64_tr_b16 a[62:63], v249 offset:16896
ds_read_b64_tr_b16 a[64:65], v249 offset:15424
ds_read_b64_tr_b16 a[66:67], v249 offset:16960
v_mfma_f32_32x32x16_bf16 v[144:159], a[72:75], a[224:227], v[144:159]
ds_read_b64_tr_b16 a[68:69], v249 offset:15488
ds_read_b64_tr_b16 a[70:71], v249 offset:17024
ds_read_b64_tr_b16 a[72:73], v249 offset:18432
v_mfma_f32_32x32x16_bf16 v[160:175], a[76:79], a[224:227], v[160:175]
ds_read_b64_tr_b16 a[74:75], v249 offset:19968
ds_read_b64_tr_b16 a[76:77], v249 offset:18496
v_mfma_f32_32x32x16_bf16 v[176:191], a[80:83], a[224:227], v[176:191]
buffer_load_dwordx2 v[236:237], v235, s[88:91], s44 offen sc1
ds_read_b64_tr_b16 a[78:79], v249 offset:20032
ds_read_b64_tr_b16 a[80:81], v249 offset:18560
ds_read_b64_tr_b16 a[82:83], v249 offset:20096
v_mfma_f32_32x32x16_bf16 v[16:31], v[116:119], v[32:35], 0
v_mfma_f32_32x32x16_bf16 v[0:15], v[112:115], v[32:35], 0
ds_read_b128 v[32:35], v248
v_mfma_f32_32x32x16_bf16 v[16:31], v[124:127], v[36:39], v[16:31]
v_mfma_f32_32x32x16_bf16 v[0:15], v[120:123], v[36:39], v[0:15]
ds_read_b128 v[36:39], v248 offset:192
v_mfma_f32_32x32x16_bf16 v[16:31], v[132:135], v[40:43], v[16:31]
v_mfma_f32_32x32x16_bf16 v[0:15], v[128:131], v[40:43], v[0:15]
ds_read_b128 v[40:43], v248 offset:384
v_mfma_f32_32x32x16_bf16 v[16:31], v[140:143], v[44:47], v[16:31]
s_nop 6
v_mfma_f32_32x32x16_bf16 v[0:15], v[136:139], v[44:47], v[0:15]
ds_read_b128 v[44:47], v248 offset:576
s_nop 1
v_mfma_f32_32x32x16_bf16 v[144:159], a[84:87], a[228:231], v[144:159]
ds_read_b128 v[28:31], v248 offset:2112
v_rcp_f32_e64 v25, v24
ds_read_b64_tr_b16 a[84:85], v249 offset:21504
v_mfma_f32_32x32x16_bf16 v[160:175], a[88:91], a[228:231], v[160:175]
v_mul_f32_e32 v16, v25, v16
v_mul_f32_e32 v17, v25, v17
v_mul_f32_e32 v18, v25, v18
v_mul_f32_e32 v19, v25, v19
v_mul_f32_e32 v0, v25, v0
v_mul_f32_e32 v1, v25, v1
v_mfma_f32_32x32x16_bf16 v[176:191], a[92:95], a[228:231], v[176:191]
v_mul_f32_e32 v8, v25, v8
v_mul_f32_e32 v9, v25, v9
v_mul_f32_e32 v2, v25, v2
v_mul_f32_e32 v3, v25, v3
v_cvt_pk_bf16_f32 v0, v0, v1
v_mul_f32_e64 v10, v25, v10
v_mfma_f32_32x32x16_bf16 v[144:159], a[96:99], a[232:235], v[144:159]
v_mul_f32_e64 v11, v25, v11
v_cvt_pk_bf16_f32 v8, v8, v9
v_mul_f32_e32 v4, v25, v4
v_mul_f32_e32 v5, v25, v5
v_mul_f32_e32 v6, v25, v6
v_mul_f32_e32 v7, v25, v7
v_mfma_f32_32x32x16_bf16 v[160:175], a[100:103], a[232:235], v[160:175]
v_cvt_pk_bf16_f32 v1, v2, v3
v_mul_f32_e32 v12, v25, v12
v_mul_f32_e32 v13, v25, v13
v_mul_f32_e32 v14, v25, v14
v_mul_f32_e32 v15, v25, v15
v_cvt_pk_bf16_f32 v9, v10, v11
v_mfma_f32_32x32x16_bf16 v[176:191], a[104:107], a[232:235], v[176:191]
v_cvt_pk_bf16_f32 v2, v4, v5
v_cvt_pk_bf16_f32 v3, v6, v7
v_cvt_pk_bf16_f32 v10, v12, v13
v_cvt_pk_bf16_f32 v11, v14, v15
v_cvt_pk_bf16_f32 v16, v16, v17
v_mul_f32_e64 v20, v25, v20
v_mfma_f32_32x32x16_bf16 v[144:159], a[108:111], a[236:239], v[144:159]
ds_write_b128 v247, v[0:3] offset:64000
v_mul_f32_e64 v21, v25, v21
v_mfma_f32_32x32x16_bf16 v[160:175], a[112:115], a[236:239], v[160:175]
v_mul_f32_e32 v22, v25, v22
v_mul_f32_e32 v23, v25, v23
v_cvt_pk_bf16_f32 v17, v18, v19
v_cvt_pk_bf16_f32 v18, v20, v21
v_cvt_pk_bf16_f32 v19, v22, v23
v_mfma_f32_32x32x16_bf16 v[176:191], a[116:119], a[236:239], v[176:191]
ds_write_b128 v247, v[8:11] offset:64032
v_mfma_f32_32x32x16_bf16 v[144:159], a[120:123], a[240:243], v[144:159]
ds_read_b128 v[0:3], v248 offset:768
ds_read_b128 v[4:7], v248 offset:960
ds_read_b128 v[8:11], v248 offset:1152
v_mfma_f32_32x32x16_bf16 v[160:175], a[124:127], a[240:243], v[160:175]
ds_read_b128 v[12:15], v248 offset:1344
ds_read_b128 v[20:23], v248 offset:1728
v_mfma_f32_32x32x16_bf16 v[176:191], a[128:131], a[240:243], v[176:191]
ds_write_b128 v247, v[16:19] offset:64064
v_mfma_f32_32x32x16_bf16 v[144:159], a[132:135], a[244:247], v[144:159]
s_nop 6
v_mfma_f32_32x32x16_bf16 v[160:175], a[136:139], a[244:247], v[160:175]
s_nop 0
ds_read_b128 v[16:19], v248 offset:1536
ds_read_b128 v[24:27], v248 offset:1920
s_nop 2
v_mfma_f32_32x32x16_bf16 v[176:191], a[140:143], a[244:247], v[176:191]
s_nop 0
v_cvt_pk_bf16_f32 v88, v144, v145
v_cvt_pk_bf16_f32 v89, v146, v147
v_cvt_pk_bf16_f32 v90, v148, v149
v_cvt_pk_bf16_f32 v91, v150, v151
v_cvt_pk_bf16_f32 v92, v152, v153
v_cvt_pk_bf16_f32 v93, v154, v155
v_cvt_pk_bf16_f32 v100, v168, v169
v_cvt_pk_bf16_f32 v101, v170, v171
v_cvt_pk_bf16_f32 v102, v172, v173
v_cvt_pk_bf16_f32 v103, v174, v175
v_cvt_pk_bf16_f32 v94, v156, v157
v_cvt_pk_bf16_f32 v95, v158, v159
s_waitcnt lgkmcnt(2)
s_barrier
v_cvt_pk_bf16_f32 v96, v160, v161
v_cvt_pk_bf16_f32 v104, v176, v177
v_mfma_f32_32x32x16_bf16 v[0:15], v[76:79], v[64:67], v[0:15]
ds_read_b128 v[116:119], v246 offset:51200
ds_read_b128 v[120:123], v246 offset:51232
ds_read_b128 v[124:127], v246 offset:51264
v_cvt_pk_bf16_f32 v105, v178, v179
v_cvt_pk_bf16_f32 v106, v180, v181
v_cvt_pk_bf16_f32 v107, v182, v183
v_mfma_f32_32x32x16_bf16 v[0:15], v[80:83], v[68:71], v[0:15]
ds_read_b128 v[128:131], v246 offset:51296
v_cvt_pk_bf16_f32 v108, v184, v185
v_cvt_pk_bf16_f32 v109, v186, v187
v_cvt_pk_bf16_f32 v110, v188, v189
v_cvt_pk_bf16_f32 v111, v190, v191
v_cvt_pk_bf16_f32 v97, v162, v163
v_mfma_f32_32x32x16_bf16 v[0:15], v[84:87], v[72:75], v[0:15]
s_waitcnt lgkmcnt(4)
ds_read_b128 v[132:135], v246 offset:51328
v_cvt_pk_bf16_f32 v98, v164, v165
v_cvt_pk_bf16_f32 v99, v166, v167
ds_read_b128 v[136:139], v246 offset:51360
ds_read_b128 v[140:143], v246 offset:51392
v_mfma_f32_32x32x16_bf16 v[16:31], v[100:103], v[64:67], v[16:31]
s_nop 0
ds_read_b64_tr_b16 a[86:87], v249 offset:23040
ds_read_b128 v[112:115], v246 offset:51424
ds_read_b64_tr_b16 a[88:89], v249 offset:21568
ds_read_b64_tr_b16 a[90:91], v249 offset:23104
v_mfma_f32_32x32x16_bf16 v[16:31], v[104:107], v[68:71], v[16:31]
ds_read_b64_tr_b16 a[92:93], v249 offset:21632
ds_read_b64_tr_b16 a[94:95], v249 offset:23168
v_max3_f32 v224, v0, v1, v2
v_max3_f32 v224, v224, v3, v4
v_max3_f32 v224, v224, v5, v6
v_max3_f32 v224, v224, v7, v8
v_mfma_f32_32x32x16_bf16 v[16:31], v[108:111], v[72:75], v[16:31]
ds_read_b64_tr_b16 a[96:97], v249 offset:24576
ds_read_b64_tr_b16 a[98:99], v249 offset:26112
ds_read_b64_tr_b16 a[100:101], v249 offset:24640
ds_read_b64_tr_b16 a[102:103], v249 offset:26176
v_max3_f32 v224, v224, v9, v10
v_max3_f32 v224, v224, v11, v12
v_mfma_f32_32x32x16_bf16 v[32:47], v[76:79], v[88:91], v[32:47]
s_waitcnt vmcnt(0)
v_or_b32 v237, 0x01010000, v237
v_and_b32 v236, v236, v237
s_nop 0
v_readfirstlane_b32 s80, v236
s_nop 1
s_cmp_eq_u32 s80, 0x01010101
s_cbranch_scc0 L_slow_cons0
L_back_cons0:
v_mfma_f32_32x32x16_bf16 v[32:47], v[80:83], v[92:95], v[32:47]
buffer_load_dwordx4 a[144:147], v238, s[40:43], s81 offen sc1
ds_read_b64_tr_b16 a[104:105], v249 offset:24704
ds_read_b64_tr_b16 a[106:107], v249 offset:26240
ds_read_b64_tr_b16 a[108:109], v249 offset:27648
ds_read_b64_tr_b16 a[110:111], v249 offset:29184
ds_read_b64_tr_b16 a[112:113], v249 offset:27712
v_mfma_f32_32x32x16_bf16 v[32:47], v[84:87], v[96:99], v[32:47]
ds_read_b64_tr_b16 a[114:115], v249 offset:29248
ds_read_b64_tr_b16 a[116:117], v249 offset:27776
ds_read_b64_tr_b16 a[118:119], v249 offset:29312
ds_read_b64_tr_b16 a[120:121], v249 offset:30720
v_max3_f32 v225, v16, v17, v18
v_max3_f32 v225, v225, v19, v20
v_mfma_f32_32x32x16_bf16 v[48:63], v[100:103], v[88:91], v[48:63]
buffer_load_dwordx4 a[148:151], v238, s[40:43], s81 offen offset:1024 sc1
ds_read_b64_tr_b16 a[122:123], v249 offset:32256
ds_read_b64_tr_b16 a[124:125], v249 offset:30784
ds_read_b64_tr_b16 a[126:127], v249 offset:32320
ds_read_b64_tr_b16 a[128:129], v249 offset:30848
v_max3_f32 v225, v225, v21, v22
v_mfma_f32_32x32x16_bf16 v[48:63], v[104:107], v[92:95], v[48:63]
ds_read_b64_tr_b16 a[130:131], v249 offset:32384
v_max3_f32 v225, v225, v23, v24
v_max3_f32 v225, v225, v25, v26
v_max3_f32 v225, v225, v27, v28
v_max3_f32 v224, v224, v13, v14
v_max3_f32 v225, v225, v29, v30
v_mfma_f32_32x32x16_bf16 v[48:63], v[108:111], v[96:99], v[48:63]
s_waitcnt lgkmcnt(14)
buffer_load_dwordx4 a[152:155], v238, s[40:43], s81 offen offset:2048 sc1
ds_read_b64_tr_b16 a[132:133], v249 offset:33792
ds_read_b64_tr_b16 a[134:135], v249 offset:35328
ds_read_b64_tr_b16 a[136:137], v249 offset:33856
ds_read_b64_tr_b16 a[138:139], v249 offset:35392
v_max_f32_e32 v224, v224, v15
v_mfma_f32_32x32x16_bf16 v[64:79], a[0:3], v[116:119], 0
ds_read_b64_tr_b16 a[140:141], v249 offset:33920
ds_read_b64_tr_b16 a[142:143], v249 offset:35456
v_max_f32_e64 v225, v225, v31
v_fma_f32 v224, v224, s70, v254
v_fma_f32 v225, v225, s70, v255
v_max_f32_e64 v224, v224, v225
v_mfma_f32_32x32x16_bf16 v[80:95], a[4:7], v[116:119], 0
buffer_load_dwordx4 a[156:159], v238, s[40:43], s81 offen offset:3072 sc1
s_add_u32 s81, s71, 0
v_mov_b32_e64 v225, v224
s_nop 1
v_mfma_f32_32x32x16_bf16 v[96:111], a[8:11], v[116:119], 0
ds_read_b128 v[116:119], v246 offset:51456
v_permlane32_swap_b32_e32 v224, v225
v_max_f32_e32 v224, v224, v225
v_sub_f32_e64 v226, v254, v224
v_fma_f32 v0, v0, s70, v226
v_mfma_f32_32x32x16_bf16 v[64:79], a[12:15], v[120:123], v[64:79]
buffer_load_dwordx4 a[160:163], v238, s[40:43], s82 offen sc1
v_fma_f32 v1, v1, s70, v226
v_exp_f32_e32 v0, v0
v_exp_f32_e32 v1, v1
v_mfma_f32_32x32x16_bf16 v[80:95], a[16:19], v[120:123], v[80:95]
v_fma_f32 v2, v2, s70, v226
v_fma_f32 v3, v3, s70, v226
v_exp_f32_e32 v2, v2
v_exp_f32_e32 v3, v3
v_mfma_f32_32x32x16_bf16 v[96:111], a[20:23], v[120:123], v[96:111]
buffer_load_dwordx4 a[164:167], v238, s[40:43], s82 offen offset:1024 sc1
ds_read_b128 v[120:123], v246 offset:51488
v_fma_f32 v4, v4, s70, v226
v_fma_f32 v5, v5, s70, v226
v_fma_f32 v6, v6, s70, v226
v_fma_f32 v7, v7, s70, v226
v_mfma_f32_32x32x16_bf16 v[64:79], a[24:27], v[124:127], v[64:79]
v_exp_f32_e32 v4, v4
v_exp_f32_e32 v5, v5
v_exp_f32_e64 v6, v6
v_mfma_f32_32x32x16_bf16 v[80:95], a[28:31], v[124:127], v[80:95]
buffer_load_dwordx4 a[168:171], v238, s[40:43], s82 offen offset:2048 sc1
v_exp_f32_e64 v7, v7
v_cvt_pk_bf16_f32 v0, v0, v1
v_cvt_pk_bf16_f32 v1, v2, v3
v_cvt_pk_bf16_f32 v2, v4, v5
v_mfma_f32_32x32x16_bf16 v[96:111], a[32:35], v[124:127], v[96:111]
ds_read_b128 v[124:127], v246 offset:51520
v_cvt_pk_bf16_f32 v3, v6, v7
v_fma_f32 v8, v8, s70, v226
v_fma_f32 v9, v9, s70, v226
v_fma_f32 v10, v10, s70, v226
v_fma_f32 v11, v11, s70, v226
v_mfma_f32_32x32x16_bf16 v[64:79], a[36:39], v[128:131], v[64:79]
buffer_load_dwordx4 a[172:175], v238, s[40:43], s82 offen offset:3072 sc1
s_add_u32 s82, s71, 0x1000
v_fma_f32 v12, v12, s70, v226
v_fma_f32 v13, v13, s70, v226
v_fma_f32 v14, v14, s70, v226
v_fma_f32 v15, v15, s70, v226
v_mfma_f32_32x32x16_bf16 v[80:95], a[40:43], v[128:131], v[80:95]
v_exp_f32_e32 v8, v8
v_exp_f32_e32 v9, v9
v_exp_f32_e64 v10, v10
v_mfma_f32_32x32x16_bf16 v[96:111], a[44:47], v[128:131], v[96:111]
buffer_load_dwordx4 a[208:211], v238, s[40:43], s81 offen sc1
ds_read_b128 v[128:131], v246 offset:51552
v_exp_f32_e32 v11, v11
v_exp_f32_e32 v12, v12
v_mfma_f32_32x32x16_bf16 v[64:79], a[48:51], v[132:135], v[64:79]
v_exp_f32_e32 v13, v13
v_exp_f32_e32 v14, v14
v_exp_f32_e64 v15, v15
v_mfma_f32_32x32x16_bf16 v[80:95], a[52:55], v[132:135], v[80:95]
buffer_load_dwordx4 a[212:215], v238, s[40:43], s81 offen offset:1024 sc1
v_cvt_pk_bf16_f32 v4, v8, v9
v_cvt_pk_bf16_f32 v5, v10, v11
v_cvt_pk_bf16_f32 v6, v12, v13
v_cvt_pk_bf16_f32 v7, v14, v15
v_sub_f32_e64 v227, v255, v224
v_mfma_f32_32x32x16_bf16 v[96:111], a[56:59], v[132:135], v[96:111]
v_fma_f32 v16, v16, s70, v227
v_fma_f32 v17, v17, s70, v227
v_fma_f32 v18, v18, s70, v227
v_fma_f32 v19, v19, s70, v227
v_fma_f32 v20, v20, s70, v227
v_fma_f32 v21, v21, s70, v227
v_mfma_f32_32x32x16_bf16 v[64:79], a[60:63], v[136:139], v[64:79]
buffer_load_dwordx4 a[216:219], v238, s[40:43], s81 offen offset:2048 sc1
v_fma_f32 v22, v22, s70, v227
v_fma_f32 v23, v23, s70, v227
v_exp_f32_e64 v16, v16
v_max3_f32 v224, v32, v33, v34
v_mfma_f32_32x32x16_bf16 v[80:95], a[64:67], v[136:139], v[80:95]
v_exp_f32_e32 v17, v17
v_exp_f32_e32 v18, v18
v_exp_f32_e64 v19, v19
v_mfma_f32_32x32x16_bf16 v[96:111], a[68:71], v[136:139], v[96:111]
buffer_load_dwordx4 a[220:223], v238, s[40:43], s81 offen offset:3072 sc1
s_add_u32 s81, s71, 0x2000
v_exp_f32_e32 v20, v20
v_exp_f32_e32 v21, v21
v_mfma_f32_32x32x16_bf16 v[64:79], a[72:75], v[140:143], v[64:79]
v_exp_f32_e32 v22, v22
v_exp_f32_e32 v23, v23
v_cvt_pk_bf16_f32 v8, v16, v17
v_cvt_pk_bf16_f32 v9, v18, v19
v_mfma_f32_32x32x16_bf16 v[80:95], a[76:79], v[140:143], v[80:95]
buffer_load_dwordx4 a[224:227], v238, s[40:43], s82 offen sc1
v_cvt_pk_bf16_f32 v10, v20, v21
v_cvt_pk_bf16_f32 v11, v22, v23
v_max3_f32 v225, v48, v49, v50
v_max3_f32 v224, v224, v35, v36
v_max3_f32 v225, v225, v51, v52
v_mfma_f32_32x32x16_bf16 v[96:111], a[80:83], v[140:143], v[96:111]
v_max3_f32 v224, v224, v37, v38
v_max3_f32 v225, v225, v53, v54
v_max3_f32 v224, v224, v39, v40
v_max3_f32 v225, v225, v55, v56
v_max3_f32 v224, v224, v41, v42
v_max3_f32 v225, v225, v57, v58
v_mfma_f32_32x32x16_bf16 v[64:79], a[84:87], v[112:115], v[64:79]
buffer_load_dwordx4 a[228:231], v238, s[40:43], s82 offen offset:1024 sc1
v_max3_f32 v224, v224, v43, v44
v_max3_f32 v225, v225, v59, v60
v_fma_f32 v24, v24, s70, v227
v_fma_f32 v25, v25, s70, v227
v_fma_f32 v26, v26, s70, v227
v_mfma_f32_32x32x16_bf16 v[80:95], a[88:91], v[112:115], v[80:95]
v_fma_f32 v27, v27, s70, v227
v_fma_f32 v28, v28, s70, v227
v_fma_f32 v29, v29, s70, v227
v_fma_f32 v30, v30, s70, v227
v_fma_f32 v31, v31, s70, v227
v_max3_f32 v224, v224, v45, v46
v_mfma_f32_32x32x16_bf16 v[96:111], a[92:95], v[112:115], v[96:111]
s_waitcnt lgkmcnt(0)
v_max3_f32 v225, v225, v61, v62
v_exp_f32_e32 v24, v24
v_exp_f32_e32 v25, v25
v_max_f32_e32 v224, v224, v47
v_mfma_f32_32x32x16_bf16 v[64:79], a[96:99], v[116:119], v[64:79]
v_exp_f32_e32 v26, v26
v_exp_f32_e32 v27, v27
v_exp_f32_e64 v28, v28
v_mfma_f32_32x32x16_bf16 v[80:95], a[100:103], v[116:119], v[80:95]
v_exp_f32_e32 v29, v29
v_exp_f32_e32 v30, v30
v_exp_f32_e64 v31, v31
v_mfma_f32_32x32x16_bf16 v[96:111], a[104:107], v[116:119], v[96:111]
v_max_f32_e64 v225, v225, v63
v_fma_f32 v224, v224, s70, v255
v_fma_f32 v225, v225, s70, v254
v_max_f32_e64 v224, v224, v225
v_cvt_pk_bf16_f32 v12, v24, v25
v_cvt_pk_bf16_f32 v13, v26, v27
v_mfma_f32_32x32x16_bf16 v[64:79], a[108:111], v[120:123], v[64:79]
v_cvt_pk_bf16_f32 v14, v28, v29
v_cvt_pk_bf16_f32 v15, v30, v31
v_mov_b32_e32 v225, v224
s_nop 1
v_mfma_f32_32x32x16_bf16 v[80:95], a[112:115], v[120:123], v[80:95]
v_permlane32_swap_b32_e32 v224, v225
v_max_f32_e32 v224, v224, v225
v_sub_f32_e64 v228, v255, v224
v_fma_f32 v32, v32, s70, v228
v_fma_f32 v33, v33, s70, v228
v_mfma_f32_32x32x16_bf16 v[96:111], a[116:119], v[120:123], v[96:111]
v_exp_f32_e32 v32, v32
v_exp_f32_e32 v33, v33
v_fma_f32 v34, v34, s70, v228
v_fma_f32 v35, v35, s70, v228
v_mfma_f32_32x32x16_bf16 v[64:79], a[120:123], v[124:127], v[64:79]
v_exp_f32_e32 v34, v34
v_exp_f32_e32 v35, v35
v_fma_f32 v36, v36, s70, v228
v_fma_f32 v37, v37, s70, v228
v_mfma_f32_32x32x16_bf16 v[80:95], a[124:127], v[124:127], v[80:95]
v_fma_f32 v38, v38, s70, v228
v_fma_f32 v39, v39, s70, v228
v_exp_f32_e32 v36, v36
v_exp_f32_e32 v37, v37
v_mfma_f32_32x32x16_bf16 v[96:111], a[128:131], v[124:127], v[96:111]
v_exp_f32_e32 v38, v38
v_exp_f32_e32 v39, v39
v_cvt_pk_bf16_f32 v32, v32, v33
v_fma_f32 v40, v40, s70, v228
v_mfma_f32_32x32x16_bf16 v[64:79], a[132:135], v[128:131], v[64:79]
buffer_load_dwordx4 a[232:235], v238, s[40:43], s82 offen offset:2048 sc1
v_fma_f32 v41, v41, s70, v228
v_fma_f32 v42, v42, s70, v228
v_fma_f32 v43, v43, s70, v228
v_fma_f32 v44, v44, s70, v228
v_fma_f32 v45, v45, s70, v228
v_mfma_f32_32x32x16_bf16 v[80:95], a[136:139], v[128:131], v[80:95]
v_fma_f32 v46, v46, s70, v228
v_fma_f32 v47, v47, s70, v228
v_sub_f32_e64 v229, v254, v224
v_cvt_pk_bf16_f32 v33, v34, v35
v_exp_f32_e32 v40, v40
v_mfma_f32_32x32x16_bf16 v[96:111], a[140:143], v[128:131], v[96:111]
s_waitcnt vmcnt(13)
buffer_load_dwordx4 a[236:239], v238, s[40:43], s82 offen offset:3072 sc1
s_add_u32 s82, s71, 0x3000
v_cvt_pk_bf16_f32 v64, v64, v65
v_cvt_pk_bf16_f32 v72, v72, v73
v_cvt_pk_bf16_f32 v65, v66, v67
v_cvt_pk_bf16_f32 v73, v74, v75
v_mfma_f32_32x32x16_bf16 v[208:223], a[148:151], v[0:3], 0
v_cvt_pk_bf16_f32 v66, v68, v69
v_cvt_pk_bf16_f32 v67, v70, v71
v_cvt_pk_bf16_f32 v74, v76, v77
v_cvt_pk_bf16_f32 v75, v78, v79
v_exp_f32_e64 v41, v41
v_mfma_f32_32x32x16_bf16 v[192:207], a[144:147], v[0:3], 0
buffer_load_dwordx4 a[240:243], v238, s[40:43], s81 offen sc1
ds_write_b128 v230, v[64:67] offset:25600
v_exp_f32_e32 v42, v42
v_exp_f32_e32 v43, v43
v_exp_f32_e32 v44, v44
s_waitcnt vmcnt(13)
v_mfma_f32_32x32x16_bf16 v[208:223], a[156:159], v[4:7], v[208:223]
ds_write_b128 v230, v[72:75] offset:25632
buffer_load_dwordx4 a[244:247], v238, s[40:43], s81 offen offset:1024 sc1
v_mfma_f32_32x32x16_bf16 v[192:207], a[152:155], v[4:7], v[192:207]
ds_read_b128 v[68:71], v231 offset:25600
ds_read_b128 v[76:79], v231 offset:32000
v_exp_f32_e32 v45, v45
v_exp_f32_e32 v46, v46
v_exp_f32_e64 v47, v47
v_cvt_pk_bf16_f32 v34, v36, v37
v_cvt_pk_bf16_f32 v35, v38, v39
v_fma_f32 v48, v48, s70, v229
v_fma_f32 v49, v49, s70, v229
v_fma_f32 v50, v50, s70, v229
v_fma_f32 v51, v51, s70, v229
v_fma_f32 v52, v52, s70, v229
v_fma_f32 v53, v53, s70, v229
v_fma_f32 v54, v54, s70, v229
v_fma_f32 v55, v55, s70, v229
v_cvt_pk_bf16_f32 v36, v40, v41
s_waitcnt vmcnt(12)
v_mfma_f32_32x32x16_bf16 v[208:223], a[164:167], v[8:11], v[208:223]
s_nop 0
buffer_load_dwordx4 a[248:251], v238, s[40:43], s81 offen offset:2048 sc1
v_exp_f32_e32 v48, v48
v_exp_f32_e32 v49, v49
v_cvt_pk_bf16_f32 v37, v42, v43
v_mfma_f32_32x32x16_bf16 v[192:207], a[160:163], v[8:11], v[192:207]
v_exp_f32_e32 v50, v50
v_exp_f32_e32 v51, v51
v_exp_f32_e32 v52, v52
v_exp_f32_e32 v53, v53
v_exp_f32_e32 v54, v54
v_exp_f32_e32 v55, v55
v_cvt_pk_bf16_f32 v38, v44, v45
v_cvt_pk_bf16_f32 v39, v46, v47
v_fma_f32 v56, v56, s70, v229
v_fma_f32 v57, v57, s70, v229
v_fma_f32 v58, v58, s70, v229
v_fma_f32 v59, v59, s70, v229
v_fma_f32 v60, v60, s70, v229
v_fma_f32 v61, v61, s70, v229
v_fma_f32 v62, v62, s70, v229
v_fma_f32 v63, v63, s70, v229
s_waitcnt vmcnt(11) lgkmcnt(0)
v_mfma_f32_32x32x16_bf16 v[208:223], a[172:175], v[12:15], v[208:223]
s_nop 0
buffer_load_dwordx4 a[252:255], v238, s[40:43], s81 offen offset:3072 sc1
s_add_u32 s81, s71, 0x4000
v_exp_f32_e32 v56, v56
v_exp_f32_e32 v57, v57
v_mfma_f32_32x32x16_bf16 v[192:207], a[168:171], v[12:15], v[192:207]
v_exp_f32_e32 v58, v58
v_exp_f32_e32 v59, v59
v_exp_f32_e64 v60, v60
v_mfma_f32_32x32x16_bf16 v[16:31], a[148:151], v[32:35], 0
buffer_load_dwordx4 a[176:179], v238, s[40:43], s82 offen sc1
v_exp_f32_e32 v61, v61
v_exp_f32_e32 v62, v62
v_cvt_pk_bf16_f32 v40, v48, v49
v_mfma_f32_32x32x16_bf16 v[0:15], a[144:147], v[32:35], 0
ds_read_b128 v[32:35], v248
v_exp_f32_e64 v63, v63
v_cvt_pk_bf16_f32 v41, v50, v51
v_cvt_pk_bf16_f32 v42, v52, v53
v_cvt_pk_bf16_f32 v43, v54, v55
v_mfma_f32_32x32x16_bf16 v[16:31], a[156:159], v[36:39], v[16:31]
buffer_load_dwordx4 a[180:183], v238, s[40:43], s82 offen offset:1024 sc1
ds_read_b128 v[48:51], v248 offset:768
ds_read_b128 v[52:55], v248 offset:960
v_cvt_pk_bf16_f32 v44, v56, v57
v_cvt_pk_bf16_f32 v45, v58, v59
v_cvt_pk_bf16_f32 v46, v60, v61
v_mfma_f32_32x32x16_bf16 v[0:15], a[152:155], v[36:39], v[0:15]
ds_read_b128 v[36:39], v248 offset:192
ds_read_b128 v[56:59], v248 offset:1152
v_cvt_pk_bf16_f32 v47, v62, v63
v_cvt_pk_bf16_f32 v80, v80, v81
v_cvt_pk_bf16_f32 v88, v88, v89
v_cvt_pk_bf16_f32 v81, v82, v83
v_mfma_f32_32x32x16_bf16 v[16:31], a[164:167], v[40:43], v[16:31]
buffer_load_dwordx4 a[184:187], v238, s[40:43], s82 offen offset:2048 sc1
ds_read_b128 v[60:63], v248 offset:1344
v_cvt_pk_bf16_f32 v89, v90, v91
v_cvt_pk_bf16_f32 v82, v84, v85
v_cvt_pk_bf16_f32 v83, v86, v87
v_cvt_pk_bf16_f32 v90, v92, v93
v_mfma_f32_32x32x16_bf16 v[0:15], a[160:163], v[40:43], v[0:15]
ds_write_b128 v230, v[80:83] offset:25664
v_cvt_pk_bf16_f32 v91, v94, v95
v_mfma_f32_32x32x16_bf16 v[16:31], a[172:175], v[44:47], v[16:31]
buffer_load_dwordx4 a[188:191], v238, s[40:43], s82 offen offset:3072 sc1
v_rcp_f32_e64 v217, v216
v_cvt_pk_bf16_f32 v96, v96, v97
v_mul_f32_e32 v208, v217, v208
v_mul_f32_e32 v209, v217, v209
v_mfma_f32_32x32x16_bf16 v[0:15], a[168:171], v[44:47], v[0:15]
ds_write_b128 v230, v[88:91] offset:25696
buffer_load_dwordx4 a[192:195], v238, s[40:43], s81 offen sc1
ds_read_b128 v[84:87], v231 offset:25664
ds_read_b128 v[92:95], v231 offset:32064
ds_read_b128 v[40:43], v248 offset:384
ds_read_b128 v[44:47], v248 offset:576
v_rcp_f32_e64 v25, v24
ds_read_b128 v[28:31], v248 offset:2112
buffer_load_dwordx4 a[196:199], v238, s[40:43], s81 offen offset:1024 sc1
v_mul_f32_e32 v16, v25, v16
v_mul_f32_e32 v17, v25, v17
v_mul_f32_e32 v18, v25, v18
v_mul_f32_e32 v0, v25, v0
v_mul_f32_e32 v1, v25, v1
v_mul_f32_e32 v8, v25, v8
v_mul_f32_e32 v9, v25, v9
v_mul_f32_e32 v2, v25, v2
v_mul_f32_e64 v3, v25, v3
v_cvt_pk_bf16_f32 v0, v0, v1
v_mul_f32_e32 v10, v25, v10
v_mul_f32_e32 v11, v25, v11
buffer_load_dwordx4 a[200:203], v238, s[40:43], s81 offen offset:2048 sc1
v_cvt_pk_bf16_f32 v8, v8, v9
v_mul_f32_e32 v4, v25, v4
v_mul_f32_e32 v5, v25, v5
v_mul_f32_e32 v6, v25, v6
v_mul_f32_e32 v7, v25, v7
v_cvt_pk_bf16_f32 v1, v2, v3
v_mul_f32_e32 v12, v25, v12
v_mul_f32_e32 v13, v25, v13
v_mul_f32_e32 v14, v25, v14
v_mul_f32_e32 v15, v25, v15
v_cvt_pk_bf16_f32 v9, v10, v11
v_cvt_pk_bf16_f32 v2, v4, v5
buffer_load_dwordx4 a[204:207], v238, s[40:43], s81 offen offset:3072 sc1
v_cvt_pk_bf16_f32 v3, v6, v7
v_cvt_pk_bf16_f32 v10, v12, v13
v_cvt_pk_bf16_f32 v11, v14, v15
ds_write_b128 v247, v[0:3] offset:12800
v_mul_f32_e64 v19, v25, v19
v_cvt_pk_bf16_f32 v16, v16, v17
v_mul_f32_e64 v20, v25, v20
ds_write_b128 v247, v[8:11] offset:12832
v_mul_f32_e32 v21, v25, v21
v_mul_f32_e32 v22, v25, v22
v_mul_f32_e64 v23, v25, v23
ds_read_b128 v[0:3], v248 offset:768
ds_read_b128 v[4:7], v248 offset:960
ds_read_b128 v[8:11], v248 offset:1152
ds_read_b128 v[12:15], v248 offset:1344
v_cvt_pk_bf16_f32 v17, v18, v19
v_cvt_pk_bf16_f32 v18, v20, v21
v_cvt_pk_bf16_f32 v19, v22, v23
ds_write_b128 v247, v[16:19] offset:12864
v_mul_f32_e32 v192, v217, v192
v_mul_f32_e32 v193, v217, v193
v_mul_f32_e64 v200, v217, v200
ds_read_b128 v[16:19], v248 offset:1536
ds_read_b128 v[20:23], v248 offset:1728
ds_read_b128 v[24:27], v248 offset:1920
buffer_store_dwordx4 v[68:71], v251, s[36:39], s59 offen sc1
v_mul_f32_e32 v201, v217, v201
v_mul_f32_e32 v210, v217, v210
v_mul_f32_e64 v211, v217, v211
v_cvt_pk_bf16_f32 v208, v208, v209
v_mul_f32_e32 v194, v217, v194
v_mul_f32_e32 v195, v217, v195
v_cvt_pk_bf16_f32 v192, v192, v193
v_mul_f32_e32 v202, v217, v202
v_mul_f32_e32 v203, v217, v203
v_cvt_pk_bf16_f32 v200, v200, v201
v_mul_f32_e32 v212, v217, v212
v_mul_f32_e32 v213, v217, v213
v_mul_f32_e32 v214, v217, v214
v_mul_f32_e32 v215, v217, v215
v_cvt_pk_bf16_f32 v209, v210, v211
s_waitcnt vmcnt(13) lgkmcnt(3)
v_mfma_f32_32x32x16_bf16 v[0:15], a[220:223], a[208:211], v[0:15]
v_mul_f32_e32 v196, v217, v196
v_mul_f32_e32 v197, v217, v197
v_mul_f32_e32 v198, v217, v198
v_mul_f32_e64 v199, v217, v199
v_cvt_pk_bf16_f32 v193, v194, v195
v_mul_f32_e64 v204, v217, v204
v_mfma_f32_32x32x16_bf16 v[0:15], a[224:227], a[212:215], v[0:15]
v_mul_f32_e32 v205, v217, v205
v_mul_f32_e32 v206, v217, v206
v_mul_f32_e64 v207, v217, v207
v_cvt_pk_bf16_f32 v201, v202, v203
v_cvt_pk_bf16_f32 v210, v212, v213
v_cvt_pk_bf16_f32 v211, v214, v215
v_mfma_f32_32x32x16_bf16 v[0:15], a[228:231], a[216:219], v[0:15]
s_waitcnt lgkmcnt(0)
buffer_store_dwordx4 v[76:79], v251, s[36:39], s84 offen sc1
ds_write_b128 v247, v[208:211] offset:64
v_cvt_pk_bf16_f32 v194, v196, v197
v_cvt_pk_bf16_f32 v195, v198, v199
v_cvt_pk_bf16_f32 v202, v204, v205
s_waitcnt vmcnt(12)
v_mfma_f32_32x32x16_bf16 v[16:31], a[244:247], a[208:211], v[16:31]
v_cvt_pk_bf16_f32 v203, v206, v207
v_cvt_pk_bf16_f32 v104, v104, v105
v_cvt_pk_bf16_f32 v97, v98, v99
v_cvt_pk_bf16_f32 v105, v106, v107
v_cvt_pk_bf16_f32 v98, v100, v101
v_cvt_pk_bf16_f32 v99, v102, v103
v_cvt_pk_bf16_f32 v106, v108, v109
v_cvt_pk_bf16_f32 v107, v110, v111
ds_write_b128 v247, v[192:195]
v_max3_f32 v224, v0, v1, v2
v_max3_f32 v224, v224, v3, v4
v_max3_f32 v224, v224, v5, v6
v_max3_f32 v224, v224, v7, v8
v_max3_f32 v224, v224, v9, v10
v_max3_f32 v224, v224, v11, v12
v_mul_f32_e64 v254, s65, v253
v_max3_f32 v224, v224, v13, v14
v_min_f32_e64 v255, s69, v254
v_max_f32_e32 v224, v224, v15
s_waitcnt vmcnt(11)
v_mfma_f32_32x32x16_bf16 v[16:31], a[248:251], a[212:215], v[16:31]
buffer_store_dwordx4 v[84:87], v251, s[36:39], s59 offen offset:64 sc1
ds_write_b128 v247, v[200:203] offset:32
v_fma_f32 v224, v224, s70, v254
ds_write_b128 v230, v[96:99] offset:25728
s_waitcnt lgkmcnt(1)
s_barrier
s_waitcnt vmcnt(11)
v_mfma_f32_32x32x16_bf16 v[16:31], a[252:255], a[216:219], v[16:31]
ds_write_b128 v230, v[104:107] offset:25760
s_nop 0
v_mfma_f32_32x32x16_bf16 v[32:47], a[220:223], a[232:235], v[32:47]
buffer_store_dwordx4 v[92:95], v251, s[36:39], s84 offen offset:64 sc1
ds_read_b128 v[100:103], v231 offset:25728
v_mfma_f32_32x32x16_bf16 v[32:47], a[224:227], a[236:239], v[32:47]
ds_read_b128 v[132:135], v246
ds_read_b128 v[108:111], v231 offset:32128
ds_read_b128 v[136:139], v246 offset:32
ds_read_b128 v[140:143], v246 offset:64
v_mfma_f32_32x32x16_bf16 v[32:47], a[228:231], a[240:243], v[32:47]
ds_read_b128 v[112:115], v246 offset:96
v_max3_f32 v225, v16, v17, v18
v_max3_f32 v225, v225, v19, v20
v_max3_f32 v225, v225, v21, v22
v_max3_f32 v225, v225, v23, v24
v_mfma_f32_32x32x16_bf16 v[48:63], a[244:247], a[232:235], v[48:63]
ds_read_b128 v[116:119], v246 offset:128
ds_read_b128 v[120:123], v246 offset:160
v_max3_f32 v225, v225, v25, v26
v_max3_f32 v225, v225, v27, v28
v_max3_f32 v225, v225, v29, v30
v_max_f32_e64 v225, v225, v31
v_mfma_f32_32x32x16_bf16 v[48:63], a[248:251], a[236:239], v[48:63]
ds_read_b128 v[124:127], v246 offset:192
s_waitcnt lgkmcnt(8)
buffer_store_dwordx4 v[100:103], v251, s[36:39], s59 offen offset:128 sc1
v_mfma_f32_32x32x16_bf16 v[48:63], a[252:255], a[240:243], v[48:63]
s_waitcnt lgkmcnt(7)
ds_read_b128 v[128:131], v246 offset:224
v_fma_f32 v225, v225, s70, v255
v_max_f32_e64 v224, v224, v225
v_mov_b32_e32 v225, v224
s_nop 1
v_mfma_f32_32x32x16_bf16 v[64:79], a[0:3], v[132:135], 0
v_permlane32_swap_b32_e32 v224, v225
v_max_f32_e32 v224, v224, v225
v_sub_f32_e64 v226, v254, v224
v_fma_f32 v0, v0, s70, v226
v_fma_f32 v1, v1, s70, v226
v_mfma_f32_32x32x16_bf16 v[80:95], a[4:7], v[132:135], 0
s_waitcnt lgkmcnt(5)
v_exp_f32_e32 v0, v0
v_exp_f32_e64 v1, v1
v_fma_f32 v2, v2, s70, v226
buffer_store_dwordx4 v[108:111], v251, s[36:39], s84 offen offset:128 sc1
v_fma_f32 v3, v3, s70, v226
v_fma_f32 v4, v4, s70, v226
v_mfma_f32_32x32x16_bf16 v[96:111], a[8:11], v[132:135], 0
s_add_u32 s84, s61, 0x2a000
ds_read_b128 v[132:135], v246 offset:256
v_exp_f32_e32 v2, v2
v_exp_f32_e32 v3, v3
v_fma_f32 v5, v5, s70, v226
v_mfma_f32_32x32x16_bf16 v[64:79], a[12:15], v[136:139], v[64:79]
v_fma_f32 v6, v6, s70, v226
v_fma_f32 v7, v7, s70, v226
v_exp_f32_e32 v4, v4
v_exp_f32_e32 v5, v5
v_mfma_f32_32x32x16_bf16 v[80:95], a[16:19], v[136:139], v[80:95]
v_exp_f32_e32 v6, v6
v_exp_f32_e32 v7, v7
v_cvt_pk_bf16_f32 v0, v0, v1
v_cvt_pk_bf16_f32 v1, v2, v3
v_mfma_f32_32x32x16_bf16 v[96:111], a[20:23], v[136:139], v[96:111]
ds_read_b128 v[136:139], v246 offset:288
v_cvt_pk_bf16_f32 v2, v4, v5
v_cvt_pk_bf16_f32 v3, v6, v7
v_fma_f32 v8, v8, s70, v226
v_fma_f32 v9, v9, s70, v226
v_fma_f32 v10, v10, s70, v226
v_mfma_f32_32x32x16_bf16 v[64:79], a[24:27], v[140:143], v[64:79]
v_fma_f32 v11, v11, s70, v226
v_fma_f32 v12, v12, s70, v226
v_fma_f32 v13, v13, s70, v226
v_fma_f32 v14, v14, s70, v226
v_fma_f32 v15, v15, s70, v226
v_sub_f32_e64 v227, v255, v224
v_mfma_f32_32x32x16_bf16 v[80:95], a[28:31], v[140:143], v[80:95]
v_exp_f32_e32 v8, v8
v_exp_f32_e32 v9, v9
v_exp_f32_e32 v10, v10
v_mfma_f32_32x32x16_bf16 v[96:111], a[32:35], v[140:143], v[96:111]
s_waitcnt lgkmcnt(1)
ds_read_b128 v[140:143], v246 offset:320
v_exp_f32_e32 v11, v11
v_exp_f32_e32 v12, v12
v_max3_f32 v224, v32, v33, v34
v_mfma_f32_32x32x16_bf16 v[64:79], a[36:39], v[112:115], v[64:79]
v_exp_f32_e32 v13, v13
v_exp_f32_e32 v14, v14
v_exp_f32_e64 v15, v15
v_mfma_f32_32x32x16_bf16 v[80:95], a[40:43], v[112:115], v[80:95]
v_max3_f32 v225, v48, v49, v50
v_max3_f32 v224, v224, v35, v36
v_max3_f32 v225, v225, v51, v52
v_cvt_pk_bf16_f32 v4, v8, v9
v_cvt_pk_bf16_f32 v5, v10, v11
v_cvt_pk_bf16_f32 v6, v12, v13
v_mfma_f32_32x32x16_bf16 v[96:111], a[44:47], v[112:115], v[96:111]
ds_read_b128 v[112:115], v246 offset:352
v_cvt_pk_bf16_f32 v7, v14, v15
v_max3_f32 v224, v224, v37, v38
v_max3_f32 v225, v225, v53, v54
v_max3_f32 v224, v224, v39, v40
v_max3_f32 v225, v225, v55, v56
v_mfma_f32_32x32x16_bf16 v[64:79], a[48:51], v[116:119], v[64:79]
v_max3_f32 v224, v224, v41, v42
v_max3_f32 v225, v225, v57, v58
v_max3_f32 v224, v224, v43, v44
v_max3_f32 v225, v225, v59, v60
v_max3_f32 v224, v224, v45, v46
v_max3_f32 v225, v225, v61, v62
v_mfma_f32_32x32x16_bf16 v[80:95], a[52:55], v[116:119], v[80:95]
v_max_f32_e32 v224, v224, v47
v_max_f32_e32 v225, v225, v63
v_fma_f32 v224, v224, s70, v255
v_fma_f32 v225, v225, s70, v254
v_max_f32_e32 v224, v224, v225
v_mov_b32_e32 v225, v224
v_mfma_f32_32x32x16_bf16 v[96:111], a[56:59], v[116:119], v[96:111]
v_fma_f32 v16, v16, s70, v227
v_permlane32_swap_b32_e64 v224, v225
v_fma_f32 v17, v17, s70, v227
v_fma_f32 v18, v18, s70, v227
v_fma_f32 v19, v19, s70, v227
v_mfma_f32_32x32x16_bf16 v[64:79], a[60:63], v[120:123], v[64:79]
v_fma_f32 v20, v20, s70, v227
v_fma_f32 v21, v21, s70, v227
v_fma_f32 v22, v22, s70, v227
v_fma_f32 v23, v23, s70, v227
v_max_f32_e32 v224, v224, v225
v_sub_f32_e32 v228, v255, v224
v_mfma_f32_32x32x16_bf16 v[80:95], a[64:67], v[120:123], v[80:95]
v_exp_f32_e32 v16, v16
v_exp_f32_e32 v17, v17
v_exp_f32_e64 v18, v18
v_mfma_f32_32x32x16_bf16 v[96:111], a[68:71], v[120:123], v[96:111]
v_exp_f32_e32 v19, v19
v_exp_f32_e32 v20, v20
v_exp_f32_e64 v21, v21
v_mfma_f32_32x32x16_bf16 v[64:79], a[72:75], v[124:127], v[64:79]
v_exp_f32_e32 v22, v22
v_exp_f32_e32 v23, v23
v_fma_f32 v24, v24, s70, v227
v_fma_f32 v25, v25, s70, v227
v_mfma_f32_32x32x16_bf16 v[80:95], a[76:79], v[124:127], v[80:95]
v_fma_f32 v26, v26, s70, v227
v_fma_f32 v27, v27, s70, v227
v_fma_f32 v28, v28, s70, v227
v_fma_f32 v29, v29, s70, v227
v_fma_f32 v30, v30, s70, v227
v_fma_f32 v31, v31, s70, v227
v_mfma_f32_32x32x16_bf16 v[96:111], a[80:83], v[124:127], v[96:111]
v_fma_f32 v32, v32, s70, v228
v_fma_f32 v33, v33, s70, v228
v_exp_f32_e32 v24, v24
v_exp_f32_e32 v25, v25
v_mfma_f32_32x32x16_bf16 v[64:79], a[84:87], v[128:131], v[64:79]
v_exp_f32_e32 v26, v26
v_exp_f32_e32 v27, v27
v_exp_f32_e64 v28, v28
v_mfma_f32_32x32x16_bf16 v[80:95], a[88:91], v[128:131], v[80:95]
v_exp_f32_e32 v29, v29
v_exp_f32_e32 v30, v30
v_exp_f32_e64 v31, v31
v_mfma_f32_32x32x16_bf16 v[96:111], a[92:95], v[128:131], v[96:111]
v_exp_f32_e32 v32, v32
v_exp_f32_e32 v33, v33
v_fma_f32 v34, v34, s70, v228
v_fma_f32 v35, v35, s70, v228
v_mfma_f32_32x32x16_bf16 v[64:79], a[96:99], v[132:135], v[64:79]
v_cvt_pk_bf16_f32 v8, v16, v17
v_cvt_pk_bf16_f32 v9, v18, v19
v_cvt_pk_bf16_f32 v10, v20, v21
v_cvt_pk_bf16_f32 v11, v22, v23
v_exp_f32_e64 v34, v34
v_mfma_f32_32x32x16_bf16 v[80:95], a[100:103], v[132:135], v[80:95]
v_exp_f32_e64 v35, v35
v_fma_f32 v36, v36, s70, v228
v_fma_f32 v37, v37, s70, v228
v_fma_f32 v38, v38, s70, v228
v_fma_f32 v39, v39, s70, v228
v_mfma_f32_32x32x16_bf16 v[96:111], a[104:107], v[132:135], v[96:111]
s_waitcnt lgkmcnt(0)
v_exp_f32_e32 v36, v36
v_exp_f32_e32 v37, v37
v_exp_f32_e32 v38, v38
v_mfma_f32_32x32x16_bf16 v[64:79], a[108:111], v[136:139], v[64:79]
v_exp_f32_e64 v39, v39
v_cvt_pk_bf16_f32 v12, v24, v25
v_cvt_pk_bf16_f32 v13, v26, v27
v_cvt_pk_bf16_f32 v14, v28, v29
v_cvt_pk_bf16_f32 v15, v30, v31
v_mfma_f32_32x32x16_bf16 v[80:95], a[112:115], v[136:139], v[80:95]
v_cvt_pk_bf16_f32 v32, v32, v33
v_fma_f32 v40, v40, s70, v228
v_fma_f32 v41, v41, s70, v228
v_fma_f32 v42, v42, s70, v228
v_fma_f32 v43, v43, s70, v228
v_fma_f32 v44, v44, s70, v228
v_mfma_f32_32x32x16_bf16 v[96:111], a[116:119], v[136:139], v[96:111]
v_fma_f32 v45, v45, s70, v228
v_fma_f32 v46, v46, s70, v228
v_fma_f32 v47, v47, s70, v228
v_sub_f32_e64 v229, v254, v224
v_cvt_pk_bf16_f32 v33, v34, v35
v_cvt_pk_bf16_f32 v34, v36, v37
v_mfma_f32_32x32x16_bf16 v[64:79], a[120:123], v[140:143], v[64:79]
v_exp_f32_e32 v40, v40
v_exp_f32_e32 v41, v41
v_exp_f32_e64 v42, v42
v_mfma_f32_32x32x16_bf16 v[80:95], a[124:127], v[140:143], v[80:95]
v_exp_f32_e32 v43, v43
v_exp_f32_e32 v44, v44
v_exp_f32_e64 v45, v45
v_mfma_f32_32x32x16_bf16 v[96:111], a[128:131], v[140:143], v[96:111]
v_exp_f32_e32 v46, v46
v_exp_f32_e32 v47, v47
v_cvt_pk_bf16_f32 v35, v38, v39
v_fma_f32 v48, v48, s70, v229
v_mfma_f32_32x32x16_bf16 v[64:79], a[132:135], v[112:115], v[64:79]
v_fma_f32 v49, v49, s70, v229
v_fma_f32 v50, v50, s70, v229
v_fma_f32 v51, v51, s70, v229
v_fma_f32 v52, v52, s70, v229
v_fma_f32 v53, v53, s70, v229
v_fma_f32 v54, v54, s70, v229
v_mfma_f32_32x32x16_bf16 v[80:95], a[136:139], v[112:115], v[80:95]
v_fma_f32 v55, v55, s70, v229
v_exp_f32_e32 v48, v48
v_exp_f32_e32 v49, v49
v_cvt_pk_bf16_f32 v36, v40, v41
v_mfma_f32_32x32x16_bf16 v[96:111], a[140:143], v[112:115], v[96:111]
s_waitcnt vmcnt(6)
v_exp_f32_e32 v50, v50
v_exp_f32_e32 v51, v51
v_exp_f32_e32 v52, v52
v_mfma_f32_32x32x16_bf16 v[208:223], a[180:183], v[0:3], 0
v_exp_f32_e32 v53, v53
v_exp_f32_e32 v54, v54
v_exp_f32_e64 v55, v55
v_mfma_f32_32x32x16_bf16 v[192:207], a[176:179], v[0:3], 0
v_cvt_pk_bf16_f32 v37, v42, v43
v_cvt_pk_bf16_f32 v38, v44, v45
v_cvt_pk_bf16_f32 v39, v46, v47
v_fma_f32 v56, v56, s70, v229
v_fma_f32 v57, v57, s70, v229
v_fma_f32 v58, v58, s70, v229
v_mfma_f32_32x32x16_bf16 v[208:223], a[188:191], v[4:7], v[208:223]
v_fma_f32 v59, v59, s70, v229
v_fma_f32 v60, v60, s70, v229
v_fma_f32 v61, v61, s70, v229
v_fma_f32 v62, v62, s70, v229
v_fma_f32 v63, v63, s70, v229
v_cvt_pk_bf16_f32 v40, v48, v49
v_mfma_f32_32x32x16_bf16 v[192:207], a[184:187], v[4:7], v[192:207]
v_exp_f32_e32 v56, v56
v_exp_f32_e32 v57, v57
v_exp_f32_e64 v58, v58
v_mfma_f32_32x32x16_bf16 v[208:223], a[196:199], v[8:11], v[208:223]
v_exp_f32_e32 v59, v59
v_exp_f32_e32 v60, v60
v_exp_f32_e64 v61, v61
v_mfma_f32_32x32x16_bf16 v[192:207], a[192:195], v[8:11], v[192:207]
v_exp_f32_e32 v62, v62
v_exp_f32_e32 v63, v63
v_cvt_pk_bf16_f32 v41, v50, v51
v_cvt_pk_bf16_f32 v42, v52, v53
v_mfma_f32_32x32x16_bf16 v[208:223], a[204:207], v[12:15], v[208:223]
v_cvt_pk_bf16_f32 v43, v54, v55
v_cvt_pk_bf16_f32 v44, v56, v57
v_cvt_pk_bf16_f32 v45, v58, v59
v_cvt_pk_bf16_f32 v46, v60, v61
v_cvt_pk_bf16_f32 v47, v62, v63
v_cvt_pk_bf16_f32 v64, v64, v65
v_mfma_f32_32x32x16_bf16 v[192:207], a[200:203], v[12:15], v[192:207]
v_cvt_pk_bf16_f32 v72, v72, v73
v_cvt_pk_bf16_f32 v65, v66, v67
v_cvt_pk_bf16_f32 v73, v74, v75
v_cvt_pk_bf16_f32 v66, v68, v69
v_cvt_pk_bf16_f32 v67, v70, v71
v_cvt_pk_bf16_f32 v74, v76, v77
v_mfma_f32_32x32x16_bf16 v[16:31], a[180:183], v[32:35], 0
ds_write_b128 v230, v[64:67] offset:25600
v_cvt_pk_bf16_f32 v75, v78, v79
v_mfma_f32_32x32x16_bf16 v[0:15], a[176:179], v[32:35], 0
v_rcp_f32_e64 v217, v216
v_cvt_pk_bf16_f32 v80, v80, v81
v_mul_f32_e32 v208, v217, v208
v_mul_f32_e32 v209, v217, v209
v_mul_f32_e64 v192, v217, v192
v_mfma_f32_32x32x16_bf16 v[16:31], a[188:191], v[36:39], v[16:31]
ds_write_b128 v230, v[72:75] offset:25632
v_mul_f32_e64 v193, v217, v193
v_mfma_f32_32x32x16_bf16 v[0:15], a[184:187], v[36:39], v[0:15]
v_mul_f32_e32 v200, v217, v200
v_mul_f32_e32 v201, v217, v201
v_mul_f32_e32 v210, v217, v210
v_mul_f32_e32 v211, v217, v211
v_cvt_pk_bf16_f32 v208, v208, v209
v_mul_f32_e64 v194, v217, v194
v_mfma_f32_32x32x16_bf16 v[16:31], a[196:199], v[40:43], v[16:31]
ds_read_b128 v[68:71], v231 offset:25600
ds_read_b128 v[76:79], v231 offset:32000
v_mul_f32_e64 v195, v217, v195
v_cvt_pk_bf16_f32 v192, v192, v193
v_mul_f32_e32 v202, v217, v202
v_mul_f32_e32 v203, v217, v203
v_mfma_f32_32x32x16_bf16 v[0:15], a[192:195], v[40:43], v[0:15]
v_cvt_pk_bf16_f32 v200, v200, v201
v_mul_f32_e32 v212, v217, v212
v_mul_f32_e32 v213, v217, v213
v_mul_f32_e32 v214, v217, v214
v_mul_f32_e32 v215, v217, v215
v_cvt_pk_bf16_f32 v209, v210, v211
v_mfma_f32_32x32x16_bf16 v[16:31], a[204:207], v[44:47], v[16:31]
v_mul_f32_e32 v196, v217, v196
v_mul_f32_e32 v197, v217, v197
v_mul_f32_e32 v198, v217, v198
v_mul_f32_e32 v199, v217, v199
v_cvt_pk_bf16_f32 v193, v194, v195
v_mul_f32_e64 v204, v217, v204
v_mfma_f32_32x32x16_bf16 v[0:15], a[200:203], v[44:47], v[0:15]
v_mul_f32_e32 v205, v217, v205
v_mul_f32_e32 v206, v217, v206
v_mul_f32_e64 v207, v217, v207
v_cvt_pk_bf16_f32 v201, v202, v203
v_cvt_pk_bf16_f32 v210, v212, v213
v_cvt_pk_bf16_f32 v211, v214, v215
v_rcp_f32_e64 v25, v24
v_cvt_pk_bf16_f32 v194, v196, v197
v_mul_f32_e32 v16, v25, v16
v_mul_f32_e32 v17, v25, v17
v_mul_f32_e32 v18, v25, v18
v_mul_f32_e32 v19, v25, v19
v_cvt_pk_bf16_f32 v16, v16, v17
v_mul_f32_e32 v0, v25, v0
v_mul_f32_e32 v1, v25, v1
v_mul_f32_e32 v8, v25, v8
v_mul_f32_e32 v9, v25, v9
v_mul_f32_e32 v2, v25, v2
v_mul_f32_e32 v3, v25, v3
v_cvt_pk_bf16_f32 v0, v0, v1
v_mul_f32_e32 v10, v25, v10
v_mul_f32_e32 v11, v25, v11
v_cvt_pk_bf16_f32 v8, v8, v9
v_mul_f32_e32 v20, v25, v20
v_mul_f32_e32 v21, v25, v21
v_mul_f32_e32 v22, v25, v22
v_mul_f32_e32 v23, v25, v23
v_cvt_pk_bf16_f32 v17, v18, v19
v_mul_f32_e32 v4, v25, v4
v_mul_f32_e32 v5, v25, v5
v_mul_f32_e32 v6, v25, v6
v_mul_f32_e32 v7, v25, v7
v_cvt_pk_bf16_f32 v1, v2, v3
v_mul_f32_e32 v12, v25, v12
v_mul_f32_e32 v13, v25, v13
v_mul_f32_e64 v14, v25, v14
v_mul_f32_e32 v15, v25, v15
v_cvt_pk_bf16_f32 v9, v10, v11
v_cvt_pk_bf16_f32 v195, v198, v199
v_cvt_pk_bf16_f32 v202, v204, v205
v_cvt_pk_bf16_f32 v203, v206, v207
v_cvt_pk_bf16_f32 v18, v20, v21
v_cvt_pk_bf16_f32 v19, v22, v23
v_cvt_pk_bf16_f32 v2, v4, v5
v_cvt_pk_bf16_f32 v3, v6, v7
v_cvt_pk_bf16_f32 v10, v12, v13
v_cvt_pk_bf16_f32 v11, v14, v15
ds_write_b128 v247, v[208:211] offset:51264
s_waitcnt lgkmcnt(1)
buffer_store_dwordx4 v[68:71], v252, s[36:39], s60 offen sc1
ds_write_b128 v247, v[192:195] offset:51200
v_cvt_pk_bf16_f32 v88, v88, v89
v_cvt_pk_bf16_f32 v81, v82, v83
v_cvt_pk_bf16_f32 v89, v90, v91
ds_write_b128 v247, v[200:203] offset:51232
v_cvt_pk_bf16_f32 v82, v84, v85
v_cvt_pk_bf16_f32 v83, v86, v87
v_cvt_pk_bf16_f32 v90, v92, v93
ds_write_b128 v247, v[16:19] offset:64064
buffer_store_dwordx4 v[76:79], v252, s[36:39], s76 offen sc1
ds_write_b128 v247, v[0:3] offset:64000
v_cvt_pk_bf16_f32 v91, v94, v95
v_cvt_pk_bf16_f32 v96, v96, v97
v_cvt_pk_bf16_f32 v104, v104, v105
v_cvt_pk_bf16_f32 v97, v98, v99
v_cvt_pk_bf16_f32 v105, v106, v107
ds_write_b128 v247, v[8:11] offset:64032
v_cvt_pk_bf16_f32 v98, v100, v101
v_cvt_pk_bf16_f32 v99, v102, v103
v_cvt_pk_bf16_f32 v106, v108, v109
v_cvt_pk_bf16_f32 v107, v110, v111
ds_write_b128 v230, v[80:83] offset:25664
ds_write_b128 v230, v[88:91] offset:25696
s_waitcnt lgkmcnt(2)
s_barrier
ds_read_b128 v[144:147], v246 offset:51200
ds_read_b128 v[148:151], v246 offset:51232
ds_read_b128 v[152:155], v246 offset:51264
ds_read_b128 v[156:159], v246 offset:51296
ds_read_b128 v[160:163], v246 offset:51328
ds_read_b128 v[164:167], v246 offset:51360
ds_read_b128 v[168:171], v246 offset:51392
ds_read_b128 v[172:175], v246 offset:51424
ds_read_b128 v[84:87], v231 offset:25664
ds_read_b128 v[176:179], v246 offset:51456
ds_read_b128 v[180:183], v246 offset:51488
ds_read_b128 v[184:187], v246 offset:51520
s_waitcnt lgkmcnt(10)
v_mfma_f32_32x32x16_bf16 v[64:79], a[0:3], v[144:147], 0
s_nop 0
ds_read_b128 v[188:191], v246 offset:51552
ds_read_b128 v[92:95], v231 offset:32064
v_mfma_f32_32x32x16_bf16 v[64:79], a[12:15], v[148:151], v[64:79]
s_waitcnt lgkmcnt(10)
ds_write_b128 v230, v[96:99] offset:25728
v_mfma_f32_32x32x16_bf16 v[64:79], a[24:27], v[152:155], v[64:79]
v_mfma_f32_32x32x16_bf16 v[64:79], a[36:39], v[156:159], v[64:79]
s_waitcnt lgkmcnt(6)
buffer_store_dwordx4 v[84:87], v252, s[36:39], s60 offen offset:64 sc1
v_mfma_f32_32x32x16_bf16 v[64:79], a[48:51], v[160:163], v[64:79]
ds_write_b128 v230, v[104:107] offset:25760
v_mfma_f32_32x32x16_bf16 v[64:79], a[60:63], v[164:167], v[64:79]
ds_read_b128 v[100:103], v231 offset:25728
ds_read_b128 v[108:111], v231 offset:32128
v_mfma_f32_32x32x16_bf16 v[64:79], a[72:75], v[168:171], v[64:79]
s_nop 0
v_mfma_f32_32x32x16_bf16 v[64:79], a[84:87], v[172:175], v[64:79]
s_waitcnt lgkmcnt(3)
buffer_store_dwordx4 v[92:95], v252, s[36:39], s76 offen offset:64 sc1
v_mfma_f32_32x32x16_bf16 v[64:79], a[96:99], v[176:179], v[64:79]
v_mfma_f32_32x32x16_bf16 v[64:79], a[108:111], v[180:183], v[64:79]
v_mfma_f32_32x32x16_bf16 v[64:79], a[120:123], v[184:187], v[64:79]
v_mfma_f32_32x32x16_bf16 v[64:79], a[132:135], v[188:191], v[64:79]
s_waitcnt lgkmcnt(0)
buffer_store_dwordx4 v[100:103], v252, s[36:39], s60 offen offset:128 sc1
s_nop 0
v_mfma_f32_32x32x16_bf16 v[80:95], a[4:7], v[144:147], 0
s_nop 6
v_mfma_f32_32x32x16_bf16 v[80:95], a[16:19], v[148:151], v[80:95]
s_nop 0
v_cvt_pk_bf16_f32 v64, v64, v65
v_cvt_pk_bf16_f32 v72, v72, v73
v_cvt_pk_bf16_f32 v65, v66, v67
v_cvt_pk_bf16_f32 v73, v74, v75
v_cvt_pk_bf16_f32 v66, v68, v69
v_cvt_pk_bf16_f32 v67, v70, v71
v_mfma_f32_32x32x16_bf16 v[80:95], a[28:31], v[152:155], v[80:95]
ds_write_b128 v230, v[64:67] offset:25600
v_cvt_pk_bf16_f32 v74, v76, v77
v_mfma_f32_32x32x16_bf16 v[80:95], a[40:43], v[156:159], v[80:95]
buffer_store_dwordx4 v[108:111], v252, s[36:39], s76 offen offset:128 sc1
v_cvt_pk_bf16_f32 v75, v78, v79
v_mfma_f32_32x32x16_bf16 v[80:95], a[52:55], v[160:163], v[80:95]
ds_write_b128 v230, v[72:75] offset:25632
v_mfma_f32_32x32x16_bf16 v[80:95], a[64:67], v[164:167], v[80:95]
ds_read_b128 v[68:71], v231 offset:25600
ds_read_b128 v[76:79], v231 offset:32000
v_mfma_f32_32x32x16_bf16 v[80:95], a[76:79], v[168:171], v[80:95]
v_mfma_f32_32x32x16_bf16 v[80:95], a[88:91], v[172:175], v[80:95]
v_mfma_f32_32x32x16_bf16 v[80:95], a[100:103], v[176:179], v[80:95]
s_nop 0
v_mfma_f32_32x32x16_bf16 v[80:95], a[112:115], v[180:183], v[80:95]
s_waitcnt lgkmcnt(1)
buffer_store_dwordx4 v[68:71], v239, s[36:39], s61 offen sc1
v_mfma_f32_32x32x16_bf16 v[80:95], a[124:127], v[184:187], v[80:95]
v_mfma_f32_32x32x16_bf16 v[80:95], a[136:139], v[188:191], v[80:95]
s_nop 6
v_mfma_f32_32x32x16_bf16 v[96:111], a[8:11], v[144:147], 0
s_nop 2
v_mfma_f32_32x32x16_bf16 v[96:111], a[20:23], v[148:151], v[96:111]
v_cvt_pk_bf16_f32 v80, v80, v81
v_cvt_pk_bf16_f32 v88, v88, v89
v_cvt_pk_bf16_f32 v81, v82, v83
v_cvt_pk_bf16_f32 v89, v90, v91
v_cvt_pk_bf16_f32 v82, v84, v85
v_cvt_pk_bf16_f32 v83, v86, v87
v_mfma_f32_32x32x16_bf16 v[96:111], a[32:35], v[152:155], v[96:111]
s_nop 0
ds_write_b128 v230, v[80:83] offset:25664
v_cvt_pk_bf16_f32 v90, v92, v93
v_mfma_f32_32x32x16_bf16 v[96:111], a[44:47], v[156:159], v[96:111]
s_waitcnt lgkmcnt(1)
buffer_store_dwordx4 v[76:79], v239, s[36:39], s84 offen sc1
v_cvt_pk_bf16_f32 v91, v94, v95
v_mfma_f32_32x32x16_bf16 v[96:111], a[56:59], v[160:163], v[96:111]
ds_write_b128 v230, v[88:91] offset:25696
v_mfma_f32_32x32x16_bf16 v[96:111], a[68:71], v[164:167], v[96:111]
ds_read_b128 v[84:87], v231 offset:25664
ds_read_b128 v[92:95], v231 offset:32064
v_mfma_f32_32x32x16_bf16 v[96:111], a[80:83], v[168:171], v[96:111]
v_mfma_f32_32x32x16_bf16 v[96:111], a[92:95], v[172:175], v[96:111]
v_mfma_f32_32x32x16_bf16 v[96:111], a[104:107], v[176:179], v[96:111]
s_nop 0
v_mfma_f32_32x32x16_bf16 v[96:111], a[116:119], v[180:183], v[96:111]
s_waitcnt lgkmcnt(1)
buffer_store_dwordx4 v[84:87], v239, s[36:39], s61 offen offset:64 sc1
v_mfma_f32_32x32x16_bf16 v[96:111], a[128:131], v[184:187], v[96:111]
v_mfma_f32_32x32x16_bf16 v[96:111], a[140:143], v[188:191], v[96:111]
s_waitcnt lgkmcnt(0)
buffer_store_dwordx4 v[92:95], v239, s[36:39], s84 offen offset:64 sc1
s_nop 10
v_cvt_pk_bf16_f32 v96, v96, v97
v_cvt_pk_bf16_f32 v104, v104, v105
v_cvt_pk_bf16_f32 v97, v98, v99
v_cvt_pk_bf16_f32 v105, v106, v107
v_cvt_pk_bf16_f32 v98, v100, v101
v_cvt_pk_bf16_f32 v99, v102, v103
v_cvt_pk_bf16_f32 v106, v108, v109
v_cvt_pk_bf16_f32 v107, v110, v111
ds_write_b128 v230, v[96:99] offset:25728
ds_write_b128 v230, v[104:107] offset:25760
ds_read_b128 v[100:103], v231 offset:25728
ds_read_b128 v[108:111], v231 offset:32128
s_waitcnt lgkmcnt(1)
buffer_store_dwordx4 v[100:103], v239, s[36:39], s61 offen offset:128 sc1
s_waitcnt lgkmcnt(0)
buffer_store_dwordx4 v[108:111], v239, s[36:39], s84 offen offset:128 sc1
s_endpgm
L_slow_cons0:
s_add_u32 s3, s3, 1
s_cmp_gt_u32 s3, 0x8000
s_cbranch_scc1 L_back_cons0
s_sleep 32
buffer_load_dwordx2 v[236:237], v235, s[88:91], s44 offen sc1
s_waitcnt vmcnt(0)
v_or_b32 v237, 0x01010000, v237
v_and_b32 v236, v236, v237
s_nop 0
v_readfirstlane_b32 s80, v236
s_nop 1
s_cmp_eq_u32 s80, 0x01010101
s_cbranch_scc0 L_slow_cons0
s_branch L_back_cons0
.p2align 6
L_pqk:
s_mov_b32 s40, s16
s_mov_b32 s41, s17
s_mov_b32 s88, s14
s_mov_b32 s89, s15
s_mov_b32 s36, s12
s_mov_b32 s37, s13
s_add_u32 m0, s86, 0x1800
s_mov_b32 s77, 0x9000
s_mov_b32 s78, 0xd800
v_add_u32_e64 v78, 0, v64
v_mul_u32_u24 v79, 0xab, v78
v_lshl_add_u32 v74, v69, 3, v72
buffer_load_dwordx4 v90, s[24:27], s77 offen lds
s_add_u32 m0, s86, 0x1c00
v_lshrrev_b32_e64 v80, 11, v79
v_mul_u32_u24 v74, 0x60, v74
v_lshrrev_b32_e64 v79, 10, v79
v_lshl_add_u32 v74, v73, 3, v74
v_lshlrev_b32_e64 v78, 4, v78
v_mul_u32_u24 v80, 0xc0, v80
v_mul_u32_u24 v79, 0x420, v79
v_add_u32_e32 v143, s86, v74
v_add_u32_e32 v235, v80, v78
v_add3_u32 v79, v79, v78, v71
v_and_b32_e64 v74, 3, v68
buffer_load_dwordx4 v91, s[24:27], s77 offen lds
s_add_u32 m0, s86, 0x2000
v_bfe_u32 v76, v68, 2, 1
v_add_u32 v140, 0x300, v79
v_add_u32_e64 v78, 64, v64
v_lshl_or_b32 v74, v76, 3, v74
v_mul_u32_u24 v79, 0xab, v78
v_bfe_u32 v76, v68, 3, 1
v_lshrrev_b32_e64 v80, 11, v79
v_lshl_or_b32 v74, v76, 2, v74
v_lshrrev_b32_e32 v79, 10, v79
v_and_b32_e32 v77, 1, v74
v_lshlrev_b32_e64 v78, 4, v78
buffer_load_dwordx4 v92, s[24:27], s77 offen lds
s_add_u32 m0, s87, 0x1f80
s_mov_b32 s77, 0x12000
v_mul_u32_u24 v80, 0xc0, v80
v_mul_u32_u24 v79, 0x420, v79
v_bfe_u32 v76, v74, 1, 3
v_lshlrev_b32_e32 v77, 2, v77
v_add_u32_e32 v236, v80, v78
v_add3_u32 v79, v79, v78, v71
v_xor_b32_e64 v76, v76, v77
v_add_u32 v141, 0x300, v79
v_add_u32 v78, 0x80, v64
v_xor_b32_e64 v76, v76, v69
buffer_load_dwordx4 v94, s[20:23], s54 offen offset:128 nt lds
s_add_u32 m0, s87, 0x2f80
v_lshlrev_b32_e64 v74, 7, v74
v_mul_u32_u24 v79, 0xab, v78
v_lshl_add_u32 v244, v76, 4, v74
v_lshrrev_b32_e32 v80, 11, v79
v_and_b32_e32 v76, 1, v73
v_lshrrev_b32_e32 v79, 10, v79
v_lshlrev_b32_e32 v76, 1, v76
v_lshrrev_b32_e32 v77, 1, v73
v_lshlrev_b32_e32 v78, 4, v78
v_mul_u32_u24 v80, 0xc0, v80
v_mul_u32_u24 v79, 0x420, v79
buffer_load_dwordx4 v94, s[20:23], s92 offen offset:128 nt lds
s_add_u32 m0, s86, 0x2400
v_or_b32_e32 v76, v76, v77
v_add_u32_e32 v237, v80, v78
v_add3_u32 v79, v79, v78, v71
v_lshl_add_u32 v74, v67, 2, v72
v_lshrrev_b32_e64 v77, 1, v65
v_mul_u32_u24 v74, 0xc0, v74
v_lshl_add_u32 v76, v76, 3, v75
v_mul_u32_u24 v78, 0x9000, v77
v_add3_u32 v74, v74, v76, v78
v_add_u32 v249, 0x12c00, v74
v_mul_u32_u24 v74, 0x190, v66
buffer_load_dwordx4 v90, s[24:27], s78 offen lds
s_add_u32 m0, s86, 0x2800
s_waitcnt vmcnt(12)
ds_read_b64_tr_b16 a[0:1], v93
ds_read_b64_tr_b16 a[2:3], v93 offset:768
ds_read_b64_tr_b16 a[4:5], v93 offset:64
ds_read_b64_tr_b16 a[6:7], v93 offset:832
ds_read_b64_tr_b16 a[8:9], v93 offset:128
ds_read_b64_tr_b16 a[10:11], v93 offset:896
v_and_b32_e32 v75, 1, v65
v_lshl_add_u32 v74, v67, 4, v74
v_mul_u32_u24 v75, 0x3200, v75
v_add_u32_e32 v247, v74, v71
v_add_u32_e32 v246, v74, v75
buffer_load_dwordx4 v91, s[24:27], s78 offen lds
s_add_u32 m0, s86, 0x2c00
s_waitcnt vmcnt(12)
s_barrier
ds_read_b128 a[216:219], v240
ds_read_b128 a[220:223], v240 offset:4096
ds_read_b128 a[224:227], v241
ds_read_b128 a[228:231], v241 offset:4096
ds_read_b128 a[232:235], v242
ds_read_b128 a[236:239], v242 offset:4096
buffer_load_dwordx4 v92, s[24:27], s78 offen lds
s_add_u32 m0, s87, 0x8380
s_mov_b32 s78, 0x16800
ds_read_b128 a[240:243], v243
v_lshrrev_b32_e64 v74, 2, v64
v_mul_u32_u24 v76, 0x190, v74
v_mul_u32_u24 v77, 0xc0, v77
v_and_b32_e64 v74, 7, v74
v_lshl_add_u32 v78, v73, 4, v77
v_mul_u32_u24 v74, 0x180, v74
v_add3_u32 v231, v76, v75, v78
v_add_u32_e32 v74, v74, v78
s_mul_i32 s72, s2, 3
v_add_u32_e32 v76, s50, v74
s_add_u32 s72, s72, 2
v_subrev_u32 v78, 0x15000, v76
s_mul_i32 s73, s72, 0x925
v_mul_u32_u24 v75, 0x15000, v67
v_min_u32_e32 v76, v76, v78
s_lshr_b32 s73, s73, 16
v_add_u32_e32 v250, v76, v75
s_mul_i32 s74, s73, 28
v_add_u32_e64 v76, s51, v74
s_sub_u32 s64, s72, s74
v_subrev_u32 v78, 0x15000, v76
s_waitcnt lgkmcnt(5)
v_mfma_f32_32x32x16_bf16 v[0:15], a[0:3], a[216:219], 0
s_mul_i32 s72, s64, 0xc00
buffer_load_dwordx4 v139, s[20:23], s55 offen offset:128 nt lds
s_add_u32 m0, s86, 0x3000
ds_read_b128 a[244:247], v243 offset:4096
ds_read_b128 a[248:251], v240 offset:25600
v_min_u32_e64 v76, v76, v78
s_add_u32 s52, s72, 0x600
v_mfma_f32_32x32x16_bf16 v[16:31], a[4:7], a[216:219], 0
s_and_b32 s82, s2, 15
s_waitcnt vmcnt(11)
ds_read_b64_tr_b16 a[12:13], v93 offset:3072
ds_read_b64_tr_b16 a[14:15], v93 offset:3840
ds_read_b64_tr_b16 a[16:17], v93 offset:3136
ds_read_b64_tr_b16 a[18:19], v93 offset:3904
ds_read_b64_tr_b16 a[20:21], v93 offset:3200
v_add_u32_e64 v251, v76, v75
v_mfma_f32_32x32x16_bf16 v[192:207], a[8:11], a[216:219], 0
s_add_u32 s81, s82, 0x300
buffer_load_dwordx4 v90, s[24:27], s77 offen lds
s_add_u32 m0, s86, 0x3400
ds_read_b64_tr_b16 a[22:23], v93 offset:3968
v_add_u32_e64 v76, s52, v74
v_subrev_u32 v78, 0x15000, v76
v_add_u32 v142, 0x300, v79
v_mfma_f32_32x32x16_bf16 v[32:47], a[0:3], a[220:223], 0
s_mul_i32 s82, s82, 3
v_min_u32_e32 v76, v76, v78
v_add_u32_e32 v252, v76, v75
v_and_b32_e32 v79, 7, v64
v_lshrrev_b32_e32 v80, 3, v66
v_sub_u32_e32 v74, 3, v80
v_sub_u32_e32 v75, 7, v79
v_mfma_f32_32x32x16_bf16 v[48:63], a[4:7], a[220:223], 0
s_add_u32 s83, s82, 2
buffer_load_dwordx4 v91, s[24:27], s77 offen lds
s_add_u32 m0, s86, 0x3800
v_mul_u32_u24 v81, 0xc00, v65
v_mul_u32_u24 v74, 0xc0, v74
v_lshl_add_u32 v75, v67, 2, v75
v_add_u32 v81, 0x24c00, v81
v_mfma_f32_32x32x16_bf16 v[208:223], a[8:11], a[220:223], 0
s_cmp_ge_u32 s2, 0x50
s_cselect_b32 s81, s83, s81
ds_read_b128 a[220:223], v241 offset:25600
v_lshl_add_u32 v74, v75, 4, v74
v_add_u32_e32 v248, v74, v81
v_lshrrev_b32_e32 v74, 2, v79
v_xor_b32_e32 v74, v74, v67
v_cvt_f32_u32_e64 v74, v74
v_mul_f32 v253, 0xc31044fe, v74
v_lshrrev_b32_e64 v74, 1, v83
v_sub_u32 v74, 0x24ffc, v74
s_waitcnt lgkmcnt(1)
v_mfma_f32_32x32x16_bf16 v[0:15], a[12:15], a[224:227], v[0:15]
s_mul_i32 s82, s81, 0x925
buffer_load_dwordx4 v92, s[24:27], s77 offen lds
s_add_u32 m0, s86, 0x3c00
s_mov_b32 s77, 0x1b000
s_lshr_b32 s82, s82, 16
s_mul_i32 s83, s82, 28
s_sub_u32 s65, s81, s83
v_mfma_f32_32x32x16_bf16 v[16:31], a[16:19], a[224:227], v[16:31]
s_mul_i32 s81, s65, 0xc00
s_add_u32 s53, s81, 0x600
s_lshl_b32 s69, s82, 3
s_add_u32 s81, s69, s48
s_mul_i32 s81, s81, 0x15000
s_add_u32 s57, s81, 0x54000
s_add_u32 s81, s81, 0xa8000
v_mfma_f32_32x32x16_bf16 v[192:207], a[20:23], a[224:227], v[192:207]
s_cmp_eq_u32 s82, 27
s_cselect_b32 s83, 0x1260000, 0
buffer_load_dwordx4 v90, s[24:27], s78 offen lds
s_add_u32 m0, s86, 0x4000
s_sub_u32 s95, s81, s83
v_add_u32_e32 v138, s53, v232
s_and_b32 s81, s2, 16
v_mfma_f32_32x32x16_bf16 v[32:47], a[12:15], a[228:231], v[32:47]
s_cmp_eq_u32 s81, 0
s_cselect_b32 s57, s95, s57
s_waitcnt vmcnt(10)
ds_read_b64_tr_b16 a[24:25], v93 offset:6144
ds_read_b64_tr_b16 a[26:27], v93 offset:6912
ds_read_b64_tr_b16 a[28:29], v93 offset:6208
ds_read_b64_tr_b16 a[30:31], v93 offset:6976
ds_read_b64_tr_b16 a[32:33], v93 offset:6272
v_mfma_f32_32x32x16_bf16 v[48:63], a[16:19], a[228:231], v[48:63]
s_lshr_b32 s79, s48, 1
ds_read_b64_tr_b16 a[34:35], v93 offset:7040
buffer_load_dwordx4 v91, s[24:27], s78 offen lds
s_add_u32 m0, s86, 0x4400
v_subrev_u32 v238, 0x15000, v138
v_min_u32_e64 v138, v138, v238
s_mul_i32 s79, s79, 0xc0
v_mfma_f32_32x32x16_bf16 v[208:223], a[20:23], a[228:231], v[208:223]
s_and_b32 s76, s2, 15
v_add_u32_e32 v75, 0, v64
v_mul_u32_u24 v76, 0xab, v75
v_lshrrev_b32_e32 v76, 11, v76
v_mul_u32_u24_e32 v76, 3, v76
v_add_u32_e64 v75, v75, v76
v_lshl_add_u32 v75, v75, 2, v81
buffer_load_dwordx4 v92, s[24:27], s78 offen lds
s_add_u32 m0, s87, 0x3f00
s_mov_b32 s78, 0x1f800
v_add_u32_e64 v230, v246, v77
v_mov_b32_e32 v239, v82
s_lshl_b32 s76, s76, 2
s_add_u32 s76, s76, s48
s_mul_i32 s71, s76, 0xa000
s_and_b32 s76, s2, 15
s_lshl_b32 s44, s76, 4
s_sub_u32 s76, s2, 16
s_lshr_b32 s76, s76, 4
s_add_u32 s44, s44, s76
s_lshl_b32 s76, s48, 8
s_add_u32 s44, s44, s76
s_and_b32 s76, s2, 16
s_waitcnt lgkmcnt(0)
v_mfma_f32_32x32x16_bf16 v[0:15], a[24:27], a[232:235], v[0:15]
s_cmp_ge_u32 s2, 0x50
s_cselect_b32 s80, 0x5000, 0
buffer_load_dwordx4 v94, s[20:23], s54 offen offset:256 nt lds
s_add_u32 m0, s87, 0x4f00
s_add_u32 s71, s71, s80
s_cmp_eq_u32 s76, 0
s_cselect_b32 s80, 0x1800, 0
v_mfma_f32_32x32x16_bf16 v[16:31], a[28:31], a[232:235], v[16:31]
s_mov_b32 s42, 0x280000
s_mov_b32 s43, 0x20000
s_add_u32 s71, s71, s80
s_add_u32 s80, s71, 0x1000
v_xor_b32_e32 v245, 64, v244
s_lshl_b32 s68, s73, 3
s_add_u32 s72, s68, s48
v_mfma_f32_32x32x16_bf16 v[192:207], a[32:35], a[232:235], v[192:207]
s_mul_i32 s72, s72, 0x15000
ds_read_b128 a[232:235], v242 offset:25600
buffer_load_dwordx4 v94, s[20:23], s92 offen offset:256 nt lds
s_add_u32 m0, s86, 0
v_add_u32_e32 v233, s52, v232
v_subrev_u32 v238, 0x15000, v233
s_add_u32 s56, s72, 0x54000
v_mfma_f32_32x32x16_bf16 v[32:47], a[24:27], a[236:239], v[32:47]
s_cmp_eq_u32 s73, 27
s_cselect_b32 s74, 0x1260000, 0
v_min_u32_e64 v233, v233, v238
s_add_u32 s72, s72, 0xa8000
s_sub_u32 s94, s72, s74
s_add_u32 s74, s66, 8
s_add_u32 s73, s66, 4
v_mfma_f32_32x32x16_bf16 v[48:63], a[28:31], a[236:239], v[48:63]
s_cmp_eq_u32 s62, 27
s_cselect_b32 s62, 1.0, 0
buffer_load_dwordx4 v90, s[24:27], s77 offen lds
s_add_u32 m0, s86, 0x400
s_cmp_eq_u32 s66, 0xd8
s_cselect_b32 s66, 0xc31044fe, 0
v_mul_f32_e32 v254, s62, v253
v_mfma_f32_32x32x16_bf16 v[208:223], a[32:35], a[236:239], v[208:223]
s_mov_b32 s70, 0x3e553b95
s_waitcnt vmcnt(10)
ds_read_b64_tr_b16 a[36:37], v93 offset:9216
ds_read_b64_tr_b16 a[38:39], v93 offset:9984
ds_read_b64_tr_b16 a[40:41], v93 offset:9280
ds_read_b64_tr_b16 a[42:43], v93 offset:10048
ds_read_b64_tr_b16 a[44:45], v93 offset:9344
ds_read_b64_tr_b16 a[46:47], v93 offset:10112
buffer_load_dwordx4 v91, s[24:27], s77 offen lds
s_add_u32 m0, s86, 0x800
v_lshlrev_b32_e64 v86, 16, v84
v_and_b32 v87, 0xffff0000, v84
v_lshlrev_b32_e64 v88, 16, v85
v_and_b32 v89, 0xffff0000, v85
v_mul_f32 v86, 0x40ddb3d7, v86
v_mul_f32 v87, 0x40ddb3d7, v87
v_mul_f32 v88, 0x40ddb3d7, v88
v_mul_f32 v89, 0x40ddb3d7, v89
ds_write_b32 v74, v86
buffer_load_dwordx4 v92, s[24:27], s77 offen lds
s_add_u32 m0, s87, 0xa300
s_mov_b32 s77, 0x24000
ds_write_b32 v74, v87 offset:3072
ds_write_b32 v74, v88 offset:6144
ds_write_b32 v74, v89 offset:9216
v_lshl_add_u32 v74, v64, 4, v81
v_min_f32_e64 v255, s66, v254
s_mov_b32 s19, 0x3f803f80
v_mov_b32_e64 v134, s19
v_mov_b32_e32 v135, s19
s_mov_b32 s90, 0x100
s_waitcnt lgkmcnt(4)
v_mfma_f32_32x32x16_bf16 v[0:15], a[36:39], a[240:243], v[0:15]
s_mov_b32 s91, 0x20000
buffer_load_dwordx4 v139, s[20:23], s55 offen offset:256 nt lds
s_add_u32 m0, s86, 0xc00
v_mov_b32_e32 v234, 1
s_add_u32 s83, s67, 8
s_add_u32 s82, s67, 4
s_and_b32 s72, s48, 1
v_mfma_f32_32x32x16_bf16 v[16:31], a[40:43], a[240:243], v[16:31]
s_cmp_eq_u32 s63, 27
s_cselect_b32 s63, 1.0, 0
s_cmp_eq_u32 s67, 0xd8
s_cselect_b32 s67, 0xc31044fe, 0
s_cmp_ge_u32 s74, 0xe0
s_cselect_b32 s74, 0, s74
s_mov_b32 s38, 0x1260000
v_mfma_f32_32x32x16_bf16 v[192:207], a[44:47], a[240:243], v[192:207]
s_waitcnt vmcnt(10) lgkmcnt(0)
s_barrier
buffer_load_dwordx4 v90, s[24:27], s78 offen lds
s_add_u32 m0, s86, 0x1000
ds_read_b128 a[252:255], v240 offset:8192
ds_read_b128 a[216:219], v240 offset:12288
ds_read_b128 a[224:227], v241 offset:8192
s_mov_b32 s39, 0x20000
v_mfma_f32_32x32x16_bf16 v[32:47], a[36:39], a[244:247], v[32:47]
s_cmp_eq_u32 s72, 1
s_cselect_b32 s72, s74, s73
s_waitcnt vmcnt(10)
ds_read_b64_tr_b16 a[48:49], v93 offset:12288
ds_read_b64_tr_b16 a[50:51], v93 offset:13056
ds_read_b64_tr_b16 a[52:53], v93 offset:12352
s_mul_i32 s58, s72, 0x15000
ds_read_b64_tr_b16 a[54:55], v93 offset:13120
v_mfma_f32_32x32x16_bf16 v[48:63], a[40:43], a[244:247], v[48:63]
s_add_u32 s76, s58, 0x2a000
buffer_load_dwordx4 v91, s[24:27], s78 offen lds
s_add_u32 m0, s86, 0x1400
ds_read_b64_tr_b16 a[56:57], v93 offset:12416
ds_read_b64_tr_b16 a[58:59], v93 offset:13184
ds_read_b128 a[228:231], v241 offset:12288
s_add_u32 s74, s68, 8
v_mfma_f32_32x32x16_bf16 v[208:223], a[44:47], a[244:247], v[208:223]
s_add_u32 s73, s68, 4
ds_read_b128 a[236:239], v242 offset:8192
s_cmp_eq_u32 s64, 27
s_cselect_b32 s64, 1.0, 0
s_cmp_eq_u32 s68, 0xd8
s_cselect_b32 s68, 0xc31044fe, 0
ds_read_b128 a[240:243], v242 offset:12288
v_mfma_f32_32x32x16_bf16 v[144:159], a[0:3], a[248:251], 0
s_cmp_ge_u32 s83, 0xe0
s_cselect_b32 s83, 0, s83
buffer_load_dwordx4 v92, s[24:27], s78 offen lds
s_add_u32 m0, s86, 0x1800
s_mov_b32 s78, 0x28800
ds_read_b128 a[244:247], v243 offset:25600
ds_read2_b32 v[100:101], v75 offset0:31 offset1:32
v_mfma_f32_32x32x16_bf16 v[160:175], a[4:7], a[248:251], 0
s_and_b32 s81, s48, 1
ds_read2_b32 v[102:103], v75 offset0:33 offset1:34
v_add_u32_e64 v75, 64, v64
v_mul_u32_u24 v76, 0xab, v75
v_lshrrev_b32_e32 v76, 11, v76
v_mul_u32_u24_e32 v76, 3, v76
v_add_u32_e64 v75, v75, v76
v_mfma_f32_32x32x16_bf16 v[176:191], a[8:11], a[248:251], 0
s_cmp_eq_u32 s81, 1
s_cselect_b32 s81, s83, s82
buffer_load_dwordx4 v90, s[24:27], s77 offen lds
s_add_u32 m0, s86, 0x1c00
ds_read_b128 a[248:251], v243 offset:8192
v_lshl_add_u32 v75, v75, 2, v81
s_mul_i32 s59, s81, 0x15000
s_waitcnt vmcnt(10) lgkmcnt(7)
v_mfma_f32_32x32x16_bf16 v[0:15], a[48:51], a[252:255], v[0:15]
s_add_u32 s84, s59, 0x2a000
ds_read_b64_tr_b16 a[60:61], v93 offset:15360
ds_read_b64_tr_b16 a[62:63], v93 offset:16128
ds_read_b64_tr_b16 a[64:65], v93 offset:15424
ds_read_b64_tr_b16 a[66:67], v93 offset:16192
ds_read_b64_tr_b16 a[68:69], v93 offset:15488
ds_read_b64_tr_b16 a[70:71], v93 offset:16256
v_mfma_f32_32x32x16_bf16 v[16:31], a[52:55], a[252:255], v[16:31]
s_cmp_ge_u32 s74, 0xe0
s_cselect_b32 s74, 0, s74
buffer_load_dwordx4 v91, s[24:27], s77 offen lds
s_add_u32 m0, s86, 0x2000
ds_read2_b32 v[104:105], v75 offset0:31 offset1:32
ds_read2_b32 v[106:107], v75 offset0:33 offset1:34
v_add_u32 v75, 0x80, v64
v_mfma_f32_32x32x16_bf16 v[192:207], a[56:59], a[252:255], v[192:207]
s_and_b32 s72, s48, 1
ds_read_b128 a[252:255], v243 offset:12288
v_mul_u32_u24 v76, 0xab, v75
v_lshrrev_b32_e32 v76, 11, v76
v_mul_u32_u24_e32 v76, 3, v76
v_add_u32_e32 v75, v75, v76
v_lshl_add_u32 v75, v75, 2, v81
v_mfma_f32_32x32x16_bf16 v[32:47], a[48:51], a[216:219], v[32:47]
s_cmp_eq_u32 s72, 1
s_cselect_b32 s72, s74, s73
buffer_load_dwordx4 v92, s[24:27], s77 offen lds
s_add_u32 m0, s86, 0x2400
s_mov_b32 s77, 0x2d000
ds_read2_b32 v[108:109], v75 offset0:31 offset1:32
ds_read2_b32 v[110:111], v75 offset0:33 offset1:34
v_mfma_f32_32x32x16_bf16 v[48:63], a[52:55], a[216:219], v[48:63]
s_mul_i32 s60, s72, 0x15000
s_waitcnt lgkmcnt(10)
ds_write_b128 v74, v[100:103]
v_mfma_f32_32x32x16_bf16 v[208:223], a[56:59], a[216:219], v[208:223]
s_nop 0
buffer_load_dwordx4 v90, s[24:27], s78 offen lds
s_add_u32 m0, s86, 0x2800
ds_read_b128 a[216:219], v240 offset:33792
v_mfma_f32_32x32x16_bf16 v[144:159], a[12:15], a[220:223], v[144:159]
s_waitcnt lgkmcnt(5)
ds_write_b128 v74, v[104:107] offset:1024
v_mfma_f32_32x32x16_bf16 v[160:175], a[16:19], a[220:223], v[160:175]
s_nop 0
buffer_load_dwordx4 v91, s[24:27], s78 offen lds
s_add_u32 m0, s86, 0x2c00
v_mfma_f32_32x32x16_bf16 v[176:191], a[20:23], a[220:223], v[176:191]
s_waitcnt lgkmcnt(3)
ds_write_b128 v74, v[108:111] offset:2048
v_mfma_f32_32x32x16_bf16 v[0:15], a[60:63], a[224:227], v[0:15]
s_nop 0
buffer_load_dwordx4 v92, s[24:27], s78 offen lds
s_add_u32 m0, s86, 0x3000
s_mov_b32 s78, 0x31800
v_mfma_f32_32x32x16_bf16 v[16:31], a[64:67], a[224:227], v[16:31]
v_mfma_f32_32x32x16_bf16 v[192:207], a[68:71], a[224:227], v[192:207]
s_nop 0
buffer_load_dwordx4 v90, s[24:27], s77 offen lds
s_add_u32 m0, s86, 0x3400
v_mfma_f32_32x32x16_bf16 v[32:47], a[60:63], a[228:231], v[32:47]
s_waitcnt vmcnt(11)
ds_read_b64_tr_b16 a[72:73], v93
ds_read_b64_tr_b16 a[74:75], v93 offset:768
ds_read_b64_tr_b16 a[76:77], v93 offset:64
ds_read_b64_tr_b16 a[78:79], v93 offset:832
ds_read_b64_tr_b16 a[80:81], v93 offset:128
ds_read_b64_tr_b16 a[82:83], v93 offset:896
v_mfma_f32_32x32x16_bf16 v[48:63], a[64:67], a[228:231], v[48:63]
buffer_load_dwordx4 v91, s[24:27], s77 offen lds
s_add_u32 m0, s86, 0x3800
v_mfma_f32_32x32x16_bf16 v[208:223], a[68:71], a[228:231], v[208:223]
ds_read_b128 a[228:231], v241 offset:33792
v_mfma_f32_32x32x16_bf16 v[144:159], a[24:27], a[232:235], v[144:159]
buffer_load_dwordx4 v92, s[24:27], s77 offen lds
s_add_u32 m0, s86, 0x3c00
s_mov_b32 s77, 0
v_mfma_f32_32x32x16_bf16 v[160:175], a[28:31], a[232:235], v[160:175]
v_mfma_f32_32x32x16_bf16 v[176:191], a[32:35], a[232:235], v[176:191]
s_waitcnt lgkmcnt(3)
buffer_load_dwordx4 v90, s[24:27], s78 offen lds
s_add_u32 m0, s86, 0x4000
v_mfma_f32_32x32x16_bf16 v[0:15], a[72:75], a[236:239], v[0:15]
v_mfma_f32_32x32x16_bf16 v[16:31], a[76:79], a[236:239], v[16:31]
s_waitcnt lgkmcnt(0)
buffer_load_dwordx4 v91, s[24:27], s78 offen lds
s_add_u32 m0, s86, 0x4400
v_mfma_f32_32x32x16_bf16 v[192:207], a[80:83], a[236:239], v[192:207]
s_waitcnt vmcnt(11)
ds_read_b64_tr_b16 a[84:85], v93 offset:3072
ds_read_b64_tr_b16 a[86:87], v93 offset:3840
ds_read_b64_tr_b16 a[88:89], v93 offset:3136
ds_read_b64_tr_b16 a[90:91], v93 offset:3904
ds_read_b64_tr_b16 a[92:93], v93 offset:3200
ds_read_b64_tr_b16 a[94:95], v93 offset:3968
v_mfma_f32_32x32x16_bf16 v[32:47], a[72:75], a[240:243], v[32:47]
buffer_load_dwordx4 v92, s[24:27], s78 offen lds
s_add_u32 m0, s87, 0x7400
s_mov_b32 s78, 0x9000
v_mfma_f32_32x32x16_bf16 v[48:63], a[76:79], a[240:243], v[48:63]
v_mfma_f32_32x32x16_bf16 v[208:223], a[80:83], a[240:243], v[208:223]
ds_read_b128 a[240:243], v242 offset:33792
buffer_load_dwordx4 v139, s[20:23], s93 offen nt lds
s_add_u32 m0, s87, 0x9380
v_mfma_f32_32x32x16_bf16 v[144:159], a[36:39], a[244:247], v[144:159]
v_mfma_f32_32x32x16_bf16 v[160:175], a[40:43], a[244:247], v[160:175]
s_nop 0
buffer_load_dwordx4 v139, s[20:23], s93 offen offset:128 nt lds
s_add_u32 m0, s87, 0xb300
v_mfma_f32_32x32x16_bf16 v[176:191], a[44:47], a[244:247], v[176:191]
s_waitcnt vmcnt(11) lgkmcnt(1)
ds_read_b64_tr_b16 a[96:97], v93 offset:6144
ds_read_b64_tr_b16 a[98:99], v93 offset:6912
ds_read_b64_tr_b16 a[100:101], v93 offset:6208
ds_read_b64_tr_b16 a[102:103], v93 offset:6976
ds_read_b64_tr_b16 a[104:105], v93 offset:6272
ds_read_b64_tr_b16 a[106:107], v93 offset:7040
v_mfma_f32_32x32x16_bf16 v[0:15], a[84:87], a[248:251], v[0:15]
s_barrier
ds_read_b128 a[220:223], v240 offset:16384
buffer_load_dwordx4 v139, s[20:23], s93 offen offset:256 nt lds
s_add_u32 m0, s86, 0
ds_read_b128 a[224:227], v240 offset:20480
v_mfma_f32_32x32x16_bf16 v[16:31], a[88:91], a[248:251], v[16:31]
ds_read_b128 a[232:235], v241 offset:16384
ds_read_b128 a[236:239], v241 offset:20480
v_mfma_f32_32x32x16_bf16 v[192:207], a[92:95], a[248:251], v[192:207]
ds_read_b128 a[244:247], v242 offset:16384
buffer_load_dwordx4 v140, s[24:27], s77 offen lds
s_add_u32 m0, s86, 0x400
ds_read_b128 a[248:251], v242 offset:20480
v_mfma_f32_32x32x16_bf16 v[32:47], a[84:87], a[252:255], v[32:47]
v_mfma_f32_32x32x16_bf16 v[48:63], a[88:91], a[252:255], v[48:63]
s_nop 0
buffer_load_dwordx4 v141, s[24:27], s77 offen lds
s_add_u32 m0, s86, 0x800
v_mfma_f32_32x32x16_bf16 v[208:223], a[92:95], a[252:255], v[208:223]
s_waitcnt vmcnt(11)
ds_read_b64_tr_b16 a[108:109], v93 offset:9216
ds_read_b64_tr_b16 a[110:111], v93 offset:9984
ds_read_b64_tr_b16 a[112:113], v93 offset:9280
ds_read_b64_tr_b16 a[114:115], v93 offset:10048
ds_read_b64_tr_b16 a[116:117], v93 offset:9344
ds_read_b64_tr_b16 a[118:119], v93 offset:10112
v_mfma_f32_32x32x16_bf16 v[144:159], a[48:51], a[216:219], v[144:159]
ds_read_b128 a[252:255], v243 offset:33792
buffer_load_dwordx4 v142, s[24:27], s77 offen lds
s_add_u32 m0, s86, 0xc00
s_mov_b32 s77, 0x12000
v_mfma_f32_32x32x16_bf16 v[160:175], a[52:55], a[216:219], v[160:175]
s_nop 0
v_mfma_f32_32x32x16_bf16 v[176:191], a[56:59], a[216:219], v[176:191]
s_waitcnt lgkmcnt(7)
ds_read_b128 a[216:219], v243 offset:16384
buffer_load_dwordx4 v140, s[24:27], s78 offen lds
s_add_u32 m0, s86, 0x1000
v_mfma_f32_32x32x16_bf16 v[0:15], a[96:99], a[220:223], v[0:15]
v_mfma_f32_32x32x16_bf16 v[16:31], a[100:103], a[220:223], v[16:31]
s_nop 0
buffer_load_dwordx4 v141, s[24:27], s78 offen lds
s_add_u32 m0, s86, 0x1400
v_mfma_f32_32x32x16_bf16 v[192:207], a[104:107], a[220:223], v[192:207]
s_waitcnt vmcnt(11)
ds_read_b64_tr_b16 a[120:121], v93 offset:12288
ds_read_b64_tr_b16 a[122:123], v93 offset:13056
ds_read_b64_tr_b16 a[124:125], v93 offset:12352
ds_read_b64_tr_b16 a[126:127], v93 offset:13120
ds_read_b64_tr_b16 a[128:129], v93 offset:12416
ds_read_b64_tr_b16 a[130:131], v93 offset:13184
v_mfma_f32_32x32x16_bf16 v[32:47], a[96:99], a[224:227], v[32:47]
ds_read_b128 a[220:223], v243 offset:20480
buffer_load_dwordx4 v142, s[24:27], s78 offen lds
s_add_u32 m0, s86, 0x1800
s_mov_b32 s78, 0x1b000
v_mfma_f32_32x32x16_bf16 v[48:63], a[100:103], a[224:227], v[48:63]
v_mfma_f32_32x32x16_bf16 v[208:223], a[104:107], a[224:227], v[208:223]
ds_read_b128 a[224:227], v240 offset:41984
buffer_load_dwordx4 v140, s[24:27], s77 offen lds
s_add_u32 m0, s86, 0x1c00
v_mfma_f32_32x32x16_bf16 v[144:159], a[60:63], a[228:231], v[144:159]
v_mfma_f32_32x32x16_bf16 v[160:175], a[64:67], a[228:231], v[160:175]
s_nop 0
buffer_load_dwordx4 v141, s[24:27], s77 offen lds
s_add_u32 m0, s86, 0x2000
v_mfma_f32_32x32x16_bf16 v[176:191], a[68:71], a[228:231], v[176:191]
s_waitcnt vmcnt(11) lgkmcnt(1)
ds_read_b64_tr_b16 a[132:133], v93 offset:15360
ds_read_b64_tr_b16 a[134:135], v93 offset:16128
ds_read_b64_tr_b16 a[136:137], v93 offset:15424
ds_read_b64_tr_b16 a[138:139], v93 offset:16192
ds_read_b64_tr_b16 a[140:141], v93 offset:15488
ds_read_b64_tr_b16 a[142:143], v93 offset:16256
v_mfma_f32_32x32x16_bf16 v[0:15], a[108:111], a[232:235], v[0:15]
ds_read_b128 a[228:231], v241 offset:41984
buffer_load_dwordx4 v142, s[24:27], s77 offen lds
s_add_u32 m0, s87, 0xc800
s_mov_b32 s77, 0x24000
v_mfma_f32_32x32x16_bf16 v[16:31], a[112:115], a[232:235], v[16:31]
v_mfma_f32_32x32x16_bf16 v[192:207], a[116:119], a[232:235], v[192:207]
ds_read_b128 a[232:235], v242 offset:41984
buffer_load_dwordx4 v138, s[20:23], s57 offen nt lds
s_add_u32 m0, s87, 0xd780
v_mfma_f32_32x32x16_bf16 v[32:47], a[108:111], a[236:239], v[32:47]
v_mfma_f32_32x32x16_bf16 v[48:63], a[112:115], a[236:239], v[48:63]
buffer_load_dwordx4 v138, s[20:23], s57 offen offset:128 nt lds
s_add_u32 m0, s87, 0xe700
v_mfma_f32_32x32x16_bf16 v[208:223], a[116:119], a[236:239], v[208:223]
ds_read_b128 a[236:239], v243 offset:41984
v_mfma_f32_32x32x16_bf16 v[144:159], a[72:75], a[240:243], v[144:159]
buffer_load_dwordx4 v138, s[20:23], s57 offen offset:256 nt lds
s_add_u32 m0, s86, 0x2400
v_mfma_f32_32x32x16_bf16 v[160:175], a[76:79], a[240:243], v[160:175]
v_mfma_f32_32x32x16_bf16 v[176:191], a[80:83], a[240:243], v[176:191]
buffer_load_dwordx4 v140, s[24:27], s78 offen lds
s_add_u32 m0, s86, 0x2800
v_mfma_f32_32x32x16_bf16 v[0:15], a[120:123], a[244:247], v[0:15]
v_mfma_f32_32x32x16_bf16 v[16:31], a[124:127], a[244:247], v[16:31]
buffer_load_dwordx4 v141, s[24:27], s78 offen lds
s_add_u32 m0, s86, 0x2c00
v_mfma_f32_32x32x16_bf16 v[192:207], a[128:131], a[244:247], v[192:207]
v_mfma_f32_32x32x16_bf16 v[32:47], a[120:123], a[248:251], v[32:47]
s_nop 0
buffer_load_dwordx4 v142, s[24:27], s78 offen lds
s_add_u32 m0, s86, 0x3000
s_mov_b32 s78, 0x2d000
s_waitcnt vmcnt(12) lgkmcnt(0)
ds_read_b64_tr_b16 a[144:145], v143
ds_read_b64_tr_b16 a[146:147], v143 offset:384
v_mfma_f32_32x32x16_bf16 v[48:63], a[124:127], a[248:251], v[48:63]
ds_read_b64_tr_b16 a[148:149], v143 offset:32
ds_read_b64_tr_b16 a[150:151], v143 offset:416
ds_read_b64_tr_b16 a[152:153], v143 offset:64
ds_read_b64_tr_b16 a[154:155], v143 offset:448
v_mfma_f32_32x32x16_bf16 v[208:223], a[128:131], a[248:251], v[208:223]
buffer_load_dwordx4 v140, s[24:27], s77 offen lds
s_add_u32 m0, s86, 0x3400
v_mfma_f32_32x32x16_bf16 v[144:159], a[84:87], a[252:255], v[144:159]
v_mfma_f32_32x32x16_bf16 v[160:175], a[88:91], a[252:255], v[160:175]
buffer_load_dwordx4 v141, s[24:27], s77 offen lds
s_add_u32 m0, s86, 0x3800
v_mfma_f32_32x32x16_bf16 v[176:191], a[92:95], a[252:255], v[176:191]
v_mfma_f32_32x32x16_bf16 v[0:15], a[132:135], a[216:219], v[0:15]
s_nop 0
buffer_load_dwordx4 v142, s[24:27], s77 offen lds
s_add_u32 m0, s86, 0x3c00
s_waitcnt vmcnt(12)
ds_read_b64_tr_b16 a[156:157], v143 offset:3072
ds_read_b64_tr_b16 a[158:159], v143 offset:3456
ds_read_b64_tr_b16 a[160:161], v143 offset:3104
v_mfma_f32_32x32x16_bf16 v[16:31], a[136:139], a[216:219], v[16:31]
ds_read_b64_tr_b16 a[162:163], v143 offset:3488
ds_read_b64_tr_b16 a[164:165], v143 offset:3136
ds_read_b64_tr_b16 a[166:167], v143 offset:3520
s_nop 1
v_mfma_f32_32x32x16_bf16 v[192:207], a[140:143], a[216:219], v[192:207]
s_nop 0
v_cvt_pk_bf16_f32 v64, v0, v1
v_cvt_pk_bf16_f32 v65, v2, v3
v_cvt_pk_bf16_f32 v66, v4, v5
v_cvt_pk_bf16_f32 v67, v6, v7
v_cvt_pk_bf16_f32 v68, v8, v9
v_cvt_pk_bf16_f32 v69, v10, v11
v_mfma_f32_32x32x16_bf16 v[32:47], a[132:135], a[220:223], v[32:47]
buffer_load_dwordx4 v140, s[24:27], s78 offen lds
s_add_u32 m0, s86, 0x4000
ds_read_b128 v[0:3], v248 offset:768
ds_read_b128 v[4:7], v248 offset:960
ds_read_b128 v[8:11], v248 offset:1152
v_cvt_pk_bf16_f32 v70, v12, v13
v_mfma_f32_32x32x16_bf16 v[48:63], a[136:139], a[220:223], v[48:63]
v_cvt_pk_bf16_f32 v71, v14, v15
v_cvt_pk_bf16_f32 v72, v16, v17
v_cvt_pk_bf16_f32 v73, v18, v19
v_cvt_pk_bf16_f32 v74, v20, v21
v_cvt_pk_bf16_f32 v75, v22, v23
v_cvt_pk_bf16_f32 v76, v24, v25
v_mfma_f32_32x32x16_bf16 v[208:223], a[140:143], a[220:223], v[208:223]
buffer_load_dwordx4 v141, s[24:27], s78 offen lds
s_add_u32 m0, s86, 0x4400
ds_read_b128 v[12:15], v248 offset:1344
ds_read_b128 v[16:19], v248 offset:1536
ds_read_b128 v[20:23], v248 offset:1728
v_cvt_pk_bf16_f32 v77, v26, v27
v_mfma_f32_32x32x16_bf16 v[144:159], a[96:99], a[224:227], v[144:159]
ds_read_b128 v[24:27], v248 offset:1920
v_cvt_pk_bf16_f32 v78, v28, v29
v_cvt_pk_bf16_f32 v79, v30, v31
v_cvt_pk_bf16_f32 v88, v32, v33
v_cvt_pk_bf16_f32 v89, v34, v35
v_cvt_pk_bf16_f32 v90, v36, v37
v_mfma_f32_32x32x16_bf16 v[160:175], a[100:103], a[224:227], v[160:175]
s_nop 0
buffer_load_dwordx4 v142, s[24:27], s78 offen lds
s_and_b32 s78, s48, 1
s_mul_i32 s78, s78, 0x9000
s_add_u32 s79, s79, s78
s_add_u32 m0, s86, 0
s_add_u32 s78, s79, 0
v_mfma_f32_32x32x16_bf16 v[176:191], a[104:107], a[224:227], v[176:191]
s_waitcnt vmcnt(12) lgkmcnt(5)
ds_read_b64_tr_b16 a[168:169], v143 offset:6144
ds_read_b64_tr_b16 a[170:171], v143 offset:6528
ds_read_b64_tr_b16 a[172:173], v143 offset:6176
ds_read_b64_tr_b16 a[174:175], v143 offset:6560
ds_read_b64_tr_b16 a[176:177], v143 offset:6208
ds_read_b64_tr_b16 a[178:179], v143 offset:6592
v_mfma_f32_32x32x16_bf16 v[144:159], a[108:111], a[228:231], v[144:159]
buffer_load_dwordx4 v235, s[28:31], s78 offen lds
s_add_u32 m0, s86, 0x400
ds_read_b128 v[28:31], v248 offset:2112
ds_read_b128 v[32:35], v248
v_cvt_pk_bf16_f32 v91, v38, v39
v_cvt_pk_bf16_f32 v92, v40, v41
v_mfma_f32_32x32x16_bf16 v[160:175], a[112:115], a[228:231], v[160:175]
ds_read_b128 v[36:39], v248 offset:192
v_cvt_pk_bf16_f32 v93, v42, v43
v_cvt_pk_bf16_f32 v94, v44, v45
v_cvt_pk_bf16_f32 v95, v46, v47
v_cvt_pk_bf16_f32 v96, v48, v49
v_cvt_pk_bf16_f32 v97, v50, v51
v_mfma_f32_32x32x16_bf16 v[176:191], a[116:119], a[228:231], v[176:191]
buffer_load_dwordx4 v236, s[28:31], s78 offen lds
s_add_u32 m0, s86, 0x800
ds_read_b128 v[40:43], v248 offset:384
ds_read_b128 v[44:47], v248 offset:576
ds_read_b128 v[48:51], v248 offset:768
v_cvt_pk_bf16_f32 v98, v52, v53
v_mfma_f32_32x32x16_bf16 v[144:159], a[120:123], a[232:235], v[144:159]
v_cvt_pk_bf16_f32 v99, v54, v55
v_cvt_pk_bf16_f32 v100, v56, v57
v_cvt_pk_bf16_f32 v101, v58, v59
v_cvt_pk_bf16_f32 v102, v60, v61
v_cvt_pk_bf16_f32 v103, v62, v63
s_waitcnt vmcnt(11)
s_barrier
v_mfma_f32_32x32x16_bf16 v[160:175], a[124:127], a[232:235], v[160:175]
buffer_load_dwordx4 v237, s[28:31], s78 offen lds
s_add_u32 m0, s86, 0xc00
s_add_u32 s78, s79, 0x1800
ds_read_b128 v[52:55], v248 offset:960
ds_read_b128 v[56:59], v248 offset:1152
ds_read_b128 v[60:63], v248 offset:1344
v_mfma_f32_32x32x16_bf16 v[176:191], a[128:131], a[232:235], v[176:191]
ds_read_b128 a[240:243], v240 offset:51200
v_cvt_pk_bf16_f32 v80, v192, v193
v_cvt_pk_bf16_f32 v81, v194, v195
v_cvt_pk_bf16_f32 v82, v196, v197
v_cvt_pk_bf16_f32 v83, v198, v199
v_cvt_pk_bf16_f32 v84, v200, v201
v_mfma_f32_32x32x16_bf16 v[144:159], a[132:135], a[236:239], v[144:159]
buffer_load_dwordx4 v235, s[28:31], s78 offen lds
s_add_u32 m0, s86, 0x1000
ds_read_b128 a[244:247], v241 offset:51200
ds_read_b128 a[248:251], v242 offset:51200
ds_read_b128 a[252:255], v243 offset:51200
v_cvt_pk_bf16_f32 v85, v202, v203
v_mfma_f32_32x32x16_bf16 v[160:175], a[136:139], a[236:239], v[160:175]
s_nop 0
ds_read_b128 a[216:219], v240 offset:55296
v_cvt_pk_bf16_f32 v86, v204, v205
v_cvt_pk_bf16_f32 v87, v206, v207
v_cvt_pk_bf16_f32 v104, v208, v209
v_cvt_pk_bf16_f32 v105, v210, v211
v_cvt_pk_bf16_f32 v106, v212, v213
v_mfma_f32_32x32x16_bf16 v[176:191], a[140:143], a[236:239], v[176:191]
s_waitcnt lgkmcnt(8)
buffer_load_dwordx4 v236, s[28:31], s78 offen lds
s_add_u32 m0, s86, 0x1400
ds_read_b128 a[220:223], v241 offset:55296
ds_read_b128 a[224:227], v242 offset:55296
ds_read_b128 a[228:231], v243 offset:55296
v_cvt_pk_bf16_f32 v107, v214, v215
v_mfma_f32_32x32x16_bf16 v[0:15], v[76:79], v[64:67], v[0:15]
ds_read_b128 a[232:235], v240 offset:59392
v_cvt_pk_bf16_f32 v108, v216, v217
v_cvt_pk_bf16_f32 v109, v218, v219
v_cvt_pk_bf16_f32 v110, v220, v221
v_cvt_pk_bf16_f32 v111, v222, v223
v_mov_b32_e32 v142, s19
v_mfma_f32_32x32x16_bf16 v[0:15], v[80:83], v[68:71], v[0:15]
s_waitcnt vmcnt(11)
buffer_load_dwordx4 v237, s[28:31], s78 offen lds
s_add_u32 m0, s86, 0x1800
s_add_u32 s78, s79, 0x3000
ds_read_b64_tr_b16 a[180:181], v143 offset:9216
ds_read_b64_tr_b16 a[182:183], v143 offset:9600
ds_read_b64_tr_b16 a[184:185], v143 offset:9248
v_mfma_f32_32x32x16_bf16 v[0:15], v[84:87], v[72:75], v[0:15]
ds_read_b64_tr_b16 a[186:187], v143 offset:9632
ds_read_b64_tr_b16 a[188:189], v143 offset:9280
ds_read_b64_tr_b16 a[190:191], v143 offset:9664
ds_read_b128 a[236:239], v241 offset:59392
s_nop 1
v_mfma_f32_32x32x16_bf16 v[16:31], v[100:103], v[64:67], v[16:31]
s_nop 0
buffer_load_dwordx4 v235, s[28:31], s78 offen lds
s_add_u32 m0, s86, 0x1c00
v_cvt_pk_bf16_f32 v64, v144, v145
v_cvt_pk_bf16_f32 v65, v146, v147
v_cvt_pk_bf16_f32 v66, v148, v149
v_cvt_pk_bf16_f32 v67, v150, v151
v_mfma_f32_32x32x16_bf16 v[16:31], v[104:107], v[68:71], v[16:31]
v_cvt_pk_bf16_f32 v68, v152, v153
v_cvt_pk_bf16_f32 v69, v154, v155
v_cvt_pk_bf16_f32 v70, v156, v157
v_cvt_pk_bf16_f32 v71, v158, v159
v_max3_f32 v224, v0, v1, v2
v_max3_f32 v224, v224, v3, v4
v_mfma_f32_32x32x16_bf16 v[16:31], v[108:111], v[72:75], v[16:31]
buffer_load_dwordx4 v236, s[28:31], s78 offen lds
s_add_u32 m0, s86, 0x2000
v_cvt_pk_bf16_f32 v72, v160, v161
v_cvt_pk_bf16_f32 v73, v162, v163
v_cvt_pk_bf16_f32 v74, v164, v165
v_cvt_pk_bf16_f32 v75, v166, v167
v_mfma_f32_32x32x16_bf16 v[32:47], v[76:79], v[88:91], v[32:47]
v_cvt_pk_bf16_f32 v76, v168, v169
v_cvt_pk_bf16_f32 v77, v170, v171
v_cvt_pk_bf16_f32 v78, v172, v173
v_cvt_pk_bf16_f32 v79, v174, v175
v_max3_f32 v224, v224, v5, v6
v_max3_f32 v224, v224, v7, v8
v_mfma_f32_32x32x16_bf16 v[32:47], v[80:83], v[92:95], v[32:47]
s_waitcnt vmcnt(11)
buffer_load_dwordx4 v237, s[28:31], s78 offen lds
s_add_u32 m0, s86, 0x2400
s_add_u32 s78, s79, 0x4800
ds_read_b64_tr_b16 a[192:193], v143 offset:12288
ds_read_b64_tr_b16 a[194:195], v143 offset:12672
ds_read_b64_tr_b16 a[196:197], v143 offset:12320
v_mfma_f32_32x32x16_bf16 v[32:47], v[84:87], v[96:99], v[32:47]
s_waitcnt lgkmcnt(3)
ds_read_b64_tr_b16 a[198:199], v143 offset:12704
ds_read_b64_tr_b16 a[200:201], v143 offset:12352
ds_read_b64_tr_b16 a[202:203], v143 offset:12736
v_cvt_pk_bf16_f32 v80, v176, v177
v_cvt_pk_bf16_f32 v81, v178, v179
v_cvt_pk_bf16_f32 v82, v180, v181
v_mfma_f32_32x32x16_bf16 v[48:63], v[100:103], v[88:91], v[48:63]
buffer_load_dwordx4 v235, s[28:31], s78 offen lds
s_add_u32 m0, s86, 0x2800
v_cvt_pk_bf16_f32 v83, v182, v183
v_cvt_pk_bf16_f32 v84, v184, v185
v_cvt_pk_bf16_f32 v85, v186, v187
v_cvt_pk_bf16_f32 v86, v188, v189
v_mfma_f32_32x32x16_bf16 v[48:63], v[104:107], v[92:95], v[48:63]
v_cvt_pk_bf16_f32 v87, v190, v191
v_max3_f32 v225, v16, v17, v18
v_max3_f32 v225, v225, v19, v20
v_max3_f32 v225, v225, v21, v22
v_max3_f32 v225, v225, v23, v24
v_max3_f32 v224, v224, v9, v10
v_mfma_f32_32x32x16_bf16 v[48:63], v[108:111], v[96:99], v[48:63]
buffer_load_dwordx4 v236, s[28:31], s78 offen lds
s_add_u32 m0, s86, 0x2c00
v_max3_f32 v225, v225, v25, v26
v_max3_f32 v224, v224, v11, v12
v_max3_f32 v225, v225, v27, v28
v_max3_f32 v224, v224, v13, v14
v_mfma_f32_32x32x16_bf16 v[192:207], a[0:3], a[240:243], 0
v_max3_f32 v225, v225, v29, v30
v_max_f32_e32 v224, v224, v15
v_max_f32_e32 v225, v225, v31
v_fma_f32 v224, v224, s70, v254
v_fma_f32 v225, v225, s70, v255
v_max_f32_e32 v224, v224, v225
v_mfma_f32_32x32x16_bf16 v[208:223], a[4:7], a[240:243], 0
s_waitcnt vmcnt(11)
buffer_load_dwordx4 v237, s[28:31], s78 offen lds
ds_read_b64_tr_b16 a[204:205], v143 offset:15360
ds_read_b64_tr_b16 a[206:207], v143 offset:15744
ds_read_b64_tr_b16 a[208:209], v143 offset:15392
ds_read_b64_tr_b16 a[210:211], v143 offset:15776
ds_read_b64_tr_b16 a[212:213], v143 offset:15424
v_mfma_f32_32x32x16_bf16 v[112:127], a[8:11], a[240:243], 0
s_add_u32 m0, s86, 0x3000
ds_read_b128 a[240:243], v242 offset:59392
ds_read_b64_tr_b16 a[214:215], v143 offset:15808
s_add_u32 s78, s79, 0x6000
v_mov_b32_e32 v225, v224
v_mov_b32_e32 v143, s19
v_mfma_f32_32x32x16_bf16 v[192:207], a[12:15], a[244:247], v[192:207]
v_permlane32_swap_b32_e32 v224, v225
v_max_f32_e32 v224, v224, v225
v_sub_f32_e64 v226, v254, v224
v_fma_f32 v0, v0, s70, v226
v_fma_f32 v1, v1, s70, v226
v_mfma_f32_32x32x16_bf16 v[208:223], a[16:19], a[244:247], v[208:223]
v_exp_f32_e32 v0, v0
v_exp_f32_e32 v1, v1
v_fma_f32 v2, v2, s70, v226
v_fma_f32 v3, v3, s70, v226
v_mfma_f32_32x32x16_bf16 v[112:127], a[20:23], a[244:247], v[112:127]
ds_read_b128 a[244:247], v243 offset:59392
v_exp_f32_e32 v2, v2
v_exp_f32_e32 v3, v3
v_fma_f32 v4, v4, s70, v226
v_mfma_f32_32x32x16_bf16 v[192:207], a[24:27], a[248:251], v[192:207]
v_fma_f32 v5, v5, s70, v226
v_fma_f32 v6, v6, s70, v226
v_fma_f32 v7, v7, s70, v226
v_exp_f32_e64 v4, v4
v_cvt_pk_bf16_f32 v0, v0, v1
v_mfma_f32_32x32x16_bf16 v[208:223], a[28:31], a[248:251], v[208:223]
v_exp_f32_e32 v5, v5
v_exp_f32_e32 v6, v6
v_exp_f32_e64 v7, v7
v_mfma_f32_32x32x16_bf16 v[112:127], a[32:35], a[248:251], v[112:127]
ds_read_b128 a[248:251], v244
v_cvt_pk_bf16_f32 v1, v2, v3
v_cvt_pk_bf16_f32 v2, v4, v5
v_cvt_pk_bf16_f32 v3, v6, v7
v_fma_f32 v8, v8, s70, v226
v_fma_f32 v9, v9, s70, v226
v_mfma_f32_32x32x16_bf16 v[192:207], a[36:39], a[252:255], v[192:207]
v_fma_f32 v10, v10, s70, v226
v_fma_f32 v11, v11, s70, v226
v_fma_f32 v12, v12, s70, v226
v_fma_f32 v13, v13, s70, v226
v_fma_f32 v14, v14, s70, v226
v_fma_f32 v15, v15, s70, v226
v_mfma_f32_32x32x16_bf16 v[208:223], a[40:43], a[252:255], v[208:223]
v_exp_f32_e32 v8, v8
v_exp_f32_e32 v9, v9
v_exp_f32_e64 v10, v10
v_mfma_f32_32x32x16_bf16 v[112:127], a[44:47], a[252:255], v[112:127]
ds_read_b128 a[252:255], v245
v_exp_f32_e32 v11, v11
v_exp_f32_e32 v12, v12
v_cvt_pk_bf16_f32 v4, v8, v9
v_mfma_f32_32x32x16_bf16 v[192:207], a[48:51], a[216:219], v[192:207]
v_exp_f32_e32 v13, v13
v_exp_f32_e32 v14, v14
v_exp_f32_e64 v15, v15
v_mfma_f32_32x32x16_bf16 v[208:223], a[52:55], a[216:219], v[208:223]
v_cvt_pk_bf16_f32 v5, v10, v11
v_cvt_pk_bf16_f32 v6, v12, v13
v_cvt_pk_bf16_f32 v7, v14, v15
v_sub_f32_e64 v227, v255, v224
v_fma_f32 v16, v16, s70, v227
v_fma_f32 v17, v17, s70, v227
v_mfma_f32_32x32x16_bf16 v[112:127], a[56:59], a[216:219], v[112:127]
ds_read_b128 a[216:219], v244 offset:8192
v_fma_f32 v18, v18, s70, v227
v_fma_f32 v19, v19, s70, v227
v_fma_f32 v20, v20, s70, v227
v_fma_f32 v21, v21, s70, v227
v_fma_f32 v22, v22, s70, v227
v_mfma_f32_32x32x16_bf16 v[192:207], a[60:63], a[220:223], v[192:207]
v_fma_f32 v23, v23, s70, v227
v_exp_f32_e32 v16, v16
v_exp_f32_e32 v17, v17
v_fma_f32 v24, v24, s70, v227
v_mfma_f32_32x32x16_bf16 v[208:223], a[64:67], a[220:223], v[208:223]
v_exp_f32_e32 v18, v18
v_exp_f32_e32 v19, v19
v_exp_f32_e64 v20, v20
v_mfma_f32_32x32x16_bf16 v[112:127], a[68:71], a[220:223], v[112:127]
ds_read_b128 a[220:223], v245 offset:8192
v_exp_f32_e32 v21, v21
v_exp_f32_e32 v22, v22
v_cvt_pk_bf16_f32 v8, v16, v17
v_mfma_f32_32x32x16_bf16 v[192:207], a[72:75], a[224:227], v[192:207]
v_exp_f32_e64 v23, v23
v_cvt_pk_bf16_f32 v9, v18, v19
v_cvt_pk_bf16_f32 v10, v20, v21
v_cvt_pk_bf16_f32 v11, v22, v23
v_fma_f32 v25, v25, s70, v227
v_mfma_f32_32x32x16_bf16 v[208:223], a[76:79], a[224:227], v[208:223]
v_fma_f32 v26, v26, s70, v227
v_fma_f32 v27, v27, s70, v227
v_fma_f32 v28, v28, s70, v227
v_fma_f32 v29, v29, s70, v227
v_fma_f32 v30, v30, s70, v227
v_fma_f32 v31, v31, s70, v227
v_mfma_f32_32x32x16_bf16 v[112:127], a[80:83], a[224:227], v[112:127]
ds_read_b128 a[224:227], v244 offset:16384
v_exp_f32_e32 v24, v24
v_exp_f32_e32 v25, v25
v_max3_f32 v224, v32, v33, v34
v_mfma_f32_32x32x16_bf16 v[192:207], a[84:87], a[228:231], v[192:207]
v_exp_f32_e32 v26, v26
v_exp_f32_e32 v27, v27
v_exp_f32_e64 v28, v28
v_mfma_f32_32x32x16_bf16 v[208:223], a[88:91], a[228:231], v[208:223]
v_exp_f32_e32 v29, v29
v_exp_f32_e32 v30, v30
v_exp_f32_e64 v31, v31
v_mfma_f32_32x32x16_bf16 v[112:127], a[92:95], a[228:231], v[112:127]
ds_read_b128 a[228:231], v245 offset:16384
v_cvt_pk_bf16_f32 v12, v24, v25
v_cvt_pk_bf16_f32 v13, v26, v27
v_cvt_pk_bf16_f32 v14, v28, v29
v_cvt_pk_bf16_f32 v15, v30, v31
v_max3_f32 v225, v48, v49, v50
v_mfma_f32_32x32x16_bf16 v[192:207], a[96:99], a[232:235], v[192:207]
v_max3_f32 v224, v224, v35, v36
v_max3_f32 v225, v225, v51, v52
v_max3_f32 v224, v224, v37, v38
v_max3_f32 v225, v225, v53, v54
v_max3_f32 v224, v224, v39, v40
v_max3_f32 v225, v225, v55, v56
v_mfma_f32_32x32x16_bf16 v[208:223], a[100:103], a[232:235], v[208:223]
v_max3_f32 v224, v224, v41, v42
v_max3_f32 v225, v225, v57, v58
v_max3_f32 v224, v224, v43, v44
v_max3_f32 v225, v225, v59, v60
v_max3_f32 v224, v224, v45, v46
v_max3_f32 v225, v225, v61, v62
v_mfma_f32_32x32x16_bf16 v[112:127], a[104:107], a[232:235], v[112:127]
ds_read_b128 a[232:235], v244 offset:2048
v_max_f32_e32 v224, v224, v47
v_max_f32_e32 v225, v225, v63
v_fma_f32 v224, v224, s70, v255
v_fma_f32 v225, v225, s70, v254
v_max_f32_e64 v224, v224, v225
v_mfma_f32_32x32x16_bf16 v[192:207], a[108:111], a[236:239], v[192:207]
v_mov_b32_e32 v225, v224
s_nop 1
v_permlane32_swap_b32_e32 v224, v225
v_max_f32_e32 v224, v224, v225
v_mfma_f32_32x32x16_bf16 v[208:223], a[112:115], a[236:239], v[208:223]
v_sub_f32_e64 v228, v255, v224
v_fma_f32 v32, v32, s70, v228
v_fma_f32 v33, v33, s70, v228
v_exp_f32_e64 v32, v32
v_fma_f32 v34, v34, s70, v228
v_mfma_f32_32x32x16_bf16 v[112:127], a[116:119], a[236:239], v[112:127]
s_waitcnt lgkmcnt(1)
ds_read_b128 a[236:239], v245 offset:2048
v_exp_f32_e32 v33, v33
v_fma_f32 v35, v35, s70, v228
v_exp_f32_e64 v34, v34
v_mfma_f32_32x32x16_bf16 v[192:207], a[120:123], a[240:243], v[192:207]
v_exp_f32_e64 v35, v35
v_fma_f32 v36, v36, s70, v228
v_fma_f32 v37, v37, s70, v228
v_fma_f32 v38, v38, s70, v228
v_fma_f32 v39, v39, s70, v228
v_mfma_f32_32x32x16_bf16 v[208:223], a[124:127], a[240:243], v[208:223]
v_exp_f32_e32 v36, v36
v_exp_f32_e32 v37, v37
v_exp_f32_e64 v38, v38
v_mfma_f32_32x32x16_bf16 v[112:127], a[128:131], a[240:243], v[112:127]
ds_read_b128 a[240:243], v244 offset:10240
v_exp_f32_e64 v39, v39
v_cvt_pk_bf16_f32 v32, v32, v33
v_cvt_pk_bf16_f32 v33, v34, v35
v_cvt_pk_bf16_f32 v34, v36, v37
v_mfma_f32_32x32x16_bf16 v[192:207], a[132:135], a[244:247], v[192:207]
v_cvt_pk_bf16_f32 v35, v38, v39
v_fma_f32 v40, v40, s70, v228
v_fma_f32 v41, v41, s70, v228
v_fma_f32 v42, v42, s70, v228
v_fma_f32 v43, v43, s70, v228
v_fma_f32 v44, v44, s70, v228
v_mfma_f32_32x32x16_bf16 v[208:223], a[136:139], a[244:247], v[208:223]
v_fma_f32 v45, v45, s70, v228
v_fma_f32 v46, v46, s70, v228
v_fma_f32 v47, v47, s70, v228
v_exp_f32_e32 v40, v40
v_sub_f32_e32 v229, v254, v224
v_mfma_f32_32x32x16_bf16 v[112:127], a[140:143], a[244:247], v[112:127]
v_cvt_pk_bf16_f32 v88, v192, v193
v_cvt_pk_bf16_f32 v89, v194, v195
v_cvt_pk_bf16_f32 v90, v196, v197
v_cvt_pk_bf16_f32 v91, v198, v199
v_cvt_pk_bf16_f32 v92, v200, v201
v_cvt_pk_bf16_f32 v93, v202, v203
v_mfma_f32_16x16x32_bf16 v[144:147], a[248:251], a[144:147], 0
buffer_store_dwordx4 v[88:91], v239, s[40:43], s71 offen sc1
v_mfma_f32_16x16x32_bf16 v[148:151], a[248:251], a[148:151], 0
ds_read_b128 a[244:247], v245 offset:10240
v_cvt_pk_bf16_f32 v94, v204, v205
v_mfma_f32_16x16x32_bf16 v[152:155], a[248:251], a[152:155], 0
v_cvt_pk_bf16_f32 v95, v206, v207
v_cvt_pk_bf16_f32 v96, v208, v209
v_mfma_f32_16x16x32_bf16 v[144:147], a[252:255], a[156:159], v[144:147]
ds_read_b128 a[248:251], v244 offset:18432
v_cvt_pk_bf16_f32 v97, v210, v211
v_mfma_f32_16x16x32_bf16 v[148:151], a[252:255], a[160:163], v[148:151]
v_cvt_pk_bf16_f32 v98, v212, v213
v_cvt_pk_bf16_f32 v99, v214, v215
v_mfma_f32_16x16x32_bf16 v[152:155], a[252:255], a[164:167], v[152:155]
buffer_store_dwordx4 v[92:95], v239, s[40:43], s71 offen offset:1024 sc1
v_mfma_f32_16x16x32_bf16 v[144:147], a[216:219], a[168:171], v[144:147]
ds_read_b128 a[252:255], v245 offset:18432
v_cvt_pk_bf16_f32 v100, v216, v217
v_mfma_f32_16x16x32_bf16 v[148:151], a[216:219], a[172:175], v[148:151]
v_cvt_pk_bf16_f32 v101, v218, v219
v_cvt_pk_bf16_f32 v102, v220, v221
v_mfma_f32_16x16x32_bf16 v[152:155], a[216:219], a[176:179], v[152:155]
ds_read_b128 a[216:219], v240 offset:29696
v_cvt_pk_bf16_f32 v103, v222, v223
v_mfma_f32_16x16x32_bf16 v[144:147], a[220:223], a[180:183], v[144:147]
v_cvt_pk_bf16_f32 v104, v112, v113
v_cvt_pk_bf16_f32 v105, v114, v115
v_mfma_f32_16x16x32_bf16 v[148:151], a[220:223], a[184:187], v[148:151]
buffer_store_dwordx4 v[96:99], v239, s[40:43], s71 offen offset:2048 sc1
v_mfma_f32_16x16x32_bf16 v[152:155], a[220:223], a[188:191], v[152:155]
ds_read_b128 a[220:223], v241 offset:29696
v_cvt_pk_bf16_f32 v106, v116, v117
v_mfma_f32_16x16x32_bf16 v[144:147], a[224:227], a[192:195], v[144:147]
v_cvt_pk_bf16_f32 v107, v118, v119
v_cvt_pk_bf16_f32 v108, v120, v121
v_mfma_f32_16x16x32_bf16 v[148:151], a[224:227], a[196:199], v[148:151]
v_cvt_pk_bf16_f32 v109, v122, v123
v_cvt_pk_bf16_f32 v110, v124, v125
v_mfma_f32_16x16x32_bf16 v[152:155], a[224:227], a[200:203], v[152:155]
ds_read_b128 a[224:227], v244 offset:4096
buffer_store_dwordx4 v[100:103], v239, s[40:43], s71 offen offset:3072 sc1
v_mfma_f32_16x16x32_bf16 v[144:147], a[228:231], a[204:207], v[144:147]
v_cvt_pk_bf16_f32 v111, v126, v127
v_mov_b32_e64 v118, s19
v_mfma_f32_16x16x32_bf16 v[148:151], a[228:231], a[208:211], v[148:151]
v_mov_b32_e32 v119, s19
v_mov_b32_e32 v126, s19
v_mfma_f32_16x16x32_bf16 v[152:155], a[228:231], a[212:215], v[152:155]
s_waitcnt lgkmcnt(2)
ds_read_b128 a[228:231], v245 offset:4096
v_mov_b32_e32 v127, s19
v_mfma_f32_16x16x32_bf16 v[156:159], a[232:235], a[144:147], 0
v_cvt_pk_bf16_f32 v112, v144, v145
v_cvt_pk_bf16_f32 v113, v146, v147
v_mfma_f32_16x16x32_bf16 v[160:163], a[232:235], a[148:151], 0
buffer_store_dwordx4 v[104:107], v239, s[40:43], s80 offen sc1
v_mfma_f32_16x16x32_bf16 v[164:167], a[232:235], a[152:155], 0
s_add_u32 s80, s71, 0x1000
ds_read_b128 a[232:235], v244 offset:12288
v_cvt_pk_bf16_f32 v114, v148, v149
v_mfma_f32_16x16x32_bf16 v[156:159], a[236:239], a[156:159], v[156:159]
v_cvt_pk_bf16_f32 v115, v150, v151
v_cvt_pk_bf16_f32 v116, v152, v153
v_mfma_f32_16x16x32_bf16 v[160:163], a[236:239], a[160:163], v[160:163]
v_cvt_pk_bf16_f32 v117, v154, v155
v_fma_f32 v48, v48, s70, v229
v_mfma_f32_16x16x32_bf16 v[164:167], a[236:239], a[164:167], v[164:167]
ds_read_b128 a[236:239], v245 offset:12288
buffer_store_dwordx4 v[108:111], v239, s[40:43], s80 offen offset:1024 sc1
v_mfma_f32_16x16x32_bf16 v[156:159], a[240:243], a[168:171], v[156:159]
v_permlane16_swap_b32_e64 v116, v118
v_mfma_f32_16x16x32_bf16 v[160:163], a[240:243], a[172:175], v[160:163]
v_permlane16_swap_b32_e64 v117, v119
v_mfma_f32_16x16x32_bf16 v[164:167], a[240:243], a[176:179], v[164:167]
ds_read_b128 a[240:243], v244 offset:20480
v_fma_f32 v49, v49, s70, v229
v_mfma_f32_16x16x32_bf16 v[156:159], a[244:247], a[180:183], v[156:159]
v_permlane16_swap_b32_e64 v112, v114
v_mfma_f32_16x16x32_bf16 v[160:163], a[244:247], a[184:187], v[160:163]
buffer_load_dwordx4 v235, s[28:31], s78 offen lds
s_add_u32 m0, s86, 0x3400
v_mfma_f32_16x16x32_bf16 v[164:167], a[244:247], a[188:191], v[164:167]
ds_read_b128 a[244:247], v245 offset:20480
v_fma_f32 v50, v50, s70, v229
v_mfma_f32_16x16x32_bf16 v[156:159], a[248:251], a[192:195], v[156:159]
v_permlane16_swap_b32_e64 v113, v115
v_mfma_f32_16x16x32_bf16 v[160:163], a[248:251], a[196:199], v[160:163]
v_exp_f32_e64 v41, v41
v_mfma_f32_16x16x32_bf16 v[164:167], a[248:251], a[200:203], v[164:167]
buffer_load_dwordx4 v236, s[28:31], s78 offen lds
s_add_u32 m0, s86, 0x3800
v_mfma_f32_16x16x32_bf16 v[156:159], a[252:255], a[204:207], v[156:159]
ds_read_b128 a[248:251], v244 offset:6144
v_cvt_pk_bf16_f32 v36, v40, v41
v_mfma_f32_16x16x32_bf16 v[160:163], a[252:255], a[208:211], v[160:163]
v_exp_f32_e64 v42, v42
v_mfma_f32_16x16x32_bf16 v[164:167], a[252:255], a[212:215], v[164:167]
ds_read_b128 a[252:255], v245 offset:6144
buffer_load_dwordx4 v237, s[28:31], s78 offen lds
s_add_u32 m0, s86, 0x3c00
s_add_u32 s78, s79, 0x7800
v_cvt_pk_bf16_f32 v120, v156, v157
v_cvt_pk_bf16_f32 v121, v158, v159
v_mfma_f32_32x32x16_bf16 v[144:159], a[0:3], a[216:219], 0
v_cvt_pk_bf16_f32 v122, v160, v161
v_cvt_pk_bf16_f32 v123, v162, v163
v_cvt_pk_bf16_f32 v124, v164, v165
v_cvt_pk_bf16_f32 v125, v166, v167
v_permlane16_swap_b32_e64 v120, v122
v_mfma_f32_32x32x16_bf16 v[160:175], a[4:7], a[216:219], 0
v_permlane16_swap_b32_e32 v124, v126
v_permlane16_swap_b32_e32 v125, v127
v_permlane16_swap_b32_e32 v121, v123
v_mfma_f32_32x32x16_bf16 v[176:191], a[8:11], a[216:219], 0
s_waitcnt lgkmcnt(1)
buffer_load_dwordx4 v235, s[28:31], s78 offen lds
s_add_u32 m0, s86, 0x4000
ds_read_b128 a[216:219], v244 offset:14336
v_exp_f32_e64 v43, v43
v_fma_f32 v51, v51, s70, v229
v_mfma_f32_32x32x16_bf16 v[144:159], a[12:15], a[220:223], v[144:159]
v_exp_f32_e32 v44, v44
v_exp_f32_e32 v45, v45
v_exp_f32_e64 v46, v46
v_mfma_f32_32x32x16_bf16 v[160:175], a[16:19], a[220:223], v[160:175]
buffer_load_dwordx4 v236, s[28:31], s78 offen lds
s_add_u32 m0, s86, 0x4400
v_exp_f32_e64 v47, v47
v_cvt_pk_bf16_f32 v37, v42, v43
v_cvt_pk_bf16_f32 v38, v44, v45
v_mfma_f32_32x32x16_bf16 v[176:191], a[20:23], a[220:223], v[176:191]
ds_read_b128 a[220:223], v245 offset:14336
v_cvt_pk_bf16_f32 v39, v46, v47
v_fma_f32 v52, v52, s70, v229
v_fma_f32 v53, v53, s70, v229
v_fma_f32 v54, v54, s70, v229
v_fma_f32 v55, v55, s70, v229
v_mfma_f32_16x16x32_bf16 v[192:195], a[224:227], a[144:147], 0
buffer_load_dwordx4 v237, s[28:31], s78 offen lds
s_add_u32 m0, s87, 0
v_mfma_f32_16x16x32_bf16 v[196:199], a[224:227], a[148:151], 0
v_exp_f32_e32 v48, v48
v_mfma_f32_16x16x32_bf16 v[200:203], a[224:227], a[152:155], 0
ds_read_b128 a[224:227], v244 offset:22528
v_fma_f32 v56, v56, s70, v229
v_mfma_f32_16x16x32_bf16 v[192:195], a[228:231], a[156:159], v[192:195]
v_exp_f32_e64 v49, v49
v_mfma_f32_16x16x32_bf16 v[196:199], a[228:231], a[160:163], v[196:199]
v_exp_f32_e64 v50, v50
v_mfma_f32_16x16x32_bf16 v[200:203], a[228:231], a[164:167], v[200:203]
ds_read_b128 a[228:231], v245 offset:22528
v_cvt_pk_bf16_f32 v40, v48, v49
v_mfma_f32_16x16x32_bf16 v[192:195], a[232:235], a[168:171], v[192:195]
v_exp_f32_e64 v51, v51
v_mfma_f32_16x16x32_bf16 v[196:199], a[232:235], a[172:175], v[196:199]
v_exp_f32_e64 v52, v52
v_mfma_f32_16x16x32_bf16 v[200:203], a[232:235], a[176:179], v[200:203]
ds_read_b128 a[232:235], v242 offset:29696
v_cvt_pk_bf16_f32 v41, v50, v51
v_mfma_f32_16x16x32_bf16 v[192:195], a[236:239], a[180:183], v[192:195]
v_exp_f32_e64 v53, v53
v_mfma_f32_16x16x32_bf16 v[196:199], a[236:239], a[184:187], v[196:199]
v_exp_f32_e64 v54, v54
v_mfma_f32_16x16x32_bf16 v[200:203], a[236:239], a[188:191], v[200:203]
ds_read_b128 a[236:239], v243 offset:29696
v_cvt_pk_bf16_f32 v42, v52, v53
v_mfma_f32_16x16x32_bf16 v[192:195], a[240:243], a[192:195], v[192:195]
s_waitcnt lgkmcnt(2)
s_barrier
buffer_load_dwordx4 v233, s[20:23], s56 offen nt lds
v_mfma_f32_16x16x32_bf16 v[196:199], a[240:243], a[196:199], v[196:199]
s_add_u32 m0, s87, 0x1000
v_exp_f32_e64 v55, v55
v_mfma_f32_16x16x32_bf16 v[200:203], a[240:243], a[200:203], v[200:203]
ds_read_b128 a[240:243], v240 offset:37888
v_cvt_pk_bf16_f32 v43, v54, v55
v_mfma_f32_16x16x32_bf16 v[192:195], a[244:247], a[204:207], v[192:195]
v_fma_f32 v57, v57, s70, v229
v_fma_f32 v58, v58, s70, v229
v_mfma_f32_16x16x32_bf16 v[196:199], a[244:247], a[208:211], v[196:199]
v_fma_f32 v59, v59, s70, v229
v_fma_f32 v60, v60, s70, v229
v_mfma_f32_16x16x32_bf16 v[200:203], a[244:247], a[212:215], v[200:203]
buffer_load_dwordx4 v233, s[20:23], s94 offen nt lds
s_add_u32 m0, s87, 0x1f80
v_mfma_f32_16x16x32_bf16 v[204:207], a[248:251], a[144:147], 0
ds_read_b128 a[244:247], v241 offset:37888
v_fma_f32 v61, v61, s70, v229
v_mfma_f32_16x16x32_bf16 v[208:211], a[248:251], a[148:151], 0
v_fma_f32 v62, v62, s70, v229
v_fma_f32 v63, v63, s70, v229
v_mfma_f32_16x16x32_bf16 v[212:215], a[248:251], a[152:155], 0
v_cvt_pk_bf16_f32 v132, v200, v201
v_cvt_pk_bf16_f32 v133, v202, v203
v_mfma_f32_16x16x32_bf16 v[204:207], a[252:255], a[156:159], v[204:207]
v_permlane16_swap_b32_e64 v132, v134
v_mfma_f32_16x16x32_bf16 v[208:211], a[252:255], a[160:163], v[208:211]
v_permlane16_swap_b32_e64 v133, v135
v_mfma_f32_16x16x32_bf16 v[212:215], a[252:255], a[164:167], v[212:215]
ds_read_b128 a[248:251], v242 offset:37888
ds_read_b128 a[252:255], v244 offset:25600
v_mfma_f32_16x16x32_bf16 v[204:207], a[216:219], a[168:171], v[204:207]
v_exp_f32_e64 v56, v56
v_mfma_f32_16x16x32_bf16 v[208:211], a[216:219], a[172:175], v[208:211]
v_exp_f32_e64 v57, v57
v_mfma_f32_16x16x32_bf16 v[212:215], a[216:219], a[176:179], v[212:215]
ds_read_b128 a[216:219], v245 offset:25600
v_cvt_pk_bf16_f32 v44, v56, v57
v_mfma_f32_16x16x32_bf16 v[204:207], a[220:223], a[180:183], v[204:207]
v_exp_f32_e64 v58, v58
v_mfma_f32_16x16x32_bf16 v[208:211], a[220:223], a[184:187], v[208:211]
v_exp_f32_e64 v59, v59
v_mfma_f32_16x16x32_bf16 v[212:215], a[220:223], a[188:191], v[212:215]
ds_read_b128 a[220:223], v244 offset:33792
v_cvt_pk_bf16_f32 v45, v58, v59
v_mfma_f32_16x16x32_bf16 v[204:207], a[224:227], a[192:195], v[204:207]
v_exp_f32_e64 v60, v60
v_mfma_f32_16x16x32_bf16 v[208:211], a[224:227], a[196:199], v[208:211]
v_exp_f32_e64 v61, v61
v_mfma_f32_16x16x32_bf16 v[212:215], a[224:227], a[200:203], v[212:215]
ds_read_b128 a[224:227], v245 offset:33792
v_cvt_pk_bf16_f32 v46, v60, v61
v_mfma_f32_16x16x32_bf16 v[204:207], a[228:231], a[204:207], v[204:207]
v_exp_f32_e64 v62, v62
v_mfma_f32_16x16x32_bf16 v[208:211], a[228:231], a[208:211], v[208:211]
v_cvt_pk_bf16_f32 v128, v192, v193
v_cvt_pk_bf16_f32 v129, v194, v195
v_mfma_f32_16x16x32_bf16 v[212:215], a[228:231], a[212:215], v[212:215]
v_cvt_pk_bf16_f32 v130, v196, v197
v_cvt_pk_bf16_f32 v131, v198, v199
v_exp_f32_e64 v63, v63
v_cvt_pk_bf16_f32 v136, v204, v205
v_cvt_pk_bf16_f32 v137, v206, v207
v_cvt_pk_bf16_f32 v138, v208, v209
v_cvt_pk_bf16_f32 v139, v210, v211
v_permlane16_swap_b32_e64 v128, v130
v_cvt_pk_bf16_f32 v140, v212, v213
v_cvt_pk_bf16_f32 v141, v214, v215
v_mfma_f32_32x32x16_bf16 v[208:223], v[116:119], v[0:3], 0
v_permlane16_swap_b32_e32 v129, v131
v_permlane16_swap_b32_e32 v140, v142
v_permlane16_swap_b32_e64 v141, v143
v_mfma_f32_32x32x16_bf16 v[192:207], v[112:115], v[0:3], 0
buffer_load_dwordx4 v233, s[20:23], s56 offen offset:128 nt lds
v_permlane16_swap_b32_e32 v136, v138
v_permlane16_swap_b32_e32 v137, v139
s_add_u32 m0, s87, 0x2f80
v_mfma_f32_32x32x16_bf16 v[208:223], v[124:127], v[4:7], v[208:223]
v_cvt_pk_bf16_f32 v47, v62, v63
v_lshlrev_b32_e32 v236, 4, v239
v_mul_f32_e32 v254, s63, v253
v_min_f32_e64 v255, s67, v254
v_mfma_f32_32x32x16_bf16 v[192:207], v[120:123], v[4:7], v[192:207]
ds_read_b128 a[228:231], v244 offset:41984
buffer_load_dwordx4 v233, s[20:23], s94 offen offset:128 nt lds
s_add_u32 m0, s87, 0x3f00
ds_read_b128 v[48:51], v248 offset:768
ds_read_b128 v[52:55], v248 offset:960
ds_read_b128 v[56:59], v248 offset:1152
v_mfma_f32_32x32x16_bf16 v[208:223], v[132:135], v[8:11], v[208:223]
ds_read_b128 v[60:63], v248 offset:1344
v_mfma_f32_32x32x16_bf16 v[192:207], v[128:131], v[8:11], v[192:207]
s_nop 0
v_mfma_f32_32x32x16_bf16 v[208:223], v[140:143], v[12:15], v[208:223]
s_waitcnt lgkmcnt(5)
buffer_load_dwordx4 v233, s[20:23], s56 offen offset:256 nt lds
s_add_u32 m0, s87, 0x4f00
s_nop 3
v_mfma_f32_32x32x16_bf16 v[192:207], v[136:139], v[12:15], v[192:207]
s_nop 3
v_mfma_f32_32x32x16_bf16 v[144:159], a[24:27], a[232:235], v[144:159]
v_rcp_f32_e64 v217, v216
buffer_load_dwordx4 v233, s[20:23], s94 offen offset:256 nt lds
v_mul_f32_e64 v208, v217, v208
v_mfma_f32_32x32x16_bf16 v[160:175], a[28:31], a[232:235], v[160:175]
v_mul_f32_e32 v209, v217, v209
v_mul_f32_e32 v210, v217, v210
v_mul_f32_e32 v211, v217, v211
v_mul_f32_e32 v192, v217, v192
v_mul_f32_e32 v193, v217, v193
v_mul_f32_e32 v194, v217, v194
v_mfma_f32_32x32x16_bf16 v[176:191], a[32:35], a[232:235], v[176:191]
ds_read_b128 a[232:235], v245 offset:41984
v_mul_f32_e64 v195, v217, v195
v_cvt_pk_bf16_f32 v192, v192, v193
v_mul_f32_e32 v196, v217, v196
v_mul_f32_e32 v197, v217, v197
v_mul_f32_e64 v198, v217, v198
v_mfma_f32_32x32x16_bf16 v[144:159], a[36:39], a[236:239], v[144:159]
v_mul_f32_e64 v199, v217, v199
v_cvt_pk_bf16_f32 v193, v194, v195
v_cvt_pk_bf16_f32 v194, v196, v197
v_cvt_pk_bf16_f32 v195, v198, v199
v_mul_f32_e32 v200, v217, v200
v_mul_f32_e32 v201, v217, v201
v_mfma_f32_32x32x16_bf16 v[160:175], a[40:43], a[236:239], v[160:175]
ds_write_b128 v247, v[192:195] offset:51200
v_mul_f32_e64 v202, v217, v202
v_mfma_f32_32x32x16_bf16 v[176:191], a[44:47], a[236:239], v[176:191]
v_mul_f32_e64 v203, v217, v203
v_cvt_pk_bf16_f32 v200, v200, v201
v_mul_f32_e32 v204, v217, v204
v_mul_f32_e32 v205, v217, v205
v_mul_f32_e32 v206, v217, v206
v_mul_f32_e32 v207, v217, v207
v_mfma_f32_32x32x16_bf16 v[16:31], v[116:119], v[32:35], 0
s_waitcnt vmcnt(12)
s_barrier
buffer_store_byte v234, v236, s[88:91], s44 offen sc1
ds_read_b128 a[236:239], v243 offset:37888
v_cvt_pk_bf16_f32 v201, v202, v203
v_cvt_pk_bf16_f32 v202, v204, v205
v_cvt_pk_bf16_f32 v203, v206, v207
v_mfma_f32_32x32x16_bf16 v[0:15], v[112:115], v[32:35], 0
ds_write_b128 v247, v[200:203] offset:51232
v_cvt_pk_bf16_f32 v208, v208, v209
v_mfma_f32_32x32x16_bf16 v[16:31], v[124:127], v[36:39], v[16:31]
v_mul_f32_e32 v212, v217, v212
v_mul_f32_e32 v213, v217, v213
v_mul_f32_e32 v214, v217, v214
v_mul_f32_e32 v215, v217, v215
v_cvt_pk_bf16_f32 v209, v210, v211
v_cvt_pk_bf16_f32 v210, v212, v213
v_mfma_f32_32x32x16_bf16 v[0:15], v[120:123], v[36:39], v[0:15]
v_cvt_pk_bf16_f32 v211, v214, v215
v_mov_b32_e32 v118, s19
v_mov_b32_e32 v119, s19
v_mov_b32_e32 v126, s19
v_mov_b32_e32 v127, s19
v_mfma_f32_32x32x16_bf16 v[16:31], v[132:135], v[40:43], v[16:31]
ds_write_b128 v247, v[208:211] offset:51264
v_mov_b32_e64 v134, s19
v_mfma_f32_32x32x16_bf16 v[0:15], v[128:131], v[40:43], v[0:15]
v_mov_b32_e64 v135, s19
ds_read_b128 v[32:35], v248
ds_read_b128 v[36:39], v248 offset:192
ds_read_b128 v[40:43], v248 offset:384
v_mfma_f32_32x32x16_bf16 v[16:31], v[140:143], v[44:47], v[16:31]
v_mov_b32_e64 v142, s19
v_mov_b32_e32 v143, s19
s_nop 3
v_mfma_f32_32x32x16_bf16 v[0:15], v[136:139], v[44:47], v[0:15]
s_nop 0
ds_read_b128 v[44:47], v248 offset:576
s_nop 2
v_mfma_f32_32x32x16_bf16 v[144:159], a[48:51], a[240:243], v[144:159]
ds_read_b128 v[28:31], v248 offset:2112
v_rcp_f32_e32 v25, v24
s_nop 2
v_mfma_f32_32x32x16_bf16 v[160:175], a[52:55], a[240:243], v[160:175]
v_mul_f32_e32 v16, v25, v16
v_mul_f32_e32 v0, v25, v0
v_mul_f32_e32 v1, v25, v1
v_mul_f32_e32 v8, v25, v8
v_mul_f32_e32 v9, v25, v9
v_mul_f32_e32 v2, v25, v2
v_mfma_f32_32x32x16_bf16 v[176:191], a[56:59], a[240:243], v[176:191]
ds_read_b128 a[240:243], v240 offset:46080
v_mul_f32_e64 v3, v25, v3
v_cvt_pk_bf16_f32 v0, v0, v1
v_mul_f32_e32 v10, v25, v10
v_mul_f32_e32 v11, v25, v11
v_cvt_pk_bf16_f32 v8, v8, v9
v_mfma_f32_32x32x16_bf16 v[144:159], a[60:63], a[244:247], v[144:159]
v_mul_f32_e32 v4, v25, v4
v_mul_f32_e32 v5, v25, v5
v_mul_f32_e32 v6, v25, v6
v_mul_f32_e32 v7, v25, v7
v_cvt_pk_bf16_f32 v1, v2, v3
v_mul_f32_e64 v12, v25, v12
v_mfma_f32_32x32x16_bf16 v[160:175], a[64:67], a[244:247], v[160:175]
v_mul_f32_e32 v13, v25, v13
v_mul_f32_e32 v14, v25, v14
v_mul_f32_e64 v15, v25, v15
v_cvt_pk_bf16_f32 v9, v10, v11
v_cvt_pk_bf16_f32 v2, v4, v5
v_cvt_pk_bf16_f32 v3, v6, v7
v_mfma_f32_32x32x16_bf16 v[176:191], a[68:71], a[244:247], v[176:191]
ds_read_b128 a[244:247], v241 offset:46080
ds_write_b128 v247, v[0:3] offset:64000
v_mfma_f32_32x32x16_bf16 v[144:159], a[72:75], a[248:251], v[144:159]
v_cvt_pk_bf16_f32 v10, v12, v13
v_cvt_pk_bf16_f32 v11, v14, v15
v_mul_f32_e32 v17, v25, v17
v_mul_f32_e32 v18, v25, v18
v_mul_f32_e64 v19, v25, v19
v_cvt_pk_bf16_f32 v16, v16, v17
v_mfma_f32_32x32x16_bf16 v[160:175], a[76:79], a[248:251], v[160:175]
ds_write_b128 v247, v[8:11] offset:64032
v_mul_f32_e64 v20, v25, v20
v_mfma_f32_32x32x16_bf16 v[176:191], a[80:83], a[248:251], v[176:191]
v_mul_f32_e32 v21, v25, v21
v_mul_f32_e32 v22, v25, v22
v_mul_f32_e64 v23, v25, v23
v_cvt_pk_bf16_f32 v17, v18, v19
v_cvt_pk_bf16_f32 v18, v20, v21
v_cvt_pk_bf16_f32 v19, v22, v23
v_mfma_f32_16x16x32_bf16 v[192:195], a[252:255], a[144:147], 0
ds_read_b128 a[248:251], v244 offset:27648
ds_read_b128 v[0:3], v248 offset:768
v_mfma_f32_16x16x32_bf16 v[196:199], a[252:255], a[148:151], 0
ds_read_b128 v[4:7], v248 offset:960
ds_read_b128 v[8:11], v248 offset:1152
v_mfma_f32_16x16x32_bf16 v[200:203], a[252:255], a[152:155], 0
ds_read_b128 a[252:255], v245 offset:27648
v_mfma_f32_16x16x32_bf16 v[192:195], a[216:219], a[156:159], v[192:195]
ds_read_b128 v[12:15], v248 offset:1344
v_mfma_f32_16x16x32_bf16 v[196:199], a[216:219], a[160:163], v[196:199]
ds_read_b128 v[20:23], v248 offset:1728
v_mfma_f32_16x16x32_bf16 v[200:203], a[216:219], a[164:167], v[200:203]
ds_read_b128 a[216:219], v244 offset:35840
v_mfma_f32_16x16x32_bf16 v[192:195], a[220:223], a[168:171], v[192:195]
ds_read_b128 v[24:27], v248 offset:1920
v_mfma_f32_16x16x32_bf16 v[196:199], a[220:223], a[172:175], v[196:199]
v_mfma_f32_16x16x32_bf16 v[200:203], a[220:223], a[176:179], v[200:203]
ds_read_b128 a[220:223], v245 offset:35840
v_mfma_f32_16x16x32_bf16 v[192:195], a[224:227], a[180:183], v[192:195]
v_mfma_f32_16x16x32_bf16 v[196:199], a[224:227], a[184:187], v[196:199]
s_nop 0
v_mfma_f32_16x16x32_bf16 v[200:203], a[224:227], a[188:191], v[200:203]
s_waitcnt lgkmcnt(7)
ds_read_b128 a[224:227], v244 offset:44032
v_mfma_f32_16x16x32_bf16 v[192:195], a[228:231], a[192:195], v[192:195]
v_mfma_f32_16x16x32_bf16 v[196:199], a[228:231], a[196:199], v[196:199]
v_mfma_f32_16x16x32_bf16 v[200:203], a[228:231], a[200:203], v[200:203]
ds_read_b128 a[228:231], v245 offset:44032
v_mfma_f32_16x16x32_bf16 v[192:195], a[232:235], a[204:207], v[192:195]
s_nop 2
v_mfma_f32_16x16x32_bf16 v[196:199], a[232:235], a[208:211], v[196:199]
s_nop 2
v_mfma_f32_16x16x32_bf16 v[200:203], a[232:235], a[212:215], v[200:203]
ds_read_b128 a[232:235], v242 offset:46080
v_cvt_pk_bf16_f32 v112, v192, v193
v_mfma_f32_32x32x16_bf16 v[144:159], a[84:87], a[236:239], v[144:159]
v_cvt_pk_bf16_f32 v113, v194, v195
v_cvt_pk_bf16_f32 v114, v196, v197
v_cvt_pk_bf16_f32 v115, v198, v199
s_nop 1
v_cvt_pk_bf16_f32 v116, v200, v201
v_mfma_f32_32x32x16_bf16 v[160:175], a[88:91], a[236:239], v[160:175]
s_nop 0
v_cvt_pk_bf16_f32 v117, v202, v203
v_permlane16_swap_b32_e32 v116, v118
v_permlane16_swap_b32_e32 v112, v114
v_mfma_f32_32x32x16_bf16 v[176:191], a[92:95], a[236:239], v[176:191]
ds_read_b128 a[236:239], v243 offset:46080
ds_write_b128 v247, v[16:19] offset:64064
v_mfma_f32_32x32x16_bf16 v[144:159], a[96:99], a[240:243], v[144:159]
v_permlane16_swap_b32_e32 v117, v119
v_permlane16_swap_b32_e32 v113, v115
v_mfma_f32_32x32x16_bf16 v[160:175], a[100:103], a[240:243], v[160:175]
ds_read_b128 v[16:19], v248 offset:1536
v_mfma_f32_32x32x16_bf16 v[176:191], a[104:107], a[240:243], v[176:191]
ds_read_b128 a[240:243], v244 offset:29696
v_mfma_f32_32x32x16_bf16 v[144:159], a[108:111], a[244:247], v[144:159]
v_mfma_f32_32x32x16_bf16 v[160:175], a[112:115], a[244:247], v[160:175]
v_mfma_f32_32x32x16_bf16 v[176:191], a[116:119], a[244:247], v[176:191]
ds_read_b128 a[244:247], v245 offset:29696
v_mfma_f32_16x16x32_bf16 v[204:207], a[248:251], a[144:147], 0
v_mfma_f32_16x16x32_bf16 v[208:211], a[248:251], a[148:151], 0
s_nop 0
v_mfma_f32_16x16x32_bf16 v[212:215], a[248:251], a[152:155], 0
s_waitcnt lgkmcnt(1)
ds_read_b128 a[248:251], v244 offset:37888
v_mfma_f32_16x16x32_bf16 v[204:207], a[252:255], a[156:159], v[204:207]
v_mfma_f32_16x16x32_bf16 v[208:211], a[252:255], a[160:163], v[208:211]
v_mfma_f32_16x16x32_bf16 v[212:215], a[252:255], a[164:167], v[212:215]
ds_read_b128 a[252:255], v245 offset:37888
v_mfma_f32_16x16x32_bf16 v[204:207], a[216:219], a[168:171], v[204:207]
v_mfma_f32_16x16x32_bf16 v[208:211], a[216:219], a[172:175], v[208:211]
v_mfma_f32_16x16x32_bf16 v[212:215], a[216:219], a[176:179], v[212:215]
ds_read_b128 a[216:219], v244 offset:46080
v_mfma_f32_16x16x32_bf16 v[204:207], a[220:223], a[180:183], v[204:207]
v_mfma_f32_16x16x32_bf16 v[208:211], a[220:223], a[184:187], v[208:211]
v_mfma_f32_16x16x32_bf16 v[212:215], a[220:223], a[188:191], v[212:215]
ds_read_b128 a[220:223], v245 offset:46080
v_mfma_f32_16x16x32_bf16 v[204:207], a[224:227], a[192:195], v[204:207]
v_mfma_f32_16x16x32_bf16 v[208:211], a[224:227], a[196:199], v[208:211]
v_mfma_f32_16x16x32_bf16 v[212:215], a[224:227], a[200:203], v[212:215]
ds_read_b128 a[224:227], v244 offset:31744
v_mfma_f32_16x16x32_bf16 v[204:207], a[228:231], a[204:207], v[204:207]
s_nop 2
v_mfma_f32_16x16x32_bf16 v[208:211], a[228:231], a[208:211], v[208:211]
s_nop 2
v_mfma_f32_16x16x32_bf16 v[212:215], a[228:231], a[212:215], v[212:215]
ds_read_b128 a[228:231], v245 offset:31744
v_cvt_pk_bf16_f32 v120, v204, v205
v_mfma_f32_32x32x16_bf16 v[144:159], a[120:123], a[232:235], v[144:159]
v_cvt_pk_bf16_f32 v121, v206, v207
v_cvt_pk_bf16_f32 v122, v208, v209
v_cvt_pk_bf16_f32 v123, v210, v211
s_nop 1
v_cvt_pk_bf16_f32 v124, v212, v213
v_mfma_f32_32x32x16_bf16 v[160:175], a[124:127], a[232:235], v[160:175]
s_nop 0
v_cvt_pk_bf16_f32 v125, v214, v215
v_permlane16_swap_b32_e32 v124, v126
v_permlane16_swap_b32_e32 v120, v122
v_mfma_f32_32x32x16_bf16 v[176:191], a[128:131], a[232:235], v[176:191]
ds_read_b128 a[232:235], v244 offset:39936
v_permlane16_swap_b32_e32 v125, v127
v_permlane16_swap_b32_e32 v121, v123
v_mfma_f32_32x32x16_bf16 v[144:159], a[132:135], a[236:239], v[144:159]
s_nop 6
v_mfma_f32_32x32x16_bf16 v[160:175], a[136:139], a[236:239], v[160:175]
s_nop 6
v_mfma_f32_32x32x16_bf16 v[176:191], a[140:143], a[236:239], v[176:191]
ds_read_b128 a[236:239], v245 offset:39936
v_cvt_pk_bf16_f32 v88, v144, v145
v_cvt_pk_bf16_f32 v89, v146, v147
v_cvt_pk_bf16_f32 v90, v148, v149
v_cvt_pk_bf16_f32 v91, v150, v151
v_cvt_pk_bf16_f32 v92, v152, v153
v_mfma_f32_16x16x32_bf16 v[192:195], a[240:243], a[144:147], 0
v_cvt_pk_bf16_f32 v100, v168, v169
v_cvt_pk_bf16_f32 v101, v170, v171
v_mfma_f32_16x16x32_bf16 v[196:199], a[240:243], a[148:151], 0
s_nop 0
v_cvt_pk_bf16_f32 v102, v172, v173
v_cvt_pk_bf16_f32 v103, v174, v175
v_mfma_f32_16x16x32_bf16 v[200:203], a[240:243], a[152:155], 0
s_waitcnt lgkmcnt(1)
ds_read_b128 a[240:243], v244 offset:48128
v_cvt_pk_bf16_f32 v104, v176, v177
v_mfma_f32_16x16x32_bf16 v[192:195], a[244:247], a[156:159], v[192:195]
v_cvt_pk_bf16_f32 v105, v178, v179
v_cvt_pk_bf16_f32 v106, v180, v181
v_mfma_f32_16x16x32_bf16 v[196:199], a[244:247], a[160:163], v[196:199]
v_cvt_pk_bf16_f32 v107, v182, v183
v_cvt_pk_bf16_f32 v108, v184, v185
v_mfma_f32_16x16x32_bf16 v[200:203], a[244:247], a[164:167], v[200:203]
ds_read_b128 a[244:247], v245 offset:48128
v_cvt_pk_bf16_f32 v109, v186, v187
v_mfma_f32_16x16x32_bf16 v[192:195], a[248:251], a[168:171], v[192:195]
v_cvt_pk_bf16_f32 v110, v188, v189
v_cvt_pk_bf16_f32 v111, v190, v191
v_mfma_f32_16x16x32_bf16 v[196:199], a[248:251], a[172:175], v[196:199]
v_cvt_pk_bf16_f32 v93, v154, v155
v_cvt_pk_bf16_f32 v94, v156, v157
v_mfma_f32_16x16x32_bf16 v[200:203], a[248:251], a[176:179], v[200:203]
v_cvt_pk_bf16_f32 v95, v158, v159
v_cvt_pk_bf16_f32 v96, v160, v161
v_mfma_f32_16x16x32_bf16 v[192:195], a[252:255], a[180:183], v[192:195]
v_cvt_pk_bf16_f32 v97, v162, v163
v_cvt_pk_bf16_f32 v98, v164, v165
v_mfma_f32_16x16x32_bf16 v[196:199], a[252:255], a[184:187], v[196:199]
v_cvt_pk_bf16_f32 v99, v166, v167
v_mfma_f32_16x16x32_bf16 v[200:203], a[252:255], a[188:191], v[200:203]
v_mfma_f32_16x16x32_bf16 v[192:195], a[216:219], a[192:195], v[192:195]
v_mfma_f32_16x16x32_bf16 v[196:199], a[216:219], a[196:199], v[196:199]
v_mfma_f32_16x16x32_bf16 v[200:203], a[216:219], a[200:203], v[200:203]
v_mfma_f32_16x16x32_bf16 v[192:195], a[220:223], a[204:207], v[192:195]
s_nop 2
v_mfma_f32_16x16x32_bf16 v[196:199], a[220:223], a[208:211], v[196:199]
s_nop 2
v_mfma_f32_16x16x32_bf16 v[200:203], a[220:223], a[212:215], v[200:203]
v_cvt_pk_bf16_f32 v128, v192, v193
v_cvt_pk_bf16_f32 v129, v194, v195
v_mfma_f32_16x16x32_bf16 v[204:207], a[224:227], a[144:147], 0
s_nop 0
v_cvt_pk_bf16_f32 v130, v196, v197
v_cvt_pk_bf16_f32 v131, v198, v199
v_mfma_f32_16x16x32_bf16 v[208:211], a[224:227], a[148:151], 0
v_permlane16_swap_b32_e32 v128, v130
v_mfma_f32_16x16x32_bf16 v[212:215], a[224:227], a[152:155], 0
v_cvt_pk_bf16_f32 v132, v200, v201
v_cvt_pk_bf16_f32 v133, v202, v203
v_mfma_f32_16x16x32_bf16 v[204:207], a[228:231], a[156:159], v[204:207]
v_permlane16_swap_b32_e64 v132, v134
v_mfma_f32_16x16x32_bf16 v[208:211], a[228:231], a[160:163], v[208:211]
v_permlane16_swap_b32_e64 v133, v135
v_mfma_f32_16x16x32_bf16 v[212:215], a[228:231], a[164:167], v[212:215]
v_permlane16_swap_b32_e64 v129, v131
v_mfma_f32_16x16x32_bf16 v[204:207], a[232:235], a[168:171], v[204:207]
v_mfma_f32_16x16x32_bf16 v[208:211], a[232:235], a[172:175], v[208:211]
s_nop 0
v_mfma_f32_16x16x32_bf16 v[212:215], a[232:235], a[176:179], v[212:215]
s_waitcnt lgkmcnt(0)
v_mfma_f32_16x16x32_bf16 v[204:207], a[236:239], a[180:183], v[204:207]
v_mfma_f32_16x16x32_bf16 v[208:211], a[236:239], a[184:187], v[208:211]
v_mfma_f32_16x16x32_bf16 v[212:215], a[236:239], a[188:191], v[212:215]
v_mfma_f32_16x16x32_bf16 v[204:207], a[240:243], a[192:195], v[204:207]
v_mfma_f32_16x16x32_bf16 v[208:211], a[240:243], a[196:199], v[208:211]
v_mfma_f32_16x16x32_bf16 v[212:215], a[240:243], a[200:203], v[212:215]
v_mfma_f32_16x16x32_bf16 v[204:207], a[244:247], a[204:207], v[204:207]
s_nop 2
v_mfma_f32_16x16x32_bf16 v[208:211], a[244:247], a[208:211], v[208:211]
s_nop 2
v_mfma_f32_16x16x32_bf16 v[212:215], a[244:247], a[212:215], v[212:215]
v_cvt_pk_bf16_f32 v136, v204, v205
v_cvt_pk_bf16_f32 v137, v206, v207
v_mfma_f32_32x32x16_bf16 v[0:15], v[76:79], v[64:67], v[0:15]
s_nop 0
v_cvt_pk_bf16_f32 v138, v208, v209
v_cvt_pk_bf16_f32 v139, v210, v211
s_nop 1
v_cvt_pk_bf16_f32 v140, v212, v213
v_cvt_pk_bf16_f32 v141, v214, v215
v_mfma_f32_32x32x16_bf16 v[0:15], v[80:83], v[68:71], v[0:15]
v_permlane16_swap_b32_e32 v140, v142
v_permlane16_swap_b32_e32 v141, v143
v_permlane16_swap_b32_e64 v136, v138
v_mfma_f32_32x32x16_bf16 v[0:15], v[84:87], v[72:75], v[0:15]
s_waitcnt vmcnt(1)
v_permlane16_swap_b32_e32 v137, v139
s_nop 3
v_mfma_f32_32x32x16_bf16 v[16:31], v[100:103], v[64:67], v[16:31]
s_barrier
ds_read_b128 a[252:255], v246 offset:51200
ds_read_b64_tr_b16 v[232:233], v249
ds_read_b64_tr_b16 v[234:235], v249 offset:1536
ds_read_b64_tr_b16 a[216:217], v249 offset:64
ds_read_b64_tr_b16 a[218:219], v249 offset:1600
ds_read_b64_tr_b16 a[220:221], v249 offset:128
v_mfma_f32_32x32x16_bf16 v[16:31], v[104:107], v[68:71], v[16:31]
ds_read_b64_tr_b16 a[222:223], v249 offset:1664
v_max3_f32 v224, v0, v1, v2
v_max3_f32 v224, v224, v3, v4
v_max3_f32 v224, v224, v5, v6
v_max3_f32 v224, v224, v7, v8
v_max3_f32 v224, v224, v9, v10
v_mfma_f32_32x32x16_bf16 v[16:31], v[108:111], v[72:75], v[16:31]
ds_read_b128 a[224:227], v246 offset:51232
ds_read_b64_tr_b16 a[228:229], v249 offset:3072
ds_read_b64_tr_b16 a[230:231], v249 offset:4608
ds_read_b64_tr_b16 a[232:233], v249 offset:3136
v_max3_f32 v224, v224, v11, v12
v_max3_f32 v224, v224, v13, v14
v_mfma_f32_32x32x16_bf16 v[32:47], v[76:79], v[88:91], v[32:47]
ds_read_b64_tr_b16 a[234:235], v249 offset:4672
ds_read_b64_tr_b16 a[236:237], v249 offset:3200
ds_read_b64_tr_b16 a[238:239], v249 offset:4736
v_max_f32_e64 v224, v224, v15
v_fma_f32 v224, v224, s70, v254
v_mfma_f32_32x32x16_bf16 v[32:47], v[80:83], v[92:95], v[32:47]
ds_read_b128 a[240:243], v246 offset:51264
ds_read_b64_tr_b16 a[244:245], v249 offset:6144
v_max3_f32 v225, v16, v17, v18
v_max3_f32 v225, v225, v19, v20
v_max3_f32 v225, v225, v21, v22
v_max3_f32 v225, v225, v23, v24
v_mfma_f32_32x32x16_bf16 v[32:47], v[84:87], v[96:99], v[32:47]
ds_read_b64_tr_b16 a[246:247], v249 offset:7680
ds_read_b64_tr_b16 a[248:249], v249 offset:6208
ds_read_b64_tr_b16 a[250:251], v249 offset:7744
v_max3_f32 v225, v225, v25, v26
v_max3_f32 v225, v225, v27, v28
v_max3_f32 v225, v225, v29, v30
v_mfma_f32_32x32x16_bf16 v[48:63], v[100:103], v[88:91], v[48:63]
v_max_f32_e64 v225, v225, v31
v_fma_f32 v225, v225, s70, v255
v_max_f32_e64 v224, v224, v225
v_mov_b32_e32 v225, v224
s_nop 0
v_mfma_f32_32x32x16_bf16 v[48:63], v[104:107], v[92:95], v[48:63]
v_permlane32_swap_b32_e32 v224, v225
v_max_f32_e32 v224, v224, v225
v_sub_f32_e64 v226, v254, v224
v_fma_f32 v0, v0, s70, v226
v_fma_f32 v1, v1, s70, v226
v_mfma_f32_32x32x16_bf16 v[48:63], v[108:111], v[96:99], v[48:63]
s_waitcnt lgkmcnt(6)
v_exp_f32_e32 v0, v0
v_exp_f32_e64 v1, v1
v_fma_f32 v2, v2, s70, v226
v_fma_f32 v3, v3, s70, v226
v_mfma_f32_32x32x16_bf16 v[64:79], v[232:235], a[252:255], 0
ds_read_b128 v[232:235], v246 offset:51296
v_exp_f32_e32 v2, v2
v_exp_f32_e32 v3, v3
v_fma_f32 v4, v4, s70, v226
v_mfma_f32_32x32x16_bf16 v[80:95], a[216:219], a[252:255], 0
ds_read_b64_tr_b16 a[216:217], v249 offset:9216
ds_read_b64_tr_b16 a[218:219], v249 offset:10752
v_fma_f32 v5, v5, s70, v226
v_fma_f32 v6, v6, s70, v226
v_fma_f32 v7, v7, s70, v226
v_cvt_pk_bf16_f32 v0, v0, v1
v_mfma_f32_32x32x16_bf16 v[96:111], a[220:223], a[252:255], 0
ds_read_b64_tr_b16 a[252:253], v249 offset:6272
ds_read_b64_tr_b16 a[254:255], v249 offset:7808
ds_read_b64_tr_b16 a[220:221], v249 offset:9280
ds_read_b64_tr_b16 a[222:223], v249 offset:10816
v_exp_f32_e64 v4, v4
v_mfma_f32_32x32x16_bf16 v[64:79], a[228:231], a[224:227], v[64:79]
ds_read_b128 a[228:231], v246 offset:51328
v_exp_f32_e32 v5, v5
v_exp_f32_e32 v6, v6
v_cvt_pk_bf16_f32 v1, v2, v3
v_mfma_f32_32x32x16_bf16 v[80:95], a[232:235], a[224:227], v[80:95]
s_waitcnt lgkmcnt(8)
ds_read_b64_tr_b16 a[232:233], v249 offset:12288
ds_read_b64_tr_b16 a[234:235], v249 offset:13824
v_exp_f32_e32 v7, v7
v_cvt_pk_bf16_f32 v2, v4, v5
v_cvt_pk_bf16_f32 v3, v6, v7
v_mfma_f32_32x32x16_bf16 v[96:111], a[236:239], a[224:227], v[96:111]
ds_read_b64_tr_b16 a[224:225], v249 offset:9344
ds_read_b64_tr_b16 a[226:227], v249 offset:10880
ds_read_b64_tr_b16 a[236:237], v249 offset:12352
ds_read_b64_tr_b16 a[238:239], v249 offset:13888
v_fma_f32 v8, v8, s70, v226
v_fma_f32 v9, v9, s70, v226
v_mfma_f32_32x32x16_bf16 v[64:79], a[244:247], a[240:243], v[64:79]
ds_read_b128 a[244:247], v246 offset:51360
v_fma_f32 v10, v10, s70, v226
v_fma_f32 v11, v11, s70, v226
v_fma_f32 v12, v12, s70, v226
v_fma_f32 v13, v13, s70, v226
v_fma_f32 v14, v14, s70, v226
v_mfma_f32_32x32x16_bf16 v[80:95], a[248:251], a[240:243], v[80:95]
s_waitcnt lgkmcnt(8)
ds_read_b64_tr_b16 a[248:249], v249 offset:15360
ds_read_b64_tr_b16 a[250:251], v249 offset:16896
v_fma_f32 v15, v15, s70, v226
v_exp_f32_e32 v8, v8
v_sub_f32_e64 v227, v255, v224
v_mfma_f32_32x32x16_bf16 v[96:111], a[252:255], a[240:243], v[96:111]
ds_read_b64_tr_b16 a[240:241], v249 offset:12416
ds_read_b64_tr_b16 a[242:243], v249 offset:13952
ds_read_b64_tr_b16 a[252:253], v249 offset:15424
ds_read_b64_tr_b16 a[254:255], v249 offset:16960
v_exp_f32_e64 v9, v9
v_mfma_f32_32x32x16_bf16 v[64:79], a[216:219], v[232:235], v[64:79]
ds_read_b128 a[216:219], v246 offset:51392
v_exp_f32_e32 v10, v10
v_exp_f32_e32 v11, v11
v_cvt_pk_bf16_f32 v4, v8, v9
v_mfma_f32_32x32x16_bf16 v[80:95], a[220:223], v[232:235], v[80:95]
s_waitcnt lgkmcnt(8)
ds_read_b64_tr_b16 a[220:221], v249 offset:18432
ds_read_b64_tr_b16 a[222:223], v249 offset:19968
v_exp_f32_e32 v12, v12
v_exp_f32_e64 v13, v13
v_mfma_f32_32x32x16_bf16 v[96:111], a[224:227], v[232:235], v[96:111]
ds_read_b64_tr_b16 v[232:233], v249 offset:15488
ds_read_b64_tr_b16 v[234:235], v249 offset:17024
ds_read_b64_tr_b16 a[224:225], v249 offset:18496
ds_read_b64_tr_b16 a[226:227], v249 offset:20032
v_exp_f32_e64 v14, v14
v_mfma_f32_32x32x16_bf16 v[64:79], a[232:235], a[228:231], v[64:79]
ds_read_b128 a[232:235], v246 offset:51424
v_exp_f32_e32 v15, v15
v_cvt_pk_bf16_f32 v5, v10, v11
v_cvt_pk_bf16_f32 v6, v12, v13
v_cvt_pk_bf16_f32 v7, v14, v15
v_mfma_f32_32x32x16_bf16 v[80:95], a[236:239], a[228:231], v[80:95]
s_waitcnt lgkmcnt(8)
ds_read_b64_tr_b16 a[236:237], v249 offset:21504
ds_read_b64_tr_b16 a[238:239], v249 offset:23040
v_fma_f32 v16, v16, s70, v227
v_fma_f32 v17, v17, s70, v227
v_fma_f32 v18, v18, s70, v227
v_fma_f32 v19, v19, s70, v227
v_mfma_f32_32x32x16_bf16 v[96:111], a[240:243], a[228:231], v[96:111]
ds_read_b64_tr_b16 a[228:229], v249 offset:18560
ds_read_b64_tr_b16 a[230:231], v249 offset:20096
ds_read_b64_tr_b16 a[240:241], v249 offset:21568
ds_read_b64_tr_b16 a[242:243], v249 offset:23104
v_fma_f32 v20, v20, s70, v227
v_fma_f32 v21, v21, s70, v227
v_mfma_f32_32x32x16_bf16 v[64:79], a[248:251], a[244:247], v[64:79]
ds_read_b128 a[248:251], v246 offset:51456
v_fma_f32 v22, v22, s70, v227
v_fma_f32 v23, v23, s70, v227
v_exp_f32_e32 v16, v16
v_fma_f32 v24, v24, s70, v227
v_mfma_f32_32x32x16_bf16 v[80:95], a[252:255], a[244:247], v[80:95]
s_waitcnt lgkmcnt(8)
ds_read_b64_tr_b16 a[252:253], v249 offset:24576
ds_read_b64_tr_b16 a[254:255], v249 offset:26112
v_exp_f32_e32 v17, v17
v_exp_f32_e32 v18, v18
v_mfma_f32_32x32x16_bf16 v[96:111], v[232:235], a[244:247], v[96:111]
ds_read_b64_tr_b16 a[244:245], v249 offset:21632
ds_read_b64_tr_b16 a[246:247], v249 offset:23168
ds_read_b64_tr_b16 v[232:233], v249 offset:24640
ds_read_b64_tr_b16 v[234:235], v249 offset:26176
v_exp_f32_e64 v19, v19
v_mfma_f32_32x32x16_bf16 v[64:79], a[220:223], a[216:219], v[64:79]
ds_read_b128 a[220:223], v246 offset:51488
v_exp_f32_e32 v20, v20
v_exp_f32_e32 v21, v21
v_cvt_pk_bf16_f32 v8, v16, v17
v_mfma_f32_32x32x16_bf16 v[80:95], a[224:227], a[216:219], v[80:95]
s_waitcnt lgkmcnt(8)
ds_read_b64_tr_b16 a[224:225], v249 offset:27648
ds_read_b64_tr_b16 a[226:227], v249 offset:29184
v_exp_f32_e32 v22, v22
v_exp_f32_e64 v23, v23
v_mfma_f32_32x32x16_bf16 v[96:111], a[228:231], a[216:219], v[96:111]
ds_read_b64_tr_b16 a[216:217], v249 offset:24704
ds_read_b64_tr_b16 a[218:219], v249 offset:26240
ds_read_b64_tr_b16 a[228:229], v249 offset:27712
ds_read_b64_tr_b16 a[230:231], v249 offset:29248
v_cvt_pk_bf16_f32 v9, v18, v19
v_cvt_pk_bf16_f32 v10, v20, v21
v_mfma_f32_32x32x16_bf16 v[64:79], a[236:239], a[232:235], v[64:79]
s_nop 0
ds_read_b128 a[236:239], v246 offset:51520
v_cvt_pk_bf16_f32 v11, v22, v23
v_fma_f32 v25, v25, s70, v227
v_fma_f32 v26, v26, s70, v227
v_fma_f32 v27, v27, s70, v227
v_fma_f32 v28, v28, s70, v227
v_mfma_f32_32x32x16_bf16 v[80:95], a[240:243], a[232:235], v[80:95]
s_waitcnt lgkmcnt(8)
ds_read_b64_tr_b16 a[240:241], v249 offset:30720
ds_read_b64_tr_b16 a[242:243], v249 offset:32256
v_fma_f32 v29, v29, s70, v227
v_fma_f32 v30, v30, s70, v227
v_fma_f32 v31, v31, s70, v227
v_max3_f32 v224, v32, v33, v34
v_mfma_f32_32x32x16_bf16 v[96:111], a[244:247], a[232:235], v[96:111]
ds_read_b64_tr_b16 a[232:233], v249 offset:27776
ds_read_b64_tr_b16 a[234:235], v249 offset:29312
ds_read_b64_tr_b16 a[244:245], v249 offset:30784
ds_read_b64_tr_b16 a[246:247], v249 offset:32320
v_exp_f32_e64 v24, v24
v_mfma_f32_32x32x16_bf16 v[64:79], a[252:255], a[248:251], v[64:79]
ds_read_b128 a[252:255], v246 offset:51552
v_exp_f32_e32 v25, v25
v_exp_f32_e32 v26, v26
v_cvt_pk_bf16_f32 v12, v24, v25
v_mfma_f32_32x32x16_bf16 v[80:95], v[232:235], a[248:251], v[80:95]
s_waitcnt lgkmcnt(8)
ds_read_b64_tr_b16 v[232:233], v249 offset:33792
ds_read_b64_tr_b16 v[234:235], v249 offset:35328
v_exp_f32_e32 v27, v27
v_exp_f32_e64 v28, v28
v_mfma_f32_32x32x16_bf16 v[96:111], a[216:219], a[248:251], v[96:111]
ds_read_b64_tr_b16 a[248:249], v249 offset:30848
ds_read_b64_tr_b16 a[250:251], v249 offset:32384
ds_read_b64_tr_b16 a[216:217], v249 offset:33856
ds_read_b64_tr_b16 a[218:219], v249 offset:35392
v_exp_f32_e64 v29, v29
v_mfma_f32_32x32x16_bf16 v[64:79], a[224:227], a[220:223], v[64:79]
v_exp_f32_e32 v30, v30
v_exp_f32_e32 v31, v31
v_cvt_pk_bf16_f32 v13, v26, v27
s_waitcnt lgkmcnt(6)
s_barrier
v_mfma_f32_32x32x16_bf16 v[80:95], a[228:231], a[220:223], v[80:95]
ds_read_b128 a[224:227], v240
ds_read_b128 a[228:231], v241
v_cvt_pk_bf16_f32 v14, v28, v29
v_cvt_pk_bf16_f32 v15, v30, v31
v_max3_f32 v225, v48, v49, v50
v_max3_f32 v224, v224, v35, v36
v_mfma_f32_32x32x16_bf16 v[96:111], a[232:235], a[220:223], v[96:111]
ds_read_b64_tr_b16 a[220:221], v249 offset:33920
ds_read_b64_tr_b16 a[222:223], v249 offset:35456
ds_read_b128 a[232:235], v242
v_max3_f32 v225, v225, v51, v52
v_max3_f32 v224, v224, v37, v38
v_max3_f32 v225, v225, v53, v54
v_mfma_f32_32x32x16_bf16 v[64:79], a[240:243], a[236:239], v[64:79]
ds_read_b128 a[240:243], v240 offset:8192
v_max3_f32 v224, v224, v39, v40
v_max3_f32 v225, v225, v55, v56
v_max3_f32 v224, v224, v41, v42
v_max3_f32 v225, v225, v57, v58
v_max3_f32 v224, v224, v43, v44
v_mfma_f32_32x32x16_bf16 v[80:95], a[244:247], a[236:239], v[80:95]
s_waitcnt lgkmcnt(6)
ds_read_b128 a[244:247], v241 offset:8192
v_max3_f32 v225, v225, v59, v60
v_max3_f32 v224, v224, v45, v46
v_max3_f32 v225, v225, v61, v62
v_max_f32_e32 v224, v224, v47
v_max_f32_e64 v225, v225, v63
v_mfma_f32_32x32x16_bf16 v[96:111], a[248:251], a[236:239], v[96:111]
ds_read_b128 a[236:239], v243
ds_read_b128 a[248:251], v242 offset:8192
v_fma_f32 v224, v224, s70, v255
v_fma_f32 v225, v225, s70, v254
v_max_f32_e32 v224, v224, v225
v_mov_b32_e32 v225, v224
v_mfma_f32_32x32x16_bf16 v[64:79], v[232:235], a[252:255], v[64:79]
ds_read_b128 v[232:235], v240 offset:16384
v_permlane32_swap_b32_e32 v224, v225
v_max_f32_e32 v224, v224, v225
v_sub_f32_e32 v228, v255, v224
v_fma_f32 v32, v32, s70, v228
v_mfma_f32_32x32x16_bf16 v[80:95], a[216:219], a[252:255], v[80:95]
s_waitcnt lgkmcnt(5)
ds_read_b128 a[216:219], v241 offset:16384
v_fma_f32 v33, v33, s70, v228
v_exp_f32_e32 v32, v32
v_exp_f32_e32 v33, v33
v_mfma_f32_32x32x16_bf16 v[96:111], a[220:223], a[252:255], v[96:111]
ds_read_b128 a[252:255], v243 offset:8192
ds_read_b128 a[220:223], v242 offset:16384
v_cvt_pk_bf16_f32 v64, v64, v65
v_cvt_pk_bf16_f32 v72, v72, v73
v_cvt_pk_bf16_f32 v65, v66, v67
v_cvt_pk_bf16_f32 v73, v74, v75
v_mfma_f32_32x32x16_bf16 v[144:159], a[0:3], a[224:227], 0
v_cvt_pk_bf16_f32 v66, v68, v69
v_cvt_pk_bf16_f32 v67, v70, v71
v_cvt_pk_bf16_f32 v74, v76, v77
v_cvt_pk_bf16_f32 v75, v78, v79
v_cvt_pk_bf16_f32 v80, v80, v81
v_cvt_pk_bf16_f32 v88, v88, v89
v_mfma_f32_32x32x16_bf16 v[160:175], a[4:7], a[224:227], 0
ds_write_b128 v230, v[64:67] offset:25600
v_cvt_pk_bf16_f32 v81, v82, v83
v_mfma_f32_32x32x16_bf16 v[176:191], a[8:11], a[224:227], 0
v_cvt_pk_bf16_f32 v89, v90, v91
v_cvt_pk_bf16_f32 v82, v84, v85
v_cvt_pk_bf16_f32 v83, v86, v87
v_cvt_pk_bf16_f32 v90, v92, v93
v_cvt_pk_bf16_f32 v91, v94, v95
v_fma_f32 v34, v34, s70, v228
v_mfma_f32_32x32x16_bf16 v[144:159], a[12:15], a[228:231], v[144:159]
ds_read_b128 a[224:227], v243 offset:16384
ds_write_b128 v230, v[72:75] offset:25632
v_mfma_f32_32x32x16_bf16 v[160:175], a[16:19], a[228:231], v[160:175]
v_fma_f32 v35, v35, s70, v228
v_exp_f32_e32 v34, v34
v_exp_f32_e32 v35, v35
v_fma_f32 v36, v36, s70, v228
v_mfma_f32_32x32x16_bf16 v[176:191], a[20:23], a[228:231], v[176:191]
ds_read_b128 v[68:71], v231 offset:25600
ds_read_b128 v[76:79], v231 offset:32000
ds_read_b128 a[228:231], v240 offset:4096
v_fma_f32 v37, v37, s70, v228
v_fma_f32 v38, v38, s70, v228
v_fma_f32 v39, v39, s70, v228
v_mfma_f32_32x32x16_bf16 v[144:159], a[24:27], a[232:235], v[144:159]
ds_write_b128 v230, v[80:83] offset:25664
v_cvt_pk_bf16_f32 v32, v32, v33
v_mfma_f32_32x32x16_bf16 v[160:175], a[28:31], a[232:235], v[160:175]
v_exp_f32_e32 v36, v36
v_exp_f32_e32 v37, v37
v_exp_f32_e64 v38, v38
v_mfma_f32_32x32x16_bf16 v[176:191], a[32:35], a[232:235], v[176:191]
s_waitcnt lgkmcnt(4)
ds_write_b128 v230, v[88:91] offset:25696
v_cvt_pk_bf16_f32 v33, v34, v35
v_mfma_f32_32x32x16_bf16 v[144:159], a[36:39], a[236:239], v[144:159]
s_waitcnt lgkmcnt(4)
buffer_store_dwordx4 v[68:71], v250, s[36:39], s58 offen sc1
ds_read_b128 v[84:87], v231 offset:25664
v_mfma_f32_32x32x16_bf16 v[160:175], a[40:43], a[236:239], v[160:175]
ds_read_b128 a[232:235], v241 offset:4096
v_exp_f32_e64 v39, v39
v_cvt_pk_bf16_f32 v34, v36, v37
v_cvt_pk_bf16_f32 v35, v38, v39
v_fma_f32 v40, v40, s70, v228
v_mfma_f32_32x32x16_bf16 v[176:191], a[44:47], a[236:239], v[176:191]
ds_read_b128 a[236:239], v242 offset:4096
v_fma_f32 v41, v41, s70, v228
v_fma_f32 v42, v42, s70, v228
v_fma_f32 v43, v43, s70, v228
v_fma_f32 v44, v44, s70, v228
v_fma_f32 v45, v45, s70, v228
v_mfma_f32_32x32x16_bf16 v[144:159], a[48:51], a[240:243], v[144:159]
v_fma_f32 v46, v46, s70, v228
v_fma_f32 v47, v47, s70, v228
v_exp_f32_e64 v40, v40
v_exp_f32_e32 v41, v41
v_mfma_f32_32x32x16_bf16 v[160:175], a[52:55], a[240:243], v[160:175]
s_waitcnt lgkmcnt(3)
buffer_store_dwordx4 v[76:79], v250, s[36:39], s76 offen sc1
v_cvt_pk_bf16_f32 v36, v40, v41
v_mfma_f32_32x32x16_bf16 v[176:191], a[56:59], a[240:243], v[176:191]
ds_read_b128 a[240:243], v243 offset:4096
v_exp_f32_e32 v42, v42
v_exp_f32_e32 v43, v43
v_sub_f32_e64 v229, v254, v224
v_mfma_f32_32x32x16_bf16 v[144:159], a[60:63], a[244:247], v[144:159]
v_exp_f32_e32 v44, v44
v_exp_f32_e32 v45, v45
v_exp_f32_e64 v46, v46
v_mfma_f32_32x32x16_bf16 v[160:175], a[64:67], a[244:247], v[160:175]
v_exp_f32_e64 v47, v47
v_cvt_pk_bf16_f32 v37, v42, v43
v_cvt_pk_bf16_f32 v38, v44, v45
v_cvt_pk_bf16_f32 v39, v46, v47
v_fma_f32 v48, v48, s70, v229
v_mfma_f32_32x32x16_bf16 v[176:191], a[68:71], a[244:247], v[176:191]
s_waitcnt lgkmcnt(1)
buffer_store_dwordx4 v[84:87], v250, s[36:39], s58 offen offset:64 sc1
ds_read_b128 a[244:247], v240 offset:12288
v_mfma_f32_32x32x16_bf16 v[144:159], a[72:75], a[248:251], v[144:159]
s_nop 0
v_fma_f32 v49, v49, s70, v229
v_fma_f32 v50, v50, s70, v229
v_fma_f32 v51, v51, s70, v229
v_fma_f32 v52, v52, s70, v229
v_fma_f32 v53, v53, s70, v229
v_fma_f32 v54, v54, s70, v229
v_mfma_f32_32x32x16_bf16 v[160:175], a[76:79], a[248:251], v[160:175]
v_fma_f32 v55, v55, s70, v229
v_exp_f32_e32 v48, v48
v_exp_f32_e32 v49, v49
v_fma_f32 v56, v56, s70, v229
v_mfma_f32_32x32x16_bf16 v[176:191], a[80:83], a[248:251], v[176:191]
ds_read_b128 a[248:251], v241 offset:12288
v_exp_f32_e32 v50, v50
v_exp_f32_e32 v51, v51
v_cvt_pk_bf16_f32 v40, v48, v49
v_mfma_f32_32x32x16_bf16 v[144:159], a[84:87], a[252:255], v[144:159]
v_exp_f32_e32 v52, v52
v_exp_f32_e32 v53, v53
v_exp_f32_e64 v54, v54
v_mfma_f32_32x32x16_bf16 v[160:175], a[88:91], a[252:255], v[160:175]
v_exp_f32_e64 v55, v55
v_cvt_pk_bf16_f32 v41, v50, v51
v_cvt_pk_bf16_f32 v42, v52, v53
v_cvt_pk_bf16_f32 v43, v54, v55
v_fma_f32 v57, v57, s70, v229
v_mfma_f32_32x32x16_bf16 v[176:191], a[92:95], a[252:255], v[176:191]
ds_read_b128 a[252:255], v242 offset:12288
v_fma_f32 v58, v58, s70, v229
v_fma_f32 v59, v59, s70, v229
v_fma_f32 v60, v60, s70, v229
v_fma_f32 v61, v61, s70, v229
v_fma_f32 v62, v62, s70, v229
v_mfma_f32_32x32x16_bf16 v[144:159], a[96:99], v[232:235], v[144:159]
v_fma_f32 v63, v63, s70, v229
v_exp_f32_e32 v56, v56
v_exp_f32_e32 v57, v57
v_cvt_pk_bf16_f32 v96, v96, v97
v_mfma_f32_32x32x16_bf16 v[160:175], a[100:103], v[232:235], v[160:175]
v_exp_f32_e32 v58, v58
v_exp_f32_e32 v59, v59
v_exp_f32_e64 v60, v60
v_mfma_f32_32x32x16_bf16 v[176:191], a[104:107], v[232:235], v[176:191]
ds_read_b128 v[232:235], v243 offset:12288
v_exp_f32_e32 v61, v61
v_exp_f32_e32 v62, v62
v_cvt_pk_bf16_f32 v44, v56, v57
v_mfma_f32_32x32x16_bf16 v[144:159], a[108:111], a[216:219], v[144:159]
v_exp_f32_e64 v63, v63
v_cvt_pk_bf16_f32 v45, v58, v59
v_cvt_pk_bf16_f32 v46, v60, v61
v_cvt_pk_bf16_f32 v47, v62, v63
v_cvt_pk_bf16_f32 v104, v104, v105
v_mfma_f32_32x32x16_bf16 v[160:175], a[112:115], a[216:219], v[160:175]
ds_read_b128 v[92:95], v231 offset:32064
ds_read_b128 v[48:51], v248 offset:768
ds_read_b128 v[52:55], v248 offset:960
v_cvt_pk_bf16_f32 v97, v98, v99
v_cvt_pk_bf16_f32 v105, v106, v107
v_cvt_pk_bf16_f32 v98, v100, v101
v_mfma_f32_32x32x16_bf16 v[176:191], a[116:119], a[216:219], v[176:191]
ds_read_b128 a[216:219], v244
ds_read_b128 v[56:59], v248 offset:1152
v_cvt_pk_bf16_f32 v99, v102, v103
v_cvt_pk_bf16_f32 v106, v108, v109
v_cvt_pk_bf16_f32 v107, v110, v111
v_mul_f32_e64 v254, s64, v253
v_mfma_f32_32x32x16_bf16 v[144:159], a[120:123], a[220:223], v[144:159]
ds_write_b128 v230, v[96:99] offset:25728
v_min_f32_e64 v255, s68, v254
v_mfma_f32_32x32x16_bf16 v[160:175], a[124:127], a[220:223], v[160:175]
ds_read_b128 v[60:63], v248 offset:1344
v_mfma_f32_32x32x16_bf16 v[176:191], a[128:131], a[220:223], v[176:191]
ds_read_b128 a[220:223], v245
ds_write_b128 v230, v[104:107] offset:25760
v_mfma_f32_32x32x16_bf16 v[144:159], a[132:135], a[224:227], v[144:159]
s_waitcnt lgkmcnt(7)
buffer_store_dwordx4 v[92:95], v250, s[36:39], s76 offen offset:64 sc1
s_nop 0
v_mfma_f32_32x32x16_bf16 v[160:175], a[136:139], a[224:227], v[160:175]
ds_read_b128 v[100:103], v231 offset:25728
ds_read_b128 v[108:111], v231 offset:32128
s_nop 2
v_mfma_f32_32x32x16_bf16 v[176:191], a[140:143], a[224:227], v[176:191]
ds_read_b128 a[224:227], v244 offset:8192
s_nop 1
v_cvt_pk_bf16_f32 v64, v144, v145
v_cvt_pk_bf16_f32 v65, v146, v147
v_cvt_pk_bf16_f32 v66, v148, v149
v_mfma_f32_32x32x16_bf16 v[208:223], v[116:119], v[0:3], 0
v_cvt_pk_bf16_f32 v67, v150, v151
v_cvt_pk_bf16_f32 v68, v152, v153
v_cvt_pk_bf16_f32 v69, v154, v155
v_cvt_pk_bf16_f32 v70, v156, v157
v_cvt_pk_bf16_f32 v71, v158, v159
v_cvt_pk_bf16_f32 v72, v160, v161
v_mfma_f32_32x32x16_bf16 v[192:207], v[112:115], v[0:3], 0
v_cvt_pk_bf16_f32 v73, v162, v163
v_cvt_pk_bf16_f32 v74, v164, v165
v_cvt_pk_bf16_f32 v75, v166, v167
v_cvt_pk_bf16_f32 v76, v168, v169
v_cvt_pk_bf16_f32 v77, v170, v171
v_cvt_pk_bf16_f32 v78, v172, v173
v_mfma_f32_32x32x16_bf16 v[208:223], v[124:127], v[4:7], v[208:223]
v_cvt_pk_bf16_f32 v79, v174, v175
v_cvt_pk_bf16_f32 v80, v176, v177
v_cvt_pk_bf16_f32 v81, v178, v179
v_cvt_pk_bf16_f32 v82, v180, v181
v_cvt_pk_bf16_f32 v83, v182, v183
v_cvt_pk_bf16_f32 v84, v184, v185
v_mfma_f32_32x32x16_bf16 v[192:207], v[120:123], v[4:7], v[192:207]
v_cvt_pk_bf16_f32 v85, v186, v187
v_cvt_pk_bf16_f32 v86, v188, v189
v_cvt_pk_bf16_f32 v87, v190, v191
v_mfma_f32_32x32x16_bf16 v[208:223], v[132:135], v[8:11], v[208:223]
s_waitcnt lgkmcnt(0)
buffer_store_dwordx4 v[100:103], v250, s[36:39], s58 offen offset:128 sc1
v_mfma_f32_32x32x16_bf16 v[192:207], v[128:131], v[8:11], v[192:207]
s_nop 0
v_mfma_f32_32x32x16_bf16 v[208:223], v[140:143], v[12:15], v[208:223]
s_nop 6
v_mfma_f32_32x32x16_bf16 v[192:207], v[136:139], v[12:15], v[192:207]
s_nop 2
v_mfma_f32_32x32x16_bf16 v[144:159], a[0:3], a[228:231], 0
v_rcp_f32_e64 v217, v216
ds_read_b64_tr_b16 a[0:1], v249
v_mul_f32_e64 v208, v217, v208
v_mfma_f32_32x32x16_bf16 v[160:175], a[4:7], a[228:231], 0
v_mul_f32_e32 v209, v217, v209
v_mul_f32_e32 v210, v217, v210
v_mul_f32_e64 v211, v217, v211
v_cvt_pk_bf16_f32 v208, v208, v209
v_mul_f32_e32 v192, v217, v192
v_mul_f32_e32 v193, v217, v193
v_mfma_f32_32x32x16_bf16 v[176:191], a[8:11], a[228:231], 0
ds_read_b128 a[228:231], v245 offset:8192
v_mul_f32_e32 v194, v217, v194
v_mul_f32_e32 v195, v217, v195
v_cvt_pk_bf16_f32 v192, v192, v193
v_mul_f32_e32 v196, v217, v196
v_mul_f32_e32 v197, v217, v197
v_mfma_f32_32x32x16_bf16 v[144:159], a[12:15], a[232:235], v[144:159]
v_mul_f32_e32 v198, v217, v198
v_mul_f32_e32 v199, v217, v199
v_cvt_pk_bf16_f32 v193, v194, v195
v_cvt_pk_bf16_f32 v194, v196, v197
v_cvt_pk_bf16_f32 v195, v198, v199
v_mul_f32_e64 v200, v217, v200
v_mfma_f32_32x32x16_bf16 v[160:175], a[16:19], a[232:235], v[160:175]
ds_write_b128 v247, v[192:195] offset:51200
v_mul_f32_e64 v201, v217, v201
v_mfma_f32_32x32x16_bf16 v[176:191], a[20:23], a[232:235], v[176:191]
v_mul_f32_e32 v202, v217, v202
v_mul_f32_e32 v203, v217, v203
v_cvt_pk_bf16_f32 v200, v200, v201
v_mul_f32_e32 v204, v217, v204
v_mul_f32_e32 v205, v217, v205
v_mul_f32_e64 v206, v217, v206
v_mfma_f32_32x32x16_bf16 v[144:159], a[24:27], a[236:239], v[144:159]
ds_read_b128 a[232:235], v244 offset:16384
v_mul_f32_e64 v207, v217, v207
v_cvt_pk_bf16_f32 v201, v202, v203
v_cvt_pk_bf16_f32 v202, v204, v205
v_cvt_pk_bf16_f32 v203, v206, v207
v_mul_f32_e64 v212, v217, v212
v_mfma_f32_32x32x16_bf16 v[160:175], a[28:31], a[236:239], v[160:175]
ds_write_b128 v247, v[200:203] offset:51232
v_mul_f32_e64 v213, v217, v213
v_mfma_f32_32x32x16_bf16 v[176:191], a[32:35], a[236:239], v[176:191]
v_mul_f32_e32 v214, v217, v214
v_mul_f32_e32 v215, v217, v215
v_cvt_pk_bf16_f32 v209, v210, v211
v_cvt_pk_bf16_f32 v210, v212, v213
v_cvt_pk_bf16_f32 v211, v214, v215
v_mfma_f32_32x32x16_bf16 v[144:159], a[36:39], a[240:243], v[144:159]
ds_read_b128 a[236:239], v245 offset:16384
ds_write_b128 v247, v[208:211] offset:51264
v_mfma_f32_32x32x16_bf16 v[160:175], a[40:43], a[240:243], v[160:175]
buffer_store_dwordx4 v[108:111], v250, s[36:39], s76 offen offset:128 sc1
ds_read_b64_tr_b16 a[2:3], v249 offset:1536
v_mfma_f32_32x32x16_bf16 v[176:191], a[44:47], a[240:243], v[176:191]
s_add_u32 s76, s60, 0x2a000
ds_read_b128 a[240:243], v240 offset:20480
ds_read_b64_tr_b16 a[4:5], v249 offset:64
ds_read_b64_tr_b16 a[6:7], v249 offset:1600
ds_read_b64_tr_b16 a[8:9], v249 offset:128
v_mfma_f32_32x32x16_bf16 v[144:159], a[48:51], a[244:247], v[144:159]
ds_read_b64_tr_b16 a[10:11], v249 offset:1664
ds_read_b64_tr_b16 a[12:13], v249 offset:3072
ds_read_b64_tr_b16 a[14:15], v249 offset:4608
ds_read_b64_tr_b16 a[16:17], v249 offset:3136
v_mfma_f32_32x32x16_bf16 v[160:175], a[52:55], a[244:247], v[160:175]
ds_read_b64_tr_b16 a[18:19], v249 offset:4672
ds_read_b64_tr_b16 a[20:21], v249 offset:3200
ds_read_b64_tr_b16 a[22:23], v249 offset:4736
v_mfma_f32_32x32x16_bf16 v[176:191], a[56:59], a[244:247], v[176:191]
ds_read_b128 a[244:247], v241 offset:20480
ds_read_b64_tr_b16 a[24:25], v249 offset:6144
ds_read_b64_tr_b16 a[26:27], v249 offset:7680
v_mfma_f32_32x32x16_bf16 v[144:159], a[60:63], a[248:251], v[144:159]
ds_read_b64_tr_b16 a[28:29], v249 offset:6208
ds_read_b64_tr_b16 a[30:31], v249 offset:7744
v_mfma_f32_32x32x16_bf16 v[160:175], a[64:67], a[248:251], v[160:175]
ds_read_b64_tr_b16 a[32:33], v249 offset:6272
ds_read_b64_tr_b16 a[34:35], v249 offset:7808
ds_read_b64_tr_b16 a[36:37], v249 offset:9216
ds_read_b64_tr_b16 a[38:39], v249 offset:10752
v_mfma_f32_32x32x16_bf16 v[176:191], a[68:71], a[248:251], v[176:191]
ds_read_b128 a[248:251], v244 offset:2048
ds_read_b64_tr_b16 a[40:41], v249 offset:9280
ds_read_b64_tr_b16 a[42:43], v249 offset:10816
v_mfma_f32_32x32x16_bf16 v[16:31], v[116:119], v[32:35], 0
ds_read_b64_tr_b16 a[44:45], v249 offset:9344
ds_read_b64_tr_b16 a[46:47], v249 offset:10880
ds_read_b64_tr_b16 a[48:49], v249 offset:12288
v_mov_b32_e32 v118, s19
v_mov_b32_e32 v119, s19
v_mfma_f32_32x32x16_bf16 v[0:15], v[112:115], v[32:35], 0
ds_read_b128 v[32:35], v248
ds_read_b64_tr_b16 a[50:51], v249 offset:13824
ds_read_b64_tr_b16 a[52:53], v249 offset:12352
ds_read_b64_tr_b16 a[54:55], v249 offset:13888
v_mfma_f32_32x32x16_bf16 v[16:31], v[124:127], v[36:39], v[16:31]
ds_read_b64_tr_b16 a[56:57], v249 offset:12416
ds_read_b64_tr_b16 a[58:59], v249 offset:13952
v_mov_b32_e32 v126, s19
v_mov_b32_e32 v127, s19
v_mfma_f32_32x32x16_bf16 v[0:15], v[120:123], v[36:39], v[0:15]
ds_read_b128 v[36:39], v248 offset:192
ds_read_b64_tr_b16 a[60:61], v249 offset:15360
ds_read_b64_tr_b16 a[62:63], v249 offset:16896
ds_read_b64_tr_b16 a[64:65], v249 offset:15424
v_mfma_f32_32x32x16_bf16 v[16:31], v[132:135], v[40:43], v[16:31]
ds_read_b64_tr_b16 a[66:67], v249 offset:16960
ds_read_b64_tr_b16 a[68:69], v249 offset:15488
v_mov_b32_e32 v134, s19
v_mov_b32_e32 v135, s19
v_mfma_f32_32x32x16_bf16 v[0:15], v[128:131], v[40:43], v[0:15]
ds_read_b128 v[40:43], v248 offset:384
ds_read_b64_tr_b16 a[70:71], v249 offset:17024
v_mfma_f32_32x32x16_bf16 v[16:31], v[140:143], v[44:47], v[16:31]
v_mov_b32_e64 v142, s19
v_mov_b32_e32 v143, s19
s_nop 3
v_mfma_f32_32x32x16_bf16 v[0:15], v[136:139], v[44:47], v[0:15]
s_nop 0
ds_read_b128 v[44:47], v248 offset:576
s_nop 2
v_mfma_f32_32x32x16_bf16 v[144:159], a[72:75], a[252:255], v[144:159]
ds_read_b128 v[28:31], v248 offset:2112
v_rcp_f32_e64 v25, v24
ds_read_b64_tr_b16 a[72:73], v249 offset:18432
v_mfma_f32_32x32x16_bf16 v[160:175], a[76:79], a[252:255], v[160:175]
v_mul_f32_e32 v16, v25, v16
v_mul_f32_e32 v17, v25, v17
v_mul_f32_e32 v18, v25, v18
v_mul_f32_e32 v0, v25, v0
v_mul_f32_e32 v1, v25, v1
v_mul_f32_e32 v8, v25, v8
v_mfma_f32_32x32x16_bf16 v[176:191], a[80:83], a[252:255], v[176:191]
ds_read_b128 a[252:255], v245 offset:2048
v_mul_f32_e32 v9, v25, v9
v_mul_f32_e32 v2, v25, v2
v_mul_f32_e64 v3, v25, v3
v_cvt_pk_bf16_f32 v0, v0, v1
v_mul_f32_e64 v10, v25, v10
v_mfma_f32_32x32x16_bf16 v[144:159], a[84:87], v[232:235], v[144:159]
v_mul_f32_e64 v11, v25, v11
v_cvt_pk_bf16_f32 v8, v8, v9
v_mul_f32_e32 v4, v25, v4
v_mul_f32_e32 v5, v25, v5
v_mul_f32_e32 v6, v25, v6
v_mul_f32_e32 v7, v25, v7
v_mfma_f32_32x32x16_bf16 v[160:175], a[88:91], v[232:235], v[160:175]
v_cvt_pk_bf16_f32 v1, v2, v3
v_mul_f32_e32 v12, v25, v12
v_mul_f32_e32 v13, v25, v13
v_mul_f32_e32 v14, v25, v14
v_mul_f32_e32 v15, v25, v15
v_cvt_pk_bf16_f32 v9, v10, v11
v_mfma_f32_32x32x16_bf16 v[176:191], a[92:95], v[232:235], v[176:191]
ds_read_b128 v[232:235], v244 offset:10240
v_cvt_pk_bf16_f32 v2, v4, v5
v_cvt_pk_bf16_f32 v3, v6, v7
v_cvt_pk_bf16_f32 v10, v12, v13
v_cvt_pk_bf16_f32 v11, v14, v15
v_mul_f32_e64 v19, v25, v19
v_mfma_f32_16x16x32_bf16 v[192:195], a[216:219], a[144:147], 0
ds_read_b128 v[4:7], v248 offset:960
ds_read_b128 v[12:15], v248 offset:1344
v_mfma_f32_16x16x32_bf16 v[196:199], a[216:219], a[148:151], 0
v_cvt_pk_bf16_f32 v16, v16, v17
v_mul_f32_e64 v20, v25, v20
v_mfma_f32_16x16x32_bf16 v[200:203], a[216:219], a[152:155], 0
ds_read_b128 a[216:219], v245 offset:10240
v_mul_f32_e64 v21, v25, v21
v_mfma_f32_16x16x32_bf16 v[192:195], a[220:223], a[156:159], v[192:195]
v_mul_f32_e32 v22, v25, v22
v_mul_f32_e32 v23, v25, v23
v_mfma_f32_16x16x32_bf16 v[196:199], a[220:223], a[160:163], v[196:199]
ds_read_b128 v[24:27], v248 offset:1920
v_cvt_pk_bf16_f32 v17, v18, v19
v_mfma_f32_16x16x32_bf16 v[200:203], a[220:223], a[164:167], v[200:203]
ds_read_b128 a[220:223], v244 offset:18432
v_cvt_pk_bf16_f32 v18, v20, v21
v_mfma_f32_16x16x32_bf16 v[192:195], a[224:227], a[168:171], v[192:195]
v_cvt_pk_bf16_f32 v19, v22, v23
v_mfma_f32_16x16x32_bf16 v[196:199], a[224:227], a[172:175], v[196:199]
s_nop 0
ds_read_b128 v[20:23], v248 offset:1728
ds_read_b64_tr_b16 a[74:75], v249 offset:19968
v_mfma_f32_16x16x32_bf16 v[200:203], a[224:227], a[176:179], v[200:203]
s_waitcnt lgkmcnt(7)
ds_read_b128 a[224:227], v245 offset:18432
ds_read_b64_tr_b16 a[76:77], v249 offset:18496
v_mfma_f32_16x16x32_bf16 v[192:195], a[228:231], a[180:183], v[192:195]
ds_read_b64_tr_b16 a[78:79], v249 offset:20032
ds_read_b64_tr_b16 a[80:81], v249 offset:18560
v_mfma_f32_16x16x32_bf16 v[196:199], a[228:231], a[184:187], v[196:199]
ds_read_b64_tr_b16 a[82:83], v249 offset:20096
ds_read_b64_tr_b16 a[84:85], v249 offset:21504
v_mfma_f32_16x16x32_bf16 v[200:203], a[228:231], a[188:191], v[200:203]
ds_read_b128 a[228:231], v242 offset:20480
v_mfma_f32_16x16x32_bf16 v[192:195], a[232:235], a[192:195], v[192:195]
ds_read_b64_tr_b16 a[86:87], v249 offset:23040
ds_read_b64_tr_b16 a[88:89], v249 offset:21568
v_mfma_f32_16x16x32_bf16 v[196:199], a[232:235], a[196:199], v[196:199]
ds_read_b64_tr_b16 a[90:91], v249 offset:23104
ds_read_b64_tr_b16 a[92:93], v249 offset:21632
v_mfma_f32_16x16x32_bf16 v[200:203], a[232:235], a[200:203], v[200:203]
ds_read_b128 a[232:235], v243 offset:20480
v_mfma_f32_16x16x32_bf16 v[192:195], a[236:239], a[204:207], v[192:195]
ds_read_b64_tr_b16 a[94:95], v249 offset:23168
s_nop 0
v_mfma_f32_16x16x32_bf16 v[196:199], a[236:239], a[208:211], v[196:199]
s_nop 2
v_mfma_f32_16x16x32_bf16 v[200:203], a[236:239], a[212:215], v[200:203]
ds_read_b128 a[236:239], v244 offset:4096
v_cvt_pk_bf16_f32 v112, v192, v193
v_mfma_f32_32x32x16_bf16 v[144:159], a[96:99], a[240:243], v[144:159]
v_cvt_pk_bf16_f32 v113, v194, v195
v_cvt_pk_bf16_f32 v114, v196, v197
v_cvt_pk_bf16_f32 v115, v198, v199
ds_read_b64_tr_b16 a[96:97], v249 offset:24576
v_mfma_f32_32x32x16_bf16 v[160:175], a[100:103], a[240:243], v[160:175]
ds_write_b128 v247, v[0:3] offset:64000
v_cvt_pk_bf16_f32 v116, v200, v201
v_mfma_f32_32x32x16_bf16 v[176:191], a[104:107], a[240:243], v[176:191]
v_cvt_pk_bf16_f32 v117, v202, v203
v_permlane16_swap_b32_e32 v116, v118
v_permlane16_swap_b32_e32 v112, v114
v_mfma_f32_32x32x16_bf16 v[144:159], a[108:111], a[244:247], v[144:159]
ds_read_b128 a[240:243], v245 offset:4096
ds_write_b128 v247, v[8:11] offset:64032
v_mfma_f32_32x32x16_bf16 v[160:175], a[112:115], a[244:247], v[160:175]
v_permlane16_swap_b32_e32 v117, v119
v_permlane16_swap_b32_e32 v113, v115
v_mfma_f32_32x32x16_bf16 v[176:191], a[116:119], a[244:247], v[176:191]
ds_read_b128 a[244:247], v244 offset:12288
ds_read_b128 v[0:3], v248 offset:768
ds_read_b128 v[8:11], v248 offset:1152
ds_read_b64_tr_b16 a[98:99], v249 offset:26112
v_mfma_f32_16x16x32_bf16 v[204:207], a[248:251], a[144:147], 0
ds_read_b64_tr_b16 a[100:101], v249 offset:24640
v_mfma_f32_16x16x32_bf16 v[208:211], a[248:251], a[148:151], 0
ds_read_b64_tr_b16 a[102:103], v249 offset:26176
ds_read_b64_tr_b16 a[104:105], v249 offset:24704
v_mfma_f32_16x16x32_bf16 v[212:215], a[248:251], a[152:155], 0
ds_read_b128 a[248:251], v245 offset:12288
v_mfma_f32_16x16x32_bf16 v[204:207], a[252:255], a[156:159], v[204:207]
ds_read_b64_tr_b16 a[106:107], v249 offset:26240
ds_read_b64_tr_b16 a[108:109], v249 offset:27648
v_mfma_f32_16x16x32_bf16 v[208:211], a[252:255], a[160:163], v[208:211]
ds_read_b64_tr_b16 a[110:111], v249 offset:29184
ds_read_b64_tr_b16 a[112:113], v249 offset:27712
v_mfma_f32_16x16x32_bf16 v[212:215], a[252:255], a[164:167], v[212:215]
ds_read_b128 a[252:255], v244 offset:20480
v_mfma_f32_16x16x32_bf16 v[204:207], v[232:235], a[168:171], v[204:207]
ds_read_b64_tr_b16 a[114:115], v249 offset:29248
v_mfma_f32_16x16x32_bf16 v[208:211], v[232:235], a[172:175], v[208:211]
ds_read_b64_tr_b16 a[116:117], v249 offset:27776
ds_read_b64_tr_b16 a[118:119], v249 offset:29312
v_mfma_f32_16x16x32_bf16 v[212:215], v[232:235], a[176:179], v[212:215]
s_waitcnt lgkmcnt(14)
ds_read_b128 v[232:235], v245 offset:20480
v_mfma_f32_16x16x32_bf16 v[204:207], a[216:219], a[180:183], v[204:207]
s_nop 0
v_mfma_f32_16x16x32_bf16 v[208:211], a[216:219], a[184:187], v[208:211]
v_mfma_f32_16x16x32_bf16 v[212:215], a[216:219], a[188:191], v[212:215]
ds_read_b128 a[216:219], v244 offset:6144
v_mfma_f32_16x16x32_bf16 v[204:207], a[220:223], a[192:195], v[204:207]
v_mfma_f32_16x16x32_bf16 v[208:211], a[220:223], a[196:199], v[208:211]
v_mfma_f32_16x16x32_bf16 v[212:215], a[220:223], a[200:203], v[212:215]
ds_read_b128 a[220:223], v245 offset:6144
v_mfma_f32_16x16x32_bf16 v[204:207], a[224:227], a[204:207], v[204:207]
s_nop 2
v_mfma_f32_16x16x32_bf16 v[208:211], a[224:227], a[208:211], v[208:211]
s_nop 2
v_mfma_f32_16x16x32_bf16 v[212:215], a[224:227], a[212:215], v[212:215]
ds_read_b128 a[224:227], v244 offset:14336
v_cvt_pk_bf16_f32 v120, v204, v205
v_mfma_f32_32x32x16_bf16 v[144:159], a[120:123], a[228:231], v[144:159]
ds_write_b128 v247, v[16:19] offset:64064
v_cvt_pk_bf16_f32 v121, v206, v207
v_mfma_f32_32x32x16_bf16 v[160:175], a[124:127], a[228:231], v[160:175]
v_cvt_pk_bf16_f32 v122, v208, v209
v_cvt_pk_bf16_f32 v123, v210, v211
v_cvt_pk_bf16_f32 v124, v212, v213
v_cvt_pk_bf16_f32 v125, v214, v215
v_permlane16_swap_b32_e64 v120, v122
v_mfma_f32_32x32x16_bf16 v[176:191], a[128:131], a[228:231], v[176:191]
ds_read_b128 a[228:231], v245 offset:14336
ds_read_b128 v[16:19], v248 offset:1536
ds_read_b64_tr_b16 a[120:121], v249 offset:30720
ds_read_b64_tr_b16 a[122:123], v249 offset:32256
v_permlane16_swap_b32_e64 v124, v126
v_mfma_f32_32x32x16_bf16 v[144:159], a[132:135], a[232:235], v[144:159]
ds_read_b64_tr_b16 a[124:125], v249 offset:30784
ds_read_b64_tr_b16 a[126:127], v249 offset:32320
ds_read_b64_tr_b16 a[128:129], v249 offset:30848
v_permlane16_swap_b32_e32 v125, v127
s_nop 0
v_mfma_f32_32x32x16_bf16 v[160:175], a[136:139], a[232:235], v[160:175]
ds_read_b64_tr_b16 a[130:131], v249 offset:32384
ds_read_b64_tr_b16 a[132:133], v249 offset:33792
ds_read_b64_tr_b16 a[134:135], v249 offset:35328
ds_read_b64_tr_b16 a[136:137], v249 offset:33856
v_permlane16_swap_b32_e64 v121, v123
v_mfma_f32_32x32x16_bf16 v[176:191], a[140:143], a[232:235], v[176:191]
ds_read_b128 a[232:235], v244 offset:22528
v_cvt_pk_bf16_f32 v88, v144, v145
v_cvt_pk_bf16_f32 v89, v146, v147
v_cvt_pk_bf16_f32 v90, v148, v149
v_cvt_pk_bf16_f32 v91, v150, v151
v_cvt_pk_bf16_f32 v92, v152, v153
v_mfma_f32_16x16x32_bf16 v[192:195], a[236:239], a[144:147], 0
v_cvt_pk_bf16_f32 v100, v168, v169
v_cvt_pk_bf16_f32 v101, v170, v171
v_mfma_f32_16x16x32_bf16 v[196:199], a[236:239], a[148:151], 0
v_cvt_pk_bf16_f32 v102, v172, v173
v_cvt_pk_bf16_f32 v103, v174, v175
v_mfma_f32_16x16x32_bf16 v[200:203], a[236:239], a[152:155], 0
ds_read_b128 a[236:239], v245 offset:22528
v_cvt_pk_bf16_f32 v104, v176, v177
v_mfma_f32_16x16x32_bf16 v[192:195], a[240:243], a[156:159], v[192:195]
v_cvt_pk_bf16_f32 v105, v178, v179
v_cvt_pk_bf16_f32 v106, v180, v181
v_mfma_f32_16x16x32_bf16 v[196:199], a[240:243], a[160:163], v[196:199]
v_cvt_pk_bf16_f32 v107, v182, v183
v_cvt_pk_bf16_f32 v108, v184, v185
v_mfma_f32_16x16x32_bf16 v[200:203], a[240:243], a[164:167], v[200:203]
v_cvt_pk_bf16_f32 v109, v186, v187
v_cvt_pk_bf16_f32 v110, v188, v189
v_mfma_f32_16x16x32_bf16 v[192:195], a[244:247], a[168:171], v[192:195]
v_cvt_pk_bf16_f32 v111, v190, v191
v_cvt_pk_bf16_f32 v93, v154, v155
v_mfma_f32_16x16x32_bf16 v[196:199], a[244:247], a[172:175], v[196:199]
s_nop 0
v_cvt_pk_bf16_f32 v94, v156, v157
v_cvt_pk_bf16_f32 v95, v158, v159
v_mfma_f32_16x16x32_bf16 v[200:203], a[244:247], a[176:179], v[200:203]
s_waitcnt lgkmcnt(1)
v_cvt_pk_bf16_f32 v96, v160, v161
v_cvt_pk_bf16_f32 v97, v162, v163
v_mfma_f32_16x16x32_bf16 v[192:195], a[248:251], a[180:183], v[192:195]
s_waitcnt lgkmcnt(0)
s_barrier
ds_read_b128 a[240:243], v246 offset:51200
v_mfma_f32_16x16x32_bf16 v[196:199], a[248:251], a[184:187], v[196:199]
ds_read_b128 a[244:247], v246 offset:51232
v_cvt_pk_bf16_f32 v98, v164, v165
v_mfma_f32_16x16x32_bf16 v[200:203], a[248:251], a[188:191], v[200:203]
ds_read_b128 a[248:251], v246 offset:51264
v_cvt_pk_bf16_f32 v99, v166, v167
v_mfma_f32_16x16x32_bf16 v[192:195], a[252:255], a[192:195], v[192:195]
ds_read_b64_tr_b16 a[138:139], v249 offset:35392
ds_read_b64_tr_b16 a[140:141], v249 offset:33920
v_mfma_f32_16x16x32_bf16 v[196:199], a[252:255], a[196:199], v[196:199]
ds_read_b64_tr_b16 a[142:143], v249 offset:35456
v_mfma_f32_16x16x32_bf16 v[200:203], a[252:255], a[200:203], v[200:203]
ds_read_b128 a[252:255], v246 offset:51296
v_mfma_f32_16x16x32_bf16 v[192:195], v[232:235], a[204:207], v[192:195]
s_nop 2
v_mfma_f32_16x16x32_bf16 v[196:199], v[232:235], a[208:211], v[196:199]
s_nop 2
v_mfma_f32_16x16x32_bf16 v[200:203], v[232:235], a[212:215], v[200:203]
ds_read_b128 v[232:235], v246 offset:51328
v_cvt_pk_bf16_f32 v128, v192, v193
v_mfma_f32_16x16x32_bf16 v[204:207], a[216:219], a[144:147], 0
v_cvt_pk_bf16_f32 v129, v194, v195
v_cvt_pk_bf16_f32 v130, v196, v197
v_mfma_f32_16x16x32_bf16 v[208:211], a[216:219], a[148:151], 0
v_cvt_pk_bf16_f32 v131, v198, v199
v_mfma_f32_16x16x32_bf16 v[212:215], a[216:219], a[152:155], 0
ds_read_b128 a[216:219], v246 offset:51360
v_cvt_pk_bf16_f32 v132, v200, v201
v_mfma_f32_16x16x32_bf16 v[204:207], a[220:223], a[156:159], v[204:207]
v_cvt_pk_bf16_f32 v133, v202, v203
s_nop 0
v_mfma_f32_16x16x32_bf16 v[208:211], a[220:223], a[160:163], v[208:211]
v_permlane16_swap_b32_e32 v132, v134
v_mfma_f32_16x16x32_bf16 v[212:215], a[220:223], a[164:167], v[212:215]
ds_read_b128 a[220:223], v246 offset:51392
v_mfma_f32_16x16x32_bf16 v[204:207], a[224:227], a[168:171], v[204:207]
v_permlane16_swap_b32_e64 v133, v135
v_mfma_f32_16x16x32_bf16 v[208:211], a[224:227], a[172:175], v[208:211]
v_permlane16_swap_b32_e64 v128, v130
v_mfma_f32_16x16x32_bf16 v[212:215], a[224:227], a[176:179], v[212:215]
ds_read_b128 a[224:227], v246 offset:51424
v_mfma_f32_16x16x32_bf16 v[204:207], a[228:231], a[180:183], v[204:207]
v_permlane16_swap_b32_e64 v129, v131
v_mfma_f32_16x16x32_bf16 v[208:211], a[228:231], a[184:187], v[208:211]
v_mfma_f32_16x16x32_bf16 v[212:215], a[228:231], a[188:191], v[212:215]
ds_read_b128 a[228:231], v246 offset:51456
v_mfma_f32_16x16x32_bf16 v[204:207], a[232:235], a[192:195], v[204:207]
v_mfma_f32_16x16x32_bf16 v[208:211], a[232:235], a[196:199], v[208:211]
v_mfma_f32_16x16x32_bf16 v[212:215], a[232:235], a[200:203], v[212:215]
ds_read_b128 a[232:235], v246 offset:51488
v_mfma_f32_16x16x32_bf16 v[204:207], a[236:239], a[204:207], v[204:207]
s_nop 2
v_mfma_f32_16x16x32_bf16 v[208:211], a[236:239], a[208:211], v[208:211]
s_nop 2
v_mfma_f32_16x16x32_bf16 v[212:215], a[236:239], a[212:215], v[212:215]
ds_read_b128 a[236:239], v246 offset:51520
v_cvt_pk_bf16_f32 v136, v204, v205
v_mfma_f32_32x32x16_bf16 v[0:15], v[76:79], v[64:67], v[0:15]
v_cvt_pk_bf16_f32 v137, v206, v207
v_cvt_pk_bf16_f32 v138, v208, v209
v_cvt_pk_bf16_f32 v139, v210, v211
s_nop 1
v_cvt_pk_bf16_f32 v140, v212, v213
v_mfma_f32_32x32x16_bf16 v[0:15], v[80:83], v[68:71], v[0:15]
s_nop 0
v_cvt_pk_bf16_f32 v141, v214, v215
v_permlane16_swap_b32_e32 v140, v142
v_permlane16_swap_b32_e32 v136, v138
v_mfma_f32_32x32x16_bf16 v[0:15], v[84:87], v[72:75], v[0:15]
v_permlane16_swap_b32_e32 v141, v143
v_permlane16_swap_b32_e32 v137, v139
s_nop 1
v_mfma_f32_32x32x16_bf16 v[16:31], v[100:103], v[64:67], v[16:31]
s_nop 5
v_mfma_f32_32x32x16_bf16 v[16:31], v[104:107], v[68:71], v[16:31]
v_max3_f32 v224, v0, v1, v2
v_max3_f32 v224, v224, v3, v4
v_max3_f32 v224, v224, v5, v6
v_max3_f32 v224, v224, v7, v8
v_max3_f32 v224, v224, v9, v10
v_max3_f32 v224, v224, v11, v12
v_mfma_f32_32x32x16_bf16 v[16:31], v[108:111], v[72:75], v[16:31]
v_max3_f32 v224, v224, v13, v14
v_max_f32_e64 v224, v224, v15
v_fma_f32 v224, v224, s70, v254
s_nop 2
v_mfma_f32_32x32x16_bf16 v[32:47], v[76:79], v[88:91], v[32:47]
s_nop 3
v_mfma_f32_32x32x16_bf16 v[32:47], v[80:83], v[92:95], v[32:47]
v_max3_f32 v225, v16, v17, v18
v_max3_f32 v225, v225, v19, v20
v_max3_f32 v225, v225, v21, v22
v_max3_f32 v225, v225, v23, v24
v_max3_f32 v225, v225, v25, v26
v_max3_f32 v225, v225, v27, v28
v_mfma_f32_32x32x16_bf16 v[32:47], v[84:87], v[96:99], v[32:47]
v_max3_f32 v225, v225, v29, v30
v_max_f32_e64 v225, v225, v31
v_fma_f32 v225, v225, s70, v255
v_max_f32_e64 v224, v224, v225
v_mov_b32_e32 v225, v224
s_nop 0
v_mfma_f32_32x32x16_bf16 v[48:63], v[100:103], v[88:91], v[48:63]
v_permlane32_swap_b32_e32 v224, v225
v_max_f32_e32 v224, v224, v225
v_sub_f32_e64 v226, v254, v224
v_fma_f32 v0, v0, s70, v226
v_fma_f32 v1, v1, s70, v226
v_mfma_f32_32x32x16_bf16 v[48:63], v[104:107], v[92:95], v[48:63]
v_exp_f32_e32 v0, v0
v_exp_f32_e32 v1, v1
v_fma_f32 v2, v2, s70, v226
v_fma_f32 v3, v3, s70, v226
v_mfma_f32_32x32x16_bf16 v[48:63], v[108:111], v[96:99], v[48:63]
s_waitcnt lgkmcnt(0)
v_exp_f32_e32 v2, v2
v_exp_f32_e64 v3, v3
v_fma_f32 v4, v4, s70, v226
v_fma_f32 v5, v5, s70, v226
v_mfma_f32_32x32x16_bf16 v[64:79], a[0:3], a[240:243], 0
v_fma_f32 v6, v6, s70, v226
v_fma_f32 v7, v7, s70, v226
v_exp_f32_e32 v4, v4
v_exp_f32_e32 v5, v5
v_mfma_f32_32x32x16_bf16 v[80:95], a[4:7], a[240:243], 0
v_exp_f32_e32 v6, v6
v_exp_f32_e32 v7, v7
v_cvt_pk_bf16_f32 v0, v0, v1
v_cvt_pk_bf16_f32 v1, v2, v3
v_mfma_f32_32x32x16_bf16 v[96:111], a[8:11], a[240:243], 0
ds_read_b128 a[240:243], v246 offset:51552
v_cvt_pk_bf16_f32 v2, v4, v5
v_cvt_pk_bf16_f32 v3, v6, v7
v_fma_f32 v8, v8, s70, v226
v_fma_f32 v9, v9, s70, v226
v_fma_f32 v10, v10, s70, v226
v_mfma_f32_32x32x16_bf16 v[64:79], a[12:15], a[244:247], v[64:79]
v_fma_f32 v11, v11, s70, v226
v_fma_f32 v12, v12, s70, v226
v_fma_f32 v13, v13, s70, v226
v_fma_f32 v14, v14, s70, v226
v_fma_f32 v15, v15, s70, v226
v_sub_f32_e64 v227, v255, v224
v_mfma_f32_32x32x16_bf16 v[80:95], a[16:19], a[244:247], v[80:95]
v_exp_f32_e32 v8, v8
v_exp_f32_e32 v9, v9
v_exp_f32_e64 v10, v10
v_mfma_f32_32x32x16_bf16 v[96:111], a[20:23], a[244:247], v[96:111]
v_exp_f32_e32 v11, v11
v_exp_f32_e32 v12, v12
v_exp_f32_e64 v13, v13
v_mfma_f32_32x32x16_bf16 v[64:79], a[24:27], a[248:251], v[64:79]
v_exp_f32_e32 v14, v14
v_exp_f32_e32 v15, v15
v_cvt_pk_bf16_f32 v4, v8, v9
v_cvt_pk_bf16_f32 v5, v10, v11
v_mfma_f32_32x32x16_bf16 v[80:95], a[28:31], a[248:251], v[80:95]
v_cvt_pk_bf16_f32 v6, v12, v13
v_cvt_pk_bf16_f32 v7, v14, v15
v_fma_f32 v16, v16, s70, v227
v_fma_f32 v17, v17, s70, v227
v_fma_f32 v18, v18, s70, v227
v_fma_f32 v19, v19, s70, v227
v_mfma_f32_32x32x16_bf16 v[96:111], a[32:35], a[248:251], v[96:111]
v_fma_f32 v20, v20, s70, v227
v_fma_f32 v21, v21, s70, v227
v_fma_f32 v22, v22, s70, v227
v_fma_f32 v23, v23, s70, v227
v_exp_f32_e64 v16, v16
v_mfma_f32_32x32x16_bf16 v[64:79], a[36:39], a[252:255], v[64:79]
v_exp_f32_e32 v17, v17
v_exp_f32_e32 v18, v18
v_exp_f32_e64 v19, v19
v_mfma_f32_32x32x16_bf16 v[80:95], a[40:43], a[252:255], v[80:95]
v_exp_f32_e32 v20, v20
v_exp_f32_e32 v21, v21
v_exp_f32_e64 v22, v22
v_mfma_f32_32x32x16_bf16 v[96:111], a[44:47], a[252:255], v[96:111]
v_exp_f32_e64 v23, v23
v_cvt_pk_bf16_f32 v8, v16, v17
v_cvt_pk_bf16_f32 v9, v18, v19
v_cvt_pk_bf16_f32 v10, v20, v21
v_cvt_pk_bf16_f32 v11, v22, v23
v_mfma_f32_32x32x16_bf16 v[64:79], a[48:51], v[232:235], v[64:79]
v_max3_f32 v224, v32, v33, v34
v_max3_f32 v225, v48, v49, v50
v_max3_f32 v224, v224, v35, v36
v_max3_f32 v225, v225, v51, v52
v_fma_f32 v24, v24, s70, v227
v_fma_f32 v25, v25, s70, v227
v_mfma_f32_32x32x16_bf16 v[80:95], a[52:55], v[232:235], v[80:95]
v_fma_f32 v26, v26, s70, v227
v_fma_f32 v27, v27, s70, v227
v_fma_f32 v28, v28, s70, v227
v_fma_f32 v29, v29, s70, v227
v_fma_f32 v30, v30, s70, v227
v_fma_f32 v31, v31, s70, v227
v_mfma_f32_32x32x16_bf16 v[96:111], a[56:59], v[232:235], v[96:111]
v_max3_f32 v224, v224, v37, v38
v_max3_f32 v225, v225, v53, v54
v_exp_f32_e32 v24, v24
v_exp_f32_e32 v25, v25
v_mfma_f32_32x32x16_bf16 v[64:79], a[60:63], a[216:219], v[64:79]
v_exp_f32_e32 v26, v26
v_exp_f32_e32 v27, v27
v_exp_f32_e64 v28, v28
v_mfma_f32_32x32x16_bf16 v[80:95], a[64:67], a[216:219], v[80:95]
v_exp_f32_e32 v29, v29
v_exp_f32_e32 v30, v30
v_exp_f32_e64 v31, v31
v_mfma_f32_32x32x16_bf16 v[96:111], a[68:71], a[216:219], v[96:111]
v_max3_f32 v224, v224, v39, v40
v_max3_f32 v225, v225, v55, v56
v_max3_f32 v224, v224, v41, v42
v_max3_f32 v225, v225, v57, v58
v_max3_f32 v224, v224, v43, v44
v_max3_f32 v225, v225, v59, v60
v_mfma_f32_32x32x16_bf16 v[64:79], a[72:75], a[220:223], v[64:79]
v_cvt_pk_bf16_f32 v12, v24, v25
v_cvt_pk_bf16_f32 v13, v26, v27
v_cvt_pk_bf16_f32 v14, v28, v29
v_cvt_pk_bf16_f32 v15, v30, v31
v_max3_f32 v224, v224, v45, v46
v_max3_f32 v225, v225, v61, v62
v_mfma_f32_32x32x16_bf16 v[80:95], a[76:79], a[220:223], v[80:95]
v_max_f32_e32 v224, v224, v47
v_max_f32_e32 v225, v225, v63
v_fma_f32 v224, v224, s70, v255
v_fma_f32 v225, v225, s70, v254
v_max_f32_e32 v224, v224, v225
v_mov_b32_e32 v225, v224
v_mfma_f32_32x32x16_bf16 v[96:111], a[80:83], a[220:223], v[96:111]
s_nop 0
v_permlane32_swap_b32_e32 v224, v225
v_max_f32_e32 v224, v224, v225
v_sub_f32_e32 v228, v255, v224
v_fma_f32 v32, v32, s70, v228
v_fma_f32 v33, v33, s70, v228
v_mfma_f32_32x32x16_bf16 v[64:79], a[84:87], a[224:227], v[64:79]
v_exp_f32_e32 v32, v32
v_exp_f32_e32 v33, v33
v_fma_f32 v34, v34, s70, v228
v_fma_f32 v35, v35, s70, v228
v_mfma_f32_32x32x16_bf16 v[80:95], a[88:91], a[224:227], v[80:95]
v_exp_f32_e32 v34, v34
v_exp_f32_e32 v35, v35
v_fma_f32 v36, v36, s70, v228
v_fma_f32 v37, v37, s70, v228
v_mfma_f32_32x32x16_bf16 v[96:111], a[92:95], a[224:227], v[96:111]
v_fma_f32 v38, v38, s70, v228
v_fma_f32 v39, v39, s70, v228
v_exp_f32_e32 v36, v36
v_exp_f32_e32 v37, v37
v_mfma_f32_32x32x16_bf16 v[64:79], a[96:99], a[228:231], v[64:79]
v_exp_f32_e32 v38, v38
v_exp_f32_e32 v39, v39
v_cvt_pk_bf16_f32 v32, v32, v33
v_cvt_pk_bf16_f32 v33, v34, v35
v_mfma_f32_32x32x16_bf16 v[80:95], a[100:103], a[228:231], v[80:95]
v_cvt_pk_bf16_f32 v34, v36, v37
v_cvt_pk_bf16_f32 v35, v38, v39
v_fma_f32 v40, v40, s70, v228
v_fma_f32 v41, v41, s70, v228
v_fma_f32 v42, v42, s70, v228
v_fma_f32 v43, v43, s70, v228
v_mfma_f32_32x32x16_bf16 v[96:111], a[104:107], a[228:231], v[96:111]
v_fma_f32 v44, v44, s70, v228
v_fma_f32 v45, v45, s70, v228
v_fma_f32 v46, v46, s70, v228
v_fma_f32 v47, v47, s70, v228
v_exp_f32_e64 v40, v40
v_mfma_f32_32x32x16_bf16 v[64:79], a[108:111], a[232:235], v[64:79]
v_exp_f32_e32 v41, v41
v_exp_f32_e32 v42, v42
v_exp_f32_e64 v43, v43
v_mfma_f32_32x32x16_bf16 v[80:95], a[112:115], a[232:235], v[80:95]
v_exp_f32_e32 v44, v44
v_exp_f32_e32 v45, v45
v_exp_f32_e64 v46, v46
v_mfma_f32_32x32x16_bf16 v[96:111], a[116:119], a[232:235], v[96:111]
v_exp_f32_e64 v47, v47
v_cvt_pk_bf16_f32 v36, v40, v41
v_cvt_pk_bf16_f32 v37, v42, v43
v_cvt_pk_bf16_f32 v38, v44, v45
v_cvt_pk_bf16_f32 v39, v46, v47
v_mfma_f32_32x32x16_bf16 v[64:79], a[120:123], a[236:239], v[64:79]
v_sub_f32_e64 v229, v254, v224
v_fma_f32 v48, v48, s70, v229
v_fma_f32 v49, v49, s70, v229
v_fma_f32 v50, v50, s70, v229
v_fma_f32 v51, v51, s70, v229
v_fma_f32 v52, v52, s70, v229
v_mfma_f32_32x32x16_bf16 v[80:95], a[124:127], a[236:239], v[80:95]
v_fma_f32 v53, v53, s70, v229
v_fma_f32 v54, v54, s70, v229
v_fma_f32 v55, v55, s70, v229
v_exp_f32_e64 v48, v48
v_fma_f32 v56, v56, s70, v229
v_mfma_f32_32x32x16_bf16 v[96:111], a[128:131], a[236:239], v[96:111]
s_waitcnt lgkmcnt(0)
v_exp_f32_e32 v49, v49
v_exp_f32_e32 v50, v50
v_exp_f32_e32 v51, v51
v_mfma_f32_32x32x16_bf16 v[64:79], a[132:135], a[240:243], v[64:79]
v_exp_f32_e32 v52, v52
v_exp_f32_e32 v53, v53
v_exp_f32_e64 v54, v54
v_mfma_f32_32x32x16_bf16 v[80:95], a[136:139], a[240:243], v[80:95]
v_exp_f32_e64 v55, v55
v_cvt_pk_bf16_f32 v40, v48, v49
v_cvt_pk_bf16_f32 v41, v50, v51
v_cvt_pk_bf16_f32 v42, v52, v53
v_cvt_pk_bf16_f32 v43, v54, v55
v_mfma_f32_32x32x16_bf16 v[96:111], a[140:143], a[240:243], v[96:111]
v_fma_f32 v57, v57, s70, v229
v_fma_f32 v58, v58, s70, v229
v_fma_f32 v59, v59, s70, v229
v_fma_f32 v60, v60, s70, v229
v_fma_f32 v61, v61, s70, v229
v_fma_f32 v62, v62, s70, v229
v_mfma_f32_32x32x16_bf16 v[208:223], v[116:119], v[0:3], 0
v_fma_f32 v63, v63, s70, v229
v_exp_f32_e32 v56, v56
v_exp_f32_e32 v57, v57
v_cvt_pk_bf16_f32 v64, v64, v65
v_mfma_f32_32x32x16_bf16 v[192:207], v[112:115], v[0:3], 0
v_exp_f32_e32 v58, v58
v_exp_f32_e32 v59, v59
v_exp_f32_e64 v60, v60
v_mfma_f32_32x32x16_bf16 v[208:223], v[124:127], v[4:7], v[208:223]
v_exp_f32_e32 v61, v61
v_exp_f32_e32 v62, v62
v_exp_f32_e64 v63, v63
v_mfma_f32_32x32x16_bf16 v[192:207], v[120:123], v[4:7], v[192:207]
v_cvt_pk_bf16_f32 v44, v56, v57
v_cvt_pk_bf16_f32 v45, v58, v59
v_cvt_pk_bf16_f32 v46, v60, v61
v_cvt_pk_bf16_f32 v47, v62, v63
v_cvt_pk_bf16_f32 v72, v72, v73
v_cvt_pk_bf16_f32 v65, v66, v67
v_mfma_f32_32x32x16_bf16 v[208:223], v[132:135], v[8:11], v[208:223]
v_cvt_pk_bf16_f32 v73, v74, v75
v_cvt_pk_bf16_f32 v66, v68, v69
v_cvt_pk_bf16_f32 v67, v70, v71
v_cvt_pk_bf16_f32 v74, v76, v77
v_cvt_pk_bf16_f32 v75, v78, v79
v_cvt_pk_bf16_f32 v80, v80, v81
v_mfma_f32_32x32x16_bf16 v[192:207], v[128:131], v[8:11], v[192:207]
ds_write_b128 v230, v[64:67] offset:25600
v_cvt_pk_bf16_f32 v88, v88, v89
v_mfma_f32_32x32x16_bf16 v[208:223], v[140:143], v[12:15], v[208:223]
v_cvt_pk_bf16_f32 v81, v82, v83
v_cvt_pk_bf16_f32 v89, v90, v91
v_cvt_pk_bf16_f32 v82, v84, v85
v_cvt_pk_bf16_f32 v83, v86, v87
v_cvt_pk_bf16_f32 v90, v92, v93
v_cvt_pk_bf16_f32 v91, v94, v95
v_mfma_f32_32x32x16_bf16 v[192:207], v[136:139], v[12:15], v[192:207]
ds_write_b128 v230, v[72:75] offset:25632
v_cvt_pk_bf16_f32 v96, v96, v97
v_mfma_f32_32x32x16_bf16 v[16:31], v[116:119], v[32:35], 0
v_cvt_pk_bf16_f32 v104, v104, v105
v_cvt_pk_bf16_f32 v97, v98, v99
v_rcp_f32_e64 v217, v216
v_cvt_pk_bf16_f32 v105, v106, v107
v_mul_f32_e64 v208, v217, v208
v_mfma_f32_32x32x16_bf16 v[0:15], v[112:115], v[32:35], 0
ds_read_b128 v[68:71], v231 offset:25600
ds_read_b128 v[76:79], v231 offset:32000
v_mul_f32_e32 v209, v217, v209
v_mul_f32_e32 v192, v217, v192
v_mul_f32_e32 v193, v217, v193
v_mul_f32_e32 v200, v217, v200
v_mfma_f32_32x32x16_bf16 v[16:31], v[124:127], v[36:39], v[16:31]
ds_write_b128 v230, v[80:83] offset:25664
v_mul_f32_e64 v201, v217, v201
v_mfma_f32_32x32x16_bf16 v[0:15], v[120:123], v[36:39], v[0:15]
v_mul_f32_e32 v210, v217, v210
v_mul_f32_e32 v211, v217, v211
v_cvt_pk_bf16_f32 v208, v208, v209
v_mul_f32_e32 v194, v217, v194
v_mul_f32_e32 v195, v217, v195
v_cvt_pk_bf16_f32 v192, v192, v193
v_mfma_f32_32x32x16_bf16 v[16:31], v[132:135], v[40:43], v[16:31]
ds_write_b128 v230, v[88:91] offset:25696
v_mul_f32_e32 v202, v217, v202
v_mfma_f32_32x32x16_bf16 v[0:15], v[128:131], v[40:43], v[0:15]
s_waitcnt lgkmcnt(3)
buffer_store_dwordx4 v[68:71], v251, s[36:39], s59 offen sc1
ds_read_b128 v[84:87], v231 offset:25664
v_mfma_f32_32x32x16_bf16 v[16:31], v[140:143], v[44:47], v[16:31]
v_mul_f32_e64 v203, v217, v203
v_cvt_pk_bf16_f32 v200, v200, v201
v_mul_f32_e32 v212, v217, v212
v_mul_f32_e32 v213, v217, v213
v_mul_f32_e32 v214, v217, v214
v_mul_f32_e32 v215, v217, v215
v_mfma_f32_32x32x16_bf16 v[0:15], v[136:139], v[44:47], v[0:15]
v_cvt_pk_bf16_f32 v209, v210, v211
v_mul_f32_e32 v196, v217, v196
v_mul_f32_e32 v197, v217, v197
v_mul_f32_e32 v198, v217, v198
v_mul_f32_e32 v199, v217, v199
v_cvt_pk_bf16_f32 v193, v194, v195
v_rcp_f32_e32 v25, v24
v_mul_f32_e32 v204, v217, v204
v_mul_f32_e32 v16, v25, v16
v_mul_f32_e32 v17, v25, v17
v_mul_f32_e32 v18, v25, v18
v_mul_f32_e32 v19, v25, v19
v_cvt_pk_bf16_f32 v16, v16, v17
v_mul_f32_e32 v0, v25, v0
v_mul_f32_e32 v1, v25, v1
v_mul_f32_e32 v8, v25, v8
v_mul_f32_e32 v9, v25, v9
v_mul_f32_e32 v2, v25, v2
v_mul_f32_e32 v3, v25, v3
v_cvt_pk_bf16_f32 v0, v0, v1
v_mul_f32_e32 v10, v25, v10
v_mul_f32_e32 v11, v25, v11
v_cvt_pk_bf16_f32 v8, v8, v9
v_mul_f32_e32 v205, v217, v205
v_mul_f32_e32 v206, v217, v206
v_mul_f32_e64 v207, v217, v207
v_cvt_pk_bf16_f32 v201, v202, v203
v_mul_f32_e32 v20, v25, v20
v_mul_f32_e32 v21, v25, v21
v_mul_f32_e32 v22, v25, v22
v_mul_f32_e32 v23, v25, v23
v_cvt_pk_bf16_f32 v17, v18, v19
v_mul_f32_e32 v4, v25, v4
v_mul_f32_e32 v5, v25, v5
v_mul_f32_e32 v6, v25, v6
v_mul_f32_e32 v7, v25, v7
v_cvt_pk_bf16_f32 v1, v2, v3
v_mul_f32_e32 v12, v25, v12
v_mul_f32_e32 v13, v25, v13
v_mul_f32_e64 v14, v25, v14
v_mul_f32_e32 v15, v25, v15
v_cvt_pk_bf16_f32 v9, v10, v11
v_cvt_pk_bf16_f32 v210, v212, v213
v_cvt_pk_bf16_f32 v211, v214, v215
v_cvt_pk_bf16_f32 v194, v196, v197
v_cvt_pk_bf16_f32 v195, v198, v199
v_cvt_pk_bf16_f32 v202, v204, v205
v_cvt_pk_bf16_f32 v203, v206, v207
v_cvt_pk_bf16_f32 v18, v20, v21
v_cvt_pk_bf16_f32 v19, v22, v23
v_cvt_pk_bf16_f32 v2, v4, v5
v_cvt_pk_bf16_f32 v3, v6, v7
v_cvt_pk_bf16_f32 v10, v12, v13
v_cvt_pk_bf16_f32 v11, v14, v15
ds_write_b128 v247, v[208:211] offset:64
s_waitcnt lgkmcnt(1)
buffer_store_dwordx4 v[76:79], v251, s[36:39], s84 offen sc1
ds_write_b128 v247, v[192:195]
v_cvt_pk_bf16_f32 v98, v100, v101
v_cvt_pk_bf16_f32 v99, v102, v103
v_cvt_pk_bf16_f32 v106, v108, v109
ds_write_b128 v247, v[200:203] offset:32
v_cvt_pk_bf16_f32 v107, v110, v111
ds_write_b128 v247, v[16:19] offset:12864
buffer_store_dwordx4 v[84:87], v251, s[36:39], s59 offen offset:64 sc1
ds_write_b128 v247, v[0:3] offset:12800
ds_write_b128 v247, v[8:11] offset:12832
ds_read_b128 v[92:95], v231 offset:32064
ds_write_b128 v230, v[96:99] offset:25728
ds_write_b128 v230, v[104:107] offset:25760
s_waitcnt lgkmcnt(3)
s_barrier
ds_read_b128 v[144:147], v246
ds_read_b128 v[148:151], v246 offset:32
ds_read_b128 v[152:155], v246 offset:64
ds_read_b128 v[156:159], v246 offset:96
ds_read_b128 v[160:163], v246 offset:128
ds_read_b128 v[164:167], v246 offset:160
ds_read_b128 v[168:171], v246 offset:192
ds_read_b128 v[172:175], v246 offset:224
ds_read_b128 v[176:179], v246 offset:256
s_waitcnt lgkmcnt(9)
buffer_store_dwordx4 v[92:95], v251, s[36:39], s84 offen offset:64 sc1
ds_read_b128 v[180:183], v246 offset:288
ds_read_b128 v[184:187], v246 offset:320
ds_read_b128 v[188:191], v246 offset:352
s_waitcnt lgkmcnt(9)
v_mfma_f32_32x32x16_bf16 v[64:79], a[0:3], v[144:147], 0
ds_read_b128 v[100:103], v231 offset:25728
ds_read_b128 v[108:111], v231 offset:32128
v_mfma_f32_32x32x16_bf16 v[64:79], a[12:15], v[148:151], v[64:79]
s_nop 0
v_mfma_f32_32x32x16_bf16 v[64:79], a[24:27], v[152:155], v[64:79]
s_waitcnt lgkmcnt(8)
v_mfma_f32_32x32x16_bf16 v[64:79], a[36:39], v[156:159], v[64:79]
v_mfma_f32_32x32x16_bf16 v[64:79], a[48:51], v[160:163], v[64:79]
s_nop 0
v_mfma_f32_32x32x16_bf16 v[64:79], a[60:63], v[164:167], v[64:79]
s_waitcnt lgkmcnt(1)
buffer_store_dwordx4 v[100:103], v251, s[36:39], s59 offen offset:128 sc1
v_mfma_f32_32x32x16_bf16 v[64:79], a[72:75], v[168:171], v[64:79]
v_mfma_f32_32x32x16_bf16 v[64:79], a[84:87], v[172:175], v[64:79]
v_mfma_f32_32x32x16_bf16 v[64:79], a[96:99], v[176:179], v[64:79]
s_nop 0
v_mfma_f32_32x32x16_bf16 v[64:79], a[108:111], v[180:183], v[64:79]
s_waitcnt lgkmcnt(0)
buffer_store_dwordx4 v[108:111], v251, s[36:39], s84 offen offset:128 sc1
v_mfma_f32_32x32x16_bf16 v[64:79], a[120:123], v[184:187], v[64:79]
v_mfma_f32_32x32x16_bf16 v[64:79], a[132:135], v[188:191], v[64:79]
s_nop 6
v_mfma_f32_32x32x16_bf16 v[80:95], a[4:7], v[144:147], 0
s_nop 2
v_mfma_f32_32x32x16_bf16 v[80:95], a[16:19], v[148:151], v[80:95]
v_cvt_pk_bf16_f32 v64, v64, v65
v_cvt_pk_bf16_f32 v72, v72, v73
v_cvt_pk_bf16_f32 v65, v66, v67
v_cvt_pk_bf16_f32 v73, v74, v75
v_cvt_pk_bf16_f32 v66, v68, v69
v_cvt_pk_bf16_f32 v67, v70, v71
v_mfma_f32_32x32x16_bf16 v[80:95], a[28:31], v[152:155], v[80:95]
ds_write_b128 v230, v[64:67] offset:25600
v_cvt_pk_bf16_f32 v74, v76, v77
v_mfma_f32_32x32x16_bf16 v[80:95], a[40:43], v[156:159], v[80:95]
v_cvt_pk_bf16_f32 v75, v78, v79
v_mfma_f32_32x32x16_bf16 v[80:95], a[52:55], v[160:163], v[80:95]
ds_write_b128 v230, v[72:75] offset:25632
v_mfma_f32_32x32x16_bf16 v[80:95], a[64:67], v[164:167], v[80:95]
ds_read_b128 v[68:71], v231 offset:25600
ds_read_b128 v[76:79], v231 offset:32000
v_mfma_f32_32x32x16_bf16 v[80:95], a[76:79], v[168:171], v[80:95]
v_mfma_f32_32x32x16_bf16 v[80:95], a[88:91], v[172:175], v[80:95]
v_mfma_f32_32x32x16_bf16 v[80:95], a[100:103], v[176:179], v[80:95]
s_nop 0
v_mfma_f32_32x32x16_bf16 v[80:95], a[112:115], v[180:183], v[80:95]
s_waitcnt lgkmcnt(1)
buffer_store_dwordx4 v[68:71], v252, s[36:39], s60 offen sc1
v_mfma_f32_32x32x16_bf16 v[80:95], a[124:127], v[184:187], v[80:95]
v_mfma_f32_32x32x16_bf16 v[80:95], a[136:139], v[188:191], v[80:95]
s_nop 6
v_mfma_f32_32x32x16_bf16 v[96:111], a[8:11], v[144:147], 0
s_nop 2
v_mfma_f32_32x32x16_bf16 v[96:111], a[20:23], v[148:151], v[96:111]
v_cvt_pk_bf16_f32 v80, v80, v81
v_cvt_pk_bf16_f32 v88, v88, v89
v_cvt_pk_bf16_f32 v81, v82, v83
v_cvt_pk_bf16_f32 v89, v90, v91
v_cvt_pk_bf16_f32 v82, v84, v85
v_cvt_pk_bf16_f32 v83, v86, v87
v_mfma_f32_32x32x16_bf16 v[96:111], a[32:35], v[152:155], v[96:111]
s_nop 0
ds_write_b128 v230, v[80:83] offset:25664
v_cvt_pk_bf16_f32 v90, v92, v93
v_mfma_f32_32x32x16_bf16 v[96:111], a[44:47], v[156:159], v[96:111]
s_waitcnt lgkmcnt(1)
buffer_store_dwordx4 v[76:79], v252, s[36:39], s76 offen sc1
v_cvt_pk_bf16_f32 v91, v94, v95
v_mfma_f32_32x32x16_bf16 v[96:111], a[56:59], v[160:163], v[96:111]
ds_write_b128 v230, v[88:91] offset:25696
v_mfma_f32_32x32x16_bf16 v[96:111], a[68:71], v[164:167], v[96:111]
ds_read_b128 v[84:87], v231 offset:25664
ds_read_b128 v[92:95], v231 offset:32064
v_mfma_f32_32x32x16_bf16 v[96:111], a[80:83], v[168:171], v[96:111]
v_mfma_f32_32x32x16_bf16 v[96:111], a[92:95], v[172:175], v[96:111]
v_mfma_f32_32x32x16_bf16 v[96:111], a[104:107], v[176:179], v[96:111]
s_nop 0
v_mfma_f32_32x32x16_bf16 v[96:111], a[116:119], v[180:183], v[96:111]
s_waitcnt lgkmcnt(1)
buffer_store_dwordx4 v[84:87], v252, s[36:39], s60 offen offset:64 sc1
v_mfma_f32_32x32x16_bf16 v[96:111], a[128:131], v[184:187], v[96:111]
v_mfma_f32_32x32x16_bf16 v[96:111], a[140:143], v[188:191], v[96:111]
s_waitcnt lgkmcnt(0)
buffer_store_dwordx4 v[92:95], v252, s[36:39], s76 offen offset:64 sc1
s_nop 10
v_cvt_pk_bf16_f32 v96, v96, v97
v_cvt_pk_bf16_f32 v104, v104, v105
v_cvt_pk_bf16_f32 v97, v98, v99
v_cvt_pk_bf16_f32 v105, v106, v107
v_cvt_pk_bf16_f32 v98, v100, v101
v_cvt_pk_bf16_f32 v99, v102, v103
v_cvt_pk_bf16_f32 v106, v108, v109
v_cvt_pk_bf16_f32 v107, v110, v111
ds_write_b128 v230, v[96:99] offset:25728
ds_write_b128 v230, v[104:107] offset:25760
ds_read_b128 v[100:103], v231 offset:25728
ds_read_b128 v[108:111], v231 offset:32128
s_waitcnt lgkmcnt(1)
buffer_store_dwordx4 v[100:103], v252, s[36:39], s60 offen offset:128 sc1
s_waitcnt lgkmcnt(0)
buffer_store_dwordx4 v[108:111], v252, s[36:39], s76 offen offset:128 sc1
s_endpgm
.p2align 6
L_pv:
s_mov_b32 s40, s16
s_mov_b32 s41, s17
s_mov_b32 s88, s14
s_mov_b32 s89, s15
s_mov_b32 s36, s12
s_mov_b32 s37, s13
s_add_u32 m0, s86, 0x1800
s_mov_b32 s77, 0x9000
s_mov_b32 s78, 0xd800
v_add_u32_e64 v78, 0, v64
v_mul_u32_u24 v79, 0xab, v78
v_lshrrev_b32_e64 v80, 11, v79
buffer_load_dwordx4 v90, s[24:27], s77 offen lds
s_add_u32 m0, s86, 0x1c00
v_lshrrev_b32_e32 v79, 10, v79
v_lshlrev_b32_e32 v78, 4, v78
v_mul_u32_u24 v79, 0x420, v79
v_add3_u32 v79, v79, v78, v71
v_add_u32 v140, 0x300, v79
v_lshl_add_u32 v74, v69, 3, v72
v_mul_u32_u24 v80, 0xc0, v80
v_mul_u32_u24 v74, 0x60, v74
v_add_u32_e64 v235, v80, v78
v_lshl_add_u32 v74, v73, 3, v74
v_add_u32_e64 v78, 64, v64
buffer_load_dwordx4 v91, s[24:27], s77 offen lds
s_add_u32 m0, s86, 0x2000
v_add_u32_e64 v143, s86, v74
v_mul_u32_u24 v79, 0xab, v78
v_and_b32_e64 v74, 3, v68
v_bfe_u32 v76, v68, 2, 1
v_lshrrev_b32_e64 v80, 11, v79
v_lshl_or_b32 v74, v76, 3, v74
v_lshrrev_b32_e64 v79, 10, v79
v_bfe_u32 v76, v68, 3, 1
v_lshlrev_b32_e64 v78, 4, v78
v_mul_u32_u24 v79, 0x420, v79
v_lshl_or_b32 v74, v76, 2, v74
buffer_load_dwordx4 v92, s[24:27], s77 offen lds
s_add_u32 m0, s87, 0x1f80
s_mov_b32 s77, 0x12000
v_add3_u32 v79, v79, v78, v71
v_and_b32_e64 v77, 1, v74
v_mul_u32_u24 v80, 0xc0, v80
v_add_u32 v141, 0x300, v79
v_bfe_u32 v76, v74, 1, 3
v_lshlrev_b32_e32 v77, 2, v77
v_add_u32_e32 v236, v80, v78
v_xor_b32_e64 v76, v76, v77
v_add_u32 v78, 0x80, v64
v_xor_b32_e64 v76, v76, v69
buffer_load_dwordx4 v94, s[20:23], s54 offen offset:128 nt lds
s_add_u32 m0, s87, 0x2f80
v_lshlrev_b32_e64 v74, 7, v74
v_mul_u32_u24 v79, 0xab, v78
v_lshl_add_u32 v244, v76, 4, v74
v_lshrrev_b32_e32 v80, 11, v79
v_and_b32_e32 v76, 1, v73
v_lshrrev_b32_e32 v79, 10, v79
v_lshlrev_b32_e32 v76, 1, v76
v_lshrrev_b32_e32 v77, 1, v73
v_lshlrev_b32_e32 v78, 4, v78
v_mul_u32_u24 v80, 0xc0, v80
v_mul_u32_u24 v79, 0x420, v79
buffer_load_dwordx4 v94, s[20:23], s92 offen offset:128 nt lds
s_add_u32 m0, s86, 0x2400
v_or_b32_e32 v76, v76, v77
v_add_u32_e32 v237, v80, v78
v_add3_u32 v79, v79, v78, v71
v_lshl_add_u32 v74, v67, 2, v72
v_lshrrev_b32_e64 v77, 1, v65
v_mul_u32_u24 v74, 0xc0, v74
v_lshl_add_u32 v76, v76, 3, v75
v_mul_u32_u24 v78, 0x9000, v77
v_add3_u32 v74, v74, v76, v78
v_add_u32 v249, 0x12c00, v74
v_mul_u32_u24 v74, 0x190, v66
buffer_load_dwordx4 v90, s[24:27], s78 offen lds
s_add_u32 m0, s86, 0x2800
s_waitcnt vmcnt(12)
ds_read_b64_tr_b16 a[0:1], v93
ds_read_b64_tr_b16 a[2:3], v93 offset:768
ds_read_b64_tr_b16 a[4:5], v93 offset:64
ds_read_b64_tr_b16 a[6:7], v93 offset:832
ds_read_b64_tr_b16 a[8:9], v93 offset:128
ds_read_b64_tr_b16 a[10:11], v93 offset:896
v_and_b32_e32 v75, 1, v65
v_lshl_add_u32 v74, v67, 4, v74
v_mul_u32_u24 v75, 0x3200, v75
v_add_u32_e32 v247, v74, v71
v_add_u32_e32 v246, v74, v75
buffer_load_dwordx4 v91, s[24:27], s78 offen lds
s_add_u32 m0, s86, 0x2c00
s_waitcnt vmcnt(12)
s_barrier
ds_read_b128 a[216:219], v240
ds_read_b128 a[220:223], v240 offset:4096
ds_read_b128 a[224:227], v241
ds_read_b128 a[228:231], v241 offset:4096
ds_read_b128 a[232:235], v242
ds_read_b128 a[236:239], v242 offset:4096
buffer_load_dwordx4 v92, s[24:27], s78 offen lds
s_add_u32 m0, s87, 0x8380
s_mov_b32 s78, 0x16800
ds_read_b128 a[240:243], v243
v_lshrrev_b32_e64 v74, 2, v64
v_mul_u32_u24 v76, 0x190, v74
v_add_u32 v142, 0x300, v79
v_mul_u32_u24 v77, 0xc0, v77
v_and_b32_e64 v74, 7, v74
v_lshl_add_u32 v78, v73, 4, v77
v_mul_u32_u24 v74, 0x180, v74
v_add3_u32 v231, v76, v75, v78
v_add_u32_e32 v74, v74, v78
s_mul_i32 s72, s2, 3
v_add_u32_e32 v76, s50, v74
s_add_u32 s72, s72, 2
v_subrev_u32 v78, 0x15000, v76
s_mul_i32 s73, s72, 0x925
v_mul_u32_u24 v75, 0x15000, v67
v_min_u32_e32 v76, v76, v78
s_lshr_b32 s73, s73, 16
v_add_u32_e32 v250, v76, v75
s_mul_i32 s74, s73, 28
v_add_u32_e64 v76, s51, v74
s_sub_u32 s64, s72, s74
s_waitcnt lgkmcnt(5)
v_mfma_f32_32x32x16_bf16 v[0:15], a[0:3], a[216:219], 0
s_mul_i32 s72, s64, 0xc00
buffer_load_dwordx4 v139, s[20:23], s55 offen offset:128 nt lds
s_add_u32 m0, s86, 0x3000
ds_read_b128 a[244:247], v243 offset:4096
ds_read_b128 a[248:251], v240 offset:25600
v_subrev_u32 v78, 0x15000, v76
v_min_u32_e32 v76, v76, v78
v_mfma_f32_32x32x16_bf16 v[16:31], a[4:7], a[216:219], 0
s_add_u32 s52, s72, 0x600
s_waitcnt vmcnt(11)
ds_read_b64_tr_b16 a[12:13], v93 offset:3072
ds_read_b64_tr_b16 a[14:15], v93 offset:3840
ds_read_b64_tr_b16 a[16:17], v93 offset:3136
ds_read_b64_tr_b16 a[18:19], v93 offset:3904
ds_read_b64_tr_b16 a[20:21], v93 offset:3200
v_add_u32_e32 v251, v76, v75
v_mfma_f32_32x32x16_bf16 v[192:207], a[8:11], a[216:219], 0
s_and_b32 s82, s2, 15
buffer_load_dwordx4 v90, s[24:27], s77 offen lds
s_add_u32 m0, s86, 0x3400
ds_read_b64_tr_b16 a[22:23], v93 offset:3968
v_add_u32_e64 v76, s52, v74
v_subrev_u32 v78, 0x15000, v76
v_min_u32_e64 v76, v76, v78
v_mfma_f32_32x32x16_bf16 v[32:47], a[0:3], a[220:223], 0
s_add_u32 s81, s82, 0x300
v_add_u32_e32 v252, v76, v75
v_and_b32_e32 v79, 7, v64
v_lshrrev_b32_e32 v80, 3, v66
v_sub_u32_e32 v74, 3, v80
v_sub_u32_e32 v75, 7, v79
v_mul_u32_u24 v81, 0xc00, v65
v_mfma_f32_32x32x16_bf16 v[48:63], a[4:7], a[220:223], 0
s_mul_i32 s82, s82, 3
buffer_load_dwordx4 v91, s[24:27], s77 offen lds
s_add_u32 m0, s86, 0x3800
v_mul_u32_u24 v74, 0xc0, v74
v_lshl_add_u32 v75, v67, 2, v75
v_add_u32 v81, 0x24c00, v81
v_lshl_add_u32 v74, v75, 4, v74
v_mfma_f32_32x32x16_bf16 v[208:223], a[8:11], a[220:223], 0
s_add_u32 s83, s82, 2
ds_read_b128 a[220:223], v241 offset:25600
v_add_u32_e32 v248, v74, v81
v_lshrrev_b32_e32 v74, 2, v79
v_xor_b32_e32 v74, v74, v67
v_cvt_f32_u32_e64 v74, v74
v_mul_f32 v253, 0xc31044fe, v74
v_lshrrev_b32_e64 v74, 1, v83
v_sub_u32 v74, 0x24ffc, v74
s_cmp_ge_u32 s2, 0x50
s_cselect_b32 s81, s83, s81
s_waitcnt lgkmcnt(3)
v_mfma_f32_32x32x16_bf16 v[0:15], a[12:15], a[224:227], v[0:15]
s_mul_i32 s82, s81, 0x925
buffer_load_dwordx4 v92, s[24:27], s77 offen lds
s_add_u32 m0, s86, 0x3c00
s_mov_b32 s77, 0x1b000
s_lshr_b32 s82, s82, 16
s_mul_i32 s83, s82, 28
s_sub_u32 s65, s81, s83
v_mfma_f32_32x32x16_bf16 v[16:31], a[16:19], a[224:227], v[16:31]
s_mul_i32 s81, s65, 0xc00
s_add_u32 s53, s81, 0x600
s_lshl_b32 s69, s82, 3
s_add_u32 s81, s69, s48
s_mul_i32 s81, s81, 0x15000
s_add_u32 s57, s81, 0x54000
s_add_u32 s81, s81, 0xa8000
s_waitcnt lgkmcnt(1)
v_mfma_f32_32x32x16_bf16 v[192:207], a[20:23], a[224:227], v[192:207]
s_cmp_eq_u32 s82, 27
s_cselect_b32 s83, 0x1260000, 0
buffer_load_dwordx4 v90, s[24:27], s78 offen lds
s_add_u32 m0, s86, 0x4000
s_sub_u32 s95, s81, s83
v_add_u32_e32 v138, s53, v232
s_and_b32 s81, s2, 16
v_mfma_f32_32x32x16_bf16 v[32:47], a[12:15], a[228:231], v[32:47]
s_cmp_eq_u32 s81, 0
s_cselect_b32 s57, s95, s57
s_waitcnt vmcnt(10)
ds_read_b64_tr_b16 a[24:25], v93 offset:6144
ds_read_b64_tr_b16 a[26:27], v93 offset:6912
ds_read_b64_tr_b16 a[28:29], v93 offset:6208
ds_read_b64_tr_b16 a[30:31], v93 offset:6976
ds_read_b64_tr_b16 a[32:33], v93 offset:6272
v_mfma_f32_32x32x16_bf16 v[48:63], a[16:19], a[228:231], v[48:63]
s_lshr_b32 s79, s48, 1
ds_read_b64_tr_b16 a[34:35], v93 offset:7040
buffer_load_dwordx4 v91, s[24:27], s78 offen lds
s_add_u32 m0, s86, 0x4400
v_subrev_u32 v238, 0x15000, v138
v_min_u32_e32 v138, v138, v238
v_add_u32_e32 v75, 0, v64
v_mfma_f32_32x32x16_bf16 v[208:223], a[20:23], a[228:231], v[208:223]
s_mul_i32 s79, s79, 0xc0
v_mul_u32_u24 v76, 0xab, v75
v_lshrrev_b32_e32 v76, 11, v76
v_mul_u32_u24_e32 v76, 3, v76
v_add_u32_e64 v75, v75, v76
v_lshl_add_u32 v75, v75, 2, v81
v_add_u32_e64 v230, v246, v77
buffer_load_dwordx4 v92, s[24:27], s78 offen lds
s_add_u32 m0, s87, 0x3f00
s_mov_b32 s78, 0x1f800
v_xor_b32_e64 v245, 64, v244
v_mov_b32_e32 v239, v82
s_and_b32 s76, s2, 15
s_lshl_b32 s76, s76, 2
s_add_u32 s76, s76, s48
s_mul_i32 s71, s76, 0xa000
s_and_b32 s76, s2, 15
s_lshl_b32 s44, s76, 4
s_sub_u32 s76, s2, 16
s_lshr_b32 s76, s76, 4
s_add_u32 s44, s44, s76
s_lshl_b32 s76, s48, 8
s_add_u32 s44, s44, s76
s_waitcnt lgkmcnt(0)
v_mfma_f32_32x32x16_bf16 v[0:15], a[24:27], a[232:235], v[0:15]
s_cmp_ge_u32 s2, 0x50
s_cselect_b32 s80, 0x5000, 0
buffer_load_dwordx4 v94, s[20:23], s54 offen offset:256 nt lds
s_add_u32 m0, s87, 0x4f00
s_add_u32 s71, s71, s80
s_and_b32 s76, s2, 16
s_mov_b32 s42, 0x280000
v_mfma_f32_32x32x16_bf16 v[16:31], a[28:31], a[232:235], v[16:31]
s_cmp_eq_u32 s76, 0
s_cselect_b32 s80, 0x1000, 0
s_add_u32 s71, s71, s80
s_mov_b32 s43, 0x20000
s_add_u32 s71, s71, 0x3000
s_mov_b32 s19, 0x3f803f80
s_lshl_b32 s68, s73, 3
v_mfma_f32_32x32x16_bf16 v[192:207], a[32:35], a[232:235], v[192:207]
s_add_u32 s72, s68, s48
ds_read_b128 a[232:235], v242 offset:25600
buffer_load_dwordx4 v94, s[20:23], s92 offen offset:256 nt lds
s_add_u32 m0, s86, 0
v_add_u32_e32 v233, s52, v232
s_mul_i32 s72, s72, 0x15000
v_subrev_u32 v238, 0x15000, v233
v_mfma_f32_32x32x16_bf16 v[32:47], a[24:27], a[236:239], v[32:47]
s_add_u32 s56, s72, 0x54000
v_min_u32_e32 v233, v233, v238
s_cmp_eq_u32 s73, 27
s_cselect_b32 s74, 0x1260000, 0
s_add_u32 s72, s72, 0xa8000
s_sub_u32 s94, s72, s74
s_add_u32 s74, s66, 8
v_mfma_f32_32x32x16_bf16 v[48:63], a[28:31], a[236:239], v[48:63]
s_add_u32 s73, s66, 4
s_cmp_eq_u32 s62, 27
s_cselect_b32 s62, 1.0, 0
buffer_load_dwordx4 v90, s[24:27], s77 offen lds
s_add_u32 m0, s86, 0x400
s_cmp_eq_u32 s66, 0xd8
s_cselect_b32 s66, 0xc31044fe, 0
v_mfma_f32_32x32x16_bf16 v[208:223], a[32:35], a[236:239], v[208:223]
s_mov_b32 s70, 0x3e553b95
s_waitcnt vmcnt(10)
ds_read_b64_tr_b16 a[36:37], v93 offset:9216
ds_read_b64_tr_b16 a[38:39], v93 offset:9984
ds_read_b64_tr_b16 a[40:41], v93 offset:9280
ds_read_b64_tr_b16 a[42:43], v93 offset:10048
ds_read_b64_tr_b16 a[44:45], v93 offset:9344
ds_read_b64_tr_b16 a[46:47], v93 offset:10112
v_lshlrev_b32_e64 v86, 16, v84
buffer_load_dwordx4 v91, s[24:27], s77 offen lds
s_add_u32 m0, s86, 0x800
v_and_b32 v87, 0xffff0000, v84
v_lshlrev_b32_e64 v88, 16, v85
v_and_b32 v89, 0xffff0000, v85
v_mul_f32 v86, 0x40ddb3d7, v86
v_mul_f32 v87, 0x40ddb3d7, v87
v_mul_f32 v88, 0x40ddb3d7, v88
v_mul_f32 v89, 0x40ddb3d7, v89
ds_write_b32 v74, v86
buffer_load_dwordx4 v92, s[24:27], s77 offen lds
s_add_u32 m0, s87, 0xa300
s_mov_b32 s77, 0x24000
ds_write_b32 v74, v87 offset:3072
ds_write_b32 v74, v88 offset:6144
ds_write_b32 v74, v89 offset:9216
v_lshl_add_u32 v74, v64, 4, v81
v_mul_f32_e32 v254, s62, v253
v_min_f32_e32 v255, s66, v254
v_mov_b32_e64 v134, s19
v_mov_b32_e32 v135, s19
s_waitcnt lgkmcnt(4)
v_mfma_f32_32x32x16_bf16 v[0:15], a[36:39], a[240:243], v[0:15]
s_mov_b32 s90, 0x100
buffer_load_dwordx4 v139, s[20:23], s55 offen offset:256 nt lds
s_add_u32 m0, s86, 0xc00
s_mov_b32 s91, 0x20000
v_mov_b32_e64 v234, 1
s_add_u32 s83, s67, 8
s_add_u32 s82, s67, 4
v_mfma_f32_32x32x16_bf16 v[16:31], a[40:43], a[240:243], v[16:31]
s_cmp_eq_u32 s63, 27
s_cselect_b32 s63, 1.0, 0
s_cmp_eq_u32 s67, 0xd8
s_cselect_b32 s67, 0xc31044fe, 0
s_cmp_ge_u32 s74, 0xe0
s_cselect_b32 s74, 0, s74
s_and_b32 s72, s48, 1
v_mfma_f32_32x32x16_bf16 v[192:207], a[44:47], a[240:243], v[192:207]
s_waitcnt vmcnt(10) lgkmcnt(0)
s_barrier
buffer_load_dwordx4 v90, s[24:27], s78 offen lds
s_add_u32 m0, s86, 0x1000
ds_read_b128 a[252:255], v240 offset:8192
ds_read_b128 a[216:219], v240 offset:12288
ds_read_b128 a[224:227], v241 offset:8192
s_mov_b32 s38, 0x1260000
v_mfma_f32_32x32x16_bf16 v[32:47], a[36:39], a[244:247], v[32:47]
s_cmp_eq_u32 s72, 1
s_cselect_b32 s72, s74, s73
s_waitcnt vmcnt(10)
ds_read_b64_tr_b16 a[48:49], v93 offset:12288
ds_read_b64_tr_b16 a[50:51], v93 offset:13056
ds_read_b64_tr_b16 a[52:53], v93 offset:12352
s_mov_b32 s39, 0x20000
ds_read_b64_tr_b16 a[54:55], v93 offset:13120
v_mfma_f32_32x32x16_bf16 v[48:63], a[40:43], a[244:247], v[48:63]
s_mul_i32 s58, s72, 0x15000
buffer_load_dwordx4 v91, s[24:27], s78 offen lds
s_add_u32 m0, s86, 0x1400
ds_read_b64_tr_b16 a[56:57], v93 offset:12416
ds_read_b64_tr_b16 a[58:59], v93 offset:13184
ds_read_b128 a[228:231], v241 offset:12288
s_add_u32 s76, s58, 0x2a000
v_mfma_f32_32x32x16_bf16 v[208:223], a[44:47], a[244:247], v[208:223]
s_add_u32 s74, s68, 8
ds_read_b128 a[236:239], v242 offset:8192
s_add_u32 s73, s68, 4
s_cmp_eq_u32 s64, 27
s_cselect_b32 s64, 1.0, 0
ds_read_b128 a[240:243], v242 offset:12288
s_and_b32 s81, s48, 1
v_mfma_f32_32x32x16_bf16 v[144:159], a[0:3], a[248:251], 0
s_cmp_eq_u32 s68, 0xd8
s_cselect_b32 s68, 0xc31044fe, 0
buffer_load_dwordx4 v92, s[24:27], s78 offen lds
s_add_u32 m0, s86, 0x1800
s_mov_b32 s78, 0x28800
ds_read_b128 a[244:247], v243 offset:25600
ds_read2_b32 v[100:101], v75 offset0:31 offset1:32
v_mfma_f32_32x32x16_bf16 v[160:175], a[4:7], a[248:251], 0
s_cmp_ge_u32 s83, 0xe0
s_cselect_b32 s83, 0, s83
ds_read2_b32 v[102:103], v75 offset0:33 offset1:34
v_add_u32_e32 v75, 64, v64
v_mul_u32_u24 v76, 0xab, v75
v_lshrrev_b32_e32 v76, 11, v76
v_mul_u32_u24_e32 v76, 3, v76
v_mfma_f32_32x32x16_bf16 v[176:191], a[8:11], a[248:251], 0
s_cmp_eq_u32 s81, 1
s_cselect_b32 s81, s83, s82
buffer_load_dwordx4 v90, s[24:27], s77 offen lds
s_add_u32 m0, s86, 0x1c00
ds_read_b128 a[248:251], v243 offset:8192
v_add_u32_e32 v75, v75, v76
v_lshl_add_u32 v75, v75, 2, v81
s_waitcnt vmcnt(10) lgkmcnt(7)
v_mfma_f32_32x32x16_bf16 v[0:15], a[48:51], a[252:255], v[0:15]
s_mul_i32 s59, s81, 0x15000
ds_read_b64_tr_b16 a[60:61], v93 offset:15360
ds_read_b64_tr_b16 a[62:63], v93 offset:16128
ds_read_b64_tr_b16 a[64:65], v93 offset:15424
ds_read_b64_tr_b16 a[66:67], v93 offset:16192
ds_read_b64_tr_b16 a[68:69], v93 offset:15488
ds_read_b64_tr_b16 a[70:71], v93 offset:16256
v_mfma_f32_32x32x16_bf16 v[16:31], a[52:55], a[252:255], v[16:31]
s_add_u32 s84, s59, 0x2a000
ds_read2_b32 v[104:105], v75 offset0:31 offset1:32
buffer_load_dwordx4 v91, s[24:27], s77 offen lds
s_add_u32 m0, s86, 0x2000
ds_read2_b32 v[106:107], v75 offset0:33 offset1:34
v_add_u32 v75, 0x80, v64
v_mul_u32_u24 v76, 0xab, v75
v_mfma_f32_32x32x16_bf16 v[192:207], a[56:59], a[252:255], v[192:207]
s_cmp_ge_u32 s74, 0xe0
s_cselect_b32 s74, 0, s74
ds_read_b128 a[252:255], v243 offset:12288
v_lshrrev_b32_e32 v76, 11, v76
v_mul_u32_u24_e64 v76, 3, v76
v_add_u32_e32 v75, v75, v76
v_lshl_add_u32 v75, v75, 2, v81
v_mfma_f32_32x32x16_bf16 v[32:47], a[48:51], a[216:219], v[32:47]
s_and_b32 s72, s48, 1
ds_read2_b32 v[108:109], v75 offset0:31 offset1:32
buffer_load_dwordx4 v92, s[24:27], s77 offen lds
s_add_u32 m0, s86, 0x2400
s_mov_b32 s77, 0x2d000
ds_read2_b32 v[110:111], v75 offset0:33 offset1:34
v_mfma_f32_32x32x16_bf16 v[48:63], a[52:55], a[216:219], v[48:63]
s_cmp_eq_u32 s72, 1
s_cselect_b32 s72, s74, s73
s_waitcnt lgkmcnt(10)
ds_write_b128 v74, v[100:103]
v_mfma_f32_32x32x16_bf16 v[208:223], a[56:59], a[216:219], v[208:223]
s_mul_i32 s60, s72, 0x15000
buffer_load_dwordx4 v90, s[24:27], s78 offen lds
s_add_u32 m0, s86, 0x2800
ds_read_b128 a[216:219], v240 offset:33792
v_mfma_f32_32x32x16_bf16 v[144:159], a[12:15], a[220:223], v[144:159]
s_waitcnt lgkmcnt(5)
ds_write_b128 v74, v[104:107] offset:1024
v_mfma_f32_32x32x16_bf16 v[160:175], a[16:19], a[220:223], v[160:175]
buffer_load_dwordx4 v91, s[24:27], s78 offen lds
s_add_u32 m0, s86, 0x2c00
v_mfma_f32_32x32x16_bf16 v[176:191], a[20:23], a[220:223], v[176:191]
s_waitcnt lgkmcnt(2)
ds_write_b128 v74, v[108:111] offset:2048
v_mfma_f32_32x32x16_bf16 v[0:15], a[60:63], a[224:227], v[0:15]
s_nop 0
buffer_load_dwordx4 v92, s[24:27], s78 offen lds
s_add_u32 m0, s86, 0x3000
s_mov_b32 s78, 0x31800
v_mfma_f32_32x32x16_bf16 v[16:31], a[64:67], a[224:227], v[16:31]
v_mfma_f32_32x32x16_bf16 v[192:207], a[68:71], a[224:227], v[192:207]
s_nop 0
buffer_load_dwordx4 v90, s[24:27], s77 offen lds
s_add_u32 m0, s86, 0x3400
v_mfma_f32_32x32x16_bf16 v[32:47], a[60:63], a[228:231], v[32:47]
s_waitcnt vmcnt(11)
ds_read_b64_tr_b16 a[72:73], v93
ds_read_b64_tr_b16 a[74:75], v93 offset:768
ds_read_b64_tr_b16 a[76:77], v93 offset:64
ds_read_b64_tr_b16 a[78:79], v93 offset:832
ds_read_b64_tr_b16 a[80:81], v93 offset:128
ds_read_b64_tr_b16 a[82:83], v93 offset:896
v_mfma_f32_32x32x16_bf16 v[48:63], a[64:67], a[228:231], v[48:63]
buffer_load_dwordx4 v91, s[24:27], s77 offen lds
s_add_u32 m0, s86, 0x3800
v_mfma_f32_32x32x16_bf16 v[208:223], a[68:71], a[228:231], v[208:223]
ds_read_b128 a[228:231], v241 offset:33792
v_mfma_f32_32x32x16_bf16 v[144:159], a[24:27], a[232:235], v[144:159]
buffer_load_dwordx4 v92, s[24:27], s77 offen lds
s_add_u32 m0, s86, 0x3c00
s_mov_b32 s77, 0
v_mfma_f32_32x32x16_bf16 v[160:175], a[28:31], a[232:235], v[160:175]
v_mfma_f32_32x32x16_bf16 v[176:191], a[32:35], a[232:235], v[176:191]
s_waitcnt lgkmcnt(3)
buffer_load_dwordx4 v90, s[24:27], s78 offen lds
s_add_u32 m0, s86, 0x4000
v_mfma_f32_32x32x16_bf16 v[0:15], a[72:75], a[236:239], v[0:15]
v_mfma_f32_32x32x16_bf16 v[16:31], a[76:79], a[236:239], v[16:31]
s_waitcnt lgkmcnt(0)
buffer_load_dwordx4 v91, s[24:27], s78 offen lds
s_add_u32 m0, s86, 0x4400
v_mfma_f32_32x32x16_bf16 v[192:207], a[80:83], a[236:239], v[192:207]
s_waitcnt vmcnt(11)
ds_read_b64_tr_b16 a[84:85], v93 offset:3072
ds_read_b64_tr_b16 a[86:87], v93 offset:3840
ds_read_b64_tr_b16 a[88:89], v93 offset:3136
ds_read_b64_tr_b16 a[90:91], v93 offset:3904
ds_read_b64_tr_b16 a[92:93], v93 offset:3200
ds_read_b64_tr_b16 a[94:95], v93 offset:3968
v_mfma_f32_32x32x16_bf16 v[32:47], a[72:75], a[240:243], v[32:47]
s_nop 0
buffer_load_dwordx4 v92, s[24:27], s78 offen lds
s_add_u32 m0, s87, 0x7400
s_mov_b32 s78, 0x9000
v_mfma_f32_32x32x16_bf16 v[48:63], a[76:79], a[240:243], v[48:63]
s_barrier
ds_read_b128 a[220:223], v240 offset:16384
ds_read_b128 a[224:227], v240 offset:20480
ds_read_b128 a[232:235], v241 offset:16384
ds_read_b128 a[236:239], v241 offset:20480
v_mfma_f32_32x32x16_bf16 v[208:223], a[80:83], a[240:243], v[208:223]
ds_read_b128 a[240:243], v242 offset:33792
buffer_load_dwordx4 v139, s[20:23], s93 offen nt lds
s_add_u32 m0, s87, 0x9380
v_mfma_f32_32x32x16_bf16 v[144:159], a[36:39], a[244:247], v[144:159]
v_mfma_f32_32x32x16_bf16 v[160:175], a[40:43], a[244:247], v[160:175]
s_nop 0
buffer_load_dwordx4 v139, s[20:23], s93 offen offset:128 nt lds
s_add_u32 m0, s87, 0xb300
v_mfma_f32_32x32x16_bf16 v[176:191], a[44:47], a[244:247], v[176:191]
s_waitcnt vmcnt(11) lgkmcnt(5)
ds_read_b64_tr_b16 a[96:97], v93 offset:6144
ds_read_b64_tr_b16 a[98:99], v93 offset:6912
ds_read_b64_tr_b16 a[100:101], v93 offset:6208
ds_read_b64_tr_b16 a[102:103], v93 offset:6976
ds_read_b64_tr_b16 a[104:105], v93 offset:6272
ds_read_b64_tr_b16 a[106:107], v93 offset:7040
v_mfma_f32_32x32x16_bf16 v[0:15], a[84:87], a[248:251], v[0:15]
ds_read_b128 a[244:247], v242 offset:16384
buffer_load_dwordx4 v139, s[20:23], s93 offen offset:256 nt lds
s_add_u32 m0, s86, 0
v_mfma_f32_32x32x16_bf16 v[16:31], a[88:91], a[248:251], v[16:31]
s_nop 0
v_mfma_f32_32x32x16_bf16 v[192:207], a[92:95], a[248:251], v[192:207]
ds_read_b128 a[248:251], v242 offset:20480
buffer_load_dwordx4 v140, s[24:27], s77 offen lds
s_add_u32 m0, s86, 0x400
v_mfma_f32_32x32x16_bf16 v[32:47], a[84:87], a[252:255], v[32:47]
v_mfma_f32_32x32x16_bf16 v[48:63], a[88:91], a[252:255], v[48:63]
s_nop 0
buffer_load_dwordx4 v141, s[24:27], s77 offen lds
s_add_u32 m0, s86, 0x800
v_mfma_f32_32x32x16_bf16 v[208:223], a[92:95], a[252:255], v[208:223]
s_waitcnt vmcnt(11)
ds_read_b64_tr_b16 a[108:109], v93 offset:9216
ds_read_b64_tr_b16 a[110:111], v93 offset:9984
ds_read_b64_tr_b16 a[112:113], v93 offset:9280
ds_read_b64_tr_b16 a[114:115], v93 offset:10048
ds_read_b64_tr_b16 a[116:117], v93 offset:9344
ds_read_b64_tr_b16 a[118:119], v93 offset:10112
v_mfma_f32_32x32x16_bf16 v[144:159], a[48:51], a[216:219], v[144:159]
ds_read_b128 a[252:255], v243 offset:33792
buffer_load_dwordx4 v142, s[24:27], s77 offen lds
s_add_u32 m0, s86, 0xc00
s_mov_b32 s77, 0x12000
v_mfma_f32_32x32x16_bf16 v[160:175], a[52:55], a[216:219], v[160:175]
s_nop 0
v_mfma_f32_32x32x16_bf16 v[176:191], a[56:59], a[216:219], v[176:191]
s_waitcnt lgkmcnt(7)
ds_read_b128 a[216:219], v243 offset:16384
buffer_load_dwordx4 v140, s[24:27], s78 offen lds
s_add_u32 m0, s86, 0x1000
v_mfma_f32_32x32x16_bf16 v[0:15], a[96:99], a[220:223], v[0:15]
v_mfma_f32_32x32x16_bf16 v[16:31], a[100:103], a[220:223], v[16:31]
s_nop 0
buffer_load_dwordx4 v141, s[24:27], s78 offen lds
s_add_u32 m0, s86, 0x1400
v_mfma_f32_32x32x16_bf16 v[192:207], a[104:107], a[220:223], v[192:207]
s_waitcnt vmcnt(11)
ds_read_b64_tr_b16 a[120:121], v93 offset:12288
ds_read_b64_tr_b16 a[122:123], v93 offset:13056
ds_read_b64_tr_b16 a[124:125], v93 offset:12352
ds_read_b64_tr_b16 a[126:127], v93 offset:13120
ds_read_b64_tr_b16 a[128:129], v93 offset:12416
ds_read_b64_tr_b16 a[130:131], v93 offset:13184
v_mfma_f32_32x32x16_bf16 v[32:47], a[96:99], a[224:227], v[32:47]
ds_read_b128 a[220:223], v243 offset:20480
buffer_load_dwordx4 v142, s[24:27], s78 offen lds
s_add_u32 m0, s86, 0x1800
s_mov_b32 s78, 0x1b000
v_mfma_f32_32x32x16_bf16 v[48:63], a[100:103], a[224:227], v[48:63]
v_mfma_f32_32x32x16_bf16 v[208:223], a[104:107], a[224:227], v[208:223]
ds_read_b128 a[224:227], v240 offset:41984
buffer_load_dwordx4 v140, s[24:27], s77 offen lds
s_add_u32 m0, s86, 0x1c00
v_mfma_f32_32x32x16_bf16 v[144:159], a[60:63], a[228:231], v[144:159]
v_mfma_f32_32x32x16_bf16 v[160:175], a[64:67], a[228:231], v[160:175]
s_nop 0
buffer_load_dwordx4 v141, s[24:27], s77 offen lds
s_add_u32 m0, s86, 0x2000
v_mfma_f32_32x32x16_bf16 v[176:191], a[68:71], a[228:231], v[176:191]
s_waitcnt vmcnt(11) lgkmcnt(1)
ds_read_b64_tr_b16 a[132:133], v93 offset:15360
ds_read_b64_tr_b16 a[134:135], v93 offset:16128
ds_read_b64_tr_b16 a[136:137], v93 offset:15424
ds_read_b64_tr_b16 a[138:139], v93 offset:16192
ds_read_b64_tr_b16 a[140:141], v93 offset:15488
ds_read_b64_tr_b16 a[142:143], v93 offset:16256
v_mfma_f32_32x32x16_bf16 v[0:15], a[108:111], a[232:235], v[0:15]
ds_read_b128 a[228:231], v241 offset:41984
buffer_load_dwordx4 v142, s[24:27], s77 offen lds
s_add_u32 m0, s87, 0xc800
s_mov_b32 s77, 0x24000
v_mfma_f32_32x32x16_bf16 v[16:31], a[112:115], a[232:235], v[16:31]
v_mov_b32_e32 v118, s19
v_mov_b32_e32 v119, s19
v_mfma_f32_32x32x16_bf16 v[192:207], a[116:119], a[232:235], v[192:207]
ds_read_b128 a[232:235], v242 offset:41984
buffer_load_dwordx4 v138, s[20:23], s57 offen nt lds
s_add_u32 m0, s87, 0xd780
v_mfma_f32_32x32x16_bf16 v[32:47], a[108:111], a[236:239], v[32:47]
v_mfma_f32_32x32x16_bf16 v[48:63], a[112:115], a[236:239], v[48:63]
buffer_load_dwordx4 v138, s[20:23], s57 offen offset:128 nt lds
s_add_u32 m0, s87, 0xe700
v_mfma_f32_32x32x16_bf16 v[208:223], a[116:119], a[236:239], v[208:223]
ds_read_b128 a[236:239], v243 offset:41984
v_mfma_f32_32x32x16_bf16 v[144:159], a[72:75], a[240:243], v[144:159]
v_mov_b32_e32 v126, s19
v_mov_b32_e32 v127, s19
buffer_load_dwordx4 v138, s[20:23], s57 offen offset:256 nt lds
s_add_u32 m0, s86, 0x2400
v_mfma_f32_32x32x16_bf16 v[160:175], a[76:79], a[240:243], v[160:175]
v_mfma_f32_32x32x16_bf16 v[176:191], a[80:83], a[240:243], v[176:191]
buffer_load_dwordx4 v140, s[24:27], s78 offen lds
s_add_u32 m0, s86, 0x2800
v_mfma_f32_32x32x16_bf16 v[0:15], a[120:123], a[244:247], v[0:15]
v_mfma_f32_32x32x16_bf16 v[16:31], a[124:127], a[244:247], v[16:31]
buffer_load_dwordx4 v141, s[24:27], s78 offen lds
s_add_u32 m0, s86, 0x2c00
v_mfma_f32_32x32x16_bf16 v[192:207], a[128:131], a[244:247], v[192:207]
s_nop 0
v_mfma_f32_32x32x16_bf16 v[32:47], a[120:123], a[248:251], v[32:47]
s_waitcnt vmcnt(11) lgkmcnt(0)
ds_read_b64_tr_b16 a[144:145], v143
ds_read_b64_tr_b16 a[146:147], v143 offset:384
buffer_load_dwordx4 v142, s[24:27], s78 offen lds
s_add_u32 m0, s86, 0x3000
v_mfma_f32_32x32x16_bf16 v[48:63], a[124:127], a[248:251], v[48:63]
s_mov_b32 s78, 0x2d000
ds_read_b64_tr_b16 a[148:149], v143 offset:32
ds_read_b64_tr_b16 a[150:151], v143 offset:416
ds_read_b64_tr_b16 a[152:153], v143 offset:64
ds_read_b64_tr_b16 a[154:155], v143 offset:448
v_mfma_f32_32x32x16_bf16 v[208:223], a[128:131], a[248:251], v[208:223]
buffer_load_dwordx4 v140, s[24:27], s77 offen lds
s_add_u32 m0, s86, 0x3400
v_mfma_f32_32x32x16_bf16 v[144:159], a[84:87], a[252:255], v[144:159]
v_mfma_f32_32x32x16_bf16 v[160:175], a[88:91], a[252:255], v[160:175]
buffer_load_dwordx4 v141, s[24:27], s77 offen lds
s_add_u32 m0, s86, 0x3800
v_mfma_f32_32x32x16_bf16 v[176:191], a[92:95], a[252:255], v[176:191]
s_nop 0
v_mfma_f32_32x32x16_bf16 v[0:15], a[132:135], a[216:219], v[0:15]
s_waitcnt vmcnt(11)
ds_read_b64_tr_b16 a[156:157], v143 offset:3072
ds_read_b64_tr_b16 a[158:159], v143 offset:3456
buffer_load_dwordx4 v142, s[24:27], s77 offen lds
s_add_u32 m0, s86, 0x3c00
v_mfma_f32_32x32x16_bf16 v[16:31], a[136:139], a[216:219], v[16:31]
ds_read_b64_tr_b16 a[160:161], v143 offset:3104
ds_read_b64_tr_b16 a[162:163], v143 offset:3488
ds_read_b64_tr_b16 a[164:165], v143 offset:3136
ds_read_b64_tr_b16 a[166:167], v143 offset:3520
s_nop 1
v_mfma_f32_32x32x16_bf16 v[192:207], a[140:143], a[216:219], v[192:207]
s_nop 0
v_cvt_pk_bf16_f32 v64, v0, v1
v_cvt_pk_bf16_f32 v65, v2, v3
v_cvt_pk_bf16_f32 v66, v4, v5
v_cvt_pk_bf16_f32 v67, v6, v7
v_cvt_pk_bf16_f32 v68, v8, v9
v_cvt_pk_bf16_f32 v69, v10, v11
v_mfma_f32_32x32x16_bf16 v[32:47], a[132:135], a[220:223], v[32:47]
buffer_load_dwordx4 v140, s[24:27], s78 offen lds
s_add_u32 m0, s86, 0x4000
ds_read_b128 v[0:3], v248 offset:768
ds_read_b128 v[4:7], v248 offset:960
ds_read_b128 v[8:11], v248 offset:1152
v_cvt_pk_bf16_f32 v70, v12, v13
v_mfma_f32_32x32x16_bf16 v[48:63], a[136:139], a[220:223], v[48:63]
v_cvt_pk_bf16_f32 v71, v14, v15
v_cvt_pk_bf16_f32 v72, v16, v17
v_cvt_pk_bf16_f32 v73, v18, v19
v_cvt_pk_bf16_f32 v74, v20, v21
v_cvt_pk_bf16_f32 v75, v22, v23
v_cvt_pk_bf16_f32 v76, v24, v25
v_mfma_f32_32x32x16_bf16 v[208:223], a[140:143], a[220:223], v[208:223]
buffer_load_dwordx4 v141, s[24:27], s78 offen lds
s_add_u32 m0, s86, 0x4400
ds_read_b128 v[12:15], v248 offset:1344
ds_read_b128 v[16:19], v248 offset:1536
ds_read_b128 v[20:23], v248 offset:1728
v_cvt_pk_bf16_f32 v77, v26, v27
v_mfma_f32_32x32x16_bf16 v[144:159], a[96:99], a[224:227], v[144:159]
s_nop 0
ds_read_b128 v[24:27], v248 offset:1920
v_cvt_pk_bf16_f32 v78, v28, v29
v_cvt_pk_bf16_f32 v79, v30, v31
v_cvt_pk_bf16_f32 v88, v32, v33
v_cvt_pk_bf16_f32 v89, v34, v35
v_cvt_pk_bf16_f32 v90, v36, v37
v_mfma_f32_32x32x16_bf16 v[160:175], a[100:103], a[224:227], v[160:175]
s_waitcnt vmcnt(11) lgkmcnt(7)
buffer_load_dwordx4 v142, s[24:27], s78 offen lds
ds_read_b128 v[28:31], v248 offset:2112
ds_read_b128 v[32:35], v248
ds_read_b64_tr_b16 a[168:169], v143 offset:6144
v_cvt_pk_bf16_f32 v91, v38, v39
v_cvt_pk_bf16_f32 v92, v40, v41
v_mfma_f32_32x32x16_bf16 v[176:191], a[104:107], a[224:227], v[176:191]
s_and_b32 s78, s48, 1
ds_read_b128 v[36:39], v248 offset:192
ds_read_b64_tr_b16 a[170:171], v143 offset:6528
v_cvt_pk_bf16_f32 v93, v42, v43
v_cvt_pk_bf16_f32 v94, v44, v45
v_cvt_pk_bf16_f32 v95, v46, v47
v_cvt_pk_bf16_f32 v96, v48, v49
v_mfma_f32_32x32x16_bf16 v[144:159], a[108:111], a[228:231], v[144:159]
s_mul_i32 s78, s78, 0x9000
ds_read_b128 v[40:43], v248 offset:384
ds_read_b128 v[44:47], v248 offset:576
v_cvt_pk_bf16_f32 v97, v50, v51
v_cvt_pk_bf16_f32 v98, v52, v53
v_cvt_pk_bf16_f32 v99, v54, v55
v_cvt_pk_bf16_f32 v100, v56, v57
v_mfma_f32_32x32x16_bf16 v[160:175], a[112:115], a[228:231], v[160:175]
s_add_u32 s79, s79, s78
ds_read_b128 v[48:51], v248 offset:768
ds_read_b128 v[52:55], v248 offset:960
v_cvt_pk_bf16_f32 v101, v58, v59
v_cvt_pk_bf16_f32 v102, v60, v61
v_cvt_pk_bf16_f32 v103, v62, v63
s_add_u32 m0, s86, 0
v_mfma_f32_32x32x16_bf16 v[176:191], a[116:119], a[228:231], v[176:191]
s_add_u32 s78, s79, 0
ds_read_b128 v[56:59], v248 offset:1152
ds_read_b128 v[60:63], v248 offset:1344
buffer_load_dwordx4 v235, s[28:31], s78 offen lds
ds_read_b64_tr_b16 a[172:173], v143 offset:6176
v_cvt_pk_bf16_f32 v80, v192, v193
v_cvt_pk_bf16_f32 v81, v194, v195
v_mfma_f32_32x32x16_bf16 v[144:159], a[120:123], a[232:235], v[144:159]
s_add_u32 m0, s86, 0x400
ds_read_b64_tr_b16 a[174:175], v143 offset:6560
ds_read_b64_tr_b16 a[176:177], v143 offset:6208
s_waitcnt vmcnt(10)
s_barrier
ds_read_b128 a[240:243], v244 offset:51200
v_cvt_pk_bf16_f32 v82, v196, v197
v_cvt_pk_bf16_f32 v83, v198, v199
v_mfma_f32_32x32x16_bf16 v[160:175], a[124:127], a[232:235], v[160:175]
ds_read_b128 a[244:247], v245 offset:51200
v_cvt_pk_bf16_f32 v84, v200, v201
v_cvt_pk_bf16_f32 v85, v202, v203
v_cvt_pk_bf16_f32 v86, v204, v205
v_cvt_pk_bf16_f32 v87, v206, v207
v_cvt_pk_bf16_f32 v104, v208, v209
v_mfma_f32_32x32x16_bf16 v[176:191], a[128:131], a[232:235], v[176:191]
ds_read_b128 a[248:251], v244 offset:55296
ds_read_b64_tr_b16 a[178:179], v143 offset:6592
ds_read_b128 a[252:255], v245 offset:55296
buffer_load_dwordx4 v236, s[28:31], s78 offen lds
ds_read_b128 a[216:219], v244 offset:59392
v_cvt_pk_bf16_f32 v105, v210, v211
v_mfma_f32_32x32x16_bf16 v[144:159], a[132:135], a[236:239], v[144:159]
s_add_u32 m0, s86, 0x800
ds_read_b128 a[220:223], v245 offset:59392
v_cvt_pk_bf16_f32 v106, v212, v213
v_cvt_pk_bf16_f32 v107, v214, v215
v_cvt_pk_bf16_f32 v108, v216, v217
v_cvt_pk_bf16_f32 v109, v218, v219
v_cvt_pk_bf16_f32 v110, v220, v221
v_mfma_f32_32x32x16_bf16 v[160:175], a[136:139], a[236:239], v[160:175]
ds_read_b128 a[224:227], v244 offset:53248
ds_read_b128 a[228:231], v245 offset:53248
v_cvt_pk_bf16_f32 v111, v222, v223
v_mov_b32_e64 v142, s19
v_mfma_f32_32x32x16_bf16 v[176:191], a[140:143], a[236:239], v[176:191]
s_waitcnt lgkmcnt(9)
ds_read_b128 a[232:235], v244 offset:57344
ds_read_b128 a[236:239], v245 offset:57344
buffer_load_dwordx4 v237, s[28:31], s78 offen lds
s_add_u32 m0, s86, 0xc00
s_add_u32 s78, s79, 0x1800
v_mfma_f32_32x32x16_bf16 v[0:15], v[76:79], v[64:67], v[0:15]
s_waitcnt vmcnt(9)
ds_read_b64_tr_b16 a[180:181], v143 offset:9216
ds_read_b64_tr_b16 a[182:183], v143 offset:9600
ds_read_b64_tr_b16 a[184:185], v143 offset:9248
ds_read_b64_tr_b16 a[186:187], v143 offset:9632
v_mfma_f32_32x32x16_bf16 v[0:15], v[80:83], v[68:71], v[0:15]
ds_read_b64_tr_b16 a[188:189], v143 offset:9280
ds_read_b64_tr_b16 a[190:191], v143 offset:9664
v_mfma_f32_32x32x16_bf16 v[0:15], v[84:87], v[72:75], v[0:15]
s_nop 6
v_mfma_f32_32x32x16_bf16 v[16:31], v[100:103], v[64:67], v[16:31]
s_nop 0
v_cvt_pk_bf16_f32 v64, v144, v145
v_cvt_pk_bf16_f32 v65, v146, v147
v_cvt_pk_bf16_f32 v66, v148, v149
v_cvt_pk_bf16_f32 v67, v150, v151
v_mfma_f32_32x32x16_bf16 v[16:31], v[104:107], v[68:71], v[16:31]
v_cvt_pk_bf16_f32 v68, v152, v153
v_cvt_pk_bf16_f32 v69, v154, v155
v_cvt_pk_bf16_f32 v70, v156, v157
v_cvt_pk_bf16_f32 v71, v158, v159
v_max3_f32 v224, v0, v1, v2
v_max3_f32 v224, v224, v3, v4
v_mfma_f32_32x32x16_bf16 v[16:31], v[108:111], v[72:75], v[16:31]
v_cvt_pk_bf16_f32 v72, v160, v161
v_cvt_pk_bf16_f32 v73, v162, v163
v_cvt_pk_bf16_f32 v74, v164, v165
v_cvt_pk_bf16_f32 v75, v166, v167
v_max3_f32 v224, v224, v5, v6
v_max3_f32 v224, v224, v7, v8
v_mfma_f32_32x32x16_bf16 v[32:47], v[76:79], v[88:91], v[32:47]
s_nop 0
v_cvt_pk_bf16_f32 v76, v168, v169
v_cvt_pk_bf16_f32 v77, v170, v171
v_cvt_pk_bf16_f32 v78, v172, v173
v_cvt_pk_bf16_f32 v79, v174, v175
v_max3_f32 v224, v224, v9, v10
v_max3_f32 v224, v224, v11, v12
v_mfma_f32_32x32x16_bf16 v[32:47], v[80:83], v[92:95], v[32:47]
s_waitcnt vmcnt(6)
ds_read_b64_tr_b16 a[192:193], v143 offset:12288
ds_read_b64_tr_b16 a[194:195], v143 offset:12672
ds_read_b64_tr_b16 a[196:197], v143 offset:12320
ds_read_b64_tr_b16 a[198:199], v143 offset:12704
ds_read_b64_tr_b16 a[200:201], v143 offset:12352
ds_read_b64_tr_b16 a[202:203], v143 offset:12736
v_mfma_f32_32x32x16_bf16 v[32:47], v[84:87], v[96:99], v[32:47]
v_cvt_pk_bf16_f32 v80, v176, v177
v_cvt_pk_bf16_f32 v81, v178, v179
v_cvt_pk_bf16_f32 v82, v180, v181
v_cvt_pk_bf16_f32 v83, v182, v183
v_cvt_pk_bf16_f32 v84, v184, v185
v_cvt_pk_bf16_f32 v85, v186, v187
v_mfma_f32_32x32x16_bf16 v[48:63], v[100:103], v[88:91], v[48:63]
v_cvt_pk_bf16_f32 v86, v188, v189
v_cvt_pk_bf16_f32 v87, v190, v191
v_max3_f32 v225, v16, v17, v18
v_max3_f32 v225, v225, v19, v20
v_max3_f32 v225, v225, v21, v22
v_max3_f32 v225, v225, v23, v24
v_mfma_f32_32x32x16_bf16 v[48:63], v[104:107], v[92:95], v[48:63]
v_max3_f32 v225, v225, v25, v26
v_max3_f32 v225, v225, v27, v28
v_max3_f32 v224, v224, v13, v14
v_max3_f32 v225, v225, v29, v30
v_max_f32_e64 v224, v224, v15
v_max_f32_e32 v225, v225, v31
v_mfma_f32_32x32x16_bf16 v[48:63], v[108:111], v[96:99], v[48:63]
s_waitcnt lgkmcnt(6)
v_fma_f32 v224, v224, s70, v254
v_fma_f32 v225, v225, s70, v255
v_max_f32_e64 v224, v224, v225
v_mov_b32_e32 v225, v224
s_nop 0
v_mfma_f32_16x16x32_bf16 v[192:195], a[240:243], a[144:147], 0
v_permlane32_swap_b32_e32 v224, v225
v_mfma_f32_16x16x32_bf16 v[196:199], a[240:243], a[148:151], 0
s_waitcnt vmcnt(3)
ds_read_b64_tr_b16 a[204:205], v143 offset:15360
ds_read_b64_tr_b16 a[206:207], v143 offset:15744
v_mfma_f32_16x16x32_bf16 v[200:203], a[240:243], a[152:155], 0
ds_read_b64_tr_b16 a[208:209], v143 offset:15392
ds_read_b64_tr_b16 a[210:211], v143 offset:15776
v_mfma_f32_16x16x32_bf16 v[192:195], a[244:247], a[156:159], v[192:195]
ds_read_b64_tr_b16 a[212:213], v143 offset:15424
ds_read_b64_tr_b16 a[214:215], v143 offset:15808
v_mfma_f32_16x16x32_bf16 v[196:199], a[244:247], a[160:163], v[196:199]
ds_read_b128 a[240:243], v244 offset:61440
v_max_f32_e64 v224, v224, v225
v_mfma_f32_16x16x32_bf16 v[200:203], a[244:247], a[164:167], v[200:203]
ds_read_b128 a[244:247], v245 offset:61440
v_sub_f32_e64 v226, v254, v224
v_mfma_f32_16x16x32_bf16 v[192:195], a[248:251], a[168:171], v[192:195]
v_fma_f32 v0, v0, s70, v226
v_fma_f32 v1, v1, s70, v226
v_mfma_f32_16x16x32_bf16 v[196:199], a[248:251], a[172:175], v[196:199]
v_exp_f32_e64 v0, v0
v_mfma_f32_16x16x32_bf16 v[200:203], a[248:251], a[176:179], v[200:203]
ds_read_b128 a[248:251], v244
v_fma_f32 v2, v2, s70, v226
v_mfma_f32_16x16x32_bf16 v[192:195], a[252:255], a[180:183], v[192:195]
v_exp_f32_e64 v1, v1
v_mfma_f32_16x16x32_bf16 v[196:199], a[252:255], a[184:187], v[196:199]
v_fma_f32 v3, v3, s70, v226
v_fma_f32 v4, v4, s70, v226
v_mfma_f32_16x16x32_bf16 v[200:203], a[252:255], a[188:191], v[200:203]
s_waitcnt lgkmcnt(5)
ds_read_b128 a[252:255], v245
v_fma_f32 v5, v5, s70, v226
v_mfma_f32_16x16x32_bf16 v[192:195], a[216:219], a[192:195], v[192:195]
v_exp_f32_e32 v2, v2
v_mfma_f32_16x16x32_bf16 v[196:199], a[216:219], a[196:199], v[196:199]
v_exp_f32_e64 v3, v3
v_mfma_f32_16x16x32_bf16 v[200:203], a[216:219], a[200:203], v[200:203]
ds_read_b128 a[216:219], v244 offset:8192
v_fma_f32 v6, v6, s70, v226
v_mfma_f32_16x16x32_bf16 v[192:195], a[220:223], a[204:207], v[192:195]
v_fma_f32 v7, v7, s70, v226
v_cvt_pk_bf16_f32 v0, v0, v1
v_mfma_f32_16x16x32_bf16 v[196:199], a[220:223], a[208:211], v[196:199]
s_waitcnt lgkmcnt(3)
v_exp_f32_e32 v4, v4
v_mfma_f32_16x16x32_bf16 v[200:203], a[220:223], a[212:215], v[200:203]
ds_read_b128 a[220:223], v245 offset:8192
v_cvt_pk_bf16_f32 v1, v2, v3
v_mfma_f32_16x16x32_bf16 v[204:207], a[224:227], a[144:147], 0
v_cvt_pk_bf16_f32 v112, v192, v193
v_cvt_pk_bf16_f32 v113, v194, v195
v_mfma_f32_16x16x32_bf16 v[208:211], a[224:227], a[148:151], 0
v_cvt_pk_bf16_f32 v114, v196, v197
v_cvt_pk_bf16_f32 v115, v198, v199
v_mfma_f32_16x16x32_bf16 v[212:215], a[224:227], a[152:155], 0
v_permlane16_swap_b32_e64 v112, v114
v_mfma_f32_16x16x32_bf16 v[204:207], a[228:231], a[156:159], v[204:207]
v_permlane16_swap_b32_e64 v113, v115
v_mfma_f32_16x16x32_bf16 v[208:211], a[228:231], a[160:163], v[208:211]
buffer_store_dwordx4 v[112:115], v239, s[40:43], s71 offen sc1
v_mfma_f32_16x16x32_bf16 v[212:215], a[228:231], a[164:167], v[212:215]
v_cvt_pk_bf16_f32 v116, v200, v201
v_cvt_pk_bf16_f32 v117, v202, v203
v_mfma_f32_16x16x32_bf16 v[204:207], a[232:235], a[168:171], v[204:207]
v_permlane16_swap_b32_e64 v116, v118
v_mfma_f32_16x16x32_bf16 v[208:211], a[232:235], a[172:175], v[208:211]
v_permlane16_swap_b32_e64 v117, v119
v_mfma_f32_16x16x32_bf16 v[212:215], a[232:235], a[176:179], v[212:215]
ds_read_b128 a[224:227], v244 offset:16384
buffer_store_dwordx4 v[116:119], v239, s[40:43], s71 offen offset:1024 sc1
v_mfma_f32_16x16x32_bf16 v[204:207], a[236:239], a[180:183], v[204:207]
ds_read_b128 a[228:231], v245 offset:16384
ds_read_b128 a[232:235], v244 offset:2048
v_mfma_f32_16x16x32_bf16 v[208:211], a[236:239], a[184:187], v[208:211]
v_exp_f32_e64 v5, v5
v_mfma_f32_16x16x32_bf16 v[212:215], a[236:239], a[188:191], v[212:215]
ds_read_b128 a[236:239], v245 offset:2048
v_mov_b32_e64 v118, s19
v_mfma_f32_16x16x32_bf16 v[204:207], a[240:243], a[192:195], v[204:207]
v_exp_f32_e64 v6, v6
v_mfma_f32_16x16x32_bf16 v[208:211], a[240:243], a[196:199], v[208:211]
v_exp_f32_e64 v7, v7
v_mfma_f32_16x16x32_bf16 v[212:215], a[240:243], a[200:203], v[212:215]
ds_read_b128 a[240:243], v244 offset:10240
v_mov_b32_e64 v119, s19
v_mfma_f32_16x16x32_bf16 v[204:207], a[244:247], a[204:207], v[204:207]
v_cvt_pk_bf16_f32 v2, v4, v5
v_cvt_pk_bf16_f32 v3, v6, v7
v_mfma_f32_16x16x32_bf16 v[208:211], a[244:247], a[208:211], v[208:211]
s_nop 0
v_fma_f32 v8, v8, s70, v226
v_fma_f32 v9, v9, s70, v226
v_mfma_f32_16x16x32_bf16 v[212:215], a[244:247], a[212:215], v[212:215]
s_waitcnt lgkmcnt(4)
ds_read_b128 a[244:247], v245 offset:10240
v_fma_f32 v10, v10, s70, v226
v_mfma_f32_16x16x32_bf16 v[192:195], a[248:251], a[144:147], 0
v_cvt_pk_bf16_f32 v120, v204, v205
v_cvt_pk_bf16_f32 v121, v206, v207
v_mfma_f32_16x16x32_bf16 v[196:199], a[248:251], a[148:151], 0
v_cvt_pk_bf16_f32 v122, v208, v209
v_cvt_pk_bf16_f32 v123, v210, v211
v_mfma_f32_16x16x32_bf16 v[200:203], a[248:251], a[152:155], 0
v_permlane16_swap_b32_e64 v120, v122
v_mfma_f32_16x16x32_bf16 v[192:195], a[252:255], a[156:159], v[192:195]
v_permlane16_swap_b32_e64 v121, v123
v_mfma_f32_16x16x32_bf16 v[196:199], a[252:255], a[160:163], v[196:199]
buffer_store_dwordx4 v[120:123], v239, s[40:43], s71 offen offset:2048 sc1
v_mfma_f32_16x16x32_bf16 v[200:203], a[252:255], a[164:167], v[200:203]
v_cvt_pk_bf16_f32 v124, v212, v213
v_cvt_pk_bf16_f32 v125, v214, v215
v_mfma_f32_16x16x32_bf16 v[192:195], a[216:219], a[168:171], v[192:195]
v_permlane16_swap_b32_e64 v124, v126
v_mfma_f32_16x16x32_bf16 v[196:199], a[216:219], a[172:175], v[196:199]
v_permlane16_swap_b32_e64 v125, v127
v_mfma_f32_16x16x32_bf16 v[200:203], a[216:219], a[176:179], v[200:203]
ds_read_b128 a[248:251], v244 offset:18432
buffer_store_dwordx4 v[124:127], v239, s[40:43], s71 offen offset:3072 sc1
v_mfma_f32_16x16x32_bf16 v[192:195], a[220:223], a[180:183], v[192:195]
ds_read_b128 a[252:255], v245 offset:18432
ds_read_b128 a[216:219], v240 offset:29696
v_mfma_f32_16x16x32_bf16 v[196:199], a[220:223], a[184:187], v[196:199]
v_fma_f32 v11, v11, s70, v226
v_fma_f32 v12, v12, s70, v226
v_mfma_f32_16x16x32_bf16 v[200:203], a[220:223], a[188:191], v[200:203]
ds_read_b128 a[220:223], v241 offset:29696
v_fma_f32 v13, v13, s70, v226
v_mfma_f32_16x16x32_bf16 v[192:195], a[224:227], a[192:195], v[192:195]
v_fma_f32 v14, v14, s70, v226
v_fma_f32 v15, v15, s70, v226
v_mfma_f32_16x16x32_bf16 v[196:199], a[224:227], a[196:199], v[196:199]
buffer_load_dwordx4 v235, s[28:31], s78 offen lds
s_add_u32 m0, s86, 0x1000
v_mfma_f32_16x16x32_bf16 v[200:203], a[224:227], a[200:203], v[200:203]
s_waitcnt lgkmcnt(4)
ds_read_b128 a[224:227], v242 offset:29696
v_mov_b32_e32 v126, s19
v_mfma_f32_16x16x32_bf16 v[192:195], a[228:231], a[204:207], v[192:195]
v_exp_f32_e64 v8, v8
v_mfma_f32_16x16x32_bf16 v[196:199], a[228:231], a[208:211], v[196:199]
v_exp_f32_e64 v9, v9
v_mfma_f32_16x16x32_bf16 v[200:203], a[228:231], a[212:215], v[200:203]
buffer_load_dwordx4 v236, s[28:31], s78 offen lds
s_add_u32 m0, s86, 0x1400
v_mfma_f32_16x16x32_bf16 v[204:207], a[232:235], a[144:147], 0
ds_read_b128 a[228:231], v243 offset:29696
v_cvt_pk_bf16_f32 v112, v192, v193
v_mfma_f32_16x16x32_bf16 v[208:211], a[232:235], a[148:151], 0
v_cvt_pk_bf16_f32 v113, v194, v195
v_cvt_pk_bf16_f32 v114, v196, v197
v_mfma_f32_16x16x32_bf16 v[212:215], a[232:235], a[152:155], 0
ds_read_b128 a[232:235], v240 offset:37888
v_cvt_pk_bf16_f32 v115, v198, v199
v_mfma_f32_16x16x32_bf16 v[204:207], a[236:239], a[156:159], v[204:207]
buffer_load_dwordx4 v237, s[28:31], s78 offen lds
s_add_u32 m0, s86, 0x1800
v_mfma_f32_16x16x32_bf16 v[208:211], a[236:239], a[160:163], v[208:211]
s_add_u32 s78, s79, 0x3000
v_cvt_pk_bf16_f32 v116, v200, v201
v_cvt_pk_bf16_f32 v117, v202, v203
v_mfma_f32_16x16x32_bf16 v[212:215], a[236:239], a[164:167], v[212:215]
ds_read_b128 a[236:239], v241 offset:37888
v_mov_b32_e64 v127, s19
v_mfma_f32_16x16x32_bf16 v[204:207], a[240:243], a[168:171], v[204:207]
v_permlane16_swap_b32_e64 v116, v118
v_mfma_f32_16x16x32_bf16 v[208:211], a[240:243], a[172:175], v[208:211]
buffer_load_dwordx4 v235, s[28:31], s78 offen lds
s_add_u32 m0, s86, 0x1c00
v_mfma_f32_16x16x32_bf16 v[212:215], a[240:243], a[176:179], v[212:215]
ds_read_b128 a[240:243], v242 offset:37888
v_cvt_pk_bf16_f32 v4, v8, v9
v_mfma_f32_16x16x32_bf16 v[204:207], a[244:247], a[180:183], v[204:207]
v_permlane16_swap_b32_e64 v117, v119
v_mfma_f32_16x16x32_bf16 v[208:211], a[244:247], a[184:187], v[208:211]
v_permlane16_swap_b32_e32 v112, v114
v_mfma_f32_16x16x32_bf16 v[212:215], a[244:247], a[188:191], v[212:215]
s_waitcnt lgkmcnt(2)
buffer_load_dwordx4 v236, s[28:31], s78 offen lds
s_add_u32 m0, s86, 0x2000
v_mfma_f32_16x16x32_bf16 v[204:207], a[248:251], a[192:195], v[204:207]
ds_read_b128 a[244:247], v244 offset:4096
v_sub_f32_e64 v227, v255, v224
v_mfma_f32_16x16x32_bf16 v[208:211], a[248:251], a[196:199], v[208:211]
v_permlane16_swap_b32_e64 v113, v115
v_mfma_f32_16x16x32_bf16 v[212:215], a[248:251], a[200:203], v[212:215]
ds_read_b128 a[248:251], v245 offset:4096
v_fma_f32 v16, v16, s70, v227
v_mfma_f32_16x16x32_bf16 v[204:207], a[252:255], a[204:207], v[204:207]
buffer_load_dwordx4 v237, s[28:31], s78 offen lds
s_add_u32 m0, s86, 0x2400
v_mfma_f32_16x16x32_bf16 v[208:211], a[252:255], a[208:211], v[208:211]
s_add_u32 s78, s79, 0x4800
v_exp_f32_e64 v10, v10
v_mfma_f32_16x16x32_bf16 v[212:215], a[252:255], a[212:215], v[212:215]
ds_read_b128 a[252:255], v244 offset:12288
v_fma_f32 v17, v17, s70, v227
v_mfma_f32_32x32x16_bf16 v[144:159], a[0:3], a[216:219], 0
v_cvt_pk_bf16_f32 v120, v204, v205
v_cvt_pk_bf16_f32 v121, v206, v207
v_cvt_pk_bf16_f32 v122, v208, v209
v_cvt_pk_bf16_f32 v123, v210, v211
v_exp_f32_e64 v11, v11
v_mfma_f32_32x32x16_bf16 v[160:175], a[4:7], a[216:219], 0
buffer_load_dwordx4 v235, s[28:31], s78 offen lds
s_add_u32 m0, s86, 0x2800
v_cvt_pk_bf16_f32 v124, v212, v213
v_cvt_pk_bf16_f32 v125, v214, v215
v_exp_f32_e64 v12, v12
v_mfma_f32_32x32x16_bf16 v[176:191], a[8:11], a[216:219], 0
ds_read_b128 a[216:219], v245 offset:12288
v_exp_f32_e32 v13, v13
v_exp_f32_e32 v14, v14
v_cvt_pk_bf16_f32 v5, v10, v11
v_mfma_f32_32x32x16_bf16 v[144:159], a[12:15], a[220:223], v[144:159]
buffer_load_dwordx4 v236, s[28:31], s78 offen lds
s_add_u32 m0, s86, 0x2c00
v_exp_f32_e64 v15, v15
v_cvt_pk_bf16_f32 v6, v12, v13
v_cvt_pk_bf16_f32 v7, v14, v15
v_mfma_f32_32x32x16_bf16 v[160:175], a[16:19], a[220:223], v[160:175]
v_permlane16_swap_b32_e32 v124, v126
v_permlane16_swap_b32_e32 v125, v127
v_permlane16_swap_b32_e64 v120, v122
v_mfma_f32_32x32x16_bf16 v[176:191], a[20:23], a[220:223], v[176:191]
buffer_load_dwordx4 v237, s[28:31], s78 offen lds
s_add_u32 m0, s86, 0x3000
s_add_u32 s78, s79, 0x6000
ds_read_b128 a[220:223], v244 offset:20480
v_permlane16_swap_b32_e64 v121, v123
v_mfma_f32_32x32x16_bf16 v[144:159], a[24:27], a[224:227], v[144:159]
v_fma_f32 v18, v18, s70, v227
v_fma_f32 v19, v19, s70, v227
v_fma_f32 v20, v20, s70, v227
v_fma_f32 v21, v21, s70, v227
v_fma_f32 v22, v22, s70, v227
v_fma_f32 v23, v23, s70, v227
v_mfma_f32_32x32x16_bf16 v[160:175], a[28:31], a[224:227], v[160:175]
buffer_load_dwordx4 v235, s[28:31], s78 offen lds
s_add_u32 m0, s86, 0x3400
v_exp_f32_e32 v16, v16
v_exp_f32_e32 v17, v17
v_mfma_f32_32x32x16_bf16 v[176:191], a[32:35], a[224:227], v[176:191]
ds_read_b128 a[224:227], v245 offset:20480
v_exp_f32_e32 v18, v18
v_exp_f32_e32 v19, v19
v_cvt_pk_bf16_f32 v8, v16, v17
v_mfma_f32_32x32x16_bf16 v[144:159], a[36:39], a[228:231], v[144:159]
v_exp_f32_e32 v20, v20
v_exp_f32_e32 v21, v21
v_exp_f32_e64 v22, v22
v_mfma_f32_32x32x16_bf16 v[160:175], a[40:43], a[228:231], v[160:175]
v_exp_f32_e64 v23, v23
v_cvt_pk_bf16_f32 v9, v18, v19
v_cvt_pk_bf16_f32 v10, v20, v21
v_cvt_pk_bf16_f32 v11, v22, v23
v_fma_f32 v24, v24, s70, v227
v_mfma_f32_32x32x16_bf16 v[176:191], a[44:47], a[228:231], v[176:191]
ds_read_b128 a[228:231], v244 offset:6144
v_fma_f32 v25, v25, s70, v227
v_fma_f32 v26, v26, s70, v227
v_fma_f32 v27, v27, s70, v227
v_fma_f32 v28, v28, s70, v227
v_fma_f32 v29, v29, s70, v227
v_mfma_f32_32x32x16_bf16 v[144:159], a[48:51], a[232:235], v[144:159]
v_fma_f32 v30, v30, s70, v227
v_fma_f32 v31, v31, s70, v227
v_exp_f32_e32 v24, v24
v_exp_f32_e32 v25, v25
v_mfma_f32_32x32x16_bf16 v[160:175], a[52:55], a[232:235], v[160:175]
v_exp_f32_e32 v26, v26
v_exp_f32_e32 v27, v27
v_exp_f32_e32 v28, v28
v_mfma_f32_32x32x16_bf16 v[176:191], a[56:59], a[232:235], v[176:191]
s_waitcnt lgkmcnt(1)
ds_read_b128 a[232:235], v245 offset:6144
v_exp_f32_e32 v29, v29
v_exp_f32_e32 v30, v30
v_mov_b32_e64 v143, s19
v_mfma_f32_32x32x16_bf16 v[144:159], a[60:63], a[236:239], v[144:159]
v_exp_f32_e64 v31, v31
v_cvt_pk_bf16_f32 v12, v24, v25
v_cvt_pk_bf16_f32 v13, v26, v27
v_cvt_pk_bf16_f32 v14, v28, v29
v_cvt_pk_bf16_f32 v15, v30, v31
v_mfma_f32_32x32x16_bf16 v[160:175], a[64:67], a[236:239], v[160:175]
v_max3_f32 v224, v32, v33, v34
v_max3_f32 v225, v48, v49, v50
v_max3_f32 v224, v224, v35, v36
v_max3_f32 v225, v225, v51, v52
v_max3_f32 v224, v224, v37, v38
v_max3_f32 v225, v225, v53, v54
v_mfma_f32_32x32x16_bf16 v[176:191], a[68:71], a[236:239], v[176:191]
ds_read_b128 a[236:239], v244 offset:14336
v_max3_f32 v224, v224, v39, v40
v_max3_f32 v225, v225, v55, v56
v_max3_f32 v224, v224, v41, v42
v_max3_f32 v225, v225, v57, v58
v_max3_f32 v224, v224, v43, v44
v_mfma_f32_32x32x16_bf16 v[144:159], a[72:75], a[240:243], v[144:159]
v_max3_f32 v225, v225, v59, v60
v_max3_f32 v224, v224, v45, v46
v_max3_f32 v225, v225, v61, v62
v_max_f32_e32 v224, v224, v47
v_max_f32_e32 v225, v225, v63
v_fma_f32 v224, v224, s70, v255
v_mfma_f32_32x32x16_bf16 v[160:175], a[76:79], a[240:243], v[160:175]
v_fma_f32 v225, v225, s70, v254
v_max_f32_e64 v224, v224, v225
v_mov_b32_e32 v225, v224
s_nop 1
v_mfma_f32_32x32x16_bf16 v[176:191], a[80:83], a[240:243], v[176:191]
ds_read_b128 a[240:243], v245 offset:14336
buffer_load_dwordx4 v236, s[28:31], s78 offen lds
s_add_u32 m0, s86, 0x3800
v_permlane32_swap_b32_e32 v224, v225
v_max_f32_e32 v224, v224, v225
v_mfma_f32_16x16x32_bf16 v[192:195], a[244:247], a[144:147], 0
v_sub_f32_e64 v228, v255, v224
v_fma_f32 v32, v32, s70, v228
v_mfma_f32_16x16x32_bf16 v[196:199], a[244:247], a[148:151], 0
v_fma_f32 v33, v33, s70, v228
v_fma_f32 v34, v34, s70, v228
v_mfma_f32_16x16x32_bf16 v[200:203], a[244:247], a[152:155], 0
ds_read_b128 a[244:247], v244 offset:22528
v_fma_f32 v35, v35, s70, v228
v_mfma_f32_16x16x32_bf16 v[192:195], a[248:251], a[156:159], v[192:195]
v_exp_f32_e64 v32, v32
v_mfma_f32_16x16x32_bf16 v[196:199], a[248:251], a[160:163], v[196:199]
buffer_load_dwordx4 v237, s[28:31], s78 offen lds
s_add_u32 m0, s86, 0x3c00
v_mfma_f32_16x16x32_bf16 v[200:203], a[248:251], a[164:167], v[200:203]
s_add_u32 s78, s79, 0x7800
ds_read_b128 a[248:251], v245 offset:22528
v_fma_f32 v36, v36, s70, v228
v_mfma_f32_16x16x32_bf16 v[192:195], a[252:255], a[168:171], v[192:195]
v_exp_f32_e64 v33, v33
v_mfma_f32_16x16x32_bf16 v[196:199], a[252:255], a[172:175], v[196:199]
v_exp_f32_e64 v34, v34
v_mfma_f32_16x16x32_bf16 v[200:203], a[252:255], a[176:179], v[200:203]
ds_read_b128 a[252:255], v243 offset:37888
v_fma_f32 v37, v37, s70, v228
v_mfma_f32_16x16x32_bf16 v[192:195], a[216:219], a[180:183], v[192:195]
v_exp_f32_e64 v35, v35
v_mfma_f32_16x16x32_bf16 v[196:199], a[216:219], a[184:187], v[196:199]
v_fma_f32 v38, v38, s70, v228
v_fma_f32 v39, v39, s70, v228
v_mfma_f32_16x16x32_bf16 v[200:203], a[216:219], a[188:191], v[200:203]
ds_read_b128 a[216:219], v240 offset:46080
v_cvt_pk_bf16_f32 v32, v32, v33
v_mfma_f32_16x16x32_bf16 v[192:195], a[220:223], a[192:195], v[192:195]
s_waitcnt lgkmcnt(2)
s_barrier
v_cvt_pk_bf16_f32 v33, v34, v35
v_mfma_f32_16x16x32_bf16 v[196:199], a[220:223], a[196:199], v[196:199]
v_exp_f32_e64 v36, v36
v_mfma_f32_16x16x32_bf16 v[200:203], a[220:223], a[200:203], v[200:203]
ds_read_b128 a[220:223], v241 offset:46080
v_fma_f32 v40, v40, s70, v228
v_mfma_f32_16x16x32_bf16 v[192:195], a[224:227], a[204:207], v[192:195]
v_exp_f32_e64 v37, v37
v_mfma_f32_16x16x32_bf16 v[196:199], a[224:227], a[208:211], v[196:199]
v_exp_f32_e64 v38, v38
v_mfma_f32_16x16x32_bf16 v[200:203], a[224:227], a[212:215], v[200:203]
ds_read_b128 a[224:227], v244 offset:25600
v_cvt_pk_bf16_f32 v34, v36, v37
v_mfma_f32_16x16x32_bf16 v[204:207], a[228:231], a[144:147], 0
buffer_load_dwordx4 v235, s[28:31], s78 offen lds
s_add_u32 m0, s86, 0x4000
v_mfma_f32_16x16x32_bf16 v[208:211], a[228:231], a[148:151], 0
v_exp_f32_e64 v39, v39
v_mfma_f32_16x16x32_bf16 v[212:215], a[228:231], a[152:155], 0
v_cvt_pk_bf16_f32 v132, v200, v201
v_cvt_pk_bf16_f32 v133, v202, v203
v_mfma_f32_16x16x32_bf16 v[204:207], a[232:235], a[156:159], v[204:207]
v_permlane16_swap_b32_e64 v132, v134
v_mfma_f32_16x16x32_bf16 v[208:211], a[232:235], a[160:163], v[208:211]
v_permlane16_swap_b32_e64 v133, v135
v_mfma_f32_16x16x32_bf16 v[212:215], a[232:235], a[164:167], v[212:215]
s_waitcnt vmcnt(13)
s_barrier
buffer_load_dwordx4 v236, s[28:31], s78 offen lds
v_mfma_f32_16x16x32_bf16 v[204:207], a[236:239], a[168:171], v[204:207]
s_add_u32 m0, s86, 0x4400
ds_read_b128 a[228:231], v245 offset:25600
ds_read_b128 a[232:235], v244 offset:33792
v_mfma_f32_16x16x32_bf16 v[208:211], a[236:239], a[172:175], v[208:211]
v_cvt_pk_bf16_f32 v35, v38, v39
v_fma_f32 v41, v41, s70, v228
v_mfma_f32_16x16x32_bf16 v[212:215], a[236:239], a[176:179], v[212:215]
ds_read_b128 a[236:239], v245 offset:33792
v_fma_f32 v42, v42, s70, v228
v_mfma_f32_16x16x32_bf16 v[204:207], a[240:243], a[180:183], v[204:207]
v_fma_f32 v43, v43, s70, v228
v_fma_f32 v44, v44, s70, v228
v_mfma_f32_16x16x32_bf16 v[208:211], a[240:243], a[184:187], v[208:211]
s_nop 0
buffer_load_dwordx4 v237, s[28:31], s78 offen lds
s_add_u32 m0, s87, 0
v_mfma_f32_16x16x32_bf16 v[212:215], a[240:243], a[188:191], v[212:215]
ds_read_b128 a[240:243], v244 offset:41984
v_fma_f32 v45, v45, s70, v228
v_mfma_f32_16x16x32_bf16 v[204:207], a[244:247], a[192:195], v[204:207]
v_fma_f32 v46, v46, s70, v228
v_fma_f32 v47, v47, s70, v228
v_mfma_f32_16x16x32_bf16 v[208:211], a[244:247], a[196:199], v[208:211]
v_exp_f32_e64 v40, v40
v_mfma_f32_16x16x32_bf16 v[212:215], a[244:247], a[200:203], v[212:215]
buffer_load_dwordx4 v233, s[20:23], s56 offen nt lds
s_add_u32 m0, s87, 0x1000
v_mfma_f32_16x16x32_bf16 v[204:207], a[248:251], a[204:207], v[204:207]
ds_read_b128 a[244:247], v245 offset:41984
v_sub_f32_e64 v229, v254, v224
v_mfma_f32_16x16x32_bf16 v[208:211], a[248:251], a[208:211], v[208:211]
v_cvt_pk_bf16_f32 v128, v192, v193
v_cvt_pk_bf16_f32 v129, v194, v195
v_mfma_f32_16x16x32_bf16 v[212:215], a[248:251], a[212:215], v[212:215]
v_cvt_pk_bf16_f32 v130, v196, v197
buffer_load_dwordx4 v233, s[20:23], s94 offen nt lds
s_add_u32 m0, s87, 0x1f80
v_cvt_pk_bf16_f32 v131, v198, v199
v_cvt_pk_bf16_f32 v136, v204, v205
v_cvt_pk_bf16_f32 v138, v208, v209
v_cvt_pk_bf16_f32 v139, v210, v211
v_cvt_pk_bf16_f32 v137, v206, v207
v_cvt_pk_bf16_f32 v140, v212, v213
v_cvt_pk_bf16_f32 v141, v214, v215
v_mfma_f32_32x32x16_bf16 v[208:223], v[116:119], v[0:3], 0
v_permlane16_swap_b32_e32 v128, v130
v_permlane16_swap_b32_e32 v129, v131
v_permlane16_swap_b32_e64 v140, v142
v_mfma_f32_32x32x16_bf16 v[192:207], v[112:115], v[0:3], 0
buffer_load_dwordx4 v233, s[20:23], s56 offen offset:128 nt lds
s_add_u32 m0, s87, 0x2f80
v_permlane16_swap_b32_e32 v141, v143
v_permlane16_swap_b32_e32 v136, v138
v_mfma_f32_32x32x16_bf16 v[208:223], v[124:127], v[4:7], v[208:223]
v_permlane16_swap_b32_e32 v137, v139
v_exp_f32_e32 v41, v41
v_exp_f32_e64 v42, v42
v_mfma_f32_32x32x16_bf16 v[192:207], v[120:123], v[4:7], v[192:207]
buffer_load_dwordx4 v233, s[20:23], s94 offen offset:128 nt lds
v_exp_f32_e32 v43, v43
v_exp_f32_e32 v44, v44
v_cvt_pk_bf16_f32 v36, v40, v41
v_mfma_f32_32x32x16_bf16 v[208:223], v[132:135], v[8:11], v[208:223]
s_add_u32 m0, s87, 0x3f00
v_exp_f32_e32 v45, v45
v_exp_f32_e32 v46, v46
v_exp_f32_e64 v47, v47
v_mfma_f32_32x32x16_bf16 v[192:207], v[128:131], v[8:11], v[192:207]
buffer_load_dwordx4 v233, s[20:23], s56 offen offset:256 nt lds
v_cvt_pk_bf16_f32 v37, v42, v43
v_cvt_pk_bf16_f32 v38, v44, v45
v_cvt_pk_bf16_f32 v39, v46, v47
v_fma_f32 v48, v48, s70, v229
v_fma_f32 v49, v49, s70, v229
v_mfma_f32_32x32x16_bf16 v[208:223], v[140:143], v[12:15], v[208:223]
s_add_u32 m0, s87, 0x4f00
ds_read_b128 a[248:251], v242 offset:46080
v_fma_f32 v50, v50, s70, v229
v_fma_f32 v51, v51, s70, v229
v_fma_f32 v52, v52, s70, v229
v_fma_f32 v53, v53, s70, v229
v_fma_f32 v54, v54, s70, v229
v_mfma_f32_32x32x16_bf16 v[192:207], v[136:139], v[12:15], v[192:207]
s_waitcnt lgkmcnt(1)
v_fma_f32 v55, v55, s70, v229
v_exp_f32_e32 v48, v48
v_exp_f32_e64 v49, v49
v_fma_f32 v56, v56, s70, v229
v_mfma_f32_32x32x16_bf16 v[144:159], a[84:87], a[252:255], v[144:159]
v_exp_f32_e32 v50, v50
v_exp_f32_e32 v51, v51
v_exp_f32_e64 v52, v52
v_mfma_f32_32x32x16_bf16 v[160:175], a[88:91], a[252:255], v[160:175]
v_exp_f32_e32 v53, v53
v_exp_f32_e32 v54, v54
v_exp_f32_e64 v55, v55
v_mfma_f32_32x32x16_bf16 v[176:191], a[92:95], a[252:255], v[176:191]
v_cvt_pk_bf16_f32 v40, v48, v49
v_cvt_pk_bf16_f32 v41, v50, v51
v_cvt_pk_bf16_f32 v42, v52, v53
v_cvt_pk_bf16_f32 v43, v54, v55
v_fma_f32 v57, v57, s70, v229
v_fma_f32 v58, v58, s70, v229
v_mfma_f32_32x32x16_bf16 v[144:159], a[96:99], a[216:219], v[144:159]
v_fma_f32 v59, v59, s70, v229
v_fma_f32 v60, v60, s70, v229
v_fma_f32 v61, v61, s70, v229
v_fma_f32 v62, v62, s70, v229
v_fma_f32 v63, v63, s70, v229
v_lshlrev_b32_e64 v236, 4, v239
v_mfma_f32_32x32x16_bf16 v[160:175], a[100:103], a[216:219], v[160:175]
v_exp_f32_e32 v56, v56
v_exp_f32_e32 v57, v57
v_exp_f32_e64 v58, v58
v_mfma_f32_32x32x16_bf16 v[176:191], a[104:107], a[216:219], v[176:191]
v_exp_f32_e32 v59, v59
v_exp_f32_e32 v60, v60
v_exp_f32_e64 v61, v61
v_mfma_f32_32x32x16_bf16 v[16:31], v[116:119], v[32:35], 0
v_exp_f32_e32 v62, v62
v_exp_f32_e32 v63, v63
v_cvt_pk_bf16_f32 v44, v56, v57
v_cvt_pk_bf16_f32 v45, v58, v59
v_mfma_f32_32x32x16_bf16 v[0:15], v[112:115], v[32:35], 0
v_cvt_pk_bf16_f32 v46, v60, v61
v_cvt_pk_bf16_f32 v47, v62, v63
v_rcp_f32_e32 v217, v216
v_mul_f32_e32 v254, s63, v253
v_mul_f32_e64 v192, v217, v192
v_mfma_f32_32x32x16_bf16 v[16:31], v[124:127], v[36:39], v[16:31]
ds_read_b128 a[252:255], v244 offset:27648
ds_read_b128 a[216:219], v245 offset:27648
v_mul_f32_e32 v193, v217, v193
v_mul_f32_e32 v194, v217, v194
v_mul_f32_e64 v195, v217, v195
v_cvt_pk_bf16_f32 v192, v192, v193
v_mfma_f32_32x32x16_bf16 v[0:15], v[120:123], v[36:39], v[0:15]
v_mul_f32_e32 v196, v217, v196
v_mul_f32_e32 v197, v217, v197
v_mul_f32_e32 v198, v217, v198
v_mul_f32_e32 v199, v217, v199
v_cvt_pk_bf16_f32 v193, v194, v195
v_cvt_pk_bf16_f32 v194, v196, v197
v_mfma_f32_32x32x16_bf16 v[16:31], v[132:135], v[40:43], v[16:31]
v_cvt_pk_bf16_f32 v195, v198, v199
v_mul_f32_e32 v200, v217, v200
v_mul_f32_e32 v201, v217, v201
v_mul_f32_e32 v202, v217, v202
v_mul_f32_e32 v203, v217, v203
v_cvt_pk_bf16_f32 v200, v200, v201
v_mfma_f32_32x32x16_bf16 v[0:15], v[128:131], v[40:43], v[0:15]
ds_write_b128 v247, v[192:195] offset:51200
v_mul_f32_e64 v204, v217, v204
v_mfma_f32_32x32x16_bf16 v[16:31], v[140:143], v[44:47], v[16:31]
v_mul_f32_e32 v205, v217, v205
v_mul_f32_e32 v206, v217, v206
v_mul_f32_e64 v207, v217, v207
v_cvt_pk_bf16_f32 v201, v202, v203
v_cvt_pk_bf16_f32 v202, v204, v205
v_cvt_pk_bf16_f32 v203, v206, v207
v_mfma_f32_32x32x16_bf16 v[0:15], v[136:139], v[44:47], v[0:15]
ds_write_b128 v247, v[200:203] offset:51232
v_mul_f32_e64 v208, v217, v208
v_mfma_f32_32x32x16_bf16 v[144:159], a[108:111], a[220:223], v[144:159]
v_mul_f32_e32 v209, v217, v209
v_mul_f32_e32 v210, v217, v210
v_mul_f32_e64 v211, v217, v211
v_cvt_pk_bf16_f32 v208, v208, v209
v_mul_f32_e32 v212, v217, v212
v_mul_f32_e32 v213, v217, v213
v_mfma_f32_32x32x16_bf16 v[160:175], a[112:115], a[220:223], v[160:175]
v_mul_f32_e32 v214, v217, v214
v_mul_f32_e32 v215, v217, v215
v_cvt_pk_bf16_f32 v209, v210, v211
v_cvt_pk_bf16_f32 v210, v212, v213
v_cvt_pk_bf16_f32 v211, v214, v215
v_min_f32_e64 v255, s67, v254
v_mfma_f32_32x32x16_bf16 v[176:191], a[116:119], a[220:223], v[176:191]
ds_read_b128 a[220:223], v244 offset:35840
ds_write_b128 v247, v[208:211] offset:51264
v_mfma_f32_16x16x32_bf16 v[192:195], a[224:227], a[144:147], 0
buffer_load_dwordx4 v233, s[20:23], s94 offen offset:256 nt lds
v_mov_b32_e64 v118, s19
v_mfma_f32_16x16x32_bf16 v[196:199], a[224:227], a[148:151], 0
ds_read_b128 v[28:31], v248 offset:2112
ds_read_b128 v[32:35], v248
v_mfma_f32_16x16x32_bf16 v[200:203], a[224:227], a[152:155], 0
v_rcp_f32_e64 v25, v24
v_mfma_f32_16x16x32_bf16 v[192:195], a[228:231], a[156:159], v[192:195]
ds_read_b128 a[224:227], v245 offset:35840
ds_read_b128 v[36:39], v248 offset:192
v_mfma_f32_16x16x32_bf16 v[196:199], a[228:231], a[160:163], v[196:199]
buffer_store_byte v234, v236, s[88:91], s44 offen sc1
v_mfma_f32_16x16x32_bf16 v[200:203], a[228:231], a[164:167], v[200:203]
ds_read_b128 a[228:231], v244 offset:44032
ds_read_b128 v[40:43], v248 offset:384
v_mfma_f32_16x16x32_bf16 v[192:195], a[232:235], a[168:171], v[192:195]
v_mul_f32_e32 v0, v25, v0
v_mul_f32_e32 v1, v25, v1
v_mfma_f32_16x16x32_bf16 v[196:199], a[232:235], a[172:175], v[196:199]
ds_read_b128 v[44:47], v248 offset:576
v_mul_f32_e64 v8, v25, v8
v_mfma_f32_16x16x32_bf16 v[200:203], a[232:235], a[176:179], v[200:203]
ds_read_b128 a[232:235], v245 offset:44032
v_mul_f32_e64 v9, v25, v9
v_mfma_f32_16x16x32_bf16 v[192:195], a[236:239], a[180:183], v[192:195]
v_mul_f32_e32 v2, v25, v2
v_mul_f32_e32 v3, v25, v3
v_mfma_f32_16x16x32_bf16 v[196:199], a[236:239], a[184:187], v[196:199]
v_cvt_pk_bf16_f32 v0, v0, v1
v_mul_f32_e64 v10, v25, v10
v_mfma_f32_16x16x32_bf16 v[200:203], a[236:239], a[188:191], v[200:203]
ds_read_b128 a[236:239], v243 offset:46080
v_mul_f32_e64 v11, v25, v11
v_mfma_f32_16x16x32_bf16 v[192:195], a[240:243], a[192:195], v[192:195]
v_cvt_pk_bf16_f32 v8, v8, v9
v_mul_f32_e64 v4, v25, v4
v_mfma_f32_16x16x32_bf16 v[196:199], a[240:243], a[196:199], v[196:199]
v_mul_f32_e32 v5, v25, v5
v_mul_f32_e32 v6, v25, v6
v_mfma_f32_16x16x32_bf16 v[200:203], a[240:243], a[200:203], v[200:203]
ds_read_b128 a[240:243], v244 offset:29696
v_mul_f32_e64 v7, v25, v7
v_mfma_f32_16x16x32_bf16 v[192:195], a[244:247], a[204:207], v[192:195]
v_cvt_pk_bf16_f32 v1, v2, v3
v_mul_f32_e64 v12, v25, v12
v_mfma_f32_16x16x32_bf16 v[196:199], a[244:247], a[208:211], v[196:199]
v_mul_f32_e32 v13, v25, v13
v_mul_f32_e32 v14, v25, v14
v_mfma_f32_16x16x32_bf16 v[200:203], a[244:247], a[212:215], v[200:203]
s_waitcnt lgkmcnt(3)
ds_read_b128 a[244:247], v245 offset:29696
v_mul_f32_e32 v15, v25, v15
v_mfma_f32_32x32x16_bf16 v[144:159], a[120:123], a[248:251], v[144:159]
v_cvt_pk_bf16_f32 v112, v192, v193
v_cvt_pk_bf16_f32 v113, v194, v195
v_cvt_pk_bf16_f32 v114, v196, v197
v_cvt_pk_bf16_f32 v115, v198, v199
v_cvt_pk_bf16_f32 v9, v10, v11
v_cvt_pk_bf16_f32 v116, v200, v201
v_mfma_f32_32x32x16_bf16 v[160:175], a[124:127], a[248:251], v[160:175]
v_cvt_pk_bf16_f32 v117, v202, v203
v_cvt_pk_bf16_f32 v2, v4, v5
v_cvt_pk_bf16_f32 v3, v6, v7
v_cvt_pk_bf16_f32 v10, v12, v13
v_cvt_pk_bf16_f32 v11, v14, v15
v_mul_f32_e64 v16, v25, v16
v_mfma_f32_32x32x16_bf16 v[176:191], a[128:131], a[248:251], v[176:191]
ds_read_b128 a[248:251], v244 offset:37888
ds_write_b128 v247, v[0:3] offset:64000
v_mfma_f32_16x16x32_bf16 v[204:207], a[252:255], a[144:147], 0
v_mul_f32_e32 v17, v25, v17
v_mul_f32_e32 v18, v25, v18
v_mfma_f32_16x16x32_bf16 v[208:211], a[252:255], a[148:151], 0
ds_read_b128 v[0:3], v248 offset:768
ds_read_b128 v[4:7], v248 offset:960
v_mfma_f32_16x16x32_bf16 v[212:215], a[252:255], a[152:155], 0
v_mul_f32_e64 v19, v25, v19
v_cvt_pk_bf16_f32 v16, v16, v17
v_mfma_f32_16x16x32_bf16 v[204:207], a[216:219], a[156:159], v[204:207]
ds_read_b128 a[252:255], v245 offset:37888
ds_read_b128 v[12:15], v248 offset:1344
v_mfma_f32_16x16x32_bf16 v[208:211], a[216:219], a[160:163], v[208:211]
v_mul_f32_e32 v20, v25, v20
v_mul_f32_e32 v21, v25, v21
v_mfma_f32_16x16x32_bf16 v[212:215], a[216:219], a[164:167], v[212:215]
ds_read_b128 a[216:219], v244 offset:46080
ds_read_b128 v[48:51], v248 offset:768
v_mfma_f32_16x16x32_bf16 v[204:207], a[220:223], a[168:171], v[204:207]
v_mul_f32_e32 v22, v25, v22
v_mul_f32_e32 v23, v25, v23
v_mfma_f32_16x16x32_bf16 v[208:211], a[220:223], a[172:175], v[208:211]
ds_read_b128 v[24:27], v248 offset:1920
ds_read_b128 v[52:55], v248 offset:960
v_mfma_f32_16x16x32_bf16 v[212:215], a[220:223], a[176:179], v[212:215]
v_cvt_pk_bf16_f32 v17, v18, v19
v_cvt_pk_bf16_f32 v18, v20, v21
v_mfma_f32_16x16x32_bf16 v[204:207], a[224:227], a[180:183], v[204:207]
ds_read_b128 a[220:223], v245 offset:46080
ds_read_b128 v[56:59], v248 offset:1152
v_mfma_f32_16x16x32_bf16 v[208:211], a[224:227], a[184:187], v[208:211]
v_cvt_pk_bf16_f32 v19, v22, v23
v_mov_b32_e64 v119, s19
v_mfma_f32_16x16x32_bf16 v[212:215], a[224:227], a[188:191], v[212:215]
ds_read_b128 a[224:227], v244 offset:31744
ds_read_b128 v[20:23], v248 offset:1728
v_mfma_f32_16x16x32_bf16 v[204:207], a[228:231], a[192:195], v[204:207]
v_permlane16_swap_b32_e64 v116, v118
v_mfma_f32_16x16x32_bf16 v[208:211], a[228:231], a[196:199], v[208:211]
ds_read_b128 v[60:63], v248 offset:1344
v_mov_b32_e32 v126, s19
v_mfma_f32_16x16x32_bf16 v[212:215], a[228:231], a[200:203], v[212:215]
s_waitcnt lgkmcnt(9)
ds_read_b128 a[228:231], v245 offset:31744
v_mov_b32_e64 v127, s19
v_mfma_f32_16x16x32_bf16 v[204:207], a[232:235], a[204:207], v[204:207]
v_permlane16_swap_b32_e64 v117, v119
v_mfma_f32_16x16x32_bf16 v[208:211], a[232:235], a[208:211], v[208:211]
v_permlane16_swap_b32_e64 v112, v114
v_mfma_f32_16x16x32_bf16 v[212:215], a[232:235], a[212:215], v[212:215]
ds_read_b128 a[232:235], v244 offset:39936
v_mov_b32_e64 v134, s19
v_mfma_f32_32x32x16_bf16 v[144:159], a[132:135], a[236:239], v[144:159]
ds_write_b128 v247, v[8:11] offset:64032
v_cvt_pk_bf16_f32 v120, v204, v205
v_mfma_f32_32x32x16_bf16 v[160:175], a[136:139], a[236:239], v[160:175]
v_cvt_pk_bf16_f32 v121, v206, v207
v_cvt_pk_bf16_f32 v122, v208, v209
v_cvt_pk_bf16_f32 v123, v210, v211
v_cvt_pk_bf16_f32 v124, v212, v213
v_cvt_pk_bf16_f32 v125, v214, v215
v_mov_b32_e64 v135, s19
v_mfma_f32_32x32x16_bf16 v[176:191], a[140:143], a[236:239], v[176:191]
ds_read_b128 a[236:239], v245 offset:39936
ds_read_b128 v[8:11], v248 offset:1152
v_cvt_pk_bf16_f32 v88, v144, v145
v_cvt_pk_bf16_f32 v89, v146, v147
v_cvt_pk_bf16_f32 v90, v148, v149
v_cvt_pk_bf16_f32 v91, v150, v151
v_mfma_f32_16x16x32_bf16 v[192:195], a[240:243], a[144:147], 0
v_cvt_pk_bf16_f32 v100, v168, v169
v_cvt_pk_bf16_f32 v101, v170, v171
v_mfma_f32_16x16x32_bf16 v[196:199], a[240:243], a[148:151], 0
v_cvt_pk_bf16_f32 v102, v172, v173
v_cvt_pk_bf16_f32 v103, v174, v175
v_mfma_f32_16x16x32_bf16 v[200:203], a[240:243], a[152:155], 0
ds_read_b128 a[240:243], v244 offset:48128
v_cvt_pk_bf16_f32 v104, v176, v177
v_mfma_f32_16x16x32_bf16 v[192:195], a[244:247], a[156:159], v[192:195]
v_cvt_pk_bf16_f32 v105, v178, v179
v_cvt_pk_bf16_f32 v106, v180, v181
v_mfma_f32_16x16x32_bf16 v[196:199], a[244:247], a[160:163], v[196:199]
v_cvt_pk_bf16_f32 v107, v182, v183
v_cvt_pk_bf16_f32 v108, v184, v185
v_mfma_f32_16x16x32_bf16 v[200:203], a[244:247], a[164:167], v[200:203]
ds_read_b128 a[244:247], v245 offset:48128
v_cvt_pk_bf16_f32 v109, v186, v187
v_mfma_f32_16x16x32_bf16 v[192:195], a[248:251], a[168:171], v[192:195]
v_cvt_pk_bf16_f32 v110, v188, v189
v_cvt_pk_bf16_f32 v111, v190, v191
v_mfma_f32_16x16x32_bf16 v[196:199], a[248:251], a[172:175], v[196:199]
v_cvt_pk_bf16_f32 v92, v152, v153
v_cvt_pk_bf16_f32 v93, v154, v155
v_mfma_f32_16x16x32_bf16 v[200:203], a[248:251], a[176:179], v[200:203]
v_cvt_pk_bf16_f32 v94, v156, v157
v_cvt_pk_bf16_f32 v95, v158, v159
v_mfma_f32_16x16x32_bf16 v[192:195], a[252:255], a[180:183], v[192:195]
v_cvt_pk_bf16_f32 v96, v160, v161
v_cvt_pk_bf16_f32 v97, v162, v163
v_mfma_f32_16x16x32_bf16 v[196:199], a[252:255], a[184:187], v[196:199]
v_cvt_pk_bf16_f32 v98, v164, v165
v_cvt_pk_bf16_f32 v99, v166, v167
v_mfma_f32_16x16x32_bf16 v[200:203], a[252:255], a[188:191], v[200:203]
s_waitcnt lgkmcnt(1)
v_permlane16_swap_b32_e32 v113, v115
v_mfma_f32_16x16x32_bf16 v[192:195], a[216:219], a[192:195], v[192:195]
v_permlane16_swap_b32_e64 v124, v126
v_mfma_f32_16x16x32_bf16 v[196:199], a[216:219], a[196:199], v[196:199]
v_permlane16_swap_b32_e64 v125, v127
v_mfma_f32_16x16x32_bf16 v[200:203], a[216:219], a[200:203], v[200:203]
v_permlane16_swap_b32_e64 v120, v122
v_mfma_f32_16x16x32_bf16 v[192:195], a[220:223], a[204:207], v[192:195]
v_permlane16_swap_b32_e64 v121, v123
v_mfma_f32_16x16x32_bf16 v[196:199], a[220:223], a[208:211], v[196:199]
v_mov_b32_e64 v142, s19
v_mov_b32_e32 v143, s19
v_mfma_f32_16x16x32_bf16 v[200:203], a[220:223], a[212:215], v[200:203]
s_nop 1
v_mfma_f32_16x16x32_bf16 v[204:207], a[224:227], a[144:147], 0
v_cvt_pk_bf16_f32 v128, v192, v193
v_cvt_pk_bf16_f32 v129, v194, v195
v_mfma_f32_16x16x32_bf16 v[208:211], a[224:227], a[148:151], 0
v_cvt_pk_bf16_f32 v130, v196, v197
v_cvt_pk_bf16_f32 v131, v198, v199
v_mfma_f32_16x16x32_bf16 v[212:215], a[224:227], a[152:155], 0
v_cvt_pk_bf16_f32 v132, v200, v201
v_cvt_pk_bf16_f32 v133, v202, v203
v_mfma_f32_16x16x32_bf16 v[204:207], a[228:231], a[156:159], v[204:207]
v_permlane16_swap_b32_e64 v132, v134
v_mfma_f32_16x16x32_bf16 v[208:211], a[228:231], a[160:163], v[208:211]
v_permlane16_swap_b32_e64 v133, v135
v_mfma_f32_16x16x32_bf16 v[212:215], a[228:231], a[164:167], v[212:215]
v_permlane16_swap_b32_e64 v128, v130
v_mfma_f32_16x16x32_bf16 v[204:207], a[232:235], a[168:171], v[204:207]
v_permlane16_swap_b32_e64 v129, v131
v_mfma_f32_16x16x32_bf16 v[208:211], a[232:235], a[172:175], v[208:211]
v_mfma_f32_16x16x32_bf16 v[212:215], a[232:235], a[176:179], v[212:215]
v_mfma_f32_16x16x32_bf16 v[204:207], a[236:239], a[180:183], v[204:207]
v_mfma_f32_16x16x32_bf16 v[208:211], a[236:239], a[184:187], v[208:211]
v_mfma_f32_16x16x32_bf16 v[212:215], a[236:239], a[188:191], v[212:215]
v_mfma_f32_16x16x32_bf16 v[204:207], a[240:243], a[192:195], v[204:207]
v_mfma_f32_16x16x32_bf16 v[208:211], a[240:243], a[196:199], v[208:211]
s_nop 0
v_mfma_f32_16x16x32_bf16 v[212:215], a[240:243], a[200:203], v[212:215]
s_waitcnt lgkmcnt(0)
v_mfma_f32_16x16x32_bf16 v[204:207], a[244:247], a[204:207], v[204:207]
s_nop 2
v_mfma_f32_16x16x32_bf16 v[208:211], a[244:247], a[208:211], v[208:211]
s_nop 2
v_mfma_f32_16x16x32_bf16 v[212:215], a[244:247], a[212:215], v[212:215]
v_cvt_pk_bf16_f32 v136, v204, v205
v_cvt_pk_bf16_f32 v137, v206, v207
v_mfma_f32_32x32x16_bf16 v[0:15], v[76:79], v[64:67], v[0:15]
ds_write_b128 v247, v[16:19] offset:64064
v_cvt_pk_bf16_f32 v138, v208, v209
v_mfma_f32_32x32x16_bf16 v[0:15], v[80:83], v[68:71], v[0:15]
v_cvt_pk_bf16_f32 v139, v210, v211
v_permlane16_swap_b32_e64 v136, v138
v_cvt_pk_bf16_f32 v140, v212, v213
v_cvt_pk_bf16_f32 v141, v214, v215
v_mfma_f32_32x32x16_bf16 v[0:15], v[84:87], v[72:75], v[0:15]
ds_read_b128 v[16:19], v248 offset:1536
v_permlane16_swap_b32_e32 v140, v142
v_permlane16_swap_b32_e32 v141, v143
v_permlane16_swap_b32_e32 v137, v139
s_nop 7
v_max3_f32 v224, v0, v1, v2
v_max3_f32 v224, v224, v3, v4
v_max3_f32 v224, v224, v5, v6
v_max3_f32 v224, v224, v7, v8
v_max3_f32 v224, v224, v9, v10
v_max3_f32 v224, v224, v11, v12
v_max3_f32 v224, v224, v13, v14
v_max_f32_e64 v224, v224, v15
v_fma_f32 v224, v224, s70, v254
s_waitcnt vmcnt(1) lgkmcnt(0)
v_mfma_f32_32x32x16_bf16 v[16:31], v[100:103], v[64:67], v[16:31]
s_barrier
ds_read_b128 a[252:255], v246 offset:51200
ds_read_b64_tr_b16 v[232:233], v249
ds_read_b64_tr_b16 v[234:235], v249 offset:1536
ds_read_b64_tr_b16 a[216:217], v249 offset:64
ds_read_b64_tr_b16 a[218:219], v249 offset:1600
ds_read_b64_tr_b16 a[220:221], v249 offset:128
v_mfma_f32_32x32x16_bf16 v[16:31], v[104:107], v[68:71], v[16:31]
ds_read_b64_tr_b16 a[222:223], v249 offset:1664
ds_read_b128 a[224:227], v246 offset:51232
v_mfma_f32_32x32x16_bf16 v[16:31], v[108:111], v[72:75], v[16:31]
ds_read_b64_tr_b16 a[228:229], v249 offset:3072
ds_read_b64_tr_b16 a[230:231], v249 offset:4608
ds_read_b64_tr_b16 a[232:233], v249 offset:3136
ds_read_b64_tr_b16 a[234:235], v249 offset:4672
v_mfma_f32_32x32x16_bf16 v[32:47], v[76:79], v[88:91], v[32:47]
ds_read_b64_tr_b16 a[236:237], v249 offset:3200
ds_read_b64_tr_b16 a[238:239], v249 offset:4736
ds_read_b128 a[240:243], v246 offset:51264
s_nop 0
v_mfma_f32_32x32x16_bf16 v[32:47], v[80:83], v[92:95], v[32:47]
s_nop 0
ds_read_b64_tr_b16 a[244:245], v249 offset:6144
ds_read_b64_tr_b16 a[246:247], v249 offset:7680
v_max3_f32 v225, v16, v17, v18
v_max3_f32 v225, v225, v19, v20
v_mfma_f32_32x32x16_bf16 v[32:47], v[84:87], v[96:99], v[32:47]
ds_read_b64_tr_b16 a[248:249], v249 offset:6208
ds_read_b64_tr_b16 a[250:251], v249 offset:7744
v_max3_f32 v225, v225, v21, v22
v_max3_f32 v225, v225, v23, v24
v_max3_f32 v225, v225, v25, v26
v_max3_f32 v225, v225, v27, v28
v_mfma_f32_32x32x16_bf16 v[48:63], v[100:103], v[88:91], v[48:63]
v_max3_f32 v225, v225, v29, v30
v_max_f32_e64 v225, v225, v31
v_fma_f32 v225, v225, s70, v255
v_max_f32_e64 v224, v224, v225
v_mov_b32_e32 v225, v224
s_nop 0
v_mfma_f32_32x32x16_bf16 v[48:63], v[104:107], v[92:95], v[48:63]
v_permlane32_swap_b32_e32 v224, v225
v_max_f32_e32 v224, v224, v225
v_sub_f32_e64 v226, v254, v224
v_fma_f32 v0, v0, s70, v226
v_fma_f32 v1, v1, s70, v226
v_mfma_f32_32x32x16_bf16 v[48:63], v[108:111], v[96:99], v[48:63]
s_waitcnt lgkmcnt(6)
v_exp_f32_e32 v0, v0
v_exp_f32_e64 v1, v1
v_fma_f32 v2, v2, s70, v226
v_fma_f32 v3, v3, s70, v226
v_mfma_f32_32x32x16_bf16 v[64:79], v[232:235], a[252:255], 0
ds_read_b128 v[232:235], v246 offset:51296
v_exp_f32_e32 v2, v2
v_exp_f32_e32 v3, v3
v_fma_f32 v4, v4, s70, v226
v_mfma_f32_32x32x16_bf16 v[80:95], a[216:219], a[252:255], 0
ds_read_b64_tr_b16 a[216:217], v249 offset:9216
ds_read_b64_tr_b16 a[218:219], v249 offset:10752
v_fma_f32 v5, v5, s70, v226
v_fma_f32 v6, v6, s70, v226
v_fma_f32 v7, v7, s70, v226
v_cvt_pk_bf16_f32 v0, v0, v1
v_mfma_f32_32x32x16_bf16 v[96:111], a[220:223], a[252:255], 0
ds_read_b64_tr_b16 a[252:253], v249 offset:6272
ds_read_b64_tr_b16 a[254:255], v249 offset:7808
ds_read_b64_tr_b16 a[220:221], v249 offset:9280
ds_read_b64_tr_b16 a[222:223], v249 offset:10816
v_exp_f32_e64 v4, v4
v_mfma_f32_32x32x16_bf16 v[64:79], a[228:231], a[224:227], v[64:79]
ds_read_b128 a[228:231], v246 offset:51328
v_exp_f32_e32 v5, v5
v_exp_f32_e32 v6, v6
v_cvt_pk_bf16_f32 v1, v2, v3
v_mfma_f32_32x32x16_bf16 v[80:95], a[232:235], a[224:227], v[80:95]
s_waitcnt lgkmcnt(8)
ds_read_b64_tr_b16 a[232:233], v249 offset:12288
ds_read_b64_tr_b16 a[234:235], v249 offset:13824
v_exp_f32_e32 v7, v7
v_cvt_pk_bf16_f32 v2, v4, v5
v_cvt_pk_bf16_f32 v3, v6, v7
v_mfma_f32_32x32x16_bf16 v[96:111], a[236:239], a[224:227], v[96:111]
ds_read_b64_tr_b16 a[224:225], v249 offset:9344
ds_read_b64_tr_b16 a[226:227], v249 offset:10880
ds_read_b64_tr_b16 a[236:237], v249 offset:12352
ds_read_b64_tr_b16 a[238:239], v249 offset:13888
v_fma_f32 v8, v8, s70, v226
v_fma_f32 v9, v9, s70, v226
v_mfma_f32_32x32x16_bf16 v[64:79], a[244:247], a[240:243], v[64:79]
ds_read_b128 a[244:247], v246 offset:51360
v_fma_f32 v10, v10, s70, v226
v_fma_f32 v11, v11, s70, v226
v_fma_f32 v12, v12, s70, v226
v_fma_f32 v13, v13, s70, v226
v_fma_f32 v14, v14, s70, v226
v_mfma_f32_32x32x16_bf16 v[80:95], a[248:251], a[240:243], v[80:95]
s_waitcnt lgkmcnt(8)
ds_read_b64_tr_b16 a[248:249], v249 offset:15360
ds_read_b64_tr_b16 a[250:251], v249 offset:16896
v_fma_f32 v15, v15, s70, v226
v_exp_f32_e32 v8, v8
v_sub_f32_e64 v227, v255, v224
v_mfma_f32_32x32x16_bf16 v[96:111], a[252:255], a[240:243], v[96:111]
ds_read_b64_tr_b16 a[240:241], v249 offset:12416
ds_read_b64_tr_b16 a[242:243], v249 offset:13952
ds_read_b64_tr_b16 a[252:253], v249 offset:15424
ds_read_b64_tr_b16 a[254:255], v249 offset:16960
v_exp_f32_e64 v9, v9
v_mfma_f32_32x32x16_bf16 v[64:79], a[216:219], v[232:235], v[64:79]
ds_read_b128 a[216:219], v246 offset:51392
v_exp_f32_e32 v10, v10
v_exp_f32_e32 v11, v11
v_cvt_pk_bf16_f32 v4, v8, v9
v_mfma_f32_32x32x16_bf16 v[80:95], a[220:223], v[232:235], v[80:95]
s_waitcnt lgkmcnt(8)
ds_read_b64_tr_b16 a[220:221], v249 offset:18432
ds_read_b64_tr_b16 a[222:223], v249 offset:19968
v_exp_f32_e32 v12, v12
v_exp_f32_e64 v13, v13
v_mfma_f32_32x32x16_bf16 v[96:111], a[224:227], v[232:235], v[96:111]
ds_read_b64_tr_b16 v[232:233], v249 offset:15488
ds_read_b64_tr_b16 v[234:235], v249 offset:17024
ds_read_b64_tr_b16 a[224:225], v249 offset:18496
ds_read_b64_tr_b16 a[226:227], v249 offset:20032
v_exp_f32_e64 v14, v14
v_mfma_f32_32x32x16_bf16 v[64:79], a[232:235], a[228:231], v[64:79]
ds_read_b128 a[232:235], v246 offset:51424
v_exp_f32_e32 v15, v15
v_cvt_pk_bf16_f32 v5, v10, v11
v_cvt_pk_bf16_f32 v6, v12, v13
v_cvt_pk_bf16_f32 v7, v14, v15
v_mfma_f32_32x32x16_bf16 v[80:95], a[236:239], a[228:231], v[80:95]
s_waitcnt lgkmcnt(8)
ds_read_b64_tr_b16 a[236:237], v249 offset:21504
ds_read_b64_tr_b16 a[238:239], v249 offset:23040
v_fma_f32 v16, v16, s70, v227
v_fma_f32 v17, v17, s70, v227
v_fma_f32 v18, v18, s70, v227
v_fma_f32 v19, v19, s70, v227
v_mfma_f32_32x32x16_bf16 v[96:111], a[240:243], a[228:231], v[96:111]
ds_read_b64_tr_b16 a[228:229], v249 offset:18560
ds_read_b64_tr_b16 a[230:231], v249 offset:20096
ds_read_b64_tr_b16 a[240:241], v249 offset:21568
ds_read_b64_tr_b16 a[242:243], v249 offset:23104
v_fma_f32 v20, v20, s70, v227
v_fma_f32 v21, v21, s70, v227
v_mfma_f32_32x32x16_bf16 v[64:79], a[248:251], a[244:247], v[64:79]
ds_read_b128 a[248:251], v246 offset:51456
v_fma_f32 v22, v22, s70, v227
v_fma_f32 v23, v23, s70, v227
v_exp_f32_e32 v16, v16
v_fma_f32 v24, v24, s70, v227
v_mfma_f32_32x32x16_bf16 v[80:95], a[252:255], a[244:247], v[80:95]
s_waitcnt lgkmcnt(8)
ds_read_b64_tr_b16 a[252:253], v249 offset:24576
ds_read_b64_tr_b16 a[254:255], v249 offset:26112
v_exp_f32_e32 v17, v17
v_exp_f32_e32 v18, v18
v_mfma_f32_32x32x16_bf16 v[96:111], v[232:235], a[244:247], v[96:111]
ds_read_b64_tr_b16 a[244:245], v249 offset:21632
ds_read_b64_tr_b16 a[246:247], v249 offset:23168
ds_read_b64_tr_b16 v[232:233], v249 offset:24640
ds_read_b64_tr_b16 v[234:235], v249 offset:26176
v_exp_f32_e64 v19, v19
v_mfma_f32_32x32x16_bf16 v[64:79], a[220:223], a[216:219], v[64:79]
ds_read_b128 a[220:223], v246 offset:51488
v_exp_f32_e32 v20, v20
v_exp_f32_e32 v21, v21
v_cvt_pk_bf16_f32 v8, v16, v17
v_mfma_f32_32x32x16_bf16 v[80:95], a[224:227], a[216:219], v[80:95]
s_waitcnt lgkmcnt(8)
ds_read_b64_tr_b16 a[224:225], v249 offset:27648
ds_read_b64_tr_b16 a[226:227], v249 offset:29184
v_exp_f32_e32 v22, v22
v_exp_f32_e64 v23, v23
v_mfma_f32_32x32x16_bf16 v[96:111], a[228:231], a[216:219], v[96:111]
ds_read_b64_tr_b16 a[216:217], v249 offset:24704
ds_read_b64_tr_b16 a[218:219], v249 offset:26240
ds_read_b64_tr_b16 a[228:229], v249 offset:27712
ds_read_b64_tr_b16 a[230:231], v249 offset:29248
v_cvt_pk_bf16_f32 v9, v18, v19
v_cvt_pk_bf16_f32 v10, v20, v21
v_mfma_f32_32x32x16_bf16 v[64:79], a[236:239], a[232:235], v[64:79]
s_nop 0
ds_read_b128 a[236:239], v246 offset:51520
v_cvt_pk_bf16_f32 v11, v22, v23
v_fma_f32 v25, v25, s70, v227
v_fma_f32 v26, v26, s70, v227
v_fma_f32 v27, v27, s70, v227
v_fma_f32 v28, v28, s70, v227
v_mfma_f32_32x32x16_bf16 v[80:95], a[240:243], a[232:235], v[80:95]
s_waitcnt lgkmcnt(8)
ds_read_b64_tr_b16 a[240:241], v249 offset:30720
ds_read_b64_tr_b16 a[242:243], v249 offset:32256
v_fma_f32 v29, v29, s70, v227
v_fma_f32 v30, v30, s70, v227
v_fma_f32 v31, v31, s70, v227
v_max3_f32 v224, v32, v33, v34
v_mfma_f32_32x32x16_bf16 v[96:111], a[244:247], a[232:235], v[96:111]
ds_read_b64_tr_b16 a[232:233], v249 offset:27776
ds_read_b64_tr_b16 a[234:235], v249 offset:29312
ds_read_b64_tr_b16 a[244:245], v249 offset:30784
ds_read_b64_tr_b16 a[246:247], v249 offset:32320
v_exp_f32_e64 v24, v24
v_mfma_f32_32x32x16_bf16 v[64:79], a[252:255], a[248:251], v[64:79]
ds_read_b128 a[252:255], v246 offset:51552
v_exp_f32_e32 v25, v25
v_exp_f32_e32 v26, v26
v_cvt_pk_bf16_f32 v12, v24, v25
v_mfma_f32_32x32x16_bf16 v[80:95], v[232:235], a[248:251], v[80:95]
s_waitcnt lgkmcnt(8)
ds_read_b64_tr_b16 v[232:233], v249 offset:33792
ds_read_b64_tr_b16 v[234:235], v249 offset:35328
v_exp_f32_e32 v27, v27
v_exp_f32_e64 v28, v28
v_mfma_f32_32x32x16_bf16 v[96:111], a[216:219], a[248:251], v[96:111]
ds_read_b64_tr_b16 a[248:249], v249 offset:30848
ds_read_b64_tr_b16 a[250:251], v249 offset:32384
ds_read_b64_tr_b16 a[216:217], v249 offset:33856
ds_read_b64_tr_b16 a[218:219], v249 offset:35392
v_exp_f32_e64 v29, v29
v_mfma_f32_32x32x16_bf16 v[64:79], a[224:227], a[220:223], v[64:79]
v_exp_f32_e32 v30, v30
v_exp_f32_e32 v31, v31
v_cvt_pk_bf16_f32 v13, v26, v27
s_waitcnt lgkmcnt(6)
s_barrier
v_mfma_f32_32x32x16_bf16 v[80:95], a[228:231], a[220:223], v[80:95]
ds_read_b128 a[224:227], v240
ds_read_b128 a[228:231], v241
v_cvt_pk_bf16_f32 v14, v28, v29
v_cvt_pk_bf16_f32 v15, v30, v31
v_max3_f32 v225, v48, v49, v50
v_max3_f32 v224, v224, v35, v36
v_mfma_f32_32x32x16_bf16 v[96:111], a[232:235], a[220:223], v[96:111]
ds_read_b64_tr_b16 a[220:221], v249 offset:33920
ds_read_b64_tr_b16 a[222:223], v249 offset:35456
ds_read_b128 a[232:235], v242
v_max3_f32 v225, v225, v51, v52
v_max3_f32 v224, v224, v37, v38
v_max3_f32 v225, v225, v53, v54
v_mfma_f32_32x32x16_bf16 v[64:79], a[240:243], a[236:239], v[64:79]
ds_read_b128 a[240:243], v240 offset:8192
v_max3_f32 v224, v224, v39, v40
v_max3_f32 v225, v225, v55, v56
v_max3_f32 v224, v224, v41, v42
v_max3_f32 v225, v225, v57, v58
v_max3_f32 v224, v224, v43, v44
v_mfma_f32_32x32x16_bf16 v[80:95], a[244:247], a[236:239], v[80:95]
s_waitcnt lgkmcnt(6)
ds_read_b128 a[244:247], v241 offset:8192
v_max3_f32 v225, v225, v59, v60
v_max3_f32 v224, v224, v45, v46
v_max3_f32 v225, v225, v61, v62
v_max_f32_e32 v224, v224, v47
v_max_f32_e64 v225, v225, v63
v_mfma_f32_32x32x16_bf16 v[96:111], a[248:251], a[236:239], v[96:111]
ds_read_b128 a[236:239], v243
ds_read_b128 a[248:251], v242 offset:8192
v_fma_f32 v224, v224, s70, v255
v_fma_f32 v225, v225, s70, v254
v_max_f32_e32 v224, v224, v225
v_mov_b32_e32 v225, v224
v_mfma_f32_32x32x16_bf16 v[64:79], v[232:235], a[252:255], v[64:79]
ds_read_b128 v[232:235], v240 offset:16384
v_permlane32_swap_b32_e32 v224, v225
v_max_f32_e32 v224, v224, v225
v_sub_f32_e32 v228, v255, v224
v_fma_f32 v32, v32, s70, v228
v_mfma_f32_32x32x16_bf16 v[80:95], a[216:219], a[252:255], v[80:95]
s_waitcnt lgkmcnt(5)
ds_read_b128 a[216:219], v241 offset:16384
v_fma_f32 v33, v33, s70, v228
v_exp_f32_e32 v32, v32
v_exp_f32_e32 v33, v33
v_mfma_f32_32x32x16_bf16 v[96:111], a[220:223], a[252:255], v[96:111]
ds_read_b128 a[252:255], v243 offset:8192
ds_read_b128 a[220:223], v242 offset:16384
v_cvt_pk_bf16_f32 v64, v64, v65
v_cvt_pk_bf16_f32 v72, v72, v73
v_cvt_pk_bf16_f32 v65, v66, v67
v_cvt_pk_bf16_f32 v73, v74, v75
v_mfma_f32_32x32x16_bf16 v[144:159], a[0:3], a[224:227], 0
v_cvt_pk_bf16_f32 v66, v68, v69
v_cvt_pk_bf16_f32 v67, v70, v71
v_cvt_pk_bf16_f32 v74, v76, v77
v_cvt_pk_bf16_f32 v75, v78, v79
v_cvt_pk_bf16_f32 v80, v80, v81
v_cvt_pk_bf16_f32 v88, v88, v89
v_mfma_f32_32x32x16_bf16 v[160:175], a[4:7], a[224:227], 0
ds_write_b128 v230, v[64:67] offset:25600
v_cvt_pk_bf16_f32 v81, v82, v83
v_mfma_f32_32x32x16_bf16 v[176:191], a[8:11], a[224:227], 0
v_cvt_pk_bf16_f32 v89, v90, v91
v_cvt_pk_bf16_f32 v82, v84, v85
v_cvt_pk_bf16_f32 v83, v86, v87
v_cvt_pk_bf16_f32 v90, v92, v93
v_cvt_pk_bf16_f32 v91, v94, v95
v_fma_f32 v34, v34, s70, v228
v_mfma_f32_32x32x16_bf16 v[144:159], a[12:15], a[228:231], v[144:159]
ds_read_b128 a[224:227], v243 offset:16384
ds_write_b128 v230, v[72:75] offset:25632
v_mfma_f32_32x32x16_bf16 v[160:175], a[16:19], a[228:231], v[160:175]
v_fma_f32 v35, v35, s70, v228
v_exp_f32_e32 v34, v34
v_exp_f32_e32 v35, v35
v_fma_f32 v36, v36, s70, v228
v_mfma_f32_32x32x16_bf16 v[176:191], a[20:23], a[228:231], v[176:191]
ds_read_b128 v[68:71], v231 offset:25600
ds_read_b128 v[76:79], v231 offset:32000
ds_read_b128 a[228:231], v240 offset:4096
v_fma_f32 v37, v37, s70, v228
v_fma_f32 v38, v38, s70, v228
v_fma_f32 v39, v39, s70, v228
v_mfma_f32_32x32x16_bf16 v[144:159], a[24:27], a[232:235], v[144:159]
ds_write_b128 v230, v[80:83] offset:25664
v_cvt_pk_bf16_f32 v32, v32, v33
v_mfma_f32_32x32x16_bf16 v[160:175], a[28:31], a[232:235], v[160:175]
v_exp_f32_e32 v36, v36
v_exp_f32_e32 v37, v37
v_exp_f32_e64 v38, v38
v_mfma_f32_32x32x16_bf16 v[176:191], a[32:35], a[232:235], v[176:191]
s_waitcnt lgkmcnt(4)
ds_write_b128 v230, v[88:91] offset:25696
v_cvt_pk_bf16_f32 v33, v34, v35
v_mfma_f32_32x32x16_bf16 v[144:159], a[36:39], a[236:239], v[144:159]
s_waitcnt lgkmcnt(4)
buffer_store_dwordx4 v[68:71], v250, s[36:39], s58 offen sc1
ds_read_b128 v[84:87], v231 offset:25664
v_mfma_f32_32x32x16_bf16 v[160:175], a[40:43], a[236:239], v[160:175]
ds_read_b128 a[232:235], v241 offset:4096
v_exp_f32_e64 v39, v39
v_cvt_pk_bf16_f32 v34, v36, v37
v_cvt_pk_bf16_f32 v35, v38, v39
v_fma_f32 v40, v40, s70, v228
v_mfma_f32_32x32x16_bf16 v[176:191], a[44:47], a[236:239], v[176:191]
ds_read_b128 a[236:239], v242 offset:4096
v_fma_f32 v41, v41, s70, v228
v_fma_f32 v42, v42, s70, v228
v_fma_f32 v43, v43, s70, v228
v_fma_f32 v44, v44, s70, v228
v_fma_f32 v45, v45, s70, v228
v_mfma_f32_32x32x16_bf16 v[144:159], a[48:51], a[240:243], v[144:159]
v_fma_f32 v46, v46, s70, v228
v_fma_f32 v47, v47, s70, v228
v_exp_f32_e64 v40, v40
v_exp_f32_e32 v41, v41
v_mfma_f32_32x32x16_bf16 v[160:175], a[52:55], a[240:243], v[160:175]
s_waitcnt lgkmcnt(3)
buffer_store_dwordx4 v[76:79], v250, s[36:39], s76 offen sc1
v_cvt_pk_bf16_f32 v36, v40, v41
v_mfma_f32_32x32x16_bf16 v[176:191], a[56:59], a[240:243], v[176:191]
ds_read_b128 a[240:243], v243 offset:4096
v_exp_f32_e32 v42, v42
v_exp_f32_e32 v43, v43
v_sub_f32_e64 v229, v254, v224
v_mfma_f32_32x32x16_bf16 v[144:159], a[60:63], a[244:247], v[144:159]
v_exp_f32_e32 v44, v44
v_exp_f32_e32 v45, v45
v_exp_f32_e64 v46, v46
v_mfma_f32_32x32x16_bf16 v[160:175], a[64:67], a[244:247], v[160:175]
v_exp_f32_e64 v47, v47
v_cvt_pk_bf16_f32 v37, v42, v43
v_cvt_pk_bf16_f32 v38, v44, v45
v_cvt_pk_bf16_f32 v39, v46, v47
v_fma_f32 v48, v48, s70, v229
v_mfma_f32_32x32x16_bf16 v[176:191], a[68:71], a[244:247], v[176:191]
s_waitcnt lgkmcnt(1)
buffer_store_dwordx4 v[84:87], v250, s[36:39], s58 offen offset:64 sc1
ds_read_b128 a[244:247], v240 offset:12288
v_mfma_f32_32x32x16_bf16 v[144:159], a[72:75], a[248:251], v[144:159]
s_nop 0
v_fma_f32 v49, v49, s70, v229
v_fma_f32 v50, v50, s70, v229
v_fma_f32 v51, v51, s70, v229
v_fma_f32 v52, v52, s70, v229
v_fma_f32 v53, v53, s70, v229
v_fma_f32 v54, v54, s70, v229
v_mfma_f32_32x32x16_bf16 v[160:175], a[76:79], a[248:251], v[160:175]
v_fma_f32 v55, v55, s70, v229
v_exp_f32_e32 v48, v48
v_exp_f32_e32 v49, v49
v_fma_f32 v56, v56, s70, v229
v_mfma_f32_32x32x16_bf16 v[176:191], a[80:83], a[248:251], v[176:191]
ds_read_b128 a[248:251], v241 offset:12288
v_exp_f32_e32 v50, v50
v_exp_f32_e32 v51, v51
v_cvt_pk_bf16_f32 v40, v48, v49
v_mfma_f32_32x32x16_bf16 v[144:159], a[84:87], a[252:255], v[144:159]
v_exp_f32_e32 v52, v52
v_exp_f32_e32 v53, v53
v_exp_f32_e64 v54, v54
v_mfma_f32_32x32x16_bf16 v[160:175], a[88:91], a[252:255], v[160:175]
v_exp_f32_e64 v55, v55
v_cvt_pk_bf16_f32 v41, v50, v51
v_cvt_pk_bf16_f32 v42, v52, v53
v_cvt_pk_bf16_f32 v43, v54, v55
v_fma_f32 v57, v57, s70, v229
v_mfma_f32_32x32x16_bf16 v[176:191], a[92:95], a[252:255], v[176:191]
ds_read_b128 a[252:255], v242 offset:12288
v_fma_f32 v58, v58, s70, v229
v_fma_f32 v59, v59, s70, v229
v_fma_f32 v60, v60, s70, v229
v_fma_f32 v61, v61, s70, v229
v_fma_f32 v62, v62, s70, v229
v_mfma_f32_32x32x16_bf16 v[144:159], a[96:99], v[232:235], v[144:159]
v_fma_f32 v63, v63, s70, v229
v_exp_f32_e32 v56, v56
v_exp_f32_e32 v57, v57
v_cvt_pk_bf16_f32 v96, v96, v97
v_mfma_f32_32x32x16_bf16 v[160:175], a[100:103], v[232:235], v[160:175]
v_exp_f32_e32 v58, v58
v_exp_f32_e32 v59, v59
v_exp_f32_e64 v60, v60
v_mfma_f32_32x32x16_bf16 v[176:191], a[104:107], v[232:235], v[176:191]
ds_read_b128 v[232:235], v243 offset:12288
v_exp_f32_e32 v61, v61
v_exp_f32_e32 v62, v62
v_cvt_pk_bf16_f32 v44, v56, v57
v_mfma_f32_32x32x16_bf16 v[144:159], a[108:111], a[216:219], v[144:159]
v_exp_f32_e64 v63, v63
v_cvt_pk_bf16_f32 v45, v58, v59
v_cvt_pk_bf16_f32 v46, v60, v61
v_cvt_pk_bf16_f32 v47, v62, v63
v_cvt_pk_bf16_f32 v104, v104, v105
v_mfma_f32_32x32x16_bf16 v[160:175], a[112:115], a[216:219], v[160:175]
ds_read_b128 v[92:95], v231 offset:32064
ds_read_b128 v[48:51], v248 offset:768
ds_read_b128 v[52:55], v248 offset:960
v_cvt_pk_bf16_f32 v97, v98, v99
v_cvt_pk_bf16_f32 v105, v106, v107
v_cvt_pk_bf16_f32 v98, v100, v101
v_mfma_f32_32x32x16_bf16 v[176:191], a[116:119], a[216:219], v[176:191]
ds_read_b128 a[216:219], v244
ds_read_b128 v[56:59], v248 offset:1152
v_cvt_pk_bf16_f32 v99, v102, v103
v_cvt_pk_bf16_f32 v106, v108, v109
v_cvt_pk_bf16_f32 v107, v110, v111
v_mul_f32_e64 v254, s64, v253
v_mfma_f32_32x32x16_bf16 v[144:159], a[120:123], a[220:223], v[144:159]
ds_write_b128 v230, v[96:99] offset:25728
v_min_f32_e64 v255, s68, v254
v_mfma_f32_32x32x16_bf16 v[160:175], a[124:127], a[220:223], v[160:175]
ds_read_b128 v[60:63], v248 offset:1344
v_mfma_f32_32x32x16_bf16 v[176:191], a[128:131], a[220:223], v[176:191]
ds_read_b128 a[220:223], v245
ds_write_b128 v230, v[104:107] offset:25760
v_mfma_f32_32x32x16_bf16 v[144:159], a[132:135], a[224:227], v[144:159]
s_waitcnt lgkmcnt(7)
buffer_store_dwordx4 v[92:95], v250, s[36:39], s76 offen offset:64 sc1
s_nop 0
v_mfma_f32_32x32x16_bf16 v[160:175], a[136:139], a[224:227], v[160:175]
ds_read_b128 v[100:103], v231 offset:25728
ds_read_b128 v[108:111], v231 offset:32128
s_nop 2
v_mfma_f32_32x32x16_bf16 v[176:191], a[140:143], a[224:227], v[176:191]
ds_read_b128 a[224:227], v244 offset:8192
s_nop 1
v_cvt_pk_bf16_f32 v64, v144, v145
v_cvt_pk_bf16_f32 v65, v146, v147
v_cvt_pk_bf16_f32 v66, v148, v149
v_mfma_f32_32x32x16_bf16 v[208:223], v[116:119], v[0:3], 0
v_cvt_pk_bf16_f32 v67, v150, v151
v_cvt_pk_bf16_f32 v68, v152, v153
v_cvt_pk_bf16_f32 v69, v154, v155
v_cvt_pk_bf16_f32 v70, v156, v157
v_cvt_pk_bf16_f32 v71, v158, v159
v_cvt_pk_bf16_f32 v72, v160, v161
v_mfma_f32_32x32x16_bf16 v[192:207], v[112:115], v[0:3], 0
v_cvt_pk_bf16_f32 v73, v162, v163
v_cvt_pk_bf16_f32 v74, v164, v165
v_cvt_pk_bf16_f32 v75, v166, v167
v_cvt_pk_bf16_f32 v76, v168, v169
v_cvt_pk_bf16_f32 v77, v170, v171
v_cvt_pk_bf16_f32 v78, v172, v173
v_mfma_f32_32x32x16_bf16 v[208:223], v[124:127], v[4:7], v[208:223]
v_cvt_pk_bf16_f32 v79, v174, v175
v_cvt_pk_bf16_f32 v80, v176, v177
v_cvt_pk_bf16_f32 v81, v178, v179
v_cvt_pk_bf16_f32 v82, v180, v181
v_cvt_pk_bf16_f32 v83, v182, v183
v_cvt_pk_bf16_f32 v84, v184, v185
v_mfma_f32_32x32x16_bf16 v[192:207], v[120:123], v[4:7], v[192:207]
v_cvt_pk_bf16_f32 v85, v186, v187
v_cvt_pk_bf16_f32 v86, v188, v189
v_cvt_pk_bf16_f32 v87, v190, v191
v_mfma_f32_32x32x16_bf16 v[208:223], v[132:135], v[8:11], v[208:223]
s_waitcnt lgkmcnt(0)
buffer_store_dwordx4 v[100:103], v250, s[36:39], s58 offen offset:128 sc1
v_mfma_f32_32x32x16_bf16 v[192:207], v[128:131], v[8:11], v[192:207]
s_nop 0
v_mfma_f32_32x32x16_bf16 v[208:223], v[140:143], v[12:15], v[208:223]
s_nop 6
v_mfma_f32_32x32x16_bf16 v[192:207], v[136:139], v[12:15], v[192:207]
s_nop 2
v_mfma_f32_32x32x16_bf16 v[144:159], a[0:3], a[228:231], 0
v_rcp_f32_e64 v217, v216
ds_read_b64_tr_b16 a[0:1], v249
v_mul_f32_e64 v208, v217, v208
v_mfma_f32_32x32x16_bf16 v[160:175], a[4:7], a[228:231], 0
v_mul_f32_e32 v209, v217, v209
v_mul_f32_e32 v210, v217, v210
v_mul_f32_e64 v211, v217, v211
v_cvt_pk_bf16_f32 v208, v208, v209
v_mul_f32_e32 v192, v217, v192
v_mul_f32_e32 v193, v217, v193
v_mfma_f32_32x32x16_bf16 v[176:191], a[8:11], a[228:231], 0
ds_read_b128 a[228:231], v245 offset:8192
v_mul_f32_e32 v194, v217, v194
v_mul_f32_e32 v195, v217, v195
v_cvt_pk_bf16_f32 v192, v192, v193
v_mul_f32_e32 v196, v217, v196
v_mul_f32_e32 v197, v217, v197
v_mfma_f32_32x32x16_bf16 v[144:159], a[12:15], a[232:235], v[144:159]
v_mul_f32_e32 v198, v217, v198
v_mul_f32_e32 v199, v217, v199
v_cvt_pk_bf16_f32 v193, v194, v195
v_cvt_pk_bf16_f32 v194, v196, v197
v_cvt_pk_bf16_f32 v195, v198, v199
v_mul_f32_e64 v200, v217, v200
v_mfma_f32_32x32x16_bf16 v[160:175], a[16:19], a[232:235], v[160:175]
ds_write_b128 v247, v[192:195] offset:51200
v_mul_f32_e64 v201, v217, v201
v_mfma_f32_32x32x16_bf16 v[176:191], a[20:23], a[232:235], v[176:191]
v_mul_f32_e32 v202, v217, v202
v_mul_f32_e32 v203, v217, v203
v_cvt_pk_bf16_f32 v200, v200, v201
v_mul_f32_e32 v204, v217, v204
v_mul_f32_e32 v205, v217, v205
v_mul_f32_e64 v206, v217, v206
v_mfma_f32_32x32x16_bf16 v[144:159], a[24:27], a[236:239], v[144:159]
ds_read_b128 a[232:235], v244 offset:16384
v_mul_f32_e64 v207, v217, v207
v_cvt_pk_bf16_f32 v201, v202, v203
v_cvt_pk_bf16_f32 v202, v204, v205
v_cvt_pk_bf16_f32 v203, v206, v207
v_mul_f32_e64 v212, v217, v212
v_mfma_f32_32x32x16_bf16 v[160:175], a[28:31], a[236:239], v[160:175]
ds_write_b128 v247, v[200:203] offset:51232
v_mul_f32_e64 v213, v217, v213
v_mfma_f32_32x32x16_bf16 v[176:191], a[32:35], a[236:239], v[176:191]
v_mul_f32_e32 v214, v217, v214
v_mul_f32_e32 v215, v217, v215
v_cvt_pk_bf16_f32 v209, v210, v211
v_cvt_pk_bf16_f32 v210, v212, v213
v_cvt_pk_bf16_f32 v211, v214, v215
v_mfma_f32_32x32x16_bf16 v[144:159], a[36:39], a[240:243], v[144:159]
ds_read_b128 a[236:239], v245 offset:16384
ds_write_b128 v247, v[208:211] offset:51264
v_mfma_f32_32x32x16_bf16 v[160:175], a[40:43], a[240:243], v[160:175]
buffer_store_dwordx4 v[108:111], v250, s[36:39], s76 offen offset:128 sc1
ds_read_b64_tr_b16 a[2:3], v249 offset:1536
v_mfma_f32_32x32x16_bf16 v[176:191], a[44:47], a[240:243], v[176:191]
s_add_u32 s76, s60, 0x2a000
ds_read_b128 a[240:243], v240 offset:20480
ds_read_b64_tr_b16 a[4:5], v249 offset:64
ds_read_b64_tr_b16 a[6:7], v249 offset:1600
ds_read_b64_tr_b16 a[8:9], v249 offset:128
v_mfma_f32_32x32x16_bf16 v[144:159], a[48:51], a[244:247], v[144:159]
ds_read_b64_tr_b16 a[10:11], v249 offset:1664
ds_read_b64_tr_b16 a[12:13], v249 offset:3072
ds_read_b64_tr_b16 a[14:15], v249 offset:4608
ds_read_b64_tr_b16 a[16:17], v249 offset:3136
v_mfma_f32_32x32x16_bf16 v[160:175], a[52:55], a[244:247], v[160:175]
ds_read_b64_tr_b16 a[18:19], v249 offset:4672
ds_read_b64_tr_b16 a[20:21], v249 offset:3200
ds_read_b64_tr_b16 a[22:23], v249 offset:4736
v_mfma_f32_32x32x16_bf16 v[176:191], a[56:59], a[244:247], v[176:191]
ds_read_b128 a[244:247], v241 offset:20480
ds_read_b64_tr_b16 a[24:25], v249 offset:6144
ds_read_b64_tr_b16 a[26:27], v249 offset:7680
v_mfma_f32_32x32x16_bf16 v[144:159], a[60:63], a[248:251], v[144:159]
ds_read_b64_tr_b16 a[28:29], v249 offset:6208
ds_read_b64_tr_b16 a[30:31], v249 offset:7744
v_mfma_f32_32x32x16_bf16 v[160:175], a[64:67], a[248:251], v[160:175]
ds_read_b64_tr_b16 a[32:33], v249 offset:6272
ds_read_b64_tr_b16 a[34:35], v249 offset:7808
ds_read_b64_tr_b16 a[36:37], v249 offset:9216
ds_read_b64_tr_b16 a[38:39], v249 offset:10752
v_mfma_f32_32x32x16_bf16 v[176:191], a[68:71], a[248:251], v[176:191]
ds_read_b128 a[248:251], v244 offset:2048
ds_read_b64_tr_b16 a[40:41], v249 offset:9280
ds_read_b64_tr_b16 a[42:43], v249 offset:10816
v_mfma_f32_32x32x16_bf16 v[16:31], v[116:119], v[32:35], 0
ds_read_b64_tr_b16 a[44:45], v249 offset:9344
ds_read_b64_tr_b16 a[46:47], v249 offset:10880
ds_read_b64_tr_b16 a[48:49], v249 offset:12288
v_mov_b32_e32 v118, s19
v_mov_b32_e32 v119, s19
v_mfma_f32_32x32x16_bf16 v[0:15], v[112:115], v[32:35], 0
ds_read_b128 v[32:35], v248
ds_read_b64_tr_b16 a[50:51], v249 offset:13824
ds_read_b64_tr_b16 a[52:53], v249 offset:12352
ds_read_b64_tr_b16 a[54:55], v249 offset:13888
v_mfma_f32_32x32x16_bf16 v[16:31], v[124:127], v[36:39], v[16:31]
ds_read_b64_tr_b16 a[56:57], v249 offset:12416
ds_read_b64_tr_b16 a[58:59], v249 offset:13952
v_mov_b32_e32 v126, s19
v_mov_b32_e32 v127, s19
v_mfma_f32_32x32x16_bf16 v[0:15], v[120:123], v[36:39], v[0:15]
ds_read_b128 v[36:39], v248 offset:192
ds_read_b64_tr_b16 a[60:61], v249 offset:15360
ds_read_b64_tr_b16 a[62:63], v249 offset:16896
ds_read_b64_tr_b16 a[64:65], v249 offset:15424
v_mfma_f32_32x32x16_bf16 v[16:31], v[132:135], v[40:43], v[16:31]
ds_read_b64_tr_b16 a[66:67], v249 offset:16960
ds_read_b64_tr_b16 a[68:69], v249 offset:15488
v_mov_b32_e32 v134, s19
v_mov_b32_e32 v135, s19
v_mfma_f32_32x32x16_bf16 v[0:15], v[128:131], v[40:43], v[0:15]
ds_read_b128 v[40:43], v248 offset:384
ds_read_b64_tr_b16 a[70:71], v249 offset:17024
v_mfma_f32_32x32x16_bf16 v[16:31], v[140:143], v[44:47], v[16:31]
v_mov_b32_e64 v142, s19
v_mov_b32_e32 v143, s19
s_nop 3
v_mfma_f32_32x32x16_bf16 v[0:15], v[136:139], v[44:47], v[0:15]
s_nop 0
ds_read_b128 v[44:47], v248 offset:576
s_nop 2
v_mfma_f32_32x32x16_bf16 v[144:159], a[72:75], a[252:255], v[144:159]
ds_read_b128 v[28:31], v248 offset:2112
v_rcp_f32_e64 v25, v24
ds_read_b64_tr_b16 a[72:73], v249 offset:18432
v_mfma_f32_32x32x16_bf16 v[160:175], a[76:79], a[252:255], v[160:175]
v_mul_f32_e32 v16, v25, v16
v_mul_f32_e32 v17, v25, v17
v_mul_f32_e32 v18, v25, v18
v_mul_f32_e32 v0, v25, v0
v_mul_f32_e32 v1, v25, v1
v_mul_f32_e32 v8, v25, v8
v_mfma_f32_32x32x16_bf16 v[176:191], a[80:83], a[252:255], v[176:191]
ds_read_b128 a[252:255], v245 offset:2048
v_mul_f32_e32 v9, v25, v9
v_mul_f32_e32 v2, v25, v2
v_mul_f32_e64 v3, v25, v3
v_cvt_pk_bf16_f32 v0, v0, v1
v_mul_f32_e64 v10, v25, v10
v_mfma_f32_32x32x16_bf16 v[144:159], a[84:87], v[232:235], v[144:159]
v_mul_f32_e64 v11, v25, v11
v_cvt_pk_bf16_f32 v8, v8, v9
v_mul_f32_e32 v4, v25, v4
v_mul_f32_e32 v5, v25, v5
v_mul_f32_e32 v6, v25, v6
v_mul_f32_e32 v7, v25, v7
v_mfma_f32_32x32x16_bf16 v[160:175], a[88:91], v[232:235], v[160:175]
v_cvt_pk_bf16_f32 v1, v2, v3
v_mul_f32_e32 v12, v25, v12
v_mul_f32_e32 v13, v25, v13
v_mul_f32_e32 v14, v25, v14
v_mul_f32_e32 v15, v25, v15
v_cvt_pk_bf16_f32 v9, v10, v11
v_mfma_f32_32x32x16_bf16 v[176:191], a[92:95], v[232:235], v[176:191]
ds_read_b128 v[232:235], v244 offset:10240
v_cvt_pk_bf16_f32 v2, v4, v5
v_cvt_pk_bf16_f32 v3, v6, v7
v_cvt_pk_bf16_f32 v10, v12, v13
v_cvt_pk_bf16_f32 v11, v14, v15
v_mul_f32_e64 v19, v25, v19
v_mfma_f32_16x16x32_bf16 v[192:195], a[216:219], a[144:147], 0
ds_read_b128 v[4:7], v248 offset:960
ds_read_b128 v[12:15], v248 offset:1344
v_mfma_f32_16x16x32_bf16 v[196:199], a[216:219], a[148:151], 0
v_cvt_pk_bf16_f32 v16, v16, v17
v_mul_f32_e64 v20, v25, v20
v_mfma_f32_16x16x32_bf16 v[200:203], a[216:219], a[152:155], 0
ds_read_b128 a[216:219], v245 offset:10240
v_mul_f32_e64 v21, v25, v21
v_mfma_f32_16x16x32_bf16 v[192:195], a[220:223], a[156:159], v[192:195]
v_mul_f32_e32 v22, v25, v22
v_mul_f32_e32 v23, v25, v23
v_mfma_f32_16x16x32_bf16 v[196:199], a[220:223], a[160:163], v[196:199]
ds_read_b128 v[24:27], v248 offset:1920
v_cvt_pk_bf16_f32 v17, v18, v19
v_mfma_f32_16x16x32_bf16 v[200:203], a[220:223], a[164:167], v[200:203]
ds_read_b128 a[220:223], v244 offset:18432
v_cvt_pk_bf16_f32 v18, v20, v21
v_mfma_f32_16x16x32_bf16 v[192:195], a[224:227], a[168:171], v[192:195]
v_cvt_pk_bf16_f32 v19, v22, v23
v_mfma_f32_16x16x32_bf16 v[196:199], a[224:227], a[172:175], v[196:199]
s_nop 0
ds_read_b128 v[20:23], v248 offset:1728
ds_read_b64_tr_b16 a[74:75], v249 offset:19968
v_mfma_f32_16x16x32_bf16 v[200:203], a[224:227], a[176:179], v[200:203]
s_waitcnt lgkmcnt(7)
ds_read_b128 a[224:227], v245 offset:18432
ds_read_b64_tr_b16 a[76:77], v249 offset:18496
v_mfma_f32_16x16x32_bf16 v[192:195], a[228:231], a[180:183], v[192:195]
ds_read_b64_tr_b16 a[78:79], v249 offset:20032
ds_read_b64_tr_b16 a[80:81], v249 offset:18560
v_mfma_f32_16x16x32_bf16 v[196:199], a[228:231], a[184:187], v[196:199]
ds_read_b64_tr_b16 a[82:83], v249 offset:20096
ds_read_b64_tr_b16 a[84:85], v249 offset:21504
v_mfma_f32_16x16x32_bf16 v[200:203], a[228:231], a[188:191], v[200:203]
ds_read_b128 a[228:231], v242 offset:20480
v_mfma_f32_16x16x32_bf16 v[192:195], a[232:235], a[192:195], v[192:195]
ds_read_b64_tr_b16 a[86:87], v249 offset:23040
ds_read_b64_tr_b16 a[88:89], v249 offset:21568
v_mfma_f32_16x16x32_bf16 v[196:199], a[232:235], a[196:199], v[196:199]
ds_read_b64_tr_b16 a[90:91], v249 offset:23104
ds_read_b64_tr_b16 a[92:93], v249 offset:21632
v_mfma_f32_16x16x32_bf16 v[200:203], a[232:235], a[200:203], v[200:203]
ds_read_b128 a[232:235], v243 offset:20480
v_mfma_f32_16x16x32_bf16 v[192:195], a[236:239], a[204:207], v[192:195]
ds_read_b64_tr_b16 a[94:95], v249 offset:23168
s_nop 0
v_mfma_f32_16x16x32_bf16 v[196:199], a[236:239], a[208:211], v[196:199]
s_nop 2
v_mfma_f32_16x16x32_bf16 v[200:203], a[236:239], a[212:215], v[200:203]
ds_read_b128 a[236:239], v244 offset:4096
v_cvt_pk_bf16_f32 v112, v192, v193
v_mfma_f32_32x32x16_bf16 v[144:159], a[96:99], a[240:243], v[144:159]
v_cvt_pk_bf16_f32 v113, v194, v195
v_cvt_pk_bf16_f32 v114, v196, v197
v_cvt_pk_bf16_f32 v115, v198, v199
ds_read_b64_tr_b16 a[96:97], v249 offset:24576
v_mfma_f32_32x32x16_bf16 v[160:175], a[100:103], a[240:243], v[160:175]
ds_write_b128 v247, v[0:3] offset:64000
v_cvt_pk_bf16_f32 v116, v200, v201
v_mfma_f32_32x32x16_bf16 v[176:191], a[104:107], a[240:243], v[176:191]
v_cvt_pk_bf16_f32 v117, v202, v203
v_permlane16_swap_b32_e32 v116, v118
v_permlane16_swap_b32_e32 v112, v114
v_mfma_f32_32x32x16_bf16 v[144:159], a[108:111], a[244:247], v[144:159]
ds_read_b128 a[240:243], v245 offset:4096
ds_write_b128 v247, v[8:11] offset:64032
v_mfma_f32_32x32x16_bf16 v[160:175], a[112:115], a[244:247], v[160:175]
v_permlane16_swap_b32_e32 v117, v119
v_permlane16_swap_b32_e32 v113, v115
v_mfma_f32_32x32x16_bf16 v[176:191], a[116:119], a[244:247], v[176:191]
ds_read_b128 a[244:247], v244 offset:12288
ds_read_b128 v[0:3], v248 offset:768
ds_read_b128 v[8:11], v248 offset:1152
ds_read_b64_tr_b16 a[98:99], v249 offset:26112
v_mfma_f32_16x16x32_bf16 v[204:207], a[248:251], a[144:147], 0
ds_read_b64_tr_b16 a[100:101], v249 offset:24640
v_mfma_f32_16x16x32_bf16 v[208:211], a[248:251], a[148:151], 0
ds_read_b64_tr_b16 a[102:103], v249 offset:26176
ds_read_b64_tr_b16 a[104:105], v249 offset:24704
v_mfma_f32_16x16x32_bf16 v[212:215], a[248:251], a[152:155], 0
ds_read_b128 a[248:251], v245 offset:12288
v_mfma_f32_16x16x32_bf16 v[204:207], a[252:255], a[156:159], v[204:207]
ds_read_b64_tr_b16 a[106:107], v249 offset:26240
ds_read_b64_tr_b16 a[108:109], v249 offset:27648
v_mfma_f32_16x16x32_bf16 v[208:211], a[252:255], a[160:163], v[208:211]
ds_read_b64_tr_b16 a[110:111], v249 offset:29184
ds_read_b64_tr_b16 a[112:113], v249 offset:27712
v_mfma_f32_16x16x32_bf16 v[212:215], a[252:255], a[164:167], v[212:215]
ds_read_b128 a[252:255], v244 offset:20480
v_mfma_f32_16x16x32_bf16 v[204:207], v[232:235], a[168:171], v[204:207]
ds_read_b64_tr_b16 a[114:115], v249 offset:29248
v_mfma_f32_16x16x32_bf16 v[208:211], v[232:235], a[172:175], v[208:211]
ds_read_b64_tr_b16 a[116:117], v249 offset:27776
ds_read_b64_tr_b16 a[118:119], v249 offset:29312
v_mfma_f32_16x16x32_bf16 v[212:215], v[232:235], a[176:179], v[212:215]
s_waitcnt lgkmcnt(14)
ds_read_b128 v[232:235], v245 offset:20480
v_mfma_f32_16x16x32_bf16 v[204:207], a[216:219], a[180:183], v[204:207]
s_nop 0
v_mfma_f32_16x16x32_bf16 v[208:211], a[216:219], a[184:187], v[208:211]
v_mfma_f32_16x16x32_bf16 v[212:215], a[216:219], a[188:191], v[212:215]
ds_read_b128 a[216:219], v244 offset:6144
v_mfma_f32_16x16x32_bf16 v[204:207], a[220:223], a[192:195], v[204:207]
v_mfma_f32_16x16x32_bf16 v[208:211], a[220:223], a[196:199], v[208:211]
v_mfma_f32_16x16x32_bf16 v[212:215], a[220:223], a[200:203], v[212:215]
ds_read_b128 a[220:223], v245 offset:6144
v_mfma_f32_16x16x32_bf16 v[204:207], a[224:227], a[204:207], v[204:207]
s_nop 2
v_mfma_f32_16x16x32_bf16 v[208:211], a[224:227], a[208:211], v[208:211]
s_nop 2
v_mfma_f32_16x16x32_bf16 v[212:215], a[224:227], a[212:215], v[212:215]
ds_read_b128 a[224:227], v244 offset:14336
v_cvt_pk_bf16_f32 v120, v204, v205
v_mfma_f32_32x32x16_bf16 v[144:159], a[120:123], a[228:231], v[144:159]
ds_write_b128 v247, v[16:19] offset:64064
v_cvt_pk_bf16_f32 v121, v206, v207
v_mfma_f32_32x32x16_bf16 v[160:175], a[124:127], a[228:231], v[160:175]
v_cvt_pk_bf16_f32 v122, v208, v209
v_cvt_pk_bf16_f32 v123, v210, v211
v_cvt_pk_bf16_f32 v124, v212, v213
v_cvt_pk_bf16_f32 v125, v214, v215
v_permlane16_swap_b32_e64 v120, v122
v_mfma_f32_32x32x16_bf16 v[176:191], a[128:131], a[228:231], v[176:191]
ds_read_b128 a[228:231], v245 offset:14336
ds_read_b128 v[16:19], v248 offset:1536
ds_read_b64_tr_b16 a[120:121], v249 offset:30720
ds_read_b64_tr_b16 a[122:123], v249 offset:32256
v_permlane16_swap_b32_e64 v124, v126
v_mfma_f32_32x32x16_bf16 v[144:159], a[132:135], a[232:235], v[144:159]
ds_read_b64_tr_b16 a[124:125], v249 offset:30784
ds_read_b64_tr_b16 a[126:127], v249 offset:32320
ds_read_b64_tr_b16 a[128:129], v249 offset:30848
v_permlane16_swap_b32_e32 v125, v127
s_nop 0
v_mfma_f32_32x32x16_bf16 v[160:175], a[136:139], a[232:235], v[160:175]
ds_read_b64_tr_b16 a[130:131], v249 offset:32384
ds_read_b64_tr_b16 a[132:133], v249 offset:33792
ds_read_b64_tr_b16 a[134:135], v249 offset:35328
ds_read_b64_tr_b16 a[136:137], v249 offset:33856
v_permlane16_swap_b32_e64 v121, v123
v_mfma_f32_32x32x16_bf16 v[176:191], a[140:143], a[232:235], v[176:191]
ds_read_b128 a[232:235], v244 offset:22528
v_cvt_pk_bf16_f32 v88, v144, v145
v_cvt_pk_bf16_f32 v89, v146, v147
v_cvt_pk_bf16_f32 v90, v148, v149
v_cvt_pk_bf16_f32 v91, v150, v151
v_cvt_pk_bf16_f32 v92, v152, v153
v_mfma_f32_16x16x32_bf16 v[192:195], a[236:239], a[144:147], 0
v_cvt_pk_bf16_f32 v100, v168, v169
v_cvt_pk_bf16_f32 v101, v170, v171
v_mfma_f32_16x16x32_bf16 v[196:199], a[236:239], a[148:151], 0
v_cvt_pk_bf16_f32 v102, v172, v173
v_cvt_pk_bf16_f32 v103, v174, v175
v_mfma_f32_16x16x32_bf16 v[200:203], a[236:239], a[152:155], 0
ds_read_b128 a[236:239], v245 offset:22528
v_cvt_pk_bf16_f32 v104, v176, v177
v_mfma_f32_16x16x32_bf16 v[192:195], a[240:243], a[156:159], v[192:195]
v_cvt_pk_bf16_f32 v105, v178, v179
v_cvt_pk_bf16_f32 v106, v180, v181
v_mfma_f32_16x16x32_bf16 v[196:199], a[240:243], a[160:163], v[196:199]
v_cvt_pk_bf16_f32 v107, v182, v183
v_cvt_pk_bf16_f32 v108, v184, v185
v_mfma_f32_16x16x32_bf16 v[200:203], a[240:243], a[164:167], v[200:203]
v_cvt_pk_bf16_f32 v109, v186, v187
v_cvt_pk_bf16_f32 v110, v188, v189
v_mfma_f32_16x16x32_bf16 v[192:195], a[244:247], a[168:171], v[192:195]
v_cvt_pk_bf16_f32 v111, v190, v191
v_cvt_pk_bf16_f32 v93, v154, v155
v_mfma_f32_16x16x32_bf16 v[196:199], a[244:247], a[172:175], v[196:199]
s_nop 0
v_cvt_pk_bf16_f32 v94, v156, v157
v_cvt_pk_bf16_f32 v95, v158, v159
v_mfma_f32_16x16x32_bf16 v[200:203], a[244:247], a[176:179], v[200:203]
s_waitcnt lgkmcnt(1)
v_cvt_pk_bf16_f32 v96, v160, v161
v_cvt_pk_bf16_f32 v97, v162, v163
v_mfma_f32_16x16x32_bf16 v[192:195], a[248:251], a[180:183], v[192:195]
s_waitcnt lgkmcnt(0)
s_barrier
ds_read_b128 a[240:243], v246 offset:51200
v_mfma_f32_16x16x32_bf16 v[196:199], a[248:251], a[184:187], v[196:199]
ds_read_b128 a[244:247], v246 offset:51232
v_cvt_pk_bf16_f32 v98, v164, v165
v_mfma_f32_16x16x32_bf16 v[200:203], a[248:251], a[188:191], v[200:203]
ds_read_b128 a[248:251], v246 offset:51264
v_cvt_pk_bf16_f32 v99, v166, v167
v_mfma_f32_16x16x32_bf16 v[192:195], a[252:255], a[192:195], v[192:195]
ds_read_b64_tr_b16 a[138:139], v249 offset:35392
ds_read_b64_tr_b16 a[140:141], v249 offset:33920
v_mfma_f32_16x16x32_bf16 v[196:199], a[252:255], a[196:199], v[196:199]
ds_read_b64_tr_b16 a[142:143], v249 offset:35456
v_mfma_f32_16x16x32_bf16 v[200:203], a[252:255], a[200:203], v[200:203]
ds_read_b128 a[252:255], v246 offset:51296
v_mfma_f32_16x16x32_bf16 v[192:195], v[232:235], a[204:207], v[192:195]
s_nop 2
v_mfma_f32_16x16x32_bf16 v[196:199], v[232:235], a[208:211], v[196:199]
s_nop 2
v_mfma_f32_16x16x32_bf16 v[200:203], v[232:235], a[212:215], v[200:203]
ds_read_b128 v[232:235], v246 offset:51328
v_cvt_pk_bf16_f32 v128, v192, v193
v_mfma_f32_16x16x32_bf16 v[204:207], a[216:219], a[144:147], 0
v_cvt_pk_bf16_f32 v129, v194, v195
v_cvt_pk_bf16_f32 v130, v196, v197
v_mfma_f32_16x16x32_bf16 v[208:211], a[216:219], a[148:151], 0
v_cvt_pk_bf16_f32 v131, v198, v199
v_mfma_f32_16x16x32_bf16 v[212:215], a[216:219], a[152:155], 0
ds_read_b128 a[216:219], v246 offset:51360
v_cvt_pk_bf16_f32 v132, v200, v201
v_mfma_f32_16x16x32_bf16 v[204:207], a[220:223], a[156:159], v[204:207]
v_cvt_pk_bf16_f32 v133, v202, v203
s_nop 0
v_mfma_f32_16x16x32_bf16 v[208:211], a[220:223], a[160:163], v[208:211]
v_permlane16_swap_b32_e32 v132, v134
v_mfma_f32_16x16x32_bf16 v[212:215], a[220:223], a[164:167], v[212:215]
ds_read_b128 a[220:223], v246 offset:51392
v_mfma_f32_16x16x32_bf16 v[204:207], a[224:227], a[168:171], v[204:207]
v_permlane16_swap_b32_e64 v133, v135
v_mfma_f32_16x16x32_bf16 v[208:211], a[224:227], a[172:175], v[208:211]
v_permlane16_swap_b32_e64 v128, v130
v_mfma_f32_16x16x32_bf16 v[212:215], a[224:227], a[176:179], v[212:215]
ds_read_b128 a[224:227], v246 offset:51424
v_mfma_f32_16x16x32_bf16 v[204:207], a[228:231], a[180:183], v[204:207]
v_permlane16_swap_b32_e64 v129, v131
v_mfma_f32_16x16x32_bf16 v[208:211], a[228:231], a[184:187], v[208:211]
v_mfma_f32_16x16x32_bf16 v[212:215], a[228:231], a[188:191], v[212:215]
ds_read_b128 a[228:231], v246 offset:51456
v_mfma_f32_16x16x32_bf16 v[204:207], a[232:235], a[192:195], v[204:207]
v_mfma_f32_16x16x32_bf16 v[208:211], a[232:235], a[196:199], v[208:211]
v_mfma_f32_16x16x32_bf16 v[212:215], a[232:235], a[200:203], v[212:215]
ds_read_b128 a[232:235], v246 offset:51488
v_mfma_f32_16x16x32_bf16 v[204:207], a[236:239], a[204:207], v[204:207]
s_nop 2
v_mfma_f32_16x16x32_bf16 v[208:211], a[236:239], a[208:211], v[208:211]
s_nop 2
v_mfma_f32_16x16x32_bf16 v[212:215], a[236:239], a[212:215], v[212:215]
ds_read_b128 a[236:239], v246 offset:51520
v_cvt_pk_bf16_f32 v136, v204, v205
v_mfma_f32_32x32x16_bf16 v[0:15], v[76:79], v[64:67], v[0:15]
v_cvt_pk_bf16_f32 v137, v206, v207
v_cvt_pk_bf16_f32 v138, v208, v209
v_cvt_pk_bf16_f32 v139, v210, v211
s_nop 1
v_cvt_pk_bf16_f32 v140, v212, v213
v_mfma_f32_32x32x16_bf16 v[0:15], v[80:83], v[68:71], v[0:15]
s_nop 0
v_cvt_pk_bf16_f32 v141, v214, v215
v_permlane16_swap_b32_e32 v140, v142
v_permlane16_swap_b32_e32 v136, v138
v_mfma_f32_32x32x16_bf16 v[0:15], v[84:87], v[72:75], v[0:15]
v_permlane16_swap_b32_e32 v141, v143
v_permlane16_swap_b32_e32 v137, v139
s_nop 1
v_mfma_f32_32x32x16_bf16 v[16:31], v[100:103], v[64:67], v[16:31]
s_nop 5
v_mfma_f32_32x32x16_bf16 v[16:31], v[104:107], v[68:71], v[16:31]
v_max3_f32 v224, v0, v1, v2
v_max3_f32 v224, v224, v3, v4
v_max3_f32 v224, v224, v5, v6
v_max3_f32 v224, v224, v7, v8
v_max3_f32 v224, v224, v9, v10
v_max3_f32 v224, v224, v11, v12
v_mfma_f32_32x32x16_bf16 v[16:31], v[108:111], v[72:75], v[16:31]
v_max3_f32 v224, v224, v13, v14
v_max_f32_e64 v224, v224, v15
v_fma_f32 v224, v224, s70, v254
s_nop 2
v_mfma_f32_32x32x16_bf16 v[32:47], v[76:79], v[88:91], v[32:47]
s_nop 3
v_mfma_f32_32x32x16_bf16 v[32:47], v[80:83], v[92:95], v[32:47]
v_max3_f32 v225, v16, v17, v18
v_max3_f32 v225, v225, v19, v20
v_max3_f32 v225, v225, v21, v22
v_max3_f32 v225, v225, v23, v24
v_max3_f32 v225, v225, v25, v26
v_max3_f32 v225, v225, v27, v28
v_mfma_f32_32x32x16_bf16 v[32:47], v[84:87], v[96:99], v[32:47]
v_max3_f32 v225, v225, v29, v30
v_max_f32_e64 v225, v225, v31
v_fma_f32 v225, v225, s70, v255
v_max_f32_e64 v224, v224, v225
v_mov_b32_e32 v225, v224
s_nop 0
v_mfma_f32_32x32x16_bf16 v[48:63], v[100:103], v[88:91], v[48:63]
v_permlane32_swap_b32_e32 v224, v225
v_max_f32_e32 v224, v224, v225
v_sub_f32_e64 v226, v254, v224
v_fma_f32 v0, v0, s70, v226
v_fma_f32 v1, v1, s70, v226
v_mfma_f32_32x32x16_bf16 v[48:63], v[104:107], v[92:95], v[48:63]
v_exp_f32_e32 v0, v0
v_exp_f32_e32 v1, v1
v_fma_f32 v2, v2, s70, v226
v_fma_f32 v3, v3, s70, v226
v_mfma_f32_32x32x16_bf16 v[48:63], v[108:111], v[96:99], v[48:63]
s_waitcnt lgkmcnt(0)
v_exp_f32_e32 v2, v2
v_exp_f32_e64 v3, v3
v_fma_f32 v4, v4, s70, v226
v_fma_f32 v5, v5, s70, v226
v_mfma_f32_32x32x16_bf16 v[64:79], a[0:3], a[240:243], 0
v_fma_f32 v6, v6, s70, v226
v_fma_f32 v7, v7, s70, v226
v_exp_f32_e32 v4, v4
v_exp_f32_e32 v5, v5
v_mfma_f32_32x32x16_bf16 v[80:95], a[4:7], a[240:243], 0
v_exp_f32_e32 v6, v6
v_exp_f32_e32 v7, v7
v_cvt_pk_bf16_f32 v0, v0, v1
v_cvt_pk_bf16_f32 v1, v2, v3
v_mfma_f32_32x32x16_bf16 v[96:111], a[8:11], a[240:243], 0
ds_read_b128 a[240:243], v246 offset:51552
v_cvt_pk_bf16_f32 v2, v4, v5
v_cvt_pk_bf16_f32 v3, v6, v7
v_fma_f32 v8, v8, s70, v226
v_fma_f32 v9, v9, s70, v226
v_fma_f32 v10, v10, s70, v226
v_mfma_f32_32x32x16_bf16 v[64:79], a[12:15], a[244:247], v[64:79]
v_fma_f32 v11, v11, s70, v226
v_fma_f32 v12, v12, s70, v226
v_fma_f32 v13, v13, s70, v226
v_fma_f32 v14, v14, s70, v226
v_fma_f32 v15, v15, s70, v226
v_sub_f32_e64 v227, v255, v224
v_mfma_f32_32x32x16_bf16 v[80:95], a[16:19], a[244:247], v[80:95]
v_exp_f32_e32 v8, v8
v_exp_f32_e32 v9, v9
v_exp_f32_e64 v10, v10
v_mfma_f32_32x32x16_bf16 v[96:111], a[20:23], a[244:247], v[96:111]
v_exp_f32_e32 v11, v11
v_exp_f32_e32 v12, v12
v_exp_f32_e64 v13, v13
v_mfma_f32_32x32x16_bf16 v[64:79], a[24:27], a[248:251], v[64:79]
v_exp_f32_e32 v14, v14
v_exp_f32_e32 v15, v15
v_cvt_pk_bf16_f32 v4, v8, v9
v_cvt_pk_bf16_f32 v5, v10, v11
v_mfma_f32_32x32x16_bf16 v[80:95], a[28:31], a[248:251], v[80:95]
v_cvt_pk_bf16_f32 v6, v12, v13
v_cvt_pk_bf16_f32 v7, v14, v15
v_fma_f32 v16, v16, s70, v227
v_fma_f32 v17, v17, s70, v227
v_fma_f32 v18, v18, s70, v227
v_fma_f32 v19, v19, s70, v227
v_mfma_f32_32x32x16_bf16 v[96:111], a[32:35], a[248:251], v[96:111]
v_fma_f32 v20, v20, s70, v227
v_fma_f32 v21, v21, s70, v227
v_fma_f32 v22, v22, s70, v227
v_fma_f32 v23, v23, s70, v227
v_exp_f32_e64 v16, v16
v_mfma_f32_32x32x16_bf16 v[64:79], a[36:39], a[252:255], v[64:79]
v_exp_f32_e32 v17, v17
v_exp_f32_e32 v18, v18
v_exp_f32_e64 v19, v19
v_mfma_f32_32x32x16_bf16 v[80:95], a[40:43], a[252:255], v[80:95]
v_exp_f32_e32 v20, v20
v_exp_f32_e32 v21, v21
v_exp_f32_e64 v22, v22
v_mfma_f32_32x32x16_bf16 v[96:111], a[44:47], a[252:255], v[96:111]
v_exp_f32_e64 v23, v23
v_cvt_pk_bf16_f32 v8, v16, v17
v_cvt_pk_bf16_f32 v9, v18, v19
v_cvt_pk_bf16_f32 v10, v20, v21
v_cvt_pk_bf16_f32 v11, v22, v23
v_mfma_f32_32x32x16_bf16 v[64:79], a[48:51], v[232:235], v[64:79]
v_max3_f32 v224, v32, v33, v34
v_max3_f32 v225, v48, v49, v50
v_max3_f32 v224, v224, v35, v36
v_max3_f32 v225, v225, v51, v52
v_fma_f32 v24, v24, s70, v227
v_fma_f32 v25, v25, s70, v227
v_mfma_f32_32x32x16_bf16 v[80:95], a[52:55], v[232:235], v[80:95]
v_fma_f32 v26, v26, s70, v227
v_fma_f32 v27, v27, s70, v227
v_fma_f32 v28, v28, s70, v227
v_fma_f32 v29, v29, s70, v227
v_fma_f32 v30, v30, s70, v227
v_fma_f32 v31, v31, s70, v227
v_mfma_f32_32x32x16_bf16 v[96:111], a[56:59], v[232:235], v[96:111]
v_max3_f32 v224, v224, v37, v38
v_max3_f32 v225, v225, v53, v54
v_exp_f32_e32 v24, v24
v_exp_f32_e32 v25, v25
v_mfma_f32_32x32x16_bf16 v[64:79], a[60:63], a[216:219], v[64:79]
v_exp_f32_e32 v26, v26
v_exp_f32_e32 v27, v27
v_exp_f32_e64 v28, v28
v_mfma_f32_32x32x16_bf16 v[80:95], a[64:67], a[216:219], v[80:95]
v_exp_f32_e32 v29, v29
v_exp_f32_e32 v30, v30
v_exp_f32_e64 v31, v31
v_mfma_f32_32x32x16_bf16 v[96:111], a[68:71], a[216:219], v[96:111]
v_max3_f32 v224, v224, v39, v40
v_max3_f32 v225, v225, v55, v56
v_max3_f32 v224, v224, v41, v42
v_max3_f32 v225, v225, v57, v58
v_max3_f32 v224, v224, v43, v44
v_max3_f32 v225, v225, v59, v60
v_mfma_f32_32x32x16_bf16 v[64:79], a[72:75], a[220:223], v[64:79]
v_cvt_pk_bf16_f32 v12, v24, v25
v_cvt_pk_bf16_f32 v13, v26, v27
v_cvt_pk_bf16_f32 v14, v28, v29
v_cvt_pk_bf16_f32 v15, v30, v31
v_max3_f32 v224, v224, v45, v46
v_max3_f32 v225, v225, v61, v62
v_mfma_f32_32x32x16_bf16 v[80:95], a[76:79], a[220:223], v[80:95]
v_max_f32_e32 v224, v224, v47
v_max_f32_e32 v225, v225, v63
v_fma_f32 v224, v224, s70, v255
v_fma_f32 v225, v225, s70, v254
v_max_f32_e32 v224, v224, v225
v_mov_b32_e32 v225, v224
v_mfma_f32_32x32x16_bf16 v[96:111], a[80:83], a[220:223], v[96:111]
s_nop 0
v_permlane32_swap_b32_e32 v224, v225
v_max_f32_e32 v224, v224, v225
v_sub_f32_e32 v228, v255, v224
v_fma_f32 v32, v32, s70, v228
v_fma_f32 v33, v33, s70, v228
v_mfma_f32_32x32x16_bf16 v[64:79], a[84:87], a[224:227], v[64:79]
v_exp_f32_e32 v32, v32
v_exp_f32_e32 v33, v33
v_fma_f32 v34, v34, s70, v228
v_fma_f32 v35, v35, s70, v228
v_mfma_f32_32x32x16_bf16 v[80:95], a[88:91], a[224:227], v[80:95]
v_exp_f32_e32 v34, v34
v_exp_f32_e32 v35, v35
v_fma_f32 v36, v36, s70, v228
v_fma_f32 v37, v37, s70, v228
v_mfma_f32_32x32x16_bf16 v[96:111], a[92:95], a[224:227], v[96:111]
v_fma_f32 v38, v38, s70, v228
v_fma_f32 v39, v39, s70, v228
v_exp_f32_e32 v36, v36
v_exp_f32_e32 v37, v37
v_mfma_f32_32x32x16_bf16 v[64:79], a[96:99], a[228:231], v[64:79]
v_exp_f32_e32 v38, v38
v_exp_f32_e32 v39, v39
v_cvt_pk_bf16_f32 v32, v32, v33
v_cvt_pk_bf16_f32 v33, v34, v35
v_mfma_f32_32x32x16_bf16 v[80:95], a[100:103], a[228:231], v[80:95]
v_cvt_pk_bf16_f32 v34, v36, v37
v_cvt_pk_bf16_f32 v35, v38, v39
v_fma_f32 v40, v40, s70, v228
v_fma_f32 v41, v41, s70, v228
v_fma_f32 v42, v42, s70, v228
v_fma_f32 v43, v43, s70, v228
v_mfma_f32_32x32x16_bf16 v[96:111], a[104:107], a[228:231], v[96:111]
v_fma_f32 v44, v44, s70, v228
v_fma_f32 v45, v45, s70, v228
v_fma_f32 v46, v46, s70, v228
v_fma_f32 v47, v47, s70, v228
v_exp_f32_e64 v40, v40
v_mfma_f32_32x32x16_bf16 v[64:79], a[108:111], a[232:235], v[64:79]
v_exp_f32_e32 v41, v41
v_exp_f32_e32 v42, v42
v_exp_f32_e64 v43, v43
v_mfma_f32_32x32x16_bf16 v[80:95], a[112:115], a[232:235], v[80:95]
v_exp_f32_e32 v44, v44
v_exp_f32_e32 v45, v45
v_exp_f32_e64 v46, v46
v_mfma_f32_32x32x16_bf16 v[96:111], a[116:119], a[232:235], v[96:111]
v_exp_f32_e64 v47, v47
v_cvt_pk_bf16_f32 v36, v40, v41
v_cvt_pk_bf16_f32 v37, v42, v43
v_cvt_pk_bf16_f32 v38, v44, v45
v_cvt_pk_bf16_f32 v39, v46, v47
v_mfma_f32_32x32x16_bf16 v[64:79], a[120:123], a[236:239], v[64:79]
v_sub_f32_e64 v229, v254, v224
v_fma_f32 v48, v48, s70, v229
v_fma_f32 v49, v49, s70, v229
v_fma_f32 v50, v50, s70, v229
v_fma_f32 v51, v51, s70, v229
v_fma_f32 v52, v52, s70, v229
v_mfma_f32_32x32x16_bf16 v[80:95], a[124:127], a[236:239], v[80:95]
v_fma_f32 v53, v53, s70, v229
v_fma_f32 v54, v54, s70, v229
v_fma_f32 v55, v55, s70, v229
v_exp_f32_e64 v48, v48
v_fma_f32 v56, v56, s70, v229
v_mfma_f32_32x32x16_bf16 v[96:111], a[128:131], a[236:239], v[96:111]
s_waitcnt lgkmcnt(0)
v_exp_f32_e32 v49, v49
v_exp_f32_e32 v50, v50
v_exp_f32_e32 v51, v51
v_mfma_f32_32x32x16_bf16 v[64:79], a[132:135], a[240:243], v[64:79]
v_exp_f32_e32 v52, v52
v_exp_f32_e32 v53, v53
v_exp_f32_e64 v54, v54
v_mfma_f32_32x32x16_bf16 v[80:95], a[136:139], a[240:243], v[80:95]
v_exp_f32_e64 v55, v55
v_cvt_pk_bf16_f32 v40, v48, v49
v_cvt_pk_bf16_f32 v41, v50, v51
v_cvt_pk_bf16_f32 v42, v52, v53
v_cvt_pk_bf16_f32 v43, v54, v55
v_mfma_f32_32x32x16_bf16 v[96:111], a[140:143], a[240:243], v[96:111]
v_fma_f32 v57, v57, s70, v229
v_fma_f32 v58, v58, s70, v229
v_fma_f32 v59, v59, s70, v229
v_fma_f32 v60, v60, s70, v229
v_fma_f32 v61, v61, s70, v229
v_fma_f32 v62, v62, s70, v229
v_mfma_f32_32x32x16_bf16 v[208:223], v[116:119], v[0:3], 0
v_fma_f32 v63, v63, s70, v229
v_exp_f32_e32 v56, v56
v_exp_f32_e32 v57, v57
v_cvt_pk_bf16_f32 v64, v64, v65
v_mfma_f32_32x32x16_bf16 v[192:207], v[112:115], v[0:3], 0
v_exp_f32_e32 v58, v58
v_exp_f32_e32 v59, v59
v_exp_f32_e64 v60, v60
v_mfma_f32_32x32x16_bf16 v[208:223], v[124:127], v[4:7], v[208:223]
v_exp_f32_e32 v61, v61
v_exp_f32_e32 v62, v62
v_exp_f32_e64 v63, v63
v_mfma_f32_32x32x16_bf16 v[192:207], v[120:123], v[4:7], v[192:207]
v_cvt_pk_bf16_f32 v44, v56, v57
v_cvt_pk_bf16_f32 v45, v58, v59
v_cvt_pk_bf16_f32 v46, v60, v61
v_cvt_pk_bf16_f32 v47, v62, v63
v_cvt_pk_bf16_f32 v72, v72, v73
v_cvt_pk_bf16_f32 v65, v66, v67
v_mfma_f32_32x32x16_bf16 v[208:223], v[132:135], v[8:11], v[208:223]
v_cvt_pk_bf16_f32 v73, v74, v75
v_cvt_pk_bf16_f32 v66, v68, v69
v_cvt_pk_bf16_f32 v67, v70, v71
v_cvt_pk_bf16_f32 v74, v76, v77
v_cvt_pk_bf16_f32 v75, v78, v79
v_cvt_pk_bf16_f32 v80, v80, v81
v_mfma_f32_32x32x16_bf16 v[192:207], v[128:131], v[8:11], v[192:207]
ds_write_b128 v230, v[64:67] offset:25600
v_cvt_pk_bf16_f32 v88, v88, v89
v_mfma_f32_32x32x16_bf16 v[208:223], v[140:143], v[12:15], v[208:223]
v_cvt_pk_bf16_f32 v81, v82, v83
v_cvt_pk_bf16_f32 v89, v90, v91
v_cvt_pk_bf16_f32 v82, v84, v85
v_cvt_pk_bf16_f32 v83, v86, v87
v_cvt_pk_bf16_f32 v90, v92, v93
v_cvt_pk_bf16_f32 v91, v94, v95
v_mfma_f32_32x32x16_bf16 v[192:207], v[136:139], v[12:15], v[192:207]
ds_write_b128 v230, v[72:75] offset:25632
v_cvt_pk_bf16_f32 v96, v96, v97
v_mfma_f32_32x32x16_bf16 v[16:31], v[116:119], v[32:35], 0
v_cvt_pk_bf16_f32 v104, v104, v105
v_cvt_pk_bf16_f32 v97, v98, v99
v_rcp_f32_e64 v217, v216
v_cvt_pk_bf16_f32 v105, v106, v107
v_mul_f32_e64 v208, v217, v208
v_mfma_f32_32x32x16_bf16 v[0:15], v[112:115], v[32:35], 0
ds_read_b128 v[68:71], v231 offset:25600
ds_read_b128 v[76:79], v231 offset:32000
v_mul_f32_e32 v209, v217, v209
v_mul_f32_e32 v192, v217, v192
v_mul_f32_e32 v193, v217, v193
v_mul_f32_e32 v200, v217, v200
v_mfma_f32_32x32x16_bf16 v[16:31], v[124:127], v[36:39], v[16:31]
ds_write_b128 v230, v[80:83] offset:25664
v_mul_f32_e64 v201, v217, v201
v_mfma_f32_32x32x16_bf16 v[0:15], v[120:123], v[36:39], v[0:15]
v_mul_f32_e32 v210, v217, v210
v_mul_f32_e32 v211, v217, v211
v_cvt_pk_bf16_f32 v208, v208, v209
v_mul_f32_e32 v194, v217, v194
v_mul_f32_e32 v195, v217, v195
v_cvt_pk_bf16_f32 v192, v192, v193
v_mfma_f32_32x32x16_bf16 v[16:31], v[132:135], v[40:43], v[16:31]
ds_write_b128 v230, v[88:91] offset:25696
v_mul_f32_e32 v202, v217, v202
v_mfma_f32_32x32x16_bf16 v[0:15], v[128:131], v[40:43], v[0:15]
s_waitcnt lgkmcnt(3)
buffer_store_dwordx4 v[68:71], v251, s[36:39], s59 offen sc1
ds_read_b128 v[84:87], v231 offset:25664
v_mfma_f32_32x32x16_bf16 v[16:31], v[140:143], v[44:47], v[16:31]
v_mul_f32_e64 v203, v217, v203
v_cvt_pk_bf16_f32 v200, v200, v201
v_mul_f32_e32 v212, v217, v212
v_mul_f32_e32 v213, v217, v213
v_mul_f32_e32 v214, v217, v214
v_mul_f32_e32 v215, v217, v215
v_mfma_f32_32x32x16_bf16 v[0:15], v[136:139], v[44:47], v[0:15]
v_cvt_pk_bf16_f32 v209, v210, v211
v_mul_f32_e32 v196, v217, v196
v_mul_f32_e32 v197, v217, v197
v_mul_f32_e32 v198, v217, v198
v_mul_f32_e32 v199, v217, v199
v_cvt_pk_bf16_f32 v193, v194, v195
v_rcp_f32_e32 v25, v24
v_mul_f32_e32 v204, v217, v204
v_mul_f32_e32 v16, v25, v16
v_mul_f32_e32 v17, v25, v17
v_mul_f32_e32 v18, v25, v18
v_mul_f32_e32 v19, v25, v19
v_cvt_pk_bf16_f32 v16, v16, v17
v_mul_f32_e32 v0, v25, v0
v_mul_f32_e32 v1, v25, v1
v_mul_f32_e32 v8, v25, v8
v_mul_f32_e32 v9, v25, v9
v_mul_f32_e32 v2, v25, v2
v_mul_f32_e32 v3, v25, v3
v_cvt_pk_bf16_f32 v0, v0, v1
v_mul_f32_e32 v10, v25, v10
v_mul_f32_e32 v11, v25, v11
v_cvt_pk_bf16_f32 v8, v8, v9
v_mul_f32_e32 v205, v217, v205
v_mul_f32_e32 v206, v217, v206
v_mul_f32_e64 v207, v217, v207
v_cvt_pk_bf16_f32 v201, v202, v203
v_mul_f32_e32 v20, v25, v20
v_mul_f32_e32 v21, v25, v21
v_mul_f32_e32 v22, v25, v22
v_mul_f32_e32 v23, v25, v23
v_cvt_pk_bf16_f32 v17, v18, v19
v_mul_f32_e32 v4, v25, v4
v_mul_f32_e32 v5, v25, v5
v_mul_f32_e32 v6, v25, v6
v_mul_f32_e32 v7, v25, v7
v_cvt_pk_bf16_f32 v1, v2, v3
v_mul_f32_e32 v12, v25, v12
v_mul_f32_e32 v13, v25, v13
v_mul_f32_e64 v14, v25, v14
v_mul_f32_e32 v15, v25, v15
v_cvt_pk_bf16_f32 v9, v10, v11
v_cvt_pk_bf16_f32 v210, v212, v213
v_cvt_pk_bf16_f32 v211, v214, v215
v_cvt_pk_bf16_f32 v194, v196, v197
v_cvt_pk_bf16_f32 v195, v198, v199
v_cvt_pk_bf16_f32 v202, v204, v205
v_cvt_pk_bf16_f32 v203, v206, v207
v_cvt_pk_bf16_f32 v18, v20, v21
v_cvt_pk_bf16_f32 v19, v22, v23
v_cvt_pk_bf16_f32 v2, v4, v5
v_cvt_pk_bf16_f32 v3, v6, v7
v_cvt_pk_bf16_f32 v10, v12, v13
v_cvt_pk_bf16_f32 v11, v14, v15
ds_write_b128 v247, v[208:211] offset:64
s_waitcnt lgkmcnt(1)
buffer_store_dwordx4 v[76:79], v251, s[36:39], s84 offen sc1
ds_write_b128 v247, v[192:195]
v_cvt_pk_bf16_f32 v98, v100, v101
v_cvt_pk_bf16_f32 v99, v102, v103
v_cvt_pk_bf16_f32 v106, v108, v109
ds_write_b128 v247, v[200:203] offset:32
v_cvt_pk_bf16_f32 v107, v110, v111
ds_write_b128 v247, v[16:19] offset:12864
buffer_store_dwordx4 v[84:87], v251, s[36:39], s59 offen offset:64 sc1
ds_write_b128 v247, v[0:3] offset:12800
ds_write_b128 v247, v[8:11] offset:12832
ds_read_b128 v[92:95], v231 offset:32064
ds_write_b128 v230, v[96:99] offset:25728
ds_write_b128 v230, v[104:107] offset:25760
s_waitcnt lgkmcnt(3)
s_barrier
ds_read_b128 v[144:147], v246
ds_read_b128 v[148:151], v246 offset:32
ds_read_b128 v[152:155], v246 offset:64
ds_read_b128 v[156:159], v246 offset:96
ds_read_b128 v[160:163], v246 offset:128
ds_read_b128 v[164:167], v246 offset:160
ds_read_b128 v[168:171], v246 offset:192
ds_read_b128 v[172:175], v246 offset:224
ds_read_b128 v[176:179], v246 offset:256
s_waitcnt lgkmcnt(9)
buffer_store_dwordx4 v[92:95], v251, s[36:39], s84 offen offset:64 sc1
ds_read_b128 v[180:183], v246 offset:288
ds_read_b128 v[184:187], v246 offset:320
ds_read_b128 v[188:191], v246 offset:352
s_waitcnt lgkmcnt(9)
v_mfma_f32_32x32x16_bf16 v[64:79], a[0:3], v[144:147], 0
ds_read_b128 v[100:103], v231 offset:25728
ds_read_b128 v[108:111], v231 offset:32128
v_mfma_f32_32x32x16_bf16 v[64:79], a[12:15], v[148:151], v[64:79]
s_nop 0
v_mfma_f32_32x32x16_bf16 v[64:79], a[24:27], v[152:155], v[64:79]
s_waitcnt lgkmcnt(8)
v_mfma_f32_32x32x16_bf16 v[64:79], a[36:39], v[156:159], v[64:79]
v_mfma_f32_32x32x16_bf16 v[64:79], a[48:51], v[160:163], v[64:79]
s_nop 0
v_mfma_f32_32x32x16_bf16 v[64:79], a[60:63], v[164:167], v[64:79]
s_waitcnt lgkmcnt(1)
buffer_store_dwordx4 v[100:103], v251, s[36:39], s59 offen offset:128 sc1
v_mfma_f32_32x32x16_bf16 v[64:79], a[72:75], v[168:171], v[64:79]
v_mfma_f32_32x32x16_bf16 v[64:79], a[84:87], v[172:175], v[64:79]
v_mfma_f32_32x32x16_bf16 v[64:79], a[96:99], v[176:179], v[64:79]
s_nop 0
v_mfma_f32_32x32x16_bf16 v[64:79], a[108:111], v[180:183], v[64:79]
s_waitcnt lgkmcnt(0)
buffer_store_dwordx4 v[108:111], v251, s[36:39], s84 offen offset:128 sc1
v_mfma_f32_32x32x16_bf16 v[64:79], a[120:123], v[184:187], v[64:79]
v_mfma_f32_32x32x16_bf16 v[64:79], a[132:135], v[188:191], v[64:79]
s_nop 6
v_mfma_f32_32x32x16_bf16 v[80:95], a[4:7], v[144:147], 0
s_nop 2
v_mfma_f32_32x32x16_bf16 v[80:95], a[16:19], v[148:151], v[80:95]
v_cvt_pk_bf16_f32 v64, v64, v65
v_cvt_pk_bf16_f32 v72, v72, v73
v_cvt_pk_bf16_f32 v65, v66, v67
v_cvt_pk_bf16_f32 v73, v74, v75
v_cvt_pk_bf16_f32 v66, v68, v69
v_cvt_pk_bf16_f32 v67, v70, v71
v_mfma_f32_32x32x16_bf16 v[80:95], a[28:31], v[152:155], v[80:95]
ds_write_b128 v230, v[64:67] offset:25600
v_cvt_pk_bf16_f32 v74, v76, v77
v_mfma_f32_32x32x16_bf16 v[80:95], a[40:43], v[156:159], v[80:95]
v_cvt_pk_bf16_f32 v75, v78, v79
v_mfma_f32_32x32x16_bf16 v[80:95], a[52:55], v[160:163], v[80:95]
ds_write_b128 v230, v[72:75] offset:25632
v_mfma_f32_32x32x16_bf16 v[80:95], a[64:67], v[164:167], v[80:95]
ds_read_b128 v[68:71], v231 offset:25600
ds_read_b128 v[76:79], v231 offset:32000
v_mfma_f32_32x32x16_bf16 v[80:95], a[76:79], v[168:171], v[80:95]
v_mfma_f32_32x32x16_bf16 v[80:95], a[88:91], v[172:175], v[80:95]
v_mfma_f32_32x32x16_bf16 v[80:95], a[100:103], v[176:179], v[80:95]
s_nop 0
v_mfma_f32_32x32x16_bf16 v[80:95], a[112:115], v[180:183], v[80:95]
s_waitcnt lgkmcnt(1)
buffer_store_dwordx4 v[68:71], v252, s[36:39], s60 offen sc1
v_mfma_f32_32x32x16_bf16 v[80:95], a[124:127], v[184:187], v[80:95]
v_mfma_f32_32x32x16_bf16 v[80:95], a[136:139], v[188:191], v[80:95]
s_nop 6
v_mfma_f32_32x32x16_bf16 v[96:111], a[8:11], v[144:147], 0
s_nop 2
v_mfma_f32_32x32x16_bf16 v[96:111], a[20:23], v[148:151], v[96:111]
v_cvt_pk_bf16_f32 v80, v80, v81
v_cvt_pk_bf16_f32 v88, v88, v89
v_cvt_pk_bf16_f32 v81, v82, v83
v_cvt_pk_bf16_f32 v89, v90, v91
v_cvt_pk_bf16_f32 v82, v84, v85
v_cvt_pk_bf16_f32 v83, v86, v87
v_mfma_f32_32x32x16_bf16 v[96:111], a[32:35], v[152:155], v[96:111]
s_nop 0
ds_write_b128 v230, v[80:83] offset:25664
v_cvt_pk_bf16_f32 v90, v92, v93
v_mfma_f32_32x32x16_bf16 v[96:111], a[44:47], v[156:159], v[96:111]
s_waitcnt lgkmcnt(1)
buffer_store_dwordx4 v[76:79], v252, s[36:39], s76 offen sc1
v_cvt_pk_bf16_f32 v91, v94, v95
v_mfma_f32_32x32x16_bf16 v[96:111], a[56:59], v[160:163], v[96:111]
ds_write_b128 v230, v[88:91] offset:25696
v_mfma_f32_32x32x16_bf16 v[96:111], a[68:71], v[164:167], v[96:111]
ds_read_b128 v[84:87], v231 offset:25664
ds_read_b128 v[92:95], v231 offset:32064
v_mfma_f32_32x32x16_bf16 v[96:111], a[80:83], v[168:171], v[96:111]
v_mfma_f32_32x32x16_bf16 v[96:111], a[92:95], v[172:175], v[96:111]
v_mfma_f32_32x32x16_bf16 v[96:111], a[104:107], v[176:179], v[96:111]
s_nop 0
v_mfma_f32_32x32x16_bf16 v[96:111], a[116:119], v[180:183], v[96:111]
s_waitcnt lgkmcnt(1)
buffer_store_dwordx4 v[84:87], v252, s[36:39], s60 offen offset:64 sc1
v_mfma_f32_32x32x16_bf16 v[96:111], a[128:131], v[184:187], v[96:111]
v_mfma_f32_32x32x16_bf16 v[96:111], a[140:143], v[188:191], v[96:111]
s_waitcnt lgkmcnt(0)
buffer_store_dwordx4 v[92:95], v252, s[36:39], s76 offen offset:64 sc1
s_nop 10
v_cvt_pk_bf16_f32 v96, v96, v97
v_cvt_pk_bf16_f32 v104, v104, v105
v_cvt_pk_bf16_f32 v97, v98, v99
v_cvt_pk_bf16_f32 v105, v106, v107
v_cvt_pk_bf16_f32 v98, v100, v101
v_cvt_pk_bf16_f32 v99, v102, v103
v_cvt_pk_bf16_f32 v106, v108, v109
v_cvt_pk_bf16_f32 v107, v110, v111
ds_write_b128 v230, v[96:99] offset:25728
ds_write_b128 v230, v[104:107] offset:25760
ds_read_b128 v[100:103], v231 offset:25728
ds_read_b128 v[108:111], v231 offset:32128
s_waitcnt lgkmcnt(1)
buffer_store_dwordx4 v[100:103], v252, s[36:39], s60 offen offset:128 sc1
s_waitcnt lgkmcnt(0)
buffer_store_dwordx4 v[108:111], v252, s[36:39], s76 offen offset:128 sc1
s_endpgm
.fill 768, 4, 0xBF800000
L_code_end:
.section .rodata,"a"
.p2align 6
.amdhsa_kernel standalone__window_attn_swin__vision_kernel
  .amdhsa_next_free_vgpr 512
  .amdhsa_next_free_sgpr 102
  .amdhsa_accum_offset 256
  .amdhsa_group_segment_fixed_size 0
  .amdhsa_kernarg_size 72
  .amdhsa_user_sgpr_count 2
  .amdhsa_user_sgpr_kernarg_segment_ptr 1
  .amdhsa_system_sgpr_workgroup_id_x 1
.end_amdhsa_kernel
```
